```python
import torch

def _softmax(x, axis=-1):
    return torch.softmax(x, dim=axis)
def _gelu(x):
    return torch.nn.functional.gelu(x, approximate="tanh")
def _silu(x):
    return torch.nn.functional.silu(x)
def _sigmoid(x):
    return torch.sigmoid(x)
def _layernorm(x, axis=-1, eps=1e-5):
    m = x.mean(dim=axis, keepdim=True)
    v = x.var(dim=axis, keepdim=True, unbiased=False)
    return (x - m) / torch.sqrt(v + eps)
def _scatter_add(tgt, idx, src, axis=0):
    return tgt.clone().index_add_(axis, idx, src)
def _segment_sum(src, seg, n):
    out = torch.zeros((n,) + src.shape[1:], dtype=src.dtype)
    return out.index_add_(0, seg, src)
def _pad(x, pw):
    flat = tuple(v for pair in reversed(pw) for v in pair)
    return torch.nn.functional.pad(x, flat)

kernel_name = 'interleave_layers__sliding_local_dilated__mixer_s_mlp__prompt'

def setup_inputs():

    _w = (lambda a: (lambda t: t.to(torch.bfloat16) if t.is_floating_point() else t)(torch.as_tensor(a)))
    def _A_setup():
        B, S, D = 1, 2048, 448
        return {
            "x": _w((lambda *s: torch.randn(*s, dtype=torch.bfloat16) * 0.05)(B, S, D)),
            "wqkv": _w((lambda *s: torch.randn(*s, dtype=torch.bfloat16) * 0.1)(D, 3 * D)),
            "wo": _w((lambda *s: torch.randn(*s, dtype=torch.bfloat16) * 0.1)(D, D)),
        }
    _A_in = _A_setup()

    def _B_setup():
        B, S, D, F = 1, 2048, 448, 1792
        return {
            "x":  _w((lambda *s: torch.randn(*s, dtype=torch.bfloat16) * 0.05)(B, S, D)),
            "w1": _w((lambda *s: torch.randn(*s, dtype=torch.bfloat16) * 3.2)(D, D) * (D ** -0.5)),
            "w2": _w((lambda *s: torch.randn(*s, dtype=torch.bfloat16) * 3.2)(D, D) * (D ** -0.5)),
            "w3": _w((lambda *s: torch.randn(*s, dtype=torch.bfloat16) * 3.2)(D, F) * (D ** -0.5)),
            "w4": _w((lambda *s: torch.randn(*s, dtype=torch.bfloat16) * 3.2)(F, D) * (F ** -0.5)),
        }
    _B_in = _B_setup()

    return {
        "A_x": _A_in["x"],
        "A_wqkv": _A_in["wqkv"],
        "A_wo": _A_in["wo"],
        "B_x": _B_in["x"],
        "B_w1": _B_in["w1"],
        "B_w2": _B_in["w2"],
        "B_w3": _B_in["w3"],
        "B_w4": _B_in["w4"],
    }

def reference(A_x, A_wqkv, A_wo, B_x, B_w1, B_w2, B_w3, B_w4):
    def _A_ref(x, wqkv, wo):
        B, S, D = x.shape
        H = 16; Dh = D // H
        W, dil = 8, 2
        qkv = (lambda x, *d: x.permute(*d))((x @ wqkv).reshape(B, S, 3, H, Dh), 2, 0, 3, 1, 4)
        q, k, v = qkv[0], qkv[1], qkv[2]
        scale = Dh ** -0.5
        pos = torch.arange(S)
        off = torch.arange(W) * dil
        idx = pos[:, None] - off[None, :]
        mask = idx >= 0
        idx_c = torch.where(mask, idx, 0).reshape(-1)
        kg = k[:, :, idx_c, :].reshape(B, H, S, W, Dh)
        vg = v[:, :, idx_c, :].reshape(B, H, S, W, Dh)
        logits = torch.einsum("bhsd,bhswd->bhsw", q, kg) * scale
        logits = torch.where(mask[None, None, :, :], logits, -1e9)
        attn = _softmax(logits, axis=-1)
        o = torch.einsum("bhsw,bhswd->bhsd", attn, vg)
        return (lambda x, *d: x.permute(*d))(o, 0, 2, 1, 3).reshape(B, S, D) @ wo

    def _B_ref(x, w1, w2, w3, w4):
        B, S, D = x.shape
        h = _gelu(_layernorm(x, axis=-1) @ w1)
        c = D // 4
        g0 = _pad(h[:, :, 0*c:1*c], ((0, 0), (1, 0), (0, 0)))[:, :S, :]
        g1 = _pad(h[:, :, 1*c:2*c], ((0, 0), (0, 1), (0, 0)))[:, 1:, :]
        g2 = _pad(h[:, :, 2*c:3*c], ((0, 0), (2, 0), (0, 0)))[:, :S, :]
        g3 = _pad(h[:, :, 3*c:   ], ((0, 0), (0, 2), (0, 0)))[:, 2:, :]
        hs = torch.concatenate([g0, g1, g2, g3], axis=-1) @ w2
        x1 = x + hs
        h2 = _gelu(_layernorm(x1, axis=-1) @ w3) @ w4
        return x1 + h2

    x = A_x
    x = x + _A_ref(_layernorm(x, axis=-1), A_wqkv, A_wo)
    x = x + _B_ref(_layernorm(x, axis=-1), B_w1, B_w2, B_w3, B_w4)
    x = x + _A_ref(_layernorm(x, axis=-1), A_wqkv, A_wo)
    x = x + _B_ref(_layernorm(x, axis=-1), B_w1, B_w2, B_w3, B_w4)
    return x
```

```asm
; @launch grid=(256,1,1) block=(256,1,1) lds=163840
.amdgcn_target "amdgcn-amd-amdhsa--gfx950"
.text
.globl interleave_layers__sliding_local_dilated__mixer_s_mlp__prompt_kernel
.p2align 8
.type interleave_layers__sliding_local_dilated__mixer_s_mlp__prompt_kernel,@function
interleave_layers__sliding_local_dilated__mixer_s_mlp__prompt_kernel:
    s_cmp_ge_u32 s2, 256
    s_cbranch_scc1 L_exit
    s_load_dwordx16 s[64:79], s[0:1], 0
    s_load_dwordx4 s[80:83], s[0:1], 64
    s_load_dwordx2 s[84:85], s[0:1], 80
    v_and_b32 v1, 63, v0
    v_lshrrev_b32 v4, 6, v0
    v_and_b32 v2, 15, v0
    v_bfe_u32 v3, v0, 4, 2
    v_readfirstlane_b32 s86, v4
    s_mov_b32 s89, s2
    s_lshr_b32 s88, s2, 5
    s_and_b32 s87, s2, 7
    s_lshl_b32 s87, s87, 2
    s_lshr_b32 s32, s2, 3
    s_and_b32 s32, s32, 3
    s_add_u32 s87, s87, s32
    s_waitcnt lgkmcnt(0)
    s_mov_b32 s24, s84
    s_mov_b32 s25, s85
    s_mov_b32 s26, 268435456
    s_mov_b32 s27, 0x00020000
    s_mov_b32 s28, s82
    s_mov_b32 s29, s83
    s_mov_b32 s30, 256
    s_mov_b32 s31, 0x00020000
    v_mov_b32 v4, 0x3f803f80
    v_mov_b32 v8, 0
    v_mov_b32 v9, 0
    v_mov_b32 v10, 0
    v_mov_b32 v11, 0
    s_getreg_b32 s90, hwreg(HW_REG_XCC_ID, 0, 4)
    s_add_u32 s90, s90, 1
    s_mov_b32 s91, 0
    s_mov_b32 s92, 0
    s_mov_b32 s93, 0
    s_lshl_b32 s32, s89, 7
    v_mov_b32 v12, s32
    v_mov_b32 v13, 1
    v_mov_b32 v14, 0
    s_cmp_lg_u32 s86, 0
    s_cbranch_scc1 Lz1
    s_mov_b64 exec, 1
    buffer_store_dwordx4 v[8:11], v12, s[24:27], 0 offen sc1
    v_mov_b32 v8, s90
    buffer_store_dword v8, v12, s[24:27], 0 offen offset:16 sc1
    s_waitcnt vmcnt(0)
    buffer_atomic_add v13, v14, s[28:31], 0 offen sc1
    s_waitcnt vmcnt(0)
    s_mov_b64 exec, -1
Lz1:
    s_lshl_b32 s37, s87, 6
    s_lshr_b32 s38, s86, 1
    s_mul_i32 s38, s38, 32
    s_add_u32 s37, s37, s38
    v_add_u32 v6, s37, v2
    s_mov_b32 s38, 896
    v_mul_lo_u32 v6, v6, s38
    v_lshl_add_u32 v5, v3, 3, v6
    s_and_b32 s37, s86, 1
    s_lshl_b32 s37, s37, 6
    s_mul_i32 s38, s88, 112
    s_add_u32 s37, s37, s38
    v_add_u32 v5, s37, v5
    s_mov_b32 s20, s64
    s_mov_b32 s21, s65
    s_mov_b32 s22, 1835008
    s_mov_b32 s23, 0x00020000
    s_mov_b32 s37, 0
    buffer_load_dwordx2 v[8:9], v5, s[20:23], s37 offen offset:0
    buffer_load_dwordx2 v[10:11], v5, s[20:23], s37 offen offset:32
    s_mov_b32 s37, 14336
    buffer_load_dwordx2 v[12:13], v5, s[20:23], s37 offen offset:0
    buffer_load_dwordx2 v[14:15], v5, s[20:23], s37 offen offset:32
    s_waitcnt vmcnt(0)
    v_lshlrev_b32 v20, 16, v8
    v_and_b32 v21, 0xffff0000, v8
    v_lshlrev_b32 v22, 16, v9
    v_and_b32 v23, 0xffff0000, v9
    v_lshlrev_b32 v24, 16, v10
    v_and_b32 v25, 0xffff0000, v10
    v_lshlrev_b32 v26, 16, v11
    v_and_b32 v27, 0xffff0000, v11
    v_lshlrev_b32 v28, 16, v12
    v_and_b32 v29, 0xffff0000, v12
    v_lshlrev_b32 v30, 16, v13
    v_and_b32 v31, 0xffff0000, v13
    v_lshlrev_b32 v32, 16, v14
    v_and_b32 v33, 0xffff0000, v14
    v_lshlrev_b32 v34, 16, v15
    v_and_b32 v35, 0xffff0000, v15
    s_and_b32 s37, s86, 1
    s_cmp_eq_u32 s37, 1
    s_cselect_b32 s61, 0, -1
    s_mov_b32 s60, -1
    s_add_u32 s20, s84, 42991616
    s_addc_u32 s21, s85, 0
    s_mov_b32 s22, 262144
    s_mov_b32 s23, 0x00020000
    v_mov_b32 v40, 0
    s_lshl_b32 s37, s87, 6
    s_lshr_b32 s38, s86, 1
    s_mul_i32 s38, s38, 32
    s_add_u32 s37, s37, s38
    v_add_u32 v36, s37, v2
    v_lshlrev_b32 v36, 7, v36
    s_lshl_b32 s37, s88, 1
    s_and_b32 s38, s86, 1
    s_add_u32 s37, s37, s38
    s_lshl_b32 s37, s37, 3
    v_add_u32 v36, s37, v36
    v_mov_b32 v38, v20
    v_mul_f32 v39, v20, v20
    v_add_f32 v38, v38, v21
    v_fma_f32 v39, v21, v21, v39
    v_add_f32 v38, v38, v22
    v_fma_f32 v39, v22, v22, v39
    v_add_f32 v38, v38, v23
    v_fma_f32 v39, v23, v23, v39
    v_cndmask_b32 v16, v40, v24, s[60:61]
    v_add_f32 v38, v38, v16
    v_fma_f32 v39, v16, v16, v39
    v_cndmask_b32 v16, v40, v25, s[60:61]
    v_add_f32 v38, v38, v16
    v_fma_f32 v39, v16, v16, v39
    v_cndmask_b32 v16, v40, v26, s[60:61]
    v_add_f32 v38, v38, v16
    v_fma_f32 v39, v16, v16, v39
    v_cndmask_b32 v16, v40, v27, s[60:61]
    v_add_f32 v38, v38, v16
    v_fma_f32 v39, v16, v16, v39
    v_mov_b32 v16, v38
    s_nop 1
    v_permlane16_swap_b32 v38, v16
    v_add_f32 v38, v38, v16
    v_mov_b32 v16, v38
    s_nop 1
    v_permlane32_swap_b32 v38, v16
    v_add_f32 v38, v38, v16
    v_mov_b32 v16, v39
    s_nop 1
    v_permlane16_swap_b32 v39, v16
    v_add_f32 v39, v39, v16
    v_mov_b32 v16, v39
    s_nop 1
    v_permlane32_swap_b32 v39, v16
    v_add_f32 v39, v39, v16
    s_mov_b32 exec_lo, 0xffff
    s_mov_b32 exec_hi, 0
    buffer_store_dwordx2 v[38:39], v36, s[20:23], 0 offen offset:0 sc1
    s_mov_b64 exec, -1
    s_nop 1
    v_mov_b32 v38, v28
    v_mul_f32 v39, v28, v28
    v_add_f32 v38, v38, v29
    v_fma_f32 v39, v29, v29, v39
    v_add_f32 v38, v38, v30
    v_fma_f32 v39, v30, v30, v39
    v_add_f32 v38, v38, v31
    v_fma_f32 v39, v31, v31, v39
    v_cndmask_b32 v16, v40, v32, s[60:61]
    v_add_f32 v38, v38, v16
    v_fma_f32 v39, v16, v16, v39
    v_cndmask_b32 v16, v40, v33, s[60:61]
    v_add_f32 v38, v38, v16
    v_fma_f32 v39, v16, v16, v39
    v_cndmask_b32 v16, v40, v34, s[60:61]
    v_add_f32 v38, v38, v16
    v_fma_f32 v39, v16, v16, v39
    v_cndmask_b32 v16, v40, v35, s[60:61]
    v_add_f32 v38, v38, v16
    v_fma_f32 v39, v16, v16, v39
    v_mov_b32 v16, v38
    s_nop 1
    v_permlane16_swap_b32 v38, v16
    v_add_f32 v38, v38, v16
    v_mov_b32 v16, v38
    s_nop 1
    v_permlane32_swap_b32 v38, v16
    v_add_f32 v38, v38, v16
    v_mov_b32 v16, v39
    s_nop 1
    v_permlane16_swap_b32 v39, v16
    v_add_f32 v39, v39, v16
    v_mov_b32 v16, v39
    s_nop 1
    v_permlane32_swap_b32 v39, v16
    v_add_f32 v39, v39, v16
    s_mov_b32 exec_lo, 0xffff
    s_mov_b32 exec_hi, 0
    buffer_store_dwordx2 v[38:39], v36, s[20:23], 0 offen offset:2048 sc1
    s_mov_b64 exec, -1
    s_nop 1
    s_barrier
    s_waitcnt vmcnt(0)
    s_lshl_b32 s32, s89, 7
    s_lshl_b32 s33, s86, 2
    s_add_u32 s32, s32, s33
    v_mov_b32 v41, s32
    v_mov_b32 v42, 1
    s_mov_b64 exec, 1
    buffer_store_dword v42, v41, s[24:27], 0 offen sc1
    s_mov_b64 exec, -1
    s_barrier
    s_mov_b32 s8, s64
    s_mov_b32 s9, s65
    s_mov_b32 s10, 1835008
    s_mov_b32 s11, 0x00020000
    s_mov_b32 s12, s66
    s_mov_b32 s13, s67
    s_mov_b32 s14, 1204224
    s_mov_b32 s15, 0x00020000
    s_lshl_b32 s32, s86, 10
    s_and_b32 s40, s86, 1
    s_add_u32 s33, s40, 8
    s_mul_i32 s34, s86, 7168
    s_mul_i32 s35, s86, 21504
    s_mul_i32 s36, s88, 112
    v_lshrrev_b32 v5, 3, v1
    v_lshrrev_b32 v7, 4, v1
    s_lshl_b32 s37, s40, 2
    v_add_u32 v7, s37, v7
    v_and_b32 v6, 7, v1
    v_xor_b32 v6, v6, v7
    s_lshl_b32 s37, s87, 6
    s_sub_u32 s37, s37, 16
    s_lshl_b32 s38, s86, 3
    s_add_u32 s38, s38, 0
    s_add_u32 s38, s38, s37
    v_add_u32 v7, s38, v5
    s_mov_b32 s39, 896
    v_mul_lo_u32 v7, v7, s39
    v_lshl_add_u32 v9, v6, 4, v7
    s_lshl_b32 s38, s86, 3
    s_add_u32 s38, s38, 32
    s_add_u32 s38, s38, s37
    v_add_u32 v7, s38, v5
    s_mov_b32 s39, 896
    v_mul_lo_u32 v7, v7, s39
    v_lshl_add_u32 v10, v6, 4, v7
    s_lshl_b32 s38, s33, 3
    s_add_u32 s38, s38, s37
    v_add_u32 v7, s38, v5
    s_mov_b32 s39, 896
    v_mul_lo_u32 v7, v7, s39
    v_lshl_add_u32 v11, v6, 4, v7
    v_bfe_u32 v7, v1, 4, 1
    v_lshlrev_b32 v7, 1, v7
    s_lshl_b32 s37, s40, 2
    v_add_u32 v7, s37, v7
    v_and_b32 v8, 7, v1
    v_xor_b32 v8, v8, v7
    s_mov_b32 s39, 2688
    v_mul_lo_u32 v7, v5, s39
    v_lshl_add_u32 v12, v8, 4, v7
    s_add_u32 s42, s36, 0
    s_add_u32 s43, s36, 896
    s_add_u32 s44, s36, 1792
    s_add_u32 m0, s32, 71680
    s_add_u32 s37, s35, 0
    s_add_u32 s37, s37, s42
    buffer_load_dwordx4 v12, s[12:15], s37 offen lds
    s_add_u32 m0, s32, 75776
    s_add_u32 s37, s35, 86016
    s_add_u32 s37, s37, s42
    buffer_load_dwordx4 v12, s[12:15], s37 offen lds
    s_add_u32 m0, s32, 79872
    s_add_u32 s37, s35, 0
    s_add_u32 s37, s37, s43
    buffer_load_dwordx4 v12, s[12:15], s37 offen lds
    s_add_u32 m0, s32, 83968
    s_add_u32 s37, s35, 86016
    s_add_u32 s37, s37, s43
    buffer_load_dwordx4 v12, s[12:15], s37 offen lds
    s_add_u32 m0, s32, 88064
    s_add_u32 s37, s35, 0
    s_add_u32 s37, s37, s44
    buffer_load_dwordx4 v12, s[12:15], s37 offen lds
    s_add_u32 m0, s32, 92160
    s_add_u32 s37, s35, 86016
    s_add_u32 s37, s37, s44
    buffer_load_dwordx4 v12, s[12:15], s37 offen lds
    s_add_u32 m0, s32, 96256
    s_add_u32 s37, s35, 172032
    s_add_u32 s37, s37, s42
    buffer_load_dwordx4 v12, s[12:15], s37 offen lds
    s_add_u32 m0, s32, 100352
    s_add_u32 s37, s35, 258048
    s_add_u32 s37, s37, s42
    buffer_load_dwordx4 v12, s[12:15], s37 offen lds
    s_add_u32 m0, s32, 104448
    s_add_u32 s37, s35, 172032
    s_add_u32 s37, s37, s43
    buffer_load_dwordx4 v12, s[12:15], s37 offen lds
    s_add_u32 m0, s32, 108544
    s_add_u32 s37, s35, 258048
    s_add_u32 s37, s37, s43
    buffer_load_dwordx4 v12, s[12:15], s37 offen lds
    s_add_u32 m0, s32, 112640
    s_add_u32 s37, s35, 172032
    s_add_u32 s37, s37, s44
    buffer_load_dwordx4 v12, s[12:15], s37 offen lds
    s_add_u32 m0, s32, 116736
    s_add_u32 s37, s35, 258048
    s_add_u32 s37, s37, s44
    buffer_load_dwordx4 v12, s[12:15], s37 offen lds
    s_add_u32 m0, s32, 120832
    s_add_u32 s37, s35, 344064
    s_add_u32 s37, s37, s42
    buffer_load_dwordx4 v12, s[12:15], s37 offen lds
    s_add_u32 m0, s32, 124928
    s_add_u32 s37, s35, 430080
    s_add_u32 s37, s37, s42
    buffer_load_dwordx4 v12, s[12:15], s37 offen lds
    s_add_u32 m0, s32, 129024
    s_add_u32 s37, s35, 344064
    s_add_u32 s37, s37, s43
    buffer_load_dwordx4 v12, s[12:15], s37 offen lds
    s_add_u32 m0, s32, 133120
    s_add_u32 s37, s35, 430080
    s_add_u32 s37, s37, s43
    buffer_load_dwordx4 v12, s[12:15], s37 offen lds
    s_add_u32 m0, s32, 137216
    s_add_u32 s37, s35, 344064
    s_add_u32 s37, s37, s44
    buffer_load_dwordx4 v12, s[12:15], s37 offen lds
    s_add_u32 m0, s32, 141312
    s_add_u32 s37, s35, 430080
    s_add_u32 s37, s37, s44
    buffer_load_dwordx4 v12, s[12:15], s37 offen lds
    s_add_u32 m0, s32, 0
    s_nop 0
    s_mov_b32 s37, 0
    buffer_load_dwordx4 v9, s[8:11], s37 offen lds
    s_add_u32 m0, s32, 4096
    s_nop 0
    s_mov_b32 s37, 0
    buffer_load_dwordx4 v10, s[8:11], s37 offen lds
    s_lshl_b32 s38, s33, 10
    s_add_u32 m0, s38, 0
    s_nop 0
    s_mov_b32 s37, 0
    buffer_load_dwordx4 v11, s[8:11], s37 offen lds
    s_add_u32 m0, s32, 10240
    s_nop 0
    s_mov_b32 s37, 128
    buffer_load_dwordx4 v9, s[8:11], s37 offen lds
    s_add_u32 m0, s32, 14336
    s_nop 0
    s_mov_b32 s37, 128
    buffer_load_dwordx4 v10, s[8:11], s37 offen lds
    s_lshl_b32 s38, s33, 10
    s_add_u32 m0, s38, 10240
    s_nop 0
    s_mov_b32 s37, 128
    buffer_load_dwordx4 v11, s[8:11], s37 offen lds
    s_add_u32 m0, s32, 20480
    s_nop 0
    s_mov_b32 s37, 256
    buffer_load_dwordx4 v9, s[8:11], s37 offen lds
    s_add_u32 m0, s32, 24576
    s_nop 0
    s_mov_b32 s37, 256
    buffer_load_dwordx4 v10, s[8:11], s37 offen lds
    s_lshl_b32 s38, s33, 10
    s_add_u32 m0, s38, 20480
    s_nop 0
    s_mov_b32 s37, 256
    buffer_load_dwordx4 v11, s[8:11], s37 offen lds
    s_add_u32 m0, s32, 30720
    s_nop 0
    s_mov_b32 s37, 384
    buffer_load_dwordx4 v9, s[8:11], s37 offen lds
    s_add_u32 m0, s32, 34816
    s_nop 0
    s_mov_b32 s37, 384
    buffer_load_dwordx4 v10, s[8:11], s37 offen lds
    s_lshl_b32 s38, s33, 10
    s_add_u32 m0, s38, 30720
    s_nop 0
    s_mov_b32 s37, 384
    buffer_load_dwordx4 v11, s[8:11], s37 offen lds
    s_add_u32 m0, s32, 40960
    s_nop 0
    s_mov_b32 s37, 512
    buffer_load_dwordx4 v9, s[8:11], s37 offen lds
    s_add_u32 m0, s32, 45056
    s_nop 0
    s_mov_b32 s37, 512
    buffer_load_dwordx4 v10, s[8:11], s37 offen lds
    s_lshl_b32 s38, s33, 10
    s_add_u32 m0, s38, 40960
    s_nop 0
    s_mov_b32 s37, 512
    buffer_load_dwordx4 v11, s[8:11], s37 offen lds
    s_add_u32 m0, s32, 51200
    s_nop 0
    s_mov_b32 s37, 640
    buffer_load_dwordx4 v9, s[8:11], s37 offen lds
    s_add_u32 m0, s32, 55296
    s_nop 0
    s_mov_b32 s37, 640
    buffer_load_dwordx4 v10, s[8:11], s37 offen lds
    s_lshl_b32 s38, s33, 10
    s_add_u32 m0, s38, 51200
    s_nop 0
    s_mov_b32 s37, 640
    buffer_load_dwordx4 v11, s[8:11], s37 offen lds
    s_add_u32 m0, s32, 61440
    s_nop 0
    s_mov_b32 s37, 768
    buffer_load_dwordx4 v9, s[8:11], s37 offen lds
    s_add_u32 m0, s32, 65536
    s_nop 0
    s_mov_b32 s37, 768
    buffer_load_dwordx4 v10, s[8:11], s37 offen lds
    s_lshl_b32 s38, s33, 10
    s_add_u32 m0, s38, 61440
    s_nop 0
    s_mov_b32 s37, 768
    buffer_load_dwordx4 v11, s[8:11], s37 offen lds
    s_lshl_b32 s37, s89, 12
    v_lshlrev_b32 v13, 4, v0
    v_add_u32 v13, s37, v13
    s_mov_b32 s20, s68
    s_mov_b32 s21, s69
    s_mov_b32 s22, 401408
    s_mov_b32 s23, 0x00020000
    s_mov_b32 s38, 0
    buffer_load_dwordx4 v[16:19], v13, s[20:23], s38 offen
    s_mov_b32 s20, s72
    s_mov_b32 s21, s73
    s_mov_b32 s22, 401408
    s_mov_b32 s23, 0x00020000
    s_mov_b32 s38, 0
    buffer_load_dwordx4 v[16:19], v13, s[20:23], s38 offen
    s_mov_b32 s20, s74
    s_mov_b32 s21, s75
    s_mov_b32 s22, 401408
    s_mov_b32 s23, 0x00020000
    s_mov_b32 s38, 0
    buffer_load_dwordx4 v[16:19], v13, s[20:23], s38 offen
    s_mov_b32 s20, s76
    s_mov_b32 s21, s77
    s_mov_b32 s22, 1605632
    s_mov_b32 s23, 0x00020000
    s_mov_b32 s38, 0
    buffer_load_dwordx4 v[16:19], v13, s[20:23], s38 offen
    s_mov_b32 s38, 1048576
    buffer_load_dwordx4 v[16:19], v13, s[20:23], s38 offen
    s_mov_b32 s20, s78
    s_mov_b32 s21, s79
    s_mov_b32 s22, 1605632
    s_mov_b32 s23, 0x00020000
    s_mov_b32 s38, 0
    buffer_load_dwordx4 v[16:19], v13, s[20:23], s38 offen
    s_mov_b32 s38, 1048576
    buffer_load_dwordx4 v[16:19], v13, s[20:23], s38 offen
    v_lshrrev_b32 v7, 1, v2
    v_and_b32 v7, 7, v7
    v_add_u32 v8, 0, v3
    v_xor_b32 v8, v8, v7
    v_lshlrev_b32 v8, 4, v8
    v_lshl_add_u32 v20, v2, 7, v8
    v_add_u32 v8, 4, v3
    v_xor_b32 v8, v8, v7
    v_lshlrev_b32 v8, 4, v8
    v_lshl_add_u32 v21, v2, 7, v8
    s_lshl_b32 s37, s86, 11
    v_add_u32 v22, s37, v20
    v_add_u32 v23, s37, v21
    v_lshrrev_b32 v27, 2, v2
    v_lshl_add_u32 v27, v3, 3, v27
    v_lshlrev_b32 v27, 7, v27
    v_bfe_u32 v28, v2, 3, 1
    v_lshlrev_b32 v28, 2, v28
    v_and_b32 v7, 1, v3
    v_lshl_add_u32 v28, v7, 3, v28
    v_and_b32 v29, 3, v2
    s_mul_i32 s37, s86, 3
    s_add_u32 s38, s37, 0
    s_and_b32 s39, s38, 3
    s_lshl_b32 s39, s39, 2
    v_add_u32 v7, s39, v29
    v_xor_b32 v7, v7, v28
    v_lshl_add_u32 v7, v7, 3, v27
    s_lshr_b32 s38, s38, 2
    s_lshl_b32 s38, s38, 13
    v_add_u32 v24, s38, v7
    s_add_u32 s38, s37, 1
    s_and_b32 s39, s38, 3
    s_lshl_b32 s39, s39, 2
    v_add_u32 v7, s39, v29
    v_xor_b32 v7, v7, v28
    v_lshl_add_u32 v7, v7, 3, v27
    s_lshr_b32 s38, s38, 2
    s_lshl_b32 s38, s38, 13
    v_add_u32 v25, s38, v7
    s_add_u32 s38, s37, 2
    s_and_b32 s39, s38, 3
    s_lshl_b32 s39, s39, 2
    v_add_u32 v7, s39, v29
    v_xor_b32 v7, v7, v28
    v_lshl_add_u32 v7, v7, 3, v27
    s_lshr_b32 s38, s38, 2
    s_lshl_b32 s38, s38, 13
    v_add_u32 v26, s38, v7
    v_add_u32 v30, 65536, v20
    v_add_u32 v31, 65536, v21
    v_add_u32 v32, 65536, v22
    v_add_u32 v33, 65536, v23
    v_add_u32 v34, 65536, v24
    v_add_u32 v35, 131072, v24
    v_add_u32 v36, 65536, v25
    v_add_u32 v37, 131072, v25
    v_add_u32 v38, 65536, v26
    v_add_u32 v39, 131072, v26
    v_mov_b32 v40, 0
    v_mov_b32 v41, 0
    v_mov_b32 v42, 0
    v_mov_b32 v43, 0
    v_mov_b32 v44, 0
    v_mov_b32 v45, 0
    v_mov_b32 v46, 0
    v_mov_b32 v47, 0
    v_mov_b32 v48, 0
    v_mov_b32 v49, 0
    v_mov_b32 v50, 0
    v_mov_b32 v51, 0
    v_mov_b32 v52, 0
    v_mov_b32 v53, 0
    v_mov_b32 v54, 0
    v_mov_b32 v55, 0
    v_mov_b32 v56, 0
    v_mov_b32 v57, 0
    v_mov_b32 v58, 0
    v_mov_b32 v59, 0
    v_mov_b32 v60, 0
    v_mov_b32 v61, 0
    v_mov_b32 v62, 0
    v_mov_b32 v63, 0
    v_mov_b32 v64, 0
    v_mov_b32 v65, 0
    v_mov_b32 v66, 0
    v_mov_b32 v67, 0
    v_mov_b32 v68, 0
    v_mov_b32 v69, 0
    v_mov_b32 v70, 0
    v_mov_b32 v71, 0
    v_mov_b32 v72, 0
    v_mov_b32 v73, 0
    v_mov_b32 v74, 0
    v_mov_b32 v75, 0
    v_mov_b32 v76, 0
    v_mov_b32 v77, 0
    v_mov_b32 v78, 0
    v_mov_b32 v79, 0
    v_mov_b32 v80, 0
    v_mov_b32 v81, 0
    v_mov_b32 v82, 0
    v_mov_b32 v83, 0
    v_mov_b32 v84, 0
    v_mov_b32 v85, 0
    v_mov_b32 v86, 0
    v_mov_b32 v87, 0
    v_mov_b32 v88, 0
    v_mov_b32 v89, 0
    v_mov_b32 v90, 0
    v_mov_b32 v91, 0
    v_mov_b32 v92, 0
    v_mov_b32 v93, 0
    v_mov_b32 v94, 0
    v_mov_b32 v95, 0
    v_mov_b32 v96, 0
    v_mov_b32 v97, 0
    v_mov_b32 v98, 0
    v_mov_b32 v99, 0
    v_mov_b32 v100, 0
    v_mov_b32 v101, 0
    v_mov_b32 v102, 0
    v_mov_b32 v103, 0
    v_mov_b32 v104, 0
    v_mov_b32 v105, 0
    v_mov_b32 v106, 0
    v_mov_b32 v107, 0
    v_mov_b32 v108, 0
    v_mov_b32 v109, 0
    v_mov_b32 v110, 0
    v_mov_b32 v111, 0
    v_mov_b32 v112, 0x3f803f80
    v_mov_b32 v113, 0x3f803f80
    v_mov_b32 v114, 0x3f803f80
    v_mov_b32 v115, 0x3f803f80
    s_waitcnt vmcnt(40)
    s_waitcnt vmcnt(25)
    s_barrier
    ds_read_b128 v[116:119], v20 offset:0
    ds_read_b128 v[120:123], v20 offset:2048
    ds_read_b128 v[124:127], v20 offset:4096
    ds_read_b128 v[128:131], v20 offset:6144
    ds_read_b128 v[132:135], v20 offset:8192
    ds_read_b64_tr_b16 v[156:157], v34 offset:6144
    ds_read_b64_tr_b16 v[158:159], v34 offset:6656
    ds_read_b64_tr_b16 v[160:161], v36 offset:6144
    ds_read_b64_tr_b16 v[162:163], v36 offset:6656
    ds_read_b64_tr_b16 v[164:165], v38 offset:6144
    ds_read_b64_tr_b16 v[166:167], v38 offset:6656
    s_waitcnt lgkmcnt(0)
    v_mfma_f32_16x16x32_bf16 v[40:43], v[156:159], v[116:119], v[40:43]
    ds_read_b128 v[136:139], v21 offset:0
    ds_read_b128 v[140:143], v21 offset:2048
    v_mfma_f32_16x16x32_bf16 v[52:55], v[156:159], v[120:123], v[52:55]
    ds_read_b128 v[144:147], v21 offset:4096
    ds_read_b128 v[148:151], v21 offset:6144
    v_mfma_f32_16x16x32_bf16 v[64:67], v[156:159], v[124:127], v[64:67]
    ds_read_b128 v[152:155], v21 offset:8192
    ds_read_b64_tr_b16 v[168:169], v34 offset:10240
    v_mfma_f32_16x16x32_bf16 v[76:79], v[156:159], v[128:131], v[76:79]
    ds_read_b64_tr_b16 v[170:171], v34 offset:10752
    ds_read_b64_tr_b16 v[172:173], v36 offset:10240
    v_mfma_f32_16x16x32_bf16 v[88:91], v[156:159], v[132:135], v[88:91]
    ds_read_b64_tr_b16 v[174:175], v36 offset:10752
    ds_read_b64_tr_b16 v[176:177], v38 offset:10240
    v_mfma_f32_16x16x32_bf16 v[100:103], v[156:159], v[112:115], v[100:103]
    ds_read_b64_tr_b16 v[178:179], v38 offset:10752
    v_mfma_f32_16x16x32_bf16 v[44:47], v[160:163], v[116:119], v[44:47]
    v_mfma_f32_16x16x32_bf16 v[56:59], v[160:163], v[120:123], v[56:59]
    v_mfma_f32_16x16x32_bf16 v[68:71], v[160:163], v[124:127], v[68:71]
    v_mfma_f32_16x16x32_bf16 v[80:83], v[160:163], v[128:131], v[80:83]
    v_mfma_f32_16x16x32_bf16 v[92:95], v[160:163], v[132:135], v[92:95]
    v_mfma_f32_16x16x32_bf16 v[104:107], v[160:163], v[112:115], v[104:107]
    v_mfma_f32_16x16x32_bf16 v[48:51], v[164:167], v[116:119], v[48:51]
    v_mfma_f32_16x16x32_bf16 v[60:63], v[164:167], v[120:123], v[60:63]
    v_mfma_f32_16x16x32_bf16 v[72:75], v[164:167], v[124:127], v[72:75]
    v_mfma_f32_16x16x32_bf16 v[84:87], v[164:167], v[128:131], v[84:87]
    v_mfma_f32_16x16x32_bf16 v[96:99], v[164:167], v[132:135], v[96:99]
    v_mfma_f32_16x16x32_bf16 v[108:111], v[164:167], v[112:115], v[108:111]
    s_waitcnt lgkmcnt(0)
    s_waitcnt vmcnt(22)
    s_barrier
    s_add_u32 m0, s32, 71680
    s_add_u32 s37, s35, 516096
    s_add_u32 s37, s37, s42
    buffer_load_dwordx4 v12, s[12:15], s37 offen lds
    s_add_u32 m0, s32, 75776
    s_add_u32 s37, s35, 602112
    s_add_u32 s37, s37, s42
    buffer_load_dwordx4 v12, s[12:15], s37 offen lds
    s_add_u32 m0, s32, 79872
    s_add_u32 s37, s35, 516096
    s_add_u32 s37, s37, s43
    buffer_load_dwordx4 v12, s[12:15], s37 offen lds
    s_add_u32 m0, s32, 83968
    s_add_u32 s37, s35, 602112
    s_add_u32 s37, s37, s43
    buffer_load_dwordx4 v12, s[12:15], s37 offen lds
    s_add_u32 m0, s32, 88064
    s_add_u32 s37, s35, 516096
    s_add_u32 s37, s37, s44
    buffer_load_dwordx4 v12, s[12:15], s37 offen lds
    s_add_u32 m0, s32, 92160
    s_add_u32 s37, s35, 602112
    s_add_u32 s37, s37, s44
    buffer_load_dwordx4 v12, s[12:15], s37 offen lds
    v_mfma_f32_16x16x32_bf16 v[40:43], v[168:171], v[136:139], v[40:43]
    ds_read_b128 v[116:119], v20 offset:10240
    ds_read_b128 v[120:123], v20 offset:12288
    v_mfma_f32_16x16x32_bf16 v[52:55], v[168:171], v[140:143], v[52:55]
    ds_read_b128 v[124:127], v20 offset:14336
    ds_read_b128 v[128:131], v20 offset:16384
    v_mfma_f32_16x16x32_bf16 v[64:67], v[168:171], v[144:147], v[64:67]
    ds_read_b128 v[132:135], v20 offset:18432
    ds_read_b64_tr_b16 v[156:157], v34 offset:30720
    v_mfma_f32_16x16x32_bf16 v[76:79], v[168:171], v[148:151], v[76:79]
    ds_read_b64_tr_b16 v[158:159], v34 offset:31232
    ds_read_b64_tr_b16 v[160:161], v36 offset:30720
    v_mfma_f32_16x16x32_bf16 v[88:91], v[168:171], v[152:155], v[88:91]
    ds_read_b64_tr_b16 v[162:163], v36 offset:31232
    ds_read_b64_tr_b16 v[164:165], v38 offset:30720
    v_mfma_f32_16x16x32_bf16 v[100:103], v[168:171], v[112:115], v[100:103]
    ds_read_b64_tr_b16 v[166:167], v38 offset:31232
    v_mfma_f32_16x16x32_bf16 v[44:47], v[172:175], v[136:139], v[44:47]
    v_mfma_f32_16x16x32_bf16 v[56:59], v[172:175], v[140:143], v[56:59]
    v_mfma_f32_16x16x32_bf16 v[68:71], v[172:175], v[144:147], v[68:71]
    v_mfma_f32_16x16x32_bf16 v[80:83], v[172:175], v[148:151], v[80:83]
    v_mfma_f32_16x16x32_bf16 v[92:95], v[172:175], v[152:155], v[92:95]
    v_mfma_f32_16x16x32_bf16 v[104:107], v[172:175], v[112:115], v[104:107]
    v_mfma_f32_16x16x32_bf16 v[48:51], v[176:179], v[136:139], v[48:51]
    v_mfma_f32_16x16x32_bf16 v[60:63], v[176:179], v[140:143], v[60:63]
    v_mfma_f32_16x16x32_bf16 v[72:75], v[176:179], v[144:147], v[72:75]
    v_mfma_f32_16x16x32_bf16 v[84:87], v[176:179], v[148:151], v[84:87]
    v_mfma_f32_16x16x32_bf16 v[96:99], v[176:179], v[152:155], v[96:99]
    v_mfma_f32_16x16x32_bf16 v[108:111], v[176:179], v[112:115], v[108:111]
    s_waitcnt lgkmcnt(0)
    v_mfma_f32_16x16x32_bf16 v[40:43], v[156:159], v[116:119], v[40:43]
    ds_read_b128 v[136:139], v21 offset:10240
    ds_read_b128 v[140:143], v21 offset:12288
    v_mfma_f32_16x16x32_bf16 v[52:55], v[156:159], v[120:123], v[52:55]
    ds_read_b128 v[144:147], v21 offset:14336
    ds_read_b128 v[148:151], v21 offset:16384
    v_mfma_f32_16x16x32_bf16 v[64:67], v[156:159], v[124:127], v[64:67]
    ds_read_b128 v[152:155], v21 offset:18432
    ds_read_b64_tr_b16 v[168:169], v34 offset:34816
    v_mfma_f32_16x16x32_bf16 v[76:79], v[156:159], v[128:131], v[76:79]
    ds_read_b64_tr_b16 v[170:171], v34 offset:35328
    ds_read_b64_tr_b16 v[172:173], v36 offset:34816
    v_mfma_f32_16x16x32_bf16 v[88:91], v[156:159], v[132:135], v[88:91]
    ds_read_b64_tr_b16 v[174:175], v36 offset:35328
    ds_read_b64_tr_b16 v[176:177], v38 offset:34816
    v_mfma_f32_16x16x32_bf16 v[100:103], v[156:159], v[112:115], v[100:103]
    ds_read_b64_tr_b16 v[178:179], v38 offset:35328
    v_mfma_f32_16x16x32_bf16 v[44:47], v[160:163], v[116:119], v[44:47]
    v_mfma_f32_16x16x32_bf16 v[56:59], v[160:163], v[120:123], v[56:59]
    v_mfma_f32_16x16x32_bf16 v[68:71], v[160:163], v[124:127], v[68:71]
    v_mfma_f32_16x16x32_bf16 v[80:83], v[160:163], v[128:131], v[80:83]
    v_mfma_f32_16x16x32_bf16 v[92:95], v[160:163], v[132:135], v[92:95]
    v_mfma_f32_16x16x32_bf16 v[104:107], v[160:163], v[112:115], v[104:107]
    v_mfma_f32_16x16x32_bf16 v[48:51], v[164:167], v[116:119], v[48:51]
    v_mfma_f32_16x16x32_bf16 v[60:63], v[164:167], v[120:123], v[60:63]
    v_mfma_f32_16x16x32_bf16 v[72:75], v[164:167], v[124:127], v[72:75]
    v_mfma_f32_16x16x32_bf16 v[84:87], v[164:167], v[128:131], v[84:87]
    v_mfma_f32_16x16x32_bf16 v[96:99], v[164:167], v[132:135], v[96:99]
    v_mfma_f32_16x16x32_bf16 v[108:111], v[164:167], v[112:115], v[108:111]
    s_waitcnt lgkmcnt(0)
    s_waitcnt vmcnt(25)
    s_barrier
    s_add_u32 m0, s32, 96256
    s_add_u32 s37, s35, 688128
    s_add_u32 s37, s37, s42
    buffer_load_dwordx4 v12, s[12:15], s37 offen lds
    s_add_u32 m0, s32, 100352
    s_add_u32 s37, s35, 774144
    s_add_u32 s37, s37, s42
    buffer_load_dwordx4 v12, s[12:15], s37 offen lds
    s_add_u32 m0, s32, 104448
    s_add_u32 s37, s35, 688128
    s_add_u32 s37, s37, s43
    buffer_load_dwordx4 v12, s[12:15], s37 offen lds
    s_add_u32 m0, s32, 108544
    s_add_u32 s37, s35, 774144
    s_add_u32 s37, s37, s43
    buffer_load_dwordx4 v12, s[12:15], s37 offen lds
    s_add_u32 m0, s32, 112640
    s_add_u32 s37, s35, 688128
    s_add_u32 s37, s37, s44
    buffer_load_dwordx4 v12, s[12:15], s37 offen lds
    s_add_u32 m0, s32, 116736
    s_add_u32 s37, s35, 774144
    s_add_u32 s37, s37, s44
    buffer_load_dwordx4 v12, s[12:15], s37 offen lds
    v_mfma_f32_16x16x32_bf16 v[40:43], v[168:171], v[136:139], v[40:43]
    ds_read_b128 v[116:119], v20 offset:20480
    ds_read_b128 v[120:123], v20 offset:22528
    v_mfma_f32_16x16x32_bf16 v[52:55], v[168:171], v[140:143], v[52:55]
    ds_read_b128 v[124:127], v20 offset:24576
    ds_read_b128 v[128:131], v20 offset:26624
    v_mfma_f32_16x16x32_bf16 v[64:67], v[168:171], v[144:147], v[64:67]
    ds_read_b128 v[132:135], v20 offset:28672
    ds_read_b64_tr_b16 v[156:157], v34 offset:55296
    v_mfma_f32_16x16x32_bf16 v[76:79], v[168:171], v[148:151], v[76:79]
    ds_read_b64_tr_b16 v[158:159], v34 offset:55808
    ds_read_b64_tr_b16 v[160:161], v36 offset:55296
    v_mfma_f32_16x16x32_bf16 v[88:91], v[168:171], v[152:155], v[88:91]
    ds_read_b64_tr_b16 v[162:163], v36 offset:55808
    ds_read_b64_tr_b16 v[164:165], v38 offset:55296
    v_mfma_f32_16x16x32_bf16 v[100:103], v[168:171], v[112:115], v[100:103]
    ds_read_b64_tr_b16 v[166:167], v38 offset:55808
    v_mfma_f32_16x16x32_bf16 v[44:47], v[172:175], v[136:139], v[44:47]
    v_mfma_f32_16x16x32_bf16 v[56:59], v[172:175], v[140:143], v[56:59]
    v_mfma_f32_16x16x32_bf16 v[68:71], v[172:175], v[144:147], v[68:71]
    v_mfma_f32_16x16x32_bf16 v[80:83], v[172:175], v[148:151], v[80:83]
    v_mfma_f32_16x16x32_bf16 v[92:95], v[172:175], v[152:155], v[92:95]
    v_mfma_f32_16x16x32_bf16 v[104:107], v[172:175], v[112:115], v[104:107]
    v_mfma_f32_16x16x32_bf16 v[48:51], v[176:179], v[136:139], v[48:51]
    v_mfma_f32_16x16x32_bf16 v[60:63], v[176:179], v[140:143], v[60:63]
    v_mfma_f32_16x16x32_bf16 v[72:75], v[176:179], v[144:147], v[72:75]
    v_mfma_f32_16x16x32_bf16 v[84:87], v[176:179], v[148:151], v[84:87]
    v_mfma_f32_16x16x32_bf16 v[96:99], v[176:179], v[152:155], v[96:99]
    v_mfma_f32_16x16x32_bf16 v[108:111], v[176:179], v[112:115], v[108:111]
    s_waitcnt lgkmcnt(0)
    v_mfma_f32_16x16x32_bf16 v[40:43], v[156:159], v[116:119], v[40:43]
    ds_read_b128 v[136:139], v21 offset:20480
    ds_read_b128 v[140:143], v21 offset:22528
    v_mfma_f32_16x16x32_bf16 v[52:55], v[156:159], v[120:123], v[52:55]
    ds_read_b128 v[144:147], v21 offset:24576
    ds_read_b128 v[148:151], v21 offset:26624
    v_mfma_f32_16x16x32_bf16 v[64:67], v[156:159], v[124:127], v[64:67]
    ds_read_b128 v[152:155], v21 offset:28672
    ds_read_b64_tr_b16 v[168:169], v34 offset:59392
    v_mfma_f32_16x16x32_bf16 v[76:79], v[156:159], v[128:131], v[76:79]
    ds_read_b64_tr_b16 v[170:171], v34 offset:59904
    ds_read_b64_tr_b16 v[172:173], v36 offset:59392
    v_mfma_f32_16x16x32_bf16 v[88:91], v[156:159], v[132:135], v[88:91]
    ds_read_b64_tr_b16 v[174:175], v36 offset:59904
    ds_read_b64_tr_b16 v[176:177], v38 offset:59392
    v_mfma_f32_16x16x32_bf16 v[100:103], v[156:159], v[112:115], v[100:103]
    ds_read_b64_tr_b16 v[178:179], v38 offset:59904
    v_mfma_f32_16x16x32_bf16 v[44:47], v[160:163], v[116:119], v[44:47]
    v_mfma_f32_16x16x32_bf16 v[56:59], v[160:163], v[120:123], v[56:59]
    v_mfma_f32_16x16x32_bf16 v[68:71], v[160:163], v[124:127], v[68:71]
    v_mfma_f32_16x16x32_bf16 v[80:83], v[160:163], v[128:131], v[80:83]
    v_mfma_f32_16x16x32_bf16 v[92:95], v[160:163], v[132:135], v[92:95]
    v_mfma_f32_16x16x32_bf16 v[104:107], v[160:163], v[112:115], v[104:107]
    v_mfma_f32_16x16x32_bf16 v[48:51], v[164:167], v[116:119], v[48:51]
    v_mfma_f32_16x16x32_bf16 v[60:63], v[164:167], v[120:123], v[60:63]
    v_mfma_f32_16x16x32_bf16 v[72:75], v[164:167], v[124:127], v[72:75]
    v_mfma_f32_16x16x32_bf16 v[84:87], v[164:167], v[128:131], v[84:87]
    v_mfma_f32_16x16x32_bf16 v[96:99], v[164:167], v[132:135], v[96:99]
    v_mfma_f32_16x16x32_bf16 v[108:111], v[164:167], v[112:115], v[108:111]
    s_waitcnt lgkmcnt(0)
    s_waitcnt vmcnt(6)
    s_barrier
    s_add_u32 m0, s32, 120832
    s_add_u32 s37, s35, 860160
    s_add_u32 s37, s37, s42
    buffer_load_dwordx4 v12, s[12:15], s37 offen lds
    s_add_u32 m0, s32, 124928
    s_add_u32 s37, s35, 946176
    s_add_u32 s37, s37, s42
    buffer_load_dwordx4 v12, s[12:15], s37 offen lds
    s_add_u32 m0, s32, 129024
    s_add_u32 s37, s35, 860160
    s_add_u32 s37, s37, s43
    buffer_load_dwordx4 v12, s[12:15], s37 offen lds
    s_add_u32 m0, s32, 133120
    s_add_u32 s37, s35, 946176
    s_add_u32 s37, s37, s43
    buffer_load_dwordx4 v12, s[12:15], s37 offen lds
    s_add_u32 m0, s32, 137216
    s_add_u32 s37, s35, 860160
    s_add_u32 s37, s37, s44
    buffer_load_dwordx4 v12, s[12:15], s37 offen lds
    s_add_u32 m0, s32, 141312
    s_add_u32 s37, s35, 946176
    s_add_u32 s37, s37, s44
    buffer_load_dwordx4 v12, s[12:15], s37 offen lds
    v_mfma_f32_16x16x32_bf16 v[40:43], v[168:171], v[136:139], v[40:43]
    ds_read_b128 v[116:119], v20 offset:30720
    ds_read_b128 v[120:123], v20 offset:32768
    v_mfma_f32_16x16x32_bf16 v[52:55], v[168:171], v[140:143], v[52:55]
    ds_read_b128 v[124:127], v20 offset:34816
    ds_read_b128 v[128:131], v20 offset:36864
    v_mfma_f32_16x16x32_bf16 v[64:67], v[168:171], v[144:147], v[64:67]
    ds_read_b128 v[132:135], v20 offset:38912
    ds_read_b64_tr_b16 v[156:157], v34 offset:6144
    v_mfma_f32_16x16x32_bf16 v[76:79], v[168:171], v[148:151], v[76:79]
    ds_read_b64_tr_b16 v[158:159], v34 offset:6656
    ds_read_b64_tr_b16 v[160:161], v36 offset:6144
    v_mfma_f32_16x16x32_bf16 v[88:91], v[168:171], v[152:155], v[88:91]
    ds_read_b64_tr_b16 v[162:163], v36 offset:6656
    ds_read_b64_tr_b16 v[164:165], v38 offset:6144
    v_mfma_f32_16x16x32_bf16 v[100:103], v[168:171], v[112:115], v[100:103]
    ds_read_b64_tr_b16 v[166:167], v38 offset:6656
    v_mfma_f32_16x16x32_bf16 v[44:47], v[172:175], v[136:139], v[44:47]
    v_mfma_f32_16x16x32_bf16 v[56:59], v[172:175], v[140:143], v[56:59]
    v_mfma_f32_16x16x32_bf16 v[68:71], v[172:175], v[144:147], v[68:71]
    v_mfma_f32_16x16x32_bf16 v[80:83], v[172:175], v[148:151], v[80:83]
    v_mfma_f32_16x16x32_bf16 v[92:95], v[172:175], v[152:155], v[92:95]
    v_mfma_f32_16x16x32_bf16 v[104:107], v[172:175], v[112:115], v[104:107]
    v_mfma_f32_16x16x32_bf16 v[48:51], v[176:179], v[136:139], v[48:51]
    v_mfma_f32_16x16x32_bf16 v[60:63], v[176:179], v[140:143], v[60:63]
    v_mfma_f32_16x16x32_bf16 v[72:75], v[176:179], v[144:147], v[72:75]
    v_mfma_f32_16x16x32_bf16 v[84:87], v[176:179], v[148:151], v[84:87]
    v_mfma_f32_16x16x32_bf16 v[96:99], v[176:179], v[152:155], v[96:99]
    v_mfma_f32_16x16x32_bf16 v[108:111], v[176:179], v[112:115], v[108:111]
    s_waitcnt lgkmcnt(0)
    v_mfma_f32_16x16x32_bf16 v[40:43], v[156:159], v[116:119], v[40:43]
    ds_read_b128 v[136:139], v21 offset:30720
    ds_read_b128 v[140:143], v21 offset:32768
    v_mfma_f32_16x16x32_bf16 v[52:55], v[156:159], v[120:123], v[52:55]
    ds_read_b128 v[144:147], v21 offset:34816
    ds_read_b128 v[148:151], v21 offset:36864
    v_mfma_f32_16x16x32_bf16 v[64:67], v[156:159], v[124:127], v[64:67]
    ds_read_b128 v[152:155], v21 offset:38912
    ds_read_b64_tr_b16 v[168:169], v34 offset:10240
    v_mfma_f32_16x16x32_bf16 v[76:79], v[156:159], v[128:131], v[76:79]
    ds_read_b64_tr_b16 v[170:171], v34 offset:10752
    ds_read_b64_tr_b16 v[172:173], v36 offset:10240
    v_mfma_f32_16x16x32_bf16 v[88:91], v[156:159], v[132:135], v[88:91]
    ds_read_b64_tr_b16 v[174:175], v36 offset:10752
    ds_read_b64_tr_b16 v[176:177], v38 offset:10240
    v_mfma_f32_16x16x32_bf16 v[100:103], v[156:159], v[112:115], v[100:103]
    ds_read_b64_tr_b16 v[178:179], v38 offset:10752
    v_mfma_f32_16x16x32_bf16 v[44:47], v[160:163], v[116:119], v[44:47]
    v_mfma_f32_16x16x32_bf16 v[56:59], v[160:163], v[120:123], v[56:59]
    v_mfma_f32_16x16x32_bf16 v[68:71], v[160:163], v[124:127], v[68:71]
    v_mfma_f32_16x16x32_bf16 v[80:83], v[160:163], v[128:131], v[80:83]
    v_mfma_f32_16x16x32_bf16 v[92:95], v[160:163], v[132:135], v[92:95]
    v_mfma_f32_16x16x32_bf16 v[104:107], v[160:163], v[112:115], v[104:107]
    v_mfma_f32_16x16x32_bf16 v[48:51], v[164:167], v[116:119], v[48:51]
    v_mfma_f32_16x16x32_bf16 v[60:63], v[164:167], v[120:123], v[60:63]
    v_mfma_f32_16x16x32_bf16 v[72:75], v[164:167], v[124:127], v[72:75]
    v_mfma_f32_16x16x32_bf16 v[84:87], v[164:167], v[128:131], v[84:87]
    v_mfma_f32_16x16x32_bf16 v[96:99], v[164:167], v[132:135], v[96:99]
    v_mfma_f32_16x16x32_bf16 v[108:111], v[164:167], v[112:115], v[108:111]
    s_waitcnt lgkmcnt(0)
    s_waitcnt vmcnt(6)
    s_barrier
    s_add_u32 m0, s32, 71680
    s_add_u32 s37, s35, 1032192
    s_add_u32 s37, s37, s42
    buffer_load_dwordx4 v12, s[12:15], s37 offen lds
    s_add_u32 m0, s32, 75776
    s_add_u32 s37, s35, 1118208
    s_add_u32 s37, s37, s42
    buffer_load_dwordx4 v12, s[12:15], s37 offen lds
    s_add_u32 m0, s32, 79872
    s_add_u32 s37, s35, 1032192
    s_add_u32 s37, s37, s43
    buffer_load_dwordx4 v12, s[12:15], s37 offen lds
    s_add_u32 m0, s32, 83968
    s_add_u32 s37, s35, 1118208
    s_add_u32 s37, s37, s43
    buffer_load_dwordx4 v12, s[12:15], s37 offen lds
    s_add_u32 m0, s32, 88064
    s_add_u32 s37, s35, 1032192
    s_add_u32 s37, s37, s44
    buffer_load_dwordx4 v12, s[12:15], s37 offen lds
    s_add_u32 m0, s32, 92160
    s_add_u32 s37, s35, 1118208
    s_add_u32 s37, s37, s44
    buffer_load_dwordx4 v12, s[12:15], s37 offen lds
    v_mfma_f32_16x16x32_bf16 v[40:43], v[168:171], v[136:139], v[40:43]
    ds_read_b128 v[116:119], v20 offset:40960
    ds_read_b128 v[120:123], v20 offset:43008
    v_mfma_f32_16x16x32_bf16 v[52:55], v[168:171], v[140:143], v[52:55]
    ds_read_b128 v[124:127], v20 offset:45056
    ds_read_b128 v[128:131], v20 offset:47104
    v_mfma_f32_16x16x32_bf16 v[64:67], v[168:171], v[144:147], v[64:67]
    ds_read_b128 v[132:135], v20 offset:49152
    ds_read_b64_tr_b16 v[156:157], v34 offset:30720
    v_mfma_f32_16x16x32_bf16 v[76:79], v[168:171], v[148:151], v[76:79]
    ds_read_b64_tr_b16 v[158:159], v34 offset:31232
    ds_read_b64_tr_b16 v[160:161], v36 offset:30720
    v_mfma_f32_16x16x32_bf16 v[88:91], v[168:171], v[152:155], v[88:91]
    ds_read_b64_tr_b16 v[162:163], v36 offset:31232
    ds_read_b64_tr_b16 v[164:165], v38 offset:30720
    v_mfma_f32_16x16x32_bf16 v[100:103], v[168:171], v[112:115], v[100:103]
    ds_read_b64_tr_b16 v[166:167], v38 offset:31232
    v_mfma_f32_16x16x32_bf16 v[44:47], v[172:175], v[136:139], v[44:47]
    v_mfma_f32_16x16x32_bf16 v[56:59], v[172:175], v[140:143], v[56:59]
    v_mfma_f32_16x16x32_bf16 v[68:71], v[172:175], v[144:147], v[68:71]
    v_mfma_f32_16x16x32_bf16 v[80:83], v[172:175], v[148:151], v[80:83]
    v_mfma_f32_16x16x32_bf16 v[92:95], v[172:175], v[152:155], v[92:95]
    v_mfma_f32_16x16x32_bf16 v[104:107], v[172:175], v[112:115], v[104:107]
    v_mfma_f32_16x16x32_bf16 v[48:51], v[176:179], v[136:139], v[48:51]
    v_mfma_f32_16x16x32_bf16 v[60:63], v[176:179], v[140:143], v[60:63]
    v_mfma_f32_16x16x32_bf16 v[72:75], v[176:179], v[144:147], v[72:75]
    v_mfma_f32_16x16x32_bf16 v[84:87], v[176:179], v[148:151], v[84:87]
    v_mfma_f32_16x16x32_bf16 v[96:99], v[176:179], v[152:155], v[96:99]
    v_mfma_f32_16x16x32_bf16 v[108:111], v[176:179], v[112:115], v[108:111]
    s_waitcnt lgkmcnt(0)
    v_mfma_f32_16x16x32_bf16 v[40:43], v[156:159], v[116:119], v[40:43]
    ds_read_b128 v[136:139], v21 offset:40960
    ds_read_b128 v[140:143], v21 offset:43008
    v_mfma_f32_16x16x32_bf16 v[52:55], v[156:159], v[120:123], v[52:55]
    ds_read_b128 v[144:147], v21 offset:45056
    ds_read_b128 v[148:151], v21 offset:47104
    v_mfma_f32_16x16x32_bf16 v[64:67], v[156:159], v[124:127], v[64:67]
    ds_read_b128 v[152:155], v21 offset:49152
    ds_read_b64_tr_b16 v[168:169], v34 offset:34816
    v_mfma_f32_16x16x32_bf16 v[76:79], v[156:159], v[128:131], v[76:79]
    ds_read_b64_tr_b16 v[170:171], v34 offset:35328
    ds_read_b64_tr_b16 v[172:173], v36 offset:34816
    v_mfma_f32_16x16x32_bf16 v[88:91], v[156:159], v[132:135], v[88:91]
    ds_read_b64_tr_b16 v[174:175], v36 offset:35328
    ds_read_b64_tr_b16 v[176:177], v38 offset:34816
    v_mfma_f32_16x16x32_bf16 v[100:103], v[156:159], v[112:115], v[100:103]
    ds_read_b64_tr_b16 v[178:179], v38 offset:35328
    v_mfma_f32_16x16x32_bf16 v[44:47], v[160:163], v[116:119], v[44:47]
    v_mfma_f32_16x16x32_bf16 v[56:59], v[160:163], v[120:123], v[56:59]
    v_mfma_f32_16x16x32_bf16 v[68:71], v[160:163], v[124:127], v[68:71]
    v_mfma_f32_16x16x32_bf16 v[80:83], v[160:163], v[128:131], v[80:83]
    v_mfma_f32_16x16x32_bf16 v[92:95], v[160:163], v[132:135], v[92:95]
    v_mfma_f32_16x16x32_bf16 v[104:107], v[160:163], v[112:115], v[104:107]
    v_mfma_f32_16x16x32_bf16 v[48:51], v[164:167], v[116:119], v[48:51]
    v_mfma_f32_16x16x32_bf16 v[60:63], v[164:167], v[120:123], v[60:63]
    v_mfma_f32_16x16x32_bf16 v[72:75], v[164:167], v[124:127], v[72:75]
    v_mfma_f32_16x16x32_bf16 v[84:87], v[164:167], v[128:131], v[84:87]
    v_mfma_f32_16x16x32_bf16 v[96:99], v[164:167], v[132:135], v[96:99]
    v_mfma_f32_16x16x32_bf16 v[108:111], v[164:167], v[112:115], v[108:111]
    s_waitcnt lgkmcnt(0)
    s_waitcnt vmcnt(6)
    s_barrier
    v_mfma_f32_16x16x32_bf16 v[40:43], v[168:171], v[136:139], v[40:43]
    ds_read_b128 v[116:119], v20 offset:51200
    ds_read_b128 v[120:123], v20 offset:53248
    v_mfma_f32_16x16x32_bf16 v[52:55], v[168:171], v[140:143], v[52:55]
    ds_read_b128 v[124:127], v20 offset:55296
    ds_read_b128 v[128:131], v20 offset:57344
    v_mfma_f32_16x16x32_bf16 v[64:67], v[168:171], v[144:147], v[64:67]
    ds_read_b128 v[132:135], v20 offset:59392
    ds_read_b64_tr_b16 v[156:157], v34 offset:55296
    v_mfma_f32_16x16x32_bf16 v[76:79], v[168:171], v[148:151], v[76:79]
    ds_read_b64_tr_b16 v[158:159], v34 offset:55808
    ds_read_b64_tr_b16 v[160:161], v36 offset:55296
    v_mfma_f32_16x16x32_bf16 v[88:91], v[168:171], v[152:155], v[88:91]
    ds_read_b64_tr_b16 v[162:163], v36 offset:55808
    ds_read_b64_tr_b16 v[164:165], v38 offset:55296
    v_mfma_f32_16x16x32_bf16 v[100:103], v[168:171], v[112:115], v[100:103]
    ds_read_b64_tr_b16 v[166:167], v38 offset:55808
    v_mfma_f32_16x16x32_bf16 v[44:47], v[172:175], v[136:139], v[44:47]
    v_mfma_f32_16x16x32_bf16 v[56:59], v[172:175], v[140:143], v[56:59]
    v_mfma_f32_16x16x32_bf16 v[68:71], v[172:175], v[144:147], v[68:71]
    v_mfma_f32_16x16x32_bf16 v[80:83], v[172:175], v[148:151], v[80:83]
    v_mfma_f32_16x16x32_bf16 v[92:95], v[172:175], v[152:155], v[92:95]
    v_mfma_f32_16x16x32_bf16 v[104:107], v[172:175], v[112:115], v[104:107]
    v_mfma_f32_16x16x32_bf16 v[48:51], v[176:179], v[136:139], v[48:51]
    v_mfma_f32_16x16x32_bf16 v[60:63], v[176:179], v[140:143], v[60:63]
    v_mfma_f32_16x16x32_bf16 v[72:75], v[176:179], v[144:147], v[72:75]
    v_mfma_f32_16x16x32_bf16 v[84:87], v[176:179], v[148:151], v[84:87]
    v_mfma_f32_16x16x32_bf16 v[96:99], v[176:179], v[152:155], v[96:99]
    v_mfma_f32_16x16x32_bf16 v[108:111], v[176:179], v[112:115], v[108:111]
    s_waitcnt lgkmcnt(0)
    v_mfma_f32_16x16x32_bf16 v[40:43], v[156:159], v[116:119], v[40:43]
    ds_read_b128 v[136:139], v21 offset:51200
    ds_read_b128 v[140:143], v21 offset:53248
    v_mfma_f32_16x16x32_bf16 v[52:55], v[156:159], v[120:123], v[52:55]
    ds_read_b128 v[144:147], v21 offset:55296
    ds_read_b128 v[148:151], v21 offset:57344
    v_mfma_f32_16x16x32_bf16 v[64:67], v[156:159], v[124:127], v[64:67]
    ds_read_b128 v[152:155], v21 offset:59392
    ds_read_b64_tr_b16 v[168:169], v34 offset:59392
    v_mfma_f32_16x16x32_bf16 v[76:79], v[156:159], v[128:131], v[76:79]
    ds_read_b64_tr_b16 v[170:171], v34 offset:59904
    ds_read_b64_tr_b16 v[172:173], v36 offset:59392
    v_mfma_f32_16x16x32_bf16 v[88:91], v[156:159], v[132:135], v[88:91]
    ds_read_b64_tr_b16 v[174:175], v36 offset:59904
    ds_read_b64_tr_b16 v[176:177], v38 offset:59392
    v_mfma_f32_16x16x32_bf16 v[100:103], v[156:159], v[112:115], v[100:103]
    ds_read_b64_tr_b16 v[178:179], v38 offset:59904
    v_mfma_f32_16x16x32_bf16 v[44:47], v[160:163], v[116:119], v[44:47]
    v_mfma_f32_16x16x32_bf16 v[56:59], v[160:163], v[120:123], v[56:59]
    v_mfma_f32_16x16x32_bf16 v[68:71], v[160:163], v[124:127], v[68:71]
    v_mfma_f32_16x16x32_bf16 v[80:83], v[160:163], v[128:131], v[80:83]
    v_mfma_f32_16x16x32_bf16 v[92:95], v[160:163], v[132:135], v[92:95]
    v_mfma_f32_16x16x32_bf16 v[104:107], v[160:163], v[112:115], v[104:107]
    v_mfma_f32_16x16x32_bf16 v[48:51], v[164:167], v[116:119], v[48:51]
    v_mfma_f32_16x16x32_bf16 v[60:63], v[164:167], v[120:123], v[60:63]
    v_mfma_f32_16x16x32_bf16 v[72:75], v[164:167], v[124:127], v[72:75]
    v_mfma_f32_16x16x32_bf16 v[84:87], v[164:167], v[128:131], v[84:87]
    v_mfma_f32_16x16x32_bf16 v[96:99], v[164:167], v[132:135], v[96:99]
    v_mfma_f32_16x16x32_bf16 v[108:111], v[164:167], v[112:115], v[108:111]
    s_waitcnt lgkmcnt(0)
    s_waitcnt vmcnt(0)
    s_barrier
    v_mfma_f32_16x16x32_bf16 v[40:43], v[168:171], v[136:139], v[40:43]
    ds_read_b128 v[116:119], v20 offset:61440
    ds_read_b128 v[120:123], v20 offset:63488
    v_mfma_f32_16x16x32_bf16 v[52:55], v[168:171], v[140:143], v[52:55]
    ds_read_b128 v[124:127], v30 offset:0
    ds_read_b128 v[128:131], v30 offset:2048
    v_mfma_f32_16x16x32_bf16 v[64:67], v[168:171], v[144:147], v[64:67]
    ds_read_b128 v[132:135], v30 offset:4096
    ds_read_b64_tr_b16 v[156:157], v34 offset:6144
    v_mfma_f32_16x16x32_bf16 v[76:79], v[168:171], v[148:151], v[76:79]
    ds_read_b64_tr_b16 v[158:159], v34 offset:6656
    ds_read_b64_tr_b16 v[160:161], v36 offset:6144
    v_mfma_f32_16x16x32_bf16 v[88:91], v[168:171], v[152:155], v[88:91]
    ds_read_b64_tr_b16 v[162:163], v36 offset:6656
    ds_read_b64_tr_b16 v[164:165], v38 offset:6144
    v_mfma_f32_16x16x32_bf16 v[100:103], v[168:171], v[112:115], v[100:103]
    ds_read_b64_tr_b16 v[166:167], v38 offset:6656
    v_mfma_f32_16x16x32_bf16 v[44:47], v[172:175], v[136:139], v[44:47]
    v_mfma_f32_16x16x32_bf16 v[56:59], v[172:175], v[140:143], v[56:59]
    v_mfma_f32_16x16x32_bf16 v[68:71], v[172:175], v[144:147], v[68:71]
    v_mfma_f32_16x16x32_bf16 v[80:83], v[172:175], v[148:151], v[80:83]
    v_mfma_f32_16x16x32_bf16 v[92:95], v[172:175], v[152:155], v[92:95]
    v_mfma_f32_16x16x32_bf16 v[104:107], v[172:175], v[112:115], v[104:107]
    v_mfma_f32_16x16x32_bf16 v[48:51], v[176:179], v[136:139], v[48:51]
    v_mfma_f32_16x16x32_bf16 v[60:63], v[176:179], v[140:143], v[60:63]
    v_mfma_f32_16x16x32_bf16 v[72:75], v[176:179], v[144:147], v[72:75]
    v_mfma_f32_16x16x32_bf16 v[84:87], v[176:179], v[148:151], v[84:87]
    v_mfma_f32_16x16x32_bf16 v[96:99], v[176:179], v[152:155], v[96:99]
    v_mfma_f32_16x16x32_bf16 v[108:111], v[176:179], v[112:115], v[108:111]
    s_waitcnt lgkmcnt(0)
    v_mfma_f32_16x16x32_bf16 v[40:43], v[156:159], v[116:119], v[40:43]
    ds_read_b128 v[136:139], v21 offset:61440
    ds_read_b128 v[140:143], v21 offset:63488
    v_mfma_f32_16x16x32_bf16 v[52:55], v[156:159], v[120:123], v[52:55]
    ds_read_b128 v[144:147], v31 offset:0
    ds_read_b128 v[148:151], v31 offset:2048
    v_mfma_f32_16x16x32_bf16 v[64:67], v[156:159], v[124:127], v[64:67]
    ds_read_b128 v[152:155], v31 offset:4096
    ds_read_b64_tr_b16 v[168:169], v34 offset:10240
    v_mfma_f32_16x16x32_bf16 v[76:79], v[156:159], v[128:131], v[76:79]
    ds_read_b64_tr_b16 v[170:171], v34 offset:10752
    ds_read_b64_tr_b16 v[172:173], v36 offset:10240
    v_mfma_f32_16x16x32_bf16 v[88:91], v[156:159], v[132:135], v[88:91]
    ds_read_b64_tr_b16 v[174:175], v36 offset:10752
    ds_read_b64_tr_b16 v[176:177], v38 offset:10240
    v_mfma_f32_16x16x32_bf16 v[100:103], v[156:159], v[112:115], v[100:103]
    ds_read_b64_tr_b16 v[178:179], v38 offset:10752
    v_mfma_f32_16x16x32_bf16 v[44:47], v[160:163], v[116:119], v[44:47]
    v_mfma_f32_16x16x32_bf16 v[56:59], v[160:163], v[120:123], v[56:59]
    v_mfma_f32_16x16x32_bf16 v[68:71], v[160:163], v[124:127], v[68:71]
    v_mfma_f32_16x16x32_bf16 v[80:83], v[160:163], v[128:131], v[80:83]
    v_mfma_f32_16x16x32_bf16 v[92:95], v[160:163], v[132:135], v[92:95]
    v_mfma_f32_16x16x32_bf16 v[104:107], v[160:163], v[112:115], v[104:107]
    v_mfma_f32_16x16x32_bf16 v[48:51], v[164:167], v[116:119], v[48:51]
    v_mfma_f32_16x16x32_bf16 v[60:63], v[164:167], v[120:123], v[60:63]
    v_mfma_f32_16x16x32_bf16 v[72:75], v[164:167], v[124:127], v[72:75]
    v_mfma_f32_16x16x32_bf16 v[84:87], v[164:167], v[128:131], v[84:87]
    v_mfma_f32_16x16x32_bf16 v[96:99], v[164:167], v[132:135], v[96:99]
    v_mfma_f32_16x16x32_bf16 v[108:111], v[164:167], v[112:115], v[108:111]
    s_waitcnt lgkmcnt(0)
    v_mfma_f32_16x16x32_bf16 v[40:43], v[168:171], v[136:139], v[40:43]
    v_mfma_f32_16x16x32_bf16 v[52:55], v[168:171], v[140:143], v[52:55]
    v_mfma_f32_16x16x32_bf16 v[64:67], v[168:171], v[144:147], v[64:67]
    v_mfma_f32_16x16x32_bf16 v[76:79], v[168:171], v[148:151], v[76:79]
    v_mfma_f32_16x16x32_bf16 v[88:91], v[168:171], v[152:155], v[88:91]
    v_mfma_f32_16x16x32_bf16 v[100:103], v[168:171], v[112:115], v[100:103]
    v_mfma_f32_16x16x32_bf16 v[44:47], v[172:175], v[136:139], v[44:47]
    v_mfma_f32_16x16x32_bf16 v[56:59], v[172:175], v[140:143], v[56:59]
    v_mfma_f32_16x16x32_bf16 v[68:71], v[172:175], v[144:147], v[68:71]
    v_mfma_f32_16x16x32_bf16 v[80:83], v[172:175], v[148:151], v[80:83]
    v_mfma_f32_16x16x32_bf16 v[92:95], v[172:175], v[152:155], v[92:95]
    v_mfma_f32_16x16x32_bf16 v[104:107], v[172:175], v[112:115], v[104:107]
    v_mfma_f32_16x16x32_bf16 v[48:51], v[176:179], v[136:139], v[48:51]
    v_mfma_f32_16x16x32_bf16 v[60:63], v[176:179], v[140:143], v[60:63]
    v_mfma_f32_16x16x32_bf16 v[72:75], v[176:179], v[144:147], v[72:75]
    v_mfma_f32_16x16x32_bf16 v[84:87], v[176:179], v[148:151], v[84:87]
    v_mfma_f32_16x16x32_bf16 v[96:99], v[176:179], v[152:155], v[96:99]
    v_mfma_f32_16x16x32_bf16 v[108:111], v[176:179], v[112:115], v[108:111]
    s_nop 7
    s_nop 7
    s_barrier
    s_mov_b32 s12, s68
    s_mov_b32 s13, s69
    s_mov_b32 s14, 401408
    s_mov_b32 s15, 0x00020000
    s_lshl_b32 s32, s86, 10
    s_and_b32 s40, s86, 1
    s_mul_i32 s35, s86, 7168
    v_lshrrev_b32 v118, 3, v1
    v_bfe_u32 v116, v1, 4, 1
    v_lshlrev_b32 v116, 1, v116
    s_lshl_b32 s37, s40, 2
    v_add_u32 v116, s37, v116
    v_and_b32 v117, 7, v1
    v_xor_b32 v117, v117, v116
    s_mov_b32 s39, 896
    v_mul_lo_u32 v116, v118, s39
    v_lshl_add_u32 v119, v117, 4, v116
    s_mul_i32 s42, s88, 112
    s_add_u32 s42, s42, 0
    s_add_u32 m0, s32, 57344
    s_add_u32 s37, s35, 0
    s_add_u32 s37, s37, s42
    buffer_load_dwordx4 v119, s[12:15], s37 offen lds
    s_add_u32 m0, s32, 61440
    s_add_u32 s37, s35, 28672
    s_add_u32 s37, s37, s42
    buffer_load_dwordx4 v119, s[12:15], s37 offen lds
    s_add_u32 m0, s32, 65536
    s_add_u32 s37, s35, 57344
    s_add_u32 s37, s37, s42
    buffer_load_dwordx4 v119, s[12:15], s37 offen lds
    s_add_u32 m0, s32, 69632
    s_add_u32 s37, s35, 86016
    s_add_u32 s37, s37, s42
    buffer_load_dwordx4 v119, s[12:15], s37 offen lds
    s_add_u32 m0, s32, 73728
    s_add_u32 s37, s35, 114688
    s_add_u32 s37, s37, s42
    buffer_load_dwordx4 v119, s[12:15], s37 offen lds
    s_add_u32 m0, s32, 77824
    s_add_u32 s37, s35, 143360
    s_add_u32 s37, s37, s42
    buffer_load_dwordx4 v119, s[12:15], s37 offen lds
    s_add_u32 m0, s32, 81920
    s_add_u32 s37, s35, 172032
    s_add_u32 s37, s37, s42
    buffer_load_dwordx4 v119, s[12:15], s37 offen lds
    s_add_u32 m0, s32, 86016
    s_add_u32 s37, s35, 200704
    s_add_u32 s37, s37, s42
    buffer_load_dwordx4 v119, s[12:15], s37 offen lds
    s_add_u32 m0, s32, 90112
    s_add_u32 s37, s35, 229376
    s_add_u32 s37, s37, s42
    buffer_load_dwordx4 v119, s[12:15], s37 offen lds
    s_add_u32 m0, s32, 94208
    s_add_u32 s37, s35, 258048
    s_add_u32 s37, s37, s42
    buffer_load_dwordx4 v119, s[12:15], s37 offen lds
    s_add_u32 m0, s32, 98304
    s_add_u32 s37, s35, 286720
    s_add_u32 s37, s37, s42
    buffer_load_dwordx4 v119, s[12:15], s37 offen lds
    s_add_u32 m0, s32, 102400
    s_add_u32 s37, s35, 315392
    s_add_u32 s37, s37, s42
    buffer_load_dwordx4 v119, s[12:15], s37 offen lds
    s_add_u32 m0, s32, 106496
    s_add_u32 s37, s35, 344064
    s_add_u32 s37, s37, s42
    buffer_load_dwordx4 v119, s[12:15], s37 offen lds
    s_add_u32 m0, s32, 110592
    s_add_u32 s37, s35, 372736
    s_add_u32 s37, s37, s42
    buffer_load_dwordx4 v119, s[12:15], s37 offen lds
    s_cmp_lg_u32 s86, 0
    s_cbranch_scc1 Lp2_skip
    v_lshrrev_b32 v117, 3, v1
    v_add_u32 v117, s87, v117
    v_add_u32 v117, -1, v117
    v_mov_b32 v118, s87
    v_cmp_gt_u32 vcc, 32, v117
    s_nop 1
    v_cndmask_b32 v117, v118, v117, vcc
    v_and_b32 v116, 7, v1
    v_lshlrev_b32 v116, 5, v116
    v_and_b32 v118, 3, v117
    v_lshl_add_u32 v116, v118, 3, v116
    v_lshrrev_b32 v118, 2, v117
    v_add_u32 v116, v116, v118
    v_lshlrev_b32 v116, 7, v116
    v_add_u32 v116, 0, v116
    v_mov_b32 v124, 0
    s_mov_b32 s52, 0
    s_mov_b32 s53, 1
    s_mov_b32 exec_lo, 65535
    s_mov_b32 exec_hi, 0
Lp2_loop:
    buffer_load_dwordx4 v[120:123], v116, s[24:27], 0 offen sc1
    buffer_load_dword v118, v124, s[28:31], 0 offen sc1
    s_waitcnt vmcnt(0)
    v_cmp_ne_u32 vcc, 256, v118
    s_cbranch_vccnz Lp2_again
    v_min_u32 v120, v120, v121
    v_min_u32 v122, v122, v123
    v_min_u32 v120, v120, v122
    v_cmp_gt_u32 vcc, s53, v120
    s_cbranch_vccz Lp2_ok
Lp2_again:
    s_add_u32 s52, s52, 1
    s_cmp_lt_u32 s52, 20000
    s_cbranch_scc1 Lp2_loop
Lp2_ok:
    s_mov_b64 exec, -1
Lp2_skip:
    s_barrier
    v_lshrrev_b32 v117, 3, v1
    v_add_u32 v117, s87, v117
    v_add_u32 v117, -1, v117
    v_mov_b32 v118, s87
    v_cmp_gt_u32 vcc, 32, v117
    s_nop 1
    v_cndmask_b32 v117, v118, v117, vcc
    v_and_b32 v116, 7, v1
    v_lshlrev_b32 v116, 5, v116
    v_and_b32 v118, 3, v117
    v_lshl_add_u32 v116, v118, 3, v116
    v_lshrrev_b32 v118, 2, v117
    v_add_u32 v116, v116, v118
    v_lshlrev_b32 v116, 7, v116
    s_mov_b32 exec_lo, 0xffffff
    s_mov_b32 exec_hi, 0
    buffer_load_dword v119, v116, s[24:27], 0 offen offset:16 sc1
    s_waitcnt vmcnt(0)
    v_cmp_ne_u32 vcc, s90, v119
    s_mov_b64 exec, -1
    s_and_b32 s32, vcc_lo, 0xff00
    s_cmp_eq_u32 s32, 0
    s_cselect_b32 s91, 1, 0
    s_and_b32 s32, vcc_lo, 0xffff
    s_cmp_eq_u32 s32, 0
    s_cselect_b32 s92, 1, 0
    s_and_b32 s32, vcc_lo, 0xffff00
    s_cmp_eq_u32 s32, 0
    s_cselect_b32 s93, 1, 0
    s_add_u32 s20, s84, 42991616
    s_addc_u32 s21, s85, 0
    s_mov_b32 s22, 262144
    s_mov_b32 s23, 0x00020000
    s_lshl_b32 s37, s87, 6
    s_sub_u32 s37, s37, 16
    v_add_u32 v116, s37, v2
    v_lshlrev_b32 v116, 7, v116
    v_lshl_add_u32 v116, v3, 5, v116
    buffer_load_dwordx4 v[120:123], v116, s[20:23], 0 offen
    buffer_load_dwordx4 v[124:127], v116, s[20:23], 0 offen offset:16
    v_add_u32 v116, 2048, v116
    buffer_load_dwordx4 v[128:131], v116, s[20:23], 0 offen
    buffer_load_dwordx4 v[132:135], v116, s[20:23], 0 offen offset:16
    v_add_u32 v116, 2048, v116
    buffer_load_dwordx4 v[136:139], v116, s[20:23], 0 offen
    buffer_load_dwordx4 v[140:143], v116, s[20:23], 0 offen offset:16
    v_add_u32 v116, 2048, v116
    buffer_load_dwordx4 v[144:147], v116, s[20:23], 0 offen
    buffer_load_dwordx4 v[148:151], v116, s[20:23], 0 offen offset:16
    v_add_u32 v116, 2048, v116
    buffer_load_dwordx4 v[152:155], v116, s[20:23], 0 offen
    buffer_load_dwordx4 v[156:159], v116, s[20:23], 0 offen offset:16
    s_waitcnt vmcnt(0)
    v_add_f32 v164, v120, v122
    v_add_f32 v165, v121, v123
    v_add_f32 v160, v124, v126
    v_add_f32 v161, v125, v127
    v_add_f32 v164, v164, v160
    v_add_f32 v165, v165, v161
    v_mov_b32 v160, v164
    s_nop 1
    v_permlane16_swap_b32 v164, v160
    v_add_f32 v164, v164, v160
    v_mov_b32 v160, v164
    s_nop 1
    v_permlane32_swap_b32 v164, v160
    v_add_f32 v164, v164, v160
    v_mov_b32 v160, v165
    s_nop 1
    v_permlane16_swap_b32 v165, v160
    v_add_f32 v165, v165, v160
    v_mov_b32 v160, v165
    s_nop 1
    v_permlane32_swap_b32 v165, v160
    v_add_f32 v165, v165, v160
    v_mul_f32 v164, 991054117, v164
    v_mul_f32 v165, 991054117, v165
    v_fma_f32 v165, -v164, v164, v165
    v_max_f32 v165, 0, v165
    v_add_f32 v160, 925353388, v165
    v_rsq_f32 v161, v160
    s_nop 0
    v_mov_b32 v165, v161
    v_add_f32 v166, v128, v130
    v_add_f32 v167, v129, v131
    v_add_f32 v160, v132, v134
    v_add_f32 v161, v133, v135
    v_add_f32 v166, v166, v160
    v_add_f32 v167, v167, v161
    v_mov_b32 v160, v166
    s_nop 1
    v_permlane16_swap_b32 v166, v160
    v_add_f32 v166, v166, v160
    v_mov_b32 v160, v166
    s_nop 1
    v_permlane32_swap_b32 v166, v160
    v_add_f32 v166, v166, v160
    v_mov_b32 v160, v167
    s_nop 1
    v_permlane16_swap_b32 v167, v160
    v_add_f32 v167, v167, v160
    v_mov_b32 v160, v167
    s_nop 1
    v_permlane32_swap_b32 v167, v160
    v_add_f32 v167, v167, v160
    v_mul_f32 v166, 991054117, v166
    v_mul_f32 v167, 991054117, v167
    v_fma_f32 v167, -v166, v166, v167
    v_max_f32 v167, 0, v167
    v_add_f32 v160, 925353388, v167
    v_rsq_f32 v161, v160
    s_nop 0
    v_mov_b32 v167, v161
    v_add_f32 v168, v136, v138
    v_add_f32 v169, v137, v139
    v_add_f32 v160, v140, v142
    v_add_f32 v161, v141, v143
    v_add_f32 v168, v168, v160
    v_add_f32 v169, v169, v161
    v_mov_b32 v160, v168
    s_nop 1
    v_permlane16_swap_b32 v168, v160
    v_add_f32 v168, v168, v160
    v_mov_b32 v160, v168
    s_nop 1
    v_permlane32_swap_b32 v168, v160
    v_add_f32 v168, v168, v160
    v_mov_b32 v160, v169
    s_nop 1
    v_permlane16_swap_b32 v169, v160
    v_add_f32 v169, v169, v160
    v_mov_b32 v160, v169
    s_nop 1
    v_permlane32_swap_b32 v169, v160
    v_add_f32 v169, v169, v160
    v_mul_f32 v168, 991054117, v168
    v_mul_f32 v169, 991054117, v169
    v_fma_f32 v169, -v168, v168, v169
    v_max_f32 v169, 0, v169
    v_add_f32 v160, 925353388, v169
    v_rsq_f32 v161, v160
    s_nop 0
    v_mov_b32 v169, v161
    v_add_f32 v170, v144, v146
    v_add_f32 v171, v145, v147
    v_add_f32 v160, v148, v150
    v_add_f32 v161, v149, v151
    v_add_f32 v170, v170, v160
    v_add_f32 v171, v171, v161
    v_mov_b32 v160, v170
    s_nop 1
    v_permlane16_swap_b32 v170, v160
    v_add_f32 v170, v170, v160
    v_mov_b32 v160, v170
    s_nop 1
    v_permlane32_swap_b32 v170, v160
    v_add_f32 v170, v170, v160
    v_mov_b32 v160, v171
    s_nop 1
    v_permlane16_swap_b32 v171, v160
    v_add_f32 v171, v171, v160
    v_mov_b32 v160, v171
    s_nop 1
    v_permlane32_swap_b32 v171, v160
    v_add_f32 v171, v171, v160
    v_mul_f32 v170, 991054117, v170
    v_mul_f32 v171, 991054117, v171
    v_fma_f32 v171, -v170, v170, v171
    v_max_f32 v171, 0, v171
    v_add_f32 v160, 925353388, v171
    v_rsq_f32 v161, v160
    s_nop 0
    v_mov_b32 v171, v161
    v_add_f32 v172, v152, v154
    v_add_f32 v173, v153, v155
    v_add_f32 v160, v156, v158
    v_add_f32 v161, v157, v159
    v_add_f32 v172, v172, v160
    v_add_f32 v173, v173, v161
    v_mov_b32 v160, v172
    s_nop 1
    v_permlane16_swap_b32 v172, v160
    v_add_f32 v172, v172, v160
    v_mov_b32 v160, v172
    s_nop 1
    v_permlane32_swap_b32 v172, v160
    v_add_f32 v172, v172, v160
    v_mov_b32 v160, v173
    s_nop 1
    v_permlane16_swap_b32 v173, v160
    v_add_f32 v173, v173, v160
    v_mov_b32 v160, v173
    s_nop 1
    v_permlane32_swap_b32 v173, v160
    v_add_f32 v173, v173, v160
    v_mul_f32 v172, 991054117, v172
    v_mul_f32 v173, 991054117, v173
    v_fma_f32 v173, -v172, v172, v173
    v_max_f32 v173, 0, v173
    v_add_f32 v160, 925353388, v173
    v_rsq_f32 v161, v160
    s_nop 0
    v_mov_b32 v173, v161
    s_mov_b32 s54, 1027024659
    s_mov_b32 s55, 3222493025
    s_barrier
    s_mov_b32 s38, 400
    v_mul_lo_u32 v178, v2, s38
    s_mul_i32 s37, s86, 3
    s_add_u32 s37, s37, 0
    s_and_b32 s39, s37, 3
    s_lshl_b32 s39, s39, 4
    v_lshl_add_u32 v179, v3, 2, s39
    s_lshr_b32 s37, s37, 2
    s_lshl_b32 s37, s37, 7
    v_lshlrev_b32 v180, 1, v179
    v_add_u32 v180, s37, v180
    v_add_u32 v181, 8, v180
    v_cmp_le_u32 vcc, 28, v179
    s_nop 1
    v_cndmask_b32 v181, v180, v181, vcc
    v_add_u32 v181, v181, v178
    v_mov_b32 v180, 162816
    v_cmp_le_u32 vcc, 56, v179
    s_nop 1
    v_cndmask_b32 v181, v181, v180, vcc
    s_mul_i32 s37, s86, 3
    s_add_u32 s37, s37, 1
    s_and_b32 s39, s37, 3
    s_lshl_b32 s39, s39, 4
    v_lshl_add_u32 v179, v3, 2, s39
    s_lshr_b32 s37, s37, 2
    s_lshl_b32 s37, s37, 7
    v_lshlrev_b32 v180, 1, v179
    v_add_u32 v180, s37, v180
    v_add_u32 v182, 8, v180
    v_cmp_le_u32 vcc, 28, v179
    s_nop 1
    v_cndmask_b32 v182, v180, v182, vcc
    v_add_u32 v182, v182, v178
    v_mov_b32 v180, 162816
    v_cmp_le_u32 vcc, 56, v179
    s_nop 1
    v_cndmask_b32 v182, v182, v180, vcc
    s_mul_i32 s37, s86, 3
    s_add_u32 s37, s37, 2
    s_and_b32 s39, s37, 3
    s_lshl_b32 s39, s39, 4
    v_lshl_add_u32 v179, v3, 2, s39
    s_lshr_b32 s37, s37, 2
    s_lshl_b32 s37, s37, 7
    v_lshlrev_b32 v180, 1, v179
    v_add_u32 v180, s37, v180
    v_add_u32 v183, 8, v180
    v_cmp_le_u32 vcc, 28, v179
    s_nop 1
    v_cndmask_b32 v183, v180, v183, vcc
    v_add_u32 v183, v183, v178
    v_mov_b32 v180, 162816
    v_cmp_le_u32 vcc, 56, v179
    s_nop 1
    v_cndmask_b32 v183, v183, v180, vcc
    v_mov_b32 v184, 0
    v_mov_b32 v185, 0
    v_mul_u32_u24 v179, 43, v0
    v_lshrrev_b32 v179, 8, v179
    v_mul_u32_u24 v180, 6, v179
    v_sub_u32 v180, v0, v180
    v_lshlrev_b32 v180, 6, v180
    v_add_u32 v180, 56, v180
    v_add_u32 v178, 0, v179
    v_mul_u32_u24 v178, 400, v178
    v_add_u32 v178, v178, v180
    ds_write_b64 v178, v[184:185]
    v_add_u32 v178, 42, v179
    v_mul_u32_u24 v178, 400, v178
    v_add_u32 v178, v178, v180
    ds_write_b64 v178, v[184:185]
    v_pk_fma_f32 v[40:41], v[100:101], v[164:165], v[40:41] op_sel_hi:[1,0,1] neg_lo:[0,1,0] neg_hi:[0,1,0]
    v_pk_mul_f32 v[40:41], v[40:41], v[164:165] op_sel:[0,1] op_sel_hi:[1,1]
    v_pk_fma_f32 v[42:43], v[102:103], v[164:165], v[42:43] op_sel_hi:[1,0,1] neg_lo:[0,1,0] neg_hi:[0,1,0]
    v_pk_mul_f32 v[42:43], v[42:43], v[164:165] op_sel:[0,1] op_sel_hi:[1,1]
    v_cvt_pk_bf16_f32 v186, v40, v41
    v_cvt_pk_bf16_f32 v187, v42, v43
    ds_write_b64 v181, v[186:187] offset:0
    v_pk_fma_f32 v[44:45], v[104:105], v[164:165], v[44:45] op_sel_hi:[1,0,1] neg_lo:[0,1,0] neg_hi:[0,1,0]
    v_pk_mul_f32 v[44:45], v[44:45], v[164:165] op_sel:[0,1] op_sel_hi:[1,1]
    v_pk_fma_f32 v[46:47], v[106:107], v[164:165], v[46:47] op_sel_hi:[1,0,1] neg_lo:[0,1,0] neg_hi:[0,1,0]
    v_pk_mul_f32 v[46:47], v[46:47], v[164:165] op_sel:[0,1] op_sel_hi:[1,1]
    v_cvt_pk_bf16_f32 v188, v44, v45
    v_cvt_pk_bf16_f32 v189, v46, v47
    ds_write_b64 v182, v[188:189] offset:0
    v_pk_fma_f32 v[48:49], v[108:109], v[164:165], v[48:49] op_sel_hi:[1,0,1] neg_lo:[0,1,0] neg_hi:[0,1,0]
    v_pk_mul_f32 v[48:49], v[48:49], v[164:165] op_sel:[0,1] op_sel_hi:[1,1]
    v_pk_fma_f32 v[50:51], v[110:111], v[164:165], v[50:51] op_sel_hi:[1,0,1] neg_lo:[0,1,0] neg_hi:[0,1,0]
    v_pk_mul_f32 v[50:51], v[50:51], v[164:165] op_sel:[0,1] op_sel_hi:[1,1]
    v_cvt_pk_bf16_f32 v190, v48, v49
    v_cvt_pk_bf16_f32 v191, v50, v51
    ds_write_b64 v183, v[190:191] offset:0
    v_pk_fma_f32 v[52:53], v[100:101], v[166:167], v[52:53] op_sel_hi:[1,0,1] neg_lo:[0,1,0] neg_hi:[0,1,0]
    v_pk_mul_f32 v[52:53], v[52:53], v[166:167] op_sel:[0,1] op_sel_hi:[1,1]
    v_pk_fma_f32 v[54:55], v[102:103], v[166:167], v[54:55] op_sel_hi:[1,0,1] neg_lo:[0,1,0] neg_hi:[0,1,0]
    v_pk_mul_f32 v[54:55], v[54:55], v[166:167] op_sel:[0,1] op_sel_hi:[1,1]
    s_waitcnt lgkmcnt(0)
    v_cvt_pk_bf16_f32 v186, v52, v53
    v_cvt_pk_bf16_f32 v187, v54, v55
    ds_write_b64 v181, v[186:187] offset:6400
    v_pk_fma_f32 v[56:57], v[104:105], v[166:167], v[56:57] op_sel_hi:[1,0,1] neg_lo:[0,1,0] neg_hi:[0,1,0]
    v_pk_mul_f32 v[56:57], v[56:57], v[166:167] op_sel:[0,1] op_sel_hi:[1,1]
    v_pk_fma_f32 v[58:59], v[106:107], v[166:167], v[58:59] op_sel_hi:[1,0,1] neg_lo:[0,1,0] neg_hi:[0,1,0]
    v_pk_mul_f32 v[58:59], v[58:59], v[166:167] op_sel:[0,1] op_sel_hi:[1,1]
    s_waitcnt lgkmcnt(0)
    v_cvt_pk_bf16_f32 v188, v56, v57
    v_cvt_pk_bf16_f32 v189, v58, v59
    ds_write_b64 v182, v[188:189] offset:6400
    v_pk_fma_f32 v[60:61], v[108:109], v[166:167], v[60:61] op_sel_hi:[1,0,1] neg_lo:[0,1,0] neg_hi:[0,1,0]
    v_pk_mul_f32 v[60:61], v[60:61], v[166:167] op_sel:[0,1] op_sel_hi:[1,1]
    v_pk_fma_f32 v[62:63], v[110:111], v[166:167], v[62:63] op_sel_hi:[1,0,1] neg_lo:[0,1,0] neg_hi:[0,1,0]
    v_pk_mul_f32 v[62:63], v[62:63], v[166:167] op_sel:[0,1] op_sel_hi:[1,1]
    s_waitcnt lgkmcnt(0)
    v_cvt_pk_bf16_f32 v190, v60, v61
    v_cvt_pk_bf16_f32 v191, v62, v63
    ds_write_b64 v183, v[190:191] offset:6400
    v_pk_fma_f32 v[64:65], v[100:101], v[168:169], v[64:65] op_sel_hi:[1,0,1] neg_lo:[0,1,0] neg_hi:[0,1,0]
    v_pk_mul_f32 v[64:65], v[64:65], v[168:169] op_sel:[0,1] op_sel_hi:[1,1]
    v_pk_fma_f32 v[66:67], v[102:103], v[168:169], v[66:67] op_sel_hi:[1,0,1] neg_lo:[0,1,0] neg_hi:[0,1,0]
    v_pk_mul_f32 v[66:67], v[66:67], v[168:169] op_sel:[0,1] op_sel_hi:[1,1]
    s_waitcnt lgkmcnt(0)
    v_cvt_pk_bf16_f32 v186, v64, v65
    v_cvt_pk_bf16_f32 v187, v66, v67
    ds_write_b64 v181, v[186:187] offset:12800
    v_pk_fma_f32 v[68:69], v[104:105], v[168:169], v[68:69] op_sel_hi:[1,0,1] neg_lo:[0,1,0] neg_hi:[0,1,0]
    v_pk_mul_f32 v[68:69], v[68:69], v[168:169] op_sel:[0,1] op_sel_hi:[1,1]
    v_pk_fma_f32 v[70:71], v[106:107], v[168:169], v[70:71] op_sel_hi:[1,0,1] neg_lo:[0,1,0] neg_hi:[0,1,0]
    v_pk_mul_f32 v[70:71], v[70:71], v[168:169] op_sel:[0,1] op_sel_hi:[1,1]
    s_waitcnt lgkmcnt(0)
    v_cvt_pk_bf16_f32 v188, v68, v69
    v_cvt_pk_bf16_f32 v189, v70, v71
    ds_write_b64 v182, v[188:189] offset:12800
    v_pk_fma_f32 v[72:73], v[108:109], v[168:169], v[72:73] op_sel_hi:[1,0,1] neg_lo:[0,1,0] neg_hi:[0,1,0]
    v_pk_mul_f32 v[72:73], v[72:73], v[168:169] op_sel:[0,1] op_sel_hi:[1,1]
    v_pk_fma_f32 v[74:75], v[110:111], v[168:169], v[74:75] op_sel_hi:[1,0,1] neg_lo:[0,1,0] neg_hi:[0,1,0]
    v_pk_mul_f32 v[74:75], v[74:75], v[168:169] op_sel:[0,1] op_sel_hi:[1,1]
    s_waitcnt lgkmcnt(0)
    v_cvt_pk_bf16_f32 v190, v72, v73
    v_cvt_pk_bf16_f32 v191, v74, v75
    ds_write_b64 v183, v[190:191] offset:12800
    v_pk_fma_f32 v[76:77], v[100:101], v[170:171], v[76:77] op_sel_hi:[1,0,1] neg_lo:[0,1,0] neg_hi:[0,1,0]
    v_pk_mul_f32 v[76:77], v[76:77], v[170:171] op_sel:[0,1] op_sel_hi:[1,1]
    v_pk_fma_f32 v[78:79], v[102:103], v[170:171], v[78:79] op_sel_hi:[1,0,1] neg_lo:[0,1,0] neg_hi:[0,1,0]
    v_pk_mul_f32 v[78:79], v[78:79], v[170:171] op_sel:[0,1] op_sel_hi:[1,1]
    s_waitcnt lgkmcnt(0)
    v_cvt_pk_bf16_f32 v186, v76, v77
    v_cvt_pk_bf16_f32 v187, v78, v79
    ds_write_b64 v181, v[186:187] offset:19200
    v_pk_fma_f32 v[80:81], v[104:105], v[170:171], v[80:81] op_sel_hi:[1,0,1] neg_lo:[0,1,0] neg_hi:[0,1,0]
    v_pk_mul_f32 v[80:81], v[80:81], v[170:171] op_sel:[0,1] op_sel_hi:[1,1]
    v_pk_fma_f32 v[82:83], v[106:107], v[170:171], v[82:83] op_sel_hi:[1,0,1] neg_lo:[0,1,0] neg_hi:[0,1,0]
    v_pk_mul_f32 v[82:83], v[82:83], v[170:171] op_sel:[0,1] op_sel_hi:[1,1]
    s_waitcnt lgkmcnt(0)
    v_cvt_pk_bf16_f32 v188, v80, v81
    v_cvt_pk_bf16_f32 v189, v82, v83
    ds_write_b64 v182, v[188:189] offset:19200
    v_pk_fma_f32 v[84:85], v[108:109], v[170:171], v[84:85] op_sel_hi:[1,0,1] neg_lo:[0,1,0] neg_hi:[0,1,0]
    v_pk_mul_f32 v[84:85], v[84:85], v[170:171] op_sel:[0,1] op_sel_hi:[1,1]
    v_pk_fma_f32 v[86:87], v[110:111], v[170:171], v[86:87] op_sel_hi:[1,0,1] neg_lo:[0,1,0] neg_hi:[0,1,0]
    v_pk_mul_f32 v[86:87], v[86:87], v[170:171] op_sel:[0,1] op_sel_hi:[1,1]
    s_waitcnt lgkmcnt(0)
    v_cvt_pk_bf16_f32 v190, v84, v85
    v_cvt_pk_bf16_f32 v191, v86, v87
    ds_write_b64 v183, v[190:191] offset:19200
    v_pk_fma_f32 v[88:89], v[100:101], v[172:173], v[88:89] op_sel_hi:[1,0,1] neg_lo:[0,1,0] neg_hi:[0,1,0]
    v_pk_mul_f32 v[88:89], v[88:89], v[172:173] op_sel:[0,1] op_sel_hi:[1,1]
    v_pk_fma_f32 v[90:91], v[102:103], v[172:173], v[90:91] op_sel_hi:[1,0,1] neg_lo:[0,1,0] neg_hi:[0,1,0]
    v_pk_mul_f32 v[90:91], v[90:91], v[172:173] op_sel:[0,1] op_sel_hi:[1,1]
    s_waitcnt lgkmcnt(0)
    v_cvt_pk_bf16_f32 v186, v88, v89
    v_cvt_pk_bf16_f32 v187, v90, v91
    ds_write_b64 v181, v[186:187] offset:25600
    v_pk_fma_f32 v[92:93], v[104:105], v[172:173], v[92:93] op_sel_hi:[1,0,1] neg_lo:[0,1,0] neg_hi:[0,1,0]
    v_pk_mul_f32 v[92:93], v[92:93], v[172:173] op_sel:[0,1] op_sel_hi:[1,1]
    v_pk_fma_f32 v[94:95], v[106:107], v[172:173], v[94:95] op_sel_hi:[1,0,1] neg_lo:[0,1,0] neg_hi:[0,1,0]
    v_pk_mul_f32 v[94:95], v[94:95], v[172:173] op_sel:[0,1] op_sel_hi:[1,1]
    s_waitcnt lgkmcnt(0)
    v_cvt_pk_bf16_f32 v188, v92, v93
    v_cvt_pk_bf16_f32 v189, v94, v95
    ds_write_b64 v182, v[188:189] offset:25600
    v_pk_fma_f32 v[96:97], v[108:109], v[172:173], v[96:97] op_sel_hi:[1,0,1] neg_lo:[0,1,0] neg_hi:[0,1,0]
    v_pk_mul_f32 v[96:97], v[96:97], v[172:173] op_sel:[0,1] op_sel_hi:[1,1]
    v_pk_fma_f32 v[98:99], v[110:111], v[172:173], v[98:99] op_sel_hi:[1,0,1] neg_lo:[0,1,0] neg_hi:[0,1,0]
    v_pk_mul_f32 v[98:99], v[98:99], v[172:173] op_sel:[0,1] op_sel_hi:[1,1]
    s_waitcnt lgkmcnt(0)
    v_cvt_pk_bf16_f32 v190, v96, v97
    v_cvt_pk_bf16_f32 v191, v98, v99
    ds_write_b64 v183, v[190:191] offset:25600
    s_waitcnt lgkmcnt(0)
    s_barrier
    s_lshl_b32 s37, s86, 4
    s_add_u32 s37, s37, 16
    v_add_u32 v5, s37, v2
    v_mul_u32_u24 v8, 400, v5
    v_lshl_add_u32 v8, v3, 4, v8
    v_subrev_u32 v9, 6400, v8
    v_lshrrev_b32 v5, 2, v2
    v_lshl_add_u32 v5, v3, 3, v5
    s_lshl_b32 s37, s86, 4
    v_add_u32 v5, s37, v5
    v_mul_u32_u24 v10, 400, v5
    v_and_b32 v5, 3, v2
    v_lshl_add_u32 v10, v5, 3, v10
    v_lshlrev_b32 v5, 2, v3
    v_sub_u32 v11, v2, v5
    v_add_u32 v11, 16, v11
    s_lshl_b32 s37, s87, 6
    s_lshl_b32 s38, s86, 4
    s_add_u32 s37, s37, s38
    s_sub_u32 s37, s37, 16
    v_lshl_add_u32 v12, v3, 2, s37
    v_and_b32 v5, 1, v3
    v_lshl_add_u32 v13, v5, 5, v2
    v_lshlrev_b32 v13, 2, v13
    v_add_u32 v14, 64, v13
    s_lshl_b32 s37, s86, 4
    v_add_u32 v5, s37, v2
    v_mul_u32_u24 v15, 112, v5
    v_lshl_add_u32 v15, v3, 3, v15
    v_add_u32 v15, 40960, v15
    v_mov_b32 v16, 3463342888
    s_mov_b32 s39, 1049335798
    ds_read_b128 v[20:23], v8 offset:0
    ds_read_b128 v[24:27], v9 offset:128
    ds_read_b128 v[28:31], v8 offset:128
    ds_read_b64_tr_b16 v[40:41], v10 offset:256
    ds_read_b64_tr_b16 v[42:43], v10 offset:1856
    ds_read_b64_tr_b16 v[44:45], v10 offset:288
    ds_read_b64_tr_b16 v[46:47], v10 offset:1888
    v_mov_b32 v32, 0
    v_mov_b32 v64, 0
    v_mov_b32 v33, 0
    v_mov_b32 v65, 0
    v_mov_b32 v34, 0
    v_mov_b32 v66, 0
    v_mov_b32 v35, 0
    v_mov_b32 v67, 0
    v_mov_b32 v36, 0
    v_mov_b32 v68, 0
    v_mov_b32 v37, 0
    v_mov_b32 v69, 0
    v_mov_b32 v38, 0
    v_mov_b32 v70, 0
    v_mov_b32 v39, 0
    v_mov_b32 v71, 0
    s_waitcnt lgkmcnt(4)
    v_mfma_f32_16x16x32_bf16 v[32:35], v[24:27], v[20:23], v[32:35]
    v_mfma_f32_16x16x32_bf16 v[36:39], v[28:31], v[20:23], v[36:39]
    s_nop 7
    s_nop 1
    v_mul_f32 v32, s39, v32
    v_subrev_u32 v5, 0, v11
    v_and_b32 v5, 0xfffffff1, v5
    v_add_u32 v6, 0, v12
    v_ashrrev_i32 v6, 31, v6
    v_or_b32 v5, v5, v6
    v_cmp_eq_u32 vcc, 0, v5
    s_nop 1
    v_cndmask_b32 v32, v16, v32, vcc
    v_mul_f32 v33, s39, v33
    v_subrev_u32 v5, 1, v11
    v_and_b32 v5, 0xfffffff1, v5
    v_add_u32 v6, 1, v12
    v_ashrrev_i32 v6, 31, v6
    v_or_b32 v5, v5, v6
    v_cmp_eq_u32 vcc, 0, v5
    s_nop 1
    v_cndmask_b32 v33, v16, v33, vcc
    v_mul_f32 v34, s39, v34
    v_subrev_u32 v5, 2, v11
    v_and_b32 v5, 0xfffffff1, v5
    v_add_u32 v6, 2, v12
    v_ashrrev_i32 v6, 31, v6
    v_or_b32 v5, v5, v6
    v_cmp_eq_u32 vcc, 0, v5
    s_nop 1
    v_cndmask_b32 v34, v16, v34, vcc
    v_mul_f32 v35, s39, v35
    v_subrev_u32 v5, 3, v11
    v_and_b32 v5, 0xfffffff1, v5
    v_add_u32 v6, 3, v12
    v_ashrrev_i32 v6, 31, v6
    v_or_b32 v5, v5, v6
    v_cmp_eq_u32 vcc, 0, v5
    s_nop 1
    v_cndmask_b32 v35, v16, v35, vcc
    v_mul_f32 v36, s39, v36
    v_subrev_u32 v5, 16, v11
    v_and_b32 v5, 0xfffffff1, v5
    v_add_u32 v6, 16, v12
    v_ashrrev_i32 v6, 31, v6
    v_or_b32 v5, v5, v6
    v_cmp_eq_u32 vcc, 0, v5
    s_nop 1
    v_cndmask_b32 v36, v16, v36, vcc
    v_mul_f32 v37, s39, v37
    v_subrev_u32 v5, 17, v11
    v_and_b32 v5, 0xfffffff1, v5
    v_add_u32 v6, 17, v12
    v_ashrrev_i32 v6, 31, v6
    v_or_b32 v5, v5, v6
    v_cmp_eq_u32 vcc, 0, v5
    s_nop 1
    v_cndmask_b32 v37, v16, v37, vcc
    v_mul_f32 v38, s39, v38
    v_subrev_u32 v5, 18, v11
    v_and_b32 v5, 0xfffffff1, v5
    v_add_u32 v6, 18, v12
    v_ashrrev_i32 v6, 31, v6
    v_or_b32 v5, v5, v6
    v_cmp_eq_u32 vcc, 0, v5
    s_nop 1
    v_cndmask_b32 v38, v16, v38, vcc
    v_mul_f32 v39, s39, v39
    v_subrev_u32 v5, 19, v11
    v_and_b32 v5, 0xfffffff1, v5
    v_add_u32 v6, 19, v12
    v_ashrrev_i32 v6, 31, v6
    v_or_b32 v5, v5, v6
    v_cmp_eq_u32 vcc, 0, v5
    s_nop 1
    v_cndmask_b32 v39, v16, v39, vcc
    v_max3_f32 v72, v32, v33, v34
    v_max3_f32 v72, v35, v36, v72
    v_max3_f32 v72, v37, v38, v72
    v_max_f32 v72, v39, v72
    v_mov_b32 v5, v72
    s_nop 1
    v_permlane16_swap_b32 v72, v5
    v_max_f32 v72, v72, v5
    v_mov_b32 v5, v72
    s_nop 1
    v_permlane32_swap_b32 v72, v5
    v_max_f32 v72, v72, v5
    v_sub_f32 v32, v32, v72
    v_exp_f32 v32, v32
    v_sub_f32 v33, v33, v72
    v_exp_f32 v33, v33
    v_sub_f32 v34, v34, v72
    v_exp_f32 v34, v34
    v_sub_f32 v35, v35, v72
    v_exp_f32 v35, v35
    v_sub_f32 v36, v36, v72
    v_exp_f32 v36, v36
    v_sub_f32 v37, v37, v72
    v_exp_f32 v37, v37
    v_sub_f32 v38, v38, v72
    v_exp_f32 v38, v38
    v_sub_f32 v39, v39, v72
    v_exp_f32 v39, v39
    s_nop 0
    v_add_f32 v73, v32, v33
    v_add_f32 v73, v73, v34
    v_add_f32 v73, v73, v35
    v_add_f32 v73, v73, v36
    v_add_f32 v73, v73, v37
    v_add_f32 v73, v73, v38
    v_add_f32 v73, v73, v39
    v_mov_b32 v5, v73
    s_nop 1
    v_permlane16_swap_b32 v73, v5
    v_add_f32 v73, v73, v5
    v_mov_b32 v5, v73
    s_nop 1
    v_permlane32_swap_b32 v73, v5
    v_add_f32 v73, v73, v5
    v_rcp_f32 v73, v73
    s_nop 0
    v_mul_f32 v32, v32, v73
    v_mul_f32 v33, v33, v73
    v_mul_f32 v34, v34, v73
    v_mul_f32 v35, v35, v73
    v_mul_f32 v36, v36, v73
    v_mul_f32 v37, v37, v73
    v_mul_f32 v38, v38, v73
    v_mul_f32 v39, v39, v73
    v_cvt_pk_bf16_f32 v48, v32, v33
    v_cvt_pk_bf16_f32 v49, v34, v35
    v_cvt_pk_bf16_f32 v50, v36, v37
    v_cvt_pk_bf16_f32 v51, v38, v39
    ds_bpermute_b32 v52, v13, v48
    ds_bpermute_b32 v56, v14, v48
    ds_bpermute_b32 v53, v13, v49
    ds_bpermute_b32 v57, v14, v49
    ds_bpermute_b32 v54, v13, v50
    ds_bpermute_b32 v58, v14, v50
    ds_bpermute_b32 v55, v13, v51
    ds_bpermute_b32 v59, v14, v51
    v_cmp_le_u32 vcc, 2, v3
    s_waitcnt lgkmcnt(0)
    v_cndmask_b32 v60, v52, v54, vcc
    v_cndmask_b32 v61, v53, v55, vcc
    v_cndmask_b32 v62, v56, v58, vcc
    v_cndmask_b32 v63, v57, v59, vcc
    s_nop 1
    v_mfma_f32_16x16x32_bf16 v[64:67], v[40:43], v[60:63], v[64:67]
    v_mfma_f32_16x16x32_bf16 v[68:71], v[44:47], v[60:63], v[68:71]
    s_nop 7
    s_nop 1
    v_cvt_pk_bf16_f32 v74, v64, v65
    v_cvt_pk_bf16_f32 v75, v66, v67
    ds_write_b64 v15, v[74:75] offset:0
    s_waitcnt lgkmcnt(0)
    v_cvt_pk_bf16_f32 v74, v68, v69
    v_cvt_pk_bf16_f32 v75, v70, v71
    s_mov_b32 exec_hi, 0x0000ffff
    ds_write_b64 v15, v[74:75] offset:32
    s_mov_b64 exec, -1
    s_waitcnt lgkmcnt(0)
    ds_read_b128 v[20:23], v8 offset:64
    ds_read_b128 v[24:27], v9 offset:192
    ds_read_b128 v[28:31], v8 offset:192
    ds_read_b64_tr_b16 v[40:41], v10 offset:320
    ds_read_b64_tr_b16 v[42:43], v10 offset:1920
    ds_read_b64_tr_b16 v[44:45], v10 offset:352
    ds_read_b64_tr_b16 v[46:47], v10 offset:1952
    v_mov_b32 v32, 0
    v_mov_b32 v64, 0
    v_mov_b32 v33, 0
    v_mov_b32 v65, 0
    v_mov_b32 v34, 0
    v_mov_b32 v66, 0
    v_mov_b32 v35, 0
    v_mov_b32 v67, 0
    v_mov_b32 v36, 0
    v_mov_b32 v68, 0
    v_mov_b32 v37, 0
    v_mov_b32 v69, 0
    v_mov_b32 v38, 0
    v_mov_b32 v70, 0
    v_mov_b32 v39, 0
    v_mov_b32 v71, 0
    s_waitcnt lgkmcnt(4)
    v_mfma_f32_16x16x32_bf16 v[32:35], v[24:27], v[20:23], v[32:35]
    v_mfma_f32_16x16x32_bf16 v[36:39], v[28:31], v[20:23], v[36:39]
    s_nop 7
    s_nop 1
    v_mul_f32 v32, s39, v32
    v_subrev_u32 v5, 0, v11
    v_and_b32 v5, 0xfffffff1, v5
    v_add_u32 v6, 0, v12
    v_ashrrev_i32 v6, 31, v6
    v_or_b32 v5, v5, v6
    v_cmp_eq_u32 vcc, 0, v5
    s_nop 1
    v_cndmask_b32 v32, v16, v32, vcc
    v_mul_f32 v33, s39, v33
    v_subrev_u32 v5, 1, v11
    v_and_b32 v5, 0xfffffff1, v5
    v_add_u32 v6, 1, v12
    v_ashrrev_i32 v6, 31, v6
    v_or_b32 v5, v5, v6
    v_cmp_eq_u32 vcc, 0, v5
    s_nop 1
    v_cndmask_b32 v33, v16, v33, vcc
    v_mul_f32 v34, s39, v34
    v_subrev_u32 v5, 2, v11
    v_and_b32 v5, 0xfffffff1, v5
    v_add_u32 v6, 2, v12
    v_ashrrev_i32 v6, 31, v6
    v_or_b32 v5, v5, v6
    v_cmp_eq_u32 vcc, 0, v5
    s_nop 1
    v_cndmask_b32 v34, v16, v34, vcc
    v_mul_f32 v35, s39, v35
    v_subrev_u32 v5, 3, v11
    v_and_b32 v5, 0xfffffff1, v5
    v_add_u32 v6, 3, v12
    v_ashrrev_i32 v6, 31, v6
    v_or_b32 v5, v5, v6
    v_cmp_eq_u32 vcc, 0, v5
    s_nop 1
    v_cndmask_b32 v35, v16, v35, vcc
    v_mul_f32 v36, s39, v36
    v_subrev_u32 v5, 16, v11
    v_and_b32 v5, 0xfffffff1, v5
    v_add_u32 v6, 16, v12
    v_ashrrev_i32 v6, 31, v6
    v_or_b32 v5, v5, v6
    v_cmp_eq_u32 vcc, 0, v5
    s_nop 1
    v_cndmask_b32 v36, v16, v36, vcc
    v_mul_f32 v37, s39, v37
    v_subrev_u32 v5, 17, v11
    v_and_b32 v5, 0xfffffff1, v5
    v_add_u32 v6, 17, v12
    v_ashrrev_i32 v6, 31, v6
    v_or_b32 v5, v5, v6
    v_cmp_eq_u32 vcc, 0, v5
    s_nop 1
    v_cndmask_b32 v37, v16, v37, vcc
    v_mul_f32 v38, s39, v38
    v_subrev_u32 v5, 18, v11
    v_and_b32 v5, 0xfffffff1, v5
    v_add_u32 v6, 18, v12
    v_ashrrev_i32 v6, 31, v6
    v_or_b32 v5, v5, v6
    v_cmp_eq_u32 vcc, 0, v5
    s_nop 1
    v_cndmask_b32 v38, v16, v38, vcc
    v_mul_f32 v39, s39, v39
    v_subrev_u32 v5, 19, v11
    v_and_b32 v5, 0xfffffff1, v5
    v_add_u32 v6, 19, v12
    v_ashrrev_i32 v6, 31, v6
    v_or_b32 v5, v5, v6
    v_cmp_eq_u32 vcc, 0, v5
    s_nop 1
    v_cndmask_b32 v39, v16, v39, vcc
    v_max3_f32 v72, v32, v33, v34
    v_max3_f32 v72, v35, v36, v72
    v_max3_f32 v72, v37, v38, v72
    v_max_f32 v72, v39, v72
    v_mov_b32 v5, v72
    s_nop 1
    v_permlane16_swap_b32 v72, v5
    v_max_f32 v72, v72, v5
    v_mov_b32 v5, v72
    s_nop 1
    v_permlane32_swap_b32 v72, v5
    v_max_f32 v72, v72, v5
    v_sub_f32 v32, v32, v72
    v_exp_f32 v32, v32
    v_sub_f32 v33, v33, v72
    v_exp_f32 v33, v33
    v_sub_f32 v34, v34, v72
    v_exp_f32 v34, v34
    v_sub_f32 v35, v35, v72
    v_exp_f32 v35, v35
    v_sub_f32 v36, v36, v72
    v_exp_f32 v36, v36
    v_sub_f32 v37, v37, v72
    v_exp_f32 v37, v37
    v_sub_f32 v38, v38, v72
    v_exp_f32 v38, v38
    v_sub_f32 v39, v39, v72
    v_exp_f32 v39, v39
    s_nop 0
    v_add_f32 v73, v32, v33
    v_add_f32 v73, v73, v34
    v_add_f32 v73, v73, v35
    v_add_f32 v73, v73, v36
    v_add_f32 v73, v73, v37
    v_add_f32 v73, v73, v38
    v_add_f32 v73, v73, v39
    v_mov_b32 v5, v73
    s_nop 1
    v_permlane16_swap_b32 v73, v5
    v_add_f32 v73, v73, v5
    v_mov_b32 v5, v73
    s_nop 1
    v_permlane32_swap_b32 v73, v5
    v_add_f32 v73, v73, v5
    v_rcp_f32 v73, v73
    s_nop 0
    v_mul_f32 v32, v32, v73
    v_mul_f32 v33, v33, v73
    v_mul_f32 v34, v34, v73
    v_mul_f32 v35, v35, v73
    v_mul_f32 v36, v36, v73
    v_mul_f32 v37, v37, v73
    v_mul_f32 v38, v38, v73
    v_mul_f32 v39, v39, v73
    v_cvt_pk_bf16_f32 v48, v32, v33
    v_cvt_pk_bf16_f32 v49, v34, v35
    v_cvt_pk_bf16_f32 v50, v36, v37
    v_cvt_pk_bf16_f32 v51, v38, v39
    ds_bpermute_b32 v52, v13, v48
    ds_bpermute_b32 v56, v14, v48
    ds_bpermute_b32 v53, v13, v49
    ds_bpermute_b32 v57, v14, v49
    ds_bpermute_b32 v54, v13, v50
    ds_bpermute_b32 v58, v14, v50
    ds_bpermute_b32 v55, v13, v51
    ds_bpermute_b32 v59, v14, v51
    v_cmp_le_u32 vcc, 2, v3
    s_waitcnt lgkmcnt(0)
    v_cndmask_b32 v60, v52, v54, vcc
    v_cndmask_b32 v61, v53, v55, vcc
    v_cndmask_b32 v62, v56, v58, vcc
    v_cndmask_b32 v63, v57, v59, vcc
    s_nop 1
    v_mfma_f32_16x16x32_bf16 v[64:67], v[40:43], v[60:63], v[64:67]
    v_mfma_f32_16x16x32_bf16 v[68:71], v[44:47], v[60:63], v[68:71]
    s_nop 7
    s_nop 1
    v_cvt_pk_bf16_f32 v74, v64, v65
    v_cvt_pk_bf16_f32 v75, v66, v67
    ds_write_b64 v15, v[74:75] offset:56
    s_waitcnt lgkmcnt(0)
    v_cvt_pk_bf16_f32 v74, v68, v69
    v_cvt_pk_bf16_f32 v75, v70, v71
    s_mov_b32 exec_hi, 0x0000ffff
    ds_write_b64 v15, v[74:75] offset:88
    s_mov_b64 exec, -1
    s_waitcnt lgkmcnt(0)
    s_barrier
    s_add_u32 s16, s84, 1048576
    s_addc_u32 s17, s85, 0
    s_mov_b32 s18, 1835008
    s_mov_b32 s19, 0x00020000
    v_mul_u32_u24 v76, 37, v1
    v_lshrrev_b32 v76, 8, v76
    v_mul_u32_u24 v5, 7, v76
    v_sub_u32 v77, v1, v5
    s_lshl_b32 s37, s86, 4
    v_add_u32 v76, s37, v76
    v_mul_u32_u24 v78, 112, v76
    v_lshl_add_u32 v78, v77, 4, v78
    v_add_u32 v78, 40960, v78
    s_lshl_b32 s37, s87, 6
    v_add_u32 v79, s37, v76
    v_mul_u32_u24 v79, 896, v79
    v_lshl_add_u32 v79, v77, 4, v79
    s_mul_i32 s37, s88, 112
    v_add_u32 v79, s37, v79
    s_mov_b32 exec_hi, 0x00ffffff
    ds_read_b128 v[80:83], v78 offset:0
    s_waitcnt lgkmcnt(0)
    s_mov_b32 s37, 0
    s_cmp_eq_u32 s91, 1
    s_cbranch_scc1 Ls3_p
    buffer_store_dwordx4 v[80:83], v79, s[16:19], s37 offen sc1
    s_branch Ls3_d
Ls3_p:
    buffer_store_dwordx4 v[80:83], v79, s[16:19], s37 offen
Ls3_d:
    s_nop 1
    ds_read_b128 v[80:83], v78 offset:896
    s_waitcnt lgkmcnt(0)
    s_mov_b32 s37, 7168
    s_cmp_eq_u32 s91, 1
    s_cbranch_scc1 Ls4_p
    buffer_store_dwordx4 v[80:83], v79, s[16:19], s37 offen sc1
    s_branch Ls4_d
Ls4_p:
    buffer_store_dwordx4 v[80:83], v79, s[16:19], s37 offen
Ls4_d:
    s_nop 1
    s_mov_b64 exec, -1
    s_waitcnt vmcnt(0)
    s_lshl_b32 s32, s89, 7
    s_lshl_b32 s33, s86, 2
    s_add_u32 s32, s32, s33
    v_mov_b32 v84, s32
    v_mov_b32 v85, 2
    s_mov_b64 exec, 1
    s_mov_b32 s57, s91
    s_cmp_eq_u32 s57, 1
    s_cbranch_scc1 Ls5_p
    buffer_store_dword v85, v84, s[24:27], 0 offen sc1
    s_branch Ls5_d
Ls5_p:
    buffer_store_dword v85, v84, s[24:27], 0 offen
Ls5_d:
    s_mov_b64 exec, -1
    s_barrier
    s_add_u32 s8, s84, 1048576
    s_addc_u32 s9, s85, 0
    s_mov_b32 s10, 1835008
    s_mov_b32 s11, 0x00020000
    s_mov_b32 s12, s68
    s_mov_b32 s13, s69
    s_mov_b32 s14, 401408
    s_mov_b32 s15, 0x00020000
    s_lshl_b32 s32, s86, 10
    s_and_b32 s40, s86, 1
    s_add_u32 s33, s40, 8
    s_mul_i32 s34, s86, 7168
    s_mul_i32 s35, s86, 7168
    s_mul_i32 s36, s88, 112
    v_lshrrev_b32 v5, 3, v1
    v_lshrrev_b32 v7, 4, v1
    s_lshl_b32 s37, s40, 2
    v_add_u32 v7, s37, v7
    v_and_b32 v6, 7, v1
    v_xor_b32 v6, v6, v7
    s_lshl_b32 s37, s87, 6
    s_lshl_b32 s38, s86, 3
    s_add_u32 s38, s38, 0
    s_add_u32 s38, s38, s37
    v_add_u32 v7, s38, v5
    s_mov_b32 s39, 896
    v_mul_lo_u32 v7, v7, s39
    v_lshl_add_u32 v9, v6, 4, v7
    s_lshl_b32 s38, s86, 3
    s_add_u32 s38, s38, 32
    s_add_u32 s38, s38, s37
    v_add_u32 v7, s38, v5
    s_mov_b32 s39, 896
    v_mul_lo_u32 v7, v7, s39
    v_lshl_add_u32 v10, v6, 4, v7
    v_bfe_u32 v7, v1, 4, 1
    v_lshlrev_b32 v7, 1, v7
    s_lshl_b32 s37, s40, 2
    v_add_u32 v7, s37, v7
    v_and_b32 v8, 7, v1
    v_xor_b32 v8, v8, v7
    s_mov_b32 s39, 896
    v_mul_lo_u32 v7, v5, s39
    v_lshl_add_u32 v11, v8, 4, v7
    s_add_u32 s42, s36, 0
    s_cmp_lg_u32 s86, 0
    s_cbranch_scc1 Lp6_skip
    v_lshrrev_b32 v13, 3, v1
    v_add_u32 v13, s87, v13
    v_add_u32 v13, 0, v13
    v_mov_b32 v14, s87
    v_cmp_gt_u32 vcc, 32, v13
    s_nop 1
    v_cndmask_b32 v13, v14, v13, vcc
    v_and_b32 v12, 7, v1
    v_lshlrev_b32 v12, 5, v12
    v_and_b32 v14, 3, v13
    v_lshl_add_u32 v12, v14, 3, v12
    v_lshrrev_b32 v14, 2, v13
    v_add_u32 v12, v12, v14
    v_lshlrev_b32 v12, 7, v12
    v_add_u32 v12, 0, v12
    v_mov_b32 v20, 0
    s_mov_b32 s52, 0
    s_mov_b32 s53, 2
    s_mov_b32 exec_lo, 255
    s_mov_b32 exec_hi, 0
Lp6_loop:
    buffer_load_dwordx4 v[16:19], v12, s[24:27], 0 offen sc1
    s_waitcnt vmcnt(0)
    v_min_u32 v16, v16, v17
    v_min_u32 v18, v18, v19
    v_min_u32 v16, v16, v18
    v_cmp_gt_u32 vcc, s53, v16
    s_cbranch_vccz Lp6_ok
Lp6_again:
    s_add_u32 s52, s52, 1
    s_cmp_lt_u32 s52, 20000
    s_cbranch_scc1 Lp6_loop
Lp6_ok:
    s_mov_b64 exec, -1
Lp6_skip:
    s_barrier
    s_add_u32 m0, s32, 0
    s_nop 0
    s_mov_b32 s37, 0
    buffer_load_dwordx4 v9, s[8:11], s37 offen lds
    s_add_u32 m0, s32, 4096
    s_nop 0
    s_mov_b32 s37, 0
    buffer_load_dwordx4 v10, s[8:11], s37 offen lds
    s_add_u32 m0, s32, 8192
    s_nop 0
    s_mov_b32 s37, 128
    buffer_load_dwordx4 v9, s[8:11], s37 offen lds
    s_add_u32 m0, s32, 12288
    s_nop 0
    s_mov_b32 s37, 128
    buffer_load_dwordx4 v10, s[8:11], s37 offen lds
    s_add_u32 m0, s32, 16384
    s_nop 0
    s_mov_b32 s37, 256
    buffer_load_dwordx4 v9, s[8:11], s37 offen lds
    s_add_u32 m0, s32, 20480
    s_nop 0
    s_mov_b32 s37, 256
    buffer_load_dwordx4 v10, s[8:11], s37 offen lds
    s_add_u32 m0, s32, 24576
    s_nop 0
    s_mov_b32 s37, 384
    buffer_load_dwordx4 v9, s[8:11], s37 offen lds
    s_add_u32 m0, s32, 28672
    s_nop 0
    s_mov_b32 s37, 384
    buffer_load_dwordx4 v10, s[8:11], s37 offen lds
    s_add_u32 m0, s32, 32768
    s_nop 0
    s_mov_b32 s37, 512
    buffer_load_dwordx4 v9, s[8:11], s37 offen lds
    s_add_u32 m0, s32, 36864
    s_nop 0
    s_mov_b32 s37, 512
    buffer_load_dwordx4 v10, s[8:11], s37 offen lds
    s_add_u32 m0, s32, 40960
    s_nop 0
    s_mov_b32 s37, 640
    buffer_load_dwordx4 v9, s[8:11], s37 offen lds
    s_add_u32 m0, s32, 45056
    s_nop 0
    s_mov_b32 s37, 640
    buffer_load_dwordx4 v10, s[8:11], s37 offen lds
    s_add_u32 m0, s32, 49152
    s_nop 0
    s_mov_b32 s37, 768
    buffer_load_dwordx4 v9, s[8:11], s37 offen lds
    s_add_u32 m0, s32, 53248
    s_nop 0
    s_mov_b32 s37, 768
    buffer_load_dwordx4 v10, s[8:11], s37 offen lds
    s_lshl_b32 s37, s87, 6
    s_lshr_b32 s38, s86, 1
    s_mul_i32 s38, s38, 32
    s_add_u32 s37, s37, s38
    v_add_u32 v13, s37, v2
    s_mov_b32 s38, 896
    v_mul_lo_u32 v13, v13, s38
    v_lshl_add_u32 v12, v3, 3, v13
    s_and_b32 s37, s86, 1
    s_lshl_b32 s37, s37, 6
    s_mul_i32 s38, s88, 112
    s_add_u32 s37, s37, s38
    v_add_u32 v12, s37, v12
    s_mov_b32 s20, s64
    s_mov_b32 s21, s65
    s_mov_b32 s22, 1835008
    s_mov_b32 s23, 0x00020000
    s_mov_b32 s37, 0
    buffer_load_dwordx2 v[14:15], v12, s[20:23], s37 offen offset:0
    buffer_load_dwordx2 v[16:17], v12, s[20:23], s37 offen offset:32
    s_mov_b32 s37, 14336
    buffer_load_dwordx2 v[18:19], v12, s[20:23], s37 offen offset:0
    buffer_load_dwordx2 v[20:21], v12, s[20:23], s37 offen offset:32
    v_lshrrev_b32 v7, 1, v2
    v_and_b32 v7, 7, v7
    v_add_u32 v8, 0, v3
    v_xor_b32 v8, v8, v7
    v_lshlrev_b32 v8, 4, v8
    v_lshl_add_u32 v22, v2, 7, v8
    v_add_u32 v8, 4, v3
    v_xor_b32 v8, v8, v7
    v_lshlrev_b32 v8, 4, v8
    v_lshl_add_u32 v23, v2, 7, v8
    s_lshr_b32 s37, s86, 1
    s_mul_i32 s37, s37, 4096
    v_add_u32 v22, s37, v22
    v_add_u32 v23, s37, v23
    v_lshrrev_b32 v26, 2, v2
    v_lshl_add_u32 v26, v3, 3, v26
    v_lshlrev_b32 v26, 7, v26
    v_bfe_u32 v27, v2, 3, 1
    v_lshlrev_b32 v27, 2, v27
    v_and_b32 v7, 1, v3
    v_lshl_add_u32 v27, v7, 3, v27
    v_and_b32 v28, 3, v2
    s_and_b32 s37, s86, 1
    s_mul_i32 s37, s37, 2
    s_add_u32 s38, s37, 0
    s_and_b32 s39, s38, 3
    s_lshl_b32 s39, s39, 2
    v_add_u32 v7, s39, v28
    v_xor_b32 v7, v7, v27
    v_lshl_add_u32 v7, v7, 3, v26
    s_lshr_b32 s38, s38, 2
    s_lshl_b32 s38, s38, 13
    v_add_u32 v24, s38, v7
    s_add_u32 s38, s37, 1
    s_and_b32 s39, s38, 3
    s_lshl_b32 s39, s39, 2
    v_add_u32 v7, s39, v28
    v_xor_b32 v7, v7, v27
    v_lshl_add_u32 v7, v7, 3, v26
    s_lshr_b32 s38, s38, 2
    s_lshl_b32 s38, s38, 13
    v_add_u32 v25, s38, v7
    v_add_u32 v29, 65536, v22
    v_add_u32 v30, 65536, v23
    v_add_u32 v31, 65536, v24
    v_add_u32 v32, 65536, v25
    v_mov_b32 v36, 0
    v_mov_b32 v37, 0
    v_mov_b32 v38, 0
    v_mov_b32 v39, 0
    v_mov_b32 v40, 0
    v_mov_b32 v41, 0
    v_mov_b32 v42, 0
    v_mov_b32 v43, 0
    v_mov_b32 v44, 0
    v_mov_b32 v45, 0
    v_mov_b32 v46, 0
    v_mov_b32 v47, 0
    v_mov_b32 v48, 0
    v_mov_b32 v49, 0
    v_mov_b32 v50, 0
    v_mov_b32 v51, 0
    s_waitcnt vmcnt(14)
    s_barrier
    ds_read_b128 v[52:55], v22 offset:0
    ds_read_b128 v[56:59], v22 offset:2048
    ds_read_b64_tr_b16 v[68:69], v24 offset:57344
    ds_read_b64_tr_b16 v[70:71], v24 offset:57856
    ds_read_b64_tr_b16 v[72:73], v25 offset:57344
    ds_read_b64_tr_b16 v[74:75], v25 offset:57856
    s_waitcnt lgkmcnt(0)
    v_mfma_f32_16x16x32_bf16 v[36:39], v[68:71], v[52:55], v[36:39]
    ds_read_b128 v[60:63], v23 offset:0
    ds_read_b128 v[64:67], v23 offset:2048
    ds_read_b64_tr_b16 v[76:77], v24 offset:61440
    v_mfma_f32_16x16x32_bf16 v[44:47], v[68:71], v[56:59], v[44:47]
    ds_read_b64_tr_b16 v[78:79], v24 offset:61952
    ds_read_b64_tr_b16 v[80:81], v25 offset:61440
    ds_read_b64_tr_b16 v[82:83], v25 offset:61952
    v_mfma_f32_16x16x32_bf16 v[40:43], v[72:75], v[52:55], v[40:43]
    v_mfma_f32_16x16x32_bf16 v[48:51], v[72:75], v[56:59], v[48:51]
    s_waitcnt lgkmcnt(0)
    v_mfma_f32_16x16x32_bf16 v[36:39], v[76:79], v[60:63], v[36:39]
    ds_read_b128 v[52:55], v22 offset:8192
    ds_read_b128 v[56:59], v22 offset:10240
    ds_read_b64_tr_b16 v[68:69], v31 offset:0
    v_mfma_f32_16x16x32_bf16 v[44:47], v[76:79], v[64:67], v[44:47]
    ds_read_b64_tr_b16 v[70:71], v31 offset:512
    ds_read_b64_tr_b16 v[72:73], v32 offset:0
    ds_read_b64_tr_b16 v[74:75], v32 offset:512
    v_mfma_f32_16x16x32_bf16 v[40:43], v[80:83], v[60:63], v[40:43]
    v_mfma_f32_16x16x32_bf16 v[48:51], v[80:83], v[64:67], v[48:51]
    s_waitcnt lgkmcnt(0)
    v_mfma_f32_16x16x32_bf16 v[36:39], v[68:71], v[52:55], v[36:39]
    ds_read_b128 v[60:63], v23 offset:8192
    ds_read_b128 v[64:67], v23 offset:10240
    ds_read_b64_tr_b16 v[76:77], v31 offset:4096
    v_mfma_f32_16x16x32_bf16 v[44:47], v[68:71], v[56:59], v[44:47]
    ds_read_b64_tr_b16 v[78:79], v31 offset:4608
    ds_read_b64_tr_b16 v[80:81], v32 offset:4096
    ds_read_b64_tr_b16 v[82:83], v32 offset:4608
    v_mfma_f32_16x16x32_bf16 v[40:43], v[72:75], v[52:55], v[40:43]
    v_mfma_f32_16x16x32_bf16 v[48:51], v[72:75], v[56:59], v[48:51]
    s_waitcnt lgkmcnt(0)
    s_waitcnt vmcnt(8)
    s_barrier
    v_mfma_f32_16x16x32_bf16 v[36:39], v[76:79], v[60:63], v[36:39]
    ds_read_b128 v[52:55], v22 offset:16384
    ds_read_b128 v[56:59], v22 offset:18432
    ds_read_b64_tr_b16 v[68:69], v31 offset:8192
    v_mfma_f32_16x16x32_bf16 v[44:47], v[76:79], v[64:67], v[44:47]
    ds_read_b64_tr_b16 v[70:71], v31 offset:8704
    ds_read_b64_tr_b16 v[72:73], v32 offset:8192
    ds_read_b64_tr_b16 v[74:75], v32 offset:8704
    v_mfma_f32_16x16x32_bf16 v[40:43], v[80:83], v[60:63], v[40:43]
    v_mfma_f32_16x16x32_bf16 v[48:51], v[80:83], v[64:67], v[48:51]
    s_waitcnt lgkmcnt(0)
    v_mfma_f32_16x16x32_bf16 v[36:39], v[68:71], v[52:55], v[36:39]
    ds_read_b128 v[60:63], v23 offset:16384
    ds_read_b128 v[64:67], v23 offset:18432
    ds_read_b64_tr_b16 v[76:77], v31 offset:12288
    v_mfma_f32_16x16x32_bf16 v[44:47], v[68:71], v[56:59], v[44:47]
    ds_read_b64_tr_b16 v[78:79], v31 offset:12800
    ds_read_b64_tr_b16 v[80:81], v32 offset:12288
    ds_read_b64_tr_b16 v[82:83], v32 offset:12800
    v_mfma_f32_16x16x32_bf16 v[40:43], v[72:75], v[52:55], v[40:43]
    v_mfma_f32_16x16x32_bf16 v[48:51], v[72:75], v[56:59], v[48:51]
    s_waitcnt lgkmcnt(0)
    v_mfma_f32_16x16x32_bf16 v[36:39], v[76:79], v[60:63], v[36:39]
    ds_read_b128 v[52:55], v22 offset:24576
    ds_read_b128 v[56:59], v22 offset:26624
    ds_read_b64_tr_b16 v[68:69], v31 offset:16384
    v_mfma_f32_16x16x32_bf16 v[44:47], v[76:79], v[64:67], v[44:47]
    ds_read_b64_tr_b16 v[70:71], v31 offset:16896
    ds_read_b64_tr_b16 v[72:73], v32 offset:16384
    ds_read_b64_tr_b16 v[74:75], v32 offset:16896
    v_mfma_f32_16x16x32_bf16 v[40:43], v[80:83], v[60:63], v[40:43]
    v_mfma_f32_16x16x32_bf16 v[48:51], v[80:83], v[64:67], v[48:51]
    s_waitcnt lgkmcnt(0)
    v_mfma_f32_16x16x32_bf16 v[36:39], v[68:71], v[52:55], v[36:39]
    ds_read_b128 v[60:63], v23 offset:24576
    ds_read_b128 v[64:67], v23 offset:26624
    ds_read_b64_tr_b16 v[76:77], v31 offset:20480
    v_mfma_f32_16x16x32_bf16 v[44:47], v[68:71], v[56:59], v[44:47]
    ds_read_b64_tr_b16 v[78:79], v31 offset:20992
    ds_read_b64_tr_b16 v[80:81], v32 offset:20480
    ds_read_b64_tr_b16 v[82:83], v32 offset:20992
    v_mfma_f32_16x16x32_bf16 v[40:43], v[72:75], v[52:55], v[40:43]
    v_mfma_f32_16x16x32_bf16 v[48:51], v[72:75], v[56:59], v[48:51]
    s_waitcnt lgkmcnt(0)
    v_mfma_f32_16x16x32_bf16 v[36:39], v[76:79], v[60:63], v[36:39]
    ds_read_b128 v[52:55], v22 offset:32768
    ds_read_b128 v[56:59], v22 offset:34816
    ds_read_b64_tr_b16 v[68:69], v31 offset:24576
    v_mfma_f32_16x16x32_bf16 v[44:47], v[76:79], v[64:67], v[44:47]
    ds_read_b64_tr_b16 v[70:71], v31 offset:25088
    ds_read_b64_tr_b16 v[72:73], v32 offset:24576
    ds_read_b64_tr_b16 v[74:75], v32 offset:25088
    v_mfma_f32_16x16x32_bf16 v[40:43], v[80:83], v[60:63], v[40:43]
    v_mfma_f32_16x16x32_bf16 v[48:51], v[80:83], v[64:67], v[48:51]
    s_waitcnt lgkmcnt(0)
    v_mfma_f32_16x16x32_bf16 v[36:39], v[68:71], v[52:55], v[36:39]
    ds_read_b128 v[60:63], v23 offset:32768
    ds_read_b128 v[64:67], v23 offset:34816
    ds_read_b64_tr_b16 v[76:77], v31 offset:28672
    v_mfma_f32_16x16x32_bf16 v[44:47], v[68:71], v[56:59], v[44:47]
    ds_read_b64_tr_b16 v[78:79], v31 offset:29184
    ds_read_b64_tr_b16 v[80:81], v32 offset:28672
    ds_read_b64_tr_b16 v[82:83], v32 offset:29184
    v_mfma_f32_16x16x32_bf16 v[40:43], v[72:75], v[52:55], v[40:43]
    v_mfma_f32_16x16x32_bf16 v[48:51], v[72:75], v[56:59], v[48:51]
    s_waitcnt lgkmcnt(0)
    s_waitcnt vmcnt(4)
    s_barrier
    v_mfma_f32_16x16x32_bf16 v[36:39], v[76:79], v[60:63], v[36:39]
    ds_read_b128 v[52:55], v22 offset:40960
    ds_read_b128 v[56:59], v22 offset:43008
    ds_read_b64_tr_b16 v[68:69], v31 offset:32768
    v_mfma_f32_16x16x32_bf16 v[44:47], v[76:79], v[64:67], v[44:47]
    ds_read_b64_tr_b16 v[70:71], v31 offset:33280
    ds_read_b64_tr_b16 v[72:73], v32 offset:32768
    ds_read_b64_tr_b16 v[74:75], v32 offset:33280
    v_mfma_f32_16x16x32_bf16 v[40:43], v[80:83], v[60:63], v[40:43]
    v_mfma_f32_16x16x32_bf16 v[48:51], v[80:83], v[64:67], v[48:51]
    s_waitcnt lgkmcnt(0)
    v_mfma_f32_16x16x32_bf16 v[36:39], v[68:71], v[52:55], v[36:39]
    ds_read_b128 v[60:63], v23 offset:40960
    ds_read_b128 v[64:67], v23 offset:43008
    ds_read_b64_tr_b16 v[76:77], v31 offset:36864
    v_mfma_f32_16x16x32_bf16 v[44:47], v[68:71], v[56:59], v[44:47]
    ds_read_b64_tr_b16 v[78:79], v31 offset:37376
    ds_read_b64_tr_b16 v[80:81], v32 offset:36864
    ds_read_b64_tr_b16 v[82:83], v32 offset:37376
    v_mfma_f32_16x16x32_bf16 v[40:43], v[72:75], v[52:55], v[40:43]
    v_mfma_f32_16x16x32_bf16 v[48:51], v[72:75], v[56:59], v[48:51]
    s_waitcnt lgkmcnt(0)
    v_mfma_f32_16x16x32_bf16 v[36:39], v[76:79], v[60:63], v[36:39]
    ds_read_b128 v[52:55], v22 offset:49152
    ds_read_b128 v[56:59], v22 offset:51200
    ds_read_b64_tr_b16 v[68:69], v31 offset:40960
    v_mfma_f32_16x16x32_bf16 v[44:47], v[76:79], v[64:67], v[44:47]
    ds_read_b64_tr_b16 v[70:71], v31 offset:41472
    ds_read_b64_tr_b16 v[72:73], v32 offset:40960
    ds_read_b64_tr_b16 v[74:75], v32 offset:41472
    v_mfma_f32_16x16x32_bf16 v[40:43], v[80:83], v[60:63], v[40:43]
    v_mfma_f32_16x16x32_bf16 v[48:51], v[80:83], v[64:67], v[48:51]
    s_waitcnt lgkmcnt(0)
    v_mfma_f32_16x16x32_bf16 v[36:39], v[68:71], v[52:55], v[36:39]
    ds_read_b128 v[60:63], v23 offset:49152
    ds_read_b128 v[64:67], v23 offset:51200
    ds_read_b64_tr_b16 v[76:77], v31 offset:45056
    v_mfma_f32_16x16x32_bf16 v[44:47], v[68:71], v[56:59], v[44:47]
    ds_read_b64_tr_b16 v[78:79], v31 offset:45568
    ds_read_b64_tr_b16 v[80:81], v32 offset:45056
    ds_read_b64_tr_b16 v[82:83], v32 offset:45568
    v_mfma_f32_16x16x32_bf16 v[40:43], v[72:75], v[52:55], v[40:43]
    v_mfma_f32_16x16x32_bf16 v[48:51], v[72:75], v[56:59], v[48:51]
    s_waitcnt lgkmcnt(0)
    v_mfma_f32_16x16x32_bf16 v[36:39], v[76:79], v[60:63], v[36:39]
    v_mfma_f32_16x16x32_bf16 v[44:47], v[76:79], v[64:67], v[44:47]
    v_mfma_f32_16x16x32_bf16 v[40:43], v[80:83], v[60:63], v[40:43]
    v_mfma_f32_16x16x32_bf16 v[48:51], v[80:83], v[64:67], v[48:51]
    s_nop 7
    s_nop 7
    s_barrier
    s_mov_b32 s54, 1027024659
    s_mov_b32 s55, 3222493025
    s_waitcnt vmcnt(0)
    s_add_u32 s16, s84, 3145728
    s_addc_u32 s17, s85, 0
    s_mov_b32 s18, 1835008
    s_mov_b32 s19, 0x00020000
    s_lshl_b32 s37, s87, 6
    s_lshr_b32 s38, s86, 1
    s_mul_i32 s38, s38, 32
    s_add_u32 s37, s37, s38
    v_add_u32 v52, s37, v2
    s_mov_b32 s38, 896
    v_mul_lo_u32 v60, v52, s38
    v_and_b32 v52, 1, v3
    v_lshl_add_u32 v60, v52, 5, v60
    v_lshrrev_b32 v52, 1, v3
    v_lshl_add_u32 v60, v52, 4, v60
    v_lshlrev_b32 v52, 16, v14
    v_add_f32 v36, v36, v52
    v_and_b32 v52, 0xffff0000, v14
    v_add_f32 v37, v37, v52
    v_lshlrev_b32 v52, 16, v15
    v_add_f32 v38, v38, v52
    v_and_b32 v52, 0xffff0000, v15
    v_add_f32 v39, v39, v52
    v_lshlrev_b32 v52, 16, v16
    v_add_f32 v40, v40, v52
    v_and_b32 v52, 0xffff0000, v16
    v_add_f32 v41, v41, v52
    v_lshlrev_b32 v52, 16, v17
    v_add_f32 v42, v42, v52
    v_and_b32 v52, 0xffff0000, v17
    v_add_f32 v43, v43, v52
    v_cvt_pk_bf16_f32 v64, v36, v37
    v_cvt_pk_bf16_f32 v65, v38, v39
    v_cvt_pk_bf16_f32 v66, v40, v41
    v_cvt_pk_bf16_f32 v67, v42, v43
    s_nop 1
    v_permlane16_swap_b32 v64, v66
    v_permlane16_swap_b32 v65, v67
    s_and_b32 s37, s86, 1
    s_lshl_b32 s37, s37, 6
    s_mul_i32 s38, s88, 112
    s_add_u32 s37, s37, s38
    s_add_u32 s37, s37, 0
    s_and_b32 s38, s86, 1
    s_cmp_eq_u32 s38, 1
    s_cselect_b32 exec_hi, 0xffff, -1
    s_cmp_eq_u32 s91, 1
    s_cbranch_scc1 Ls7_p
    buffer_store_dwordx4 v[64:67], v60, s[16:19], s37 offen sc1
    s_branch Ls7_d
Ls7_p:
    buffer_store_dwordx4 v[64:67], v60, s[16:19], s37 offen
Ls7_d:
    s_mov_b64 exec, -1
    s_nop 1
    v_lshlrev_b32 v52, 16, v18
    v_add_f32 v44, v44, v52
    v_and_b32 v52, 0xffff0000, v18
    v_add_f32 v45, v45, v52
    v_lshlrev_b32 v52, 16, v19
    v_add_f32 v46, v46, v52
    v_and_b32 v52, 0xffff0000, v19
    v_add_f32 v47, v47, v52
    v_lshlrev_b32 v52, 16, v20
    v_add_f32 v48, v48, v52
    v_and_b32 v52, 0xffff0000, v20
    v_add_f32 v49, v49, v52
    v_lshlrev_b32 v52, 16, v21
    v_add_f32 v50, v50, v52
    v_and_b32 v52, 0xffff0000, v21
    v_add_f32 v51, v51, v52
    v_cvt_pk_bf16_f32 v64, v44, v45
    v_cvt_pk_bf16_f32 v65, v46, v47
    v_cvt_pk_bf16_f32 v66, v48, v49
    v_cvt_pk_bf16_f32 v67, v50, v51
    s_nop 1
    v_permlane16_swap_b32 v64, v66
    v_permlane16_swap_b32 v65, v67
    s_and_b32 s37, s86, 1
    s_lshl_b32 s37, s37, 6
    s_mul_i32 s38, s88, 112
    s_add_u32 s37, s37, s38
    s_add_u32 s37, s37, 14336
    s_and_b32 s38, s86, 1
    s_cmp_eq_u32 s38, 1
    s_cselect_b32 exec_hi, 0xffff, -1
    s_cmp_eq_u32 s91, 1
    s_cbranch_scc1 Ls8_p
    buffer_store_dwordx4 v[64:67], v60, s[16:19], s37 offen sc1
    s_branch Ls8_d
Ls8_p:
    buffer_store_dwordx4 v[64:67], v60, s[16:19], s37 offen
Ls8_d:
    s_mov_b64 exec, -1
    s_nop 1
    s_and_b32 s37, s86, 1
    s_cmp_eq_u32 s37, 1
    s_cselect_b32 s61, 0, -1
    s_mov_b32 s60, -1
    s_add_u32 s20, s84, 43253760
    s_addc_u32 s21, s85, 0
    s_mov_b32 s22, 262144
    s_mov_b32 s23, 0x00020000
    v_mov_b32 v64, 0
    s_lshl_b32 s37, s87, 6
    s_lshr_b32 s38, s86, 1
    s_mul_i32 s38, s38, 32
    s_add_u32 s37, s37, s38
    v_add_u32 v61, s37, v2
    v_lshlrev_b32 v61, 7, v61
    s_lshl_b32 s37, s88, 1
    s_and_b32 s38, s86, 1
    s_add_u32 s37, s37, s38
    s_lshl_b32 s37, s37, 3
    v_add_u32 v61, s37, v61
    v_mov_b32 v62, v36
    v_mul_f32 v63, v36, v36
    v_add_f32 v62, v62, v37
    v_fma_f32 v63, v37, v37, v63
    v_add_f32 v62, v62, v38
    v_fma_f32 v63, v38, v38, v63
    v_add_f32 v62, v62, v39
    v_fma_f32 v63, v39, v39, v63
    v_cndmask_b32 v52, v64, v40, s[60:61]
    v_add_f32 v62, v62, v52
    v_fma_f32 v63, v52, v52, v63
    v_cndmask_b32 v52, v64, v41, s[60:61]
    v_add_f32 v62, v62, v52
    v_fma_f32 v63, v52, v52, v63
    v_cndmask_b32 v52, v64, v42, s[60:61]
    v_add_f32 v62, v62, v52
    v_fma_f32 v63, v52, v52, v63
    v_cndmask_b32 v52, v64, v43, s[60:61]
    v_add_f32 v62, v62, v52
    v_fma_f32 v63, v52, v52, v63
    v_mov_b32 v52, v62
    s_nop 1
    v_permlane16_swap_b32 v62, v52
    v_add_f32 v62, v62, v52
    v_mov_b32 v52, v62
    s_nop 1
    v_permlane32_swap_b32 v62, v52
    v_add_f32 v62, v62, v52
    v_mov_b32 v52, v63
    s_nop 1
    v_permlane16_swap_b32 v63, v52
    v_add_f32 v63, v63, v52
    v_mov_b32 v52, v63
    s_nop 1
    v_permlane32_swap_b32 v63, v52
    v_add_f32 v63, v63, v52
    s_mov_b32 exec_lo, 0xffff
    s_mov_b32 exec_hi, 0
    s_cmp_eq_u32 s91, 1
    s_cbranch_scc1 Ls9_p
    buffer_store_dwordx2 v[62:63], v61, s[20:23], 0 offen offset:0 sc1
    s_branch Ls9_d
Ls9_p:
    buffer_store_dwordx2 v[62:63], v61, s[20:23], 0 offen offset:0
Ls9_d:
    s_mov_b64 exec, -1
    s_nop 1
    v_mov_b32 v62, v44
    v_mul_f32 v63, v44, v44
    v_add_f32 v62, v62, v45
    v_fma_f32 v63, v45, v45, v63
    v_add_f32 v62, v62, v46
    v_fma_f32 v63, v46, v46, v63
    v_add_f32 v62, v62, v47
    v_fma_f32 v63, v47, v47, v63
    v_cndmask_b32 v52, v64, v48, s[60:61]
    v_add_f32 v62, v62, v52
    v_fma_f32 v63, v52, v52, v63
    v_cndmask_b32 v52, v64, v49, s[60:61]
    v_add_f32 v62, v62, v52
    v_fma_f32 v63, v52, v52, v63
    v_cndmask_b32 v52, v64, v50, s[60:61]
    v_add_f32 v62, v62, v52
    v_fma_f32 v63, v52, v52, v63
    v_cndmask_b32 v52, v64, v51, s[60:61]
    v_add_f32 v62, v62, v52
    v_fma_f32 v63, v52, v52, v63
    v_mov_b32 v52, v62
    s_nop 1
    v_permlane16_swap_b32 v62, v52
    v_add_f32 v62, v62, v52
    v_mov_b32 v52, v62
    s_nop 1
    v_permlane32_swap_b32 v62, v52
    v_add_f32 v62, v62, v52
    v_mov_b32 v52, v63
    s_nop 1
    v_permlane16_swap_b32 v63, v52
    v_add_f32 v63, v63, v52
    v_mov_b32 v52, v63
    s_nop 1
    v_permlane32_swap_b32 v63, v52
    v_add_f32 v63, v63, v52
    s_mov_b32 exec_lo, 0xffff
    s_mov_b32 exec_hi, 0
    s_cmp_eq_u32 s91, 1
    s_cbranch_scc1 Ls10_p
    buffer_store_dwordx2 v[62:63], v61, s[20:23], 0 offen offset:2048 sc1
    s_branch Ls10_d
Ls10_p:
    buffer_store_dwordx2 v[62:63], v61, s[20:23], 0 offen offset:2048
Ls10_d:
    s_mov_b64 exec, -1
    s_nop 1
    s_mov_b32 s12, s72
    s_mov_b32 s13, s73
    s_mov_b32 s14, 401408
    s_mov_b32 s15, 0x00020000
    s_lshl_b32 s32, s86, 10
    s_and_b32 s40, s86, 1
    s_mul_i32 s35, s86, 7168
    v_lshrrev_b32 v67, 3, v1
    v_bfe_u32 v65, v1, 4, 1
    v_lshlrev_b32 v65, 1, v65
    s_lshl_b32 s37, s40, 2
    v_add_u32 v65, s37, v65
    v_and_b32 v66, 7, v1
    v_xor_b32 v66, v66, v65
    s_mov_b32 s39, 896
    v_mul_lo_u32 v65, v67, s39
    v_lshl_add_u32 v68, v66, 4, v65
    s_mul_i32 s42, s88, 112
    s_add_u32 s42, s42, 0
    s_add_u32 m0, s32, 57344
    s_add_u32 s37, s35, 0
    s_add_u32 s37, s37, s42
    buffer_load_dwordx4 v68, s[12:15], s37 offen lds
    s_add_u32 m0, s32, 61440
    s_add_u32 s37, s35, 28672
    s_add_u32 s37, s37, s42
    buffer_load_dwordx4 v68, s[12:15], s37 offen lds
    s_add_u32 m0, s32, 65536
    s_add_u32 s37, s35, 57344
    s_add_u32 s37, s37, s42
    buffer_load_dwordx4 v68, s[12:15], s37 offen lds
    s_add_u32 m0, s32, 69632
    s_add_u32 s37, s35, 86016
    s_add_u32 s37, s37, s42
    buffer_load_dwordx4 v68, s[12:15], s37 offen lds
    s_add_u32 m0, s32, 73728
    s_add_u32 s37, s35, 114688
    s_add_u32 s37, s37, s42
    buffer_load_dwordx4 v68, s[12:15], s37 offen lds
    s_add_u32 m0, s32, 77824
    s_add_u32 s37, s35, 143360
    s_add_u32 s37, s37, s42
    buffer_load_dwordx4 v68, s[12:15], s37 offen lds
    s_add_u32 m0, s32, 81920
    s_add_u32 s37, s35, 172032
    s_add_u32 s37, s37, s42
    buffer_load_dwordx4 v68, s[12:15], s37 offen lds
    s_add_u32 m0, s32, 86016
    s_add_u32 s37, s35, 200704
    s_add_u32 s37, s37, s42
    buffer_load_dwordx4 v68, s[12:15], s37 offen lds
    s_add_u32 m0, s32, 90112
    s_add_u32 s37, s35, 229376
    s_add_u32 s37, s37, s42
    buffer_load_dwordx4 v68, s[12:15], s37 offen lds
    s_add_u32 m0, s32, 94208
    s_add_u32 s37, s35, 258048
    s_add_u32 s37, s37, s42
    buffer_load_dwordx4 v68, s[12:15], s37 offen lds
    s_add_u32 m0, s32, 98304
    s_add_u32 s37, s35, 286720
    s_add_u32 s37, s37, s42
    buffer_load_dwordx4 v68, s[12:15], s37 offen lds
    s_add_u32 m0, s32, 102400
    s_add_u32 s37, s35, 315392
    s_add_u32 s37, s37, s42
    buffer_load_dwordx4 v68, s[12:15], s37 offen lds
    s_add_u32 m0, s32, 106496
    s_add_u32 s37, s35, 344064
    s_add_u32 s37, s37, s42
    buffer_load_dwordx4 v68, s[12:15], s37 offen lds
    s_add_u32 m0, s32, 110592
    s_add_u32 s37, s35, 372736
    s_add_u32 s37, s37, s42
    buffer_load_dwordx4 v68, s[12:15], s37 offen lds
    s_waitcnt vmcnt(14)
    s_lshl_b32 s32, s89, 7
    s_lshl_b32 s33, s86, 2
    s_add_u32 s32, s32, s33
    v_mov_b32 v65, s32
    v_mov_b32 v66, 3
    s_mov_b64 exec, 1
    s_mov_b32 s57, s91
    s_cmp_eq_u32 s57, 1
    s_cbranch_scc1 Ls11_p
    buffer_store_dword v66, v65, s[24:27], 0 offen sc1
    s_branch Ls11_d
Ls11_p:
    buffer_store_dword v66, v65, s[24:27], 0 offen
Ls11_d:
    s_mov_b64 exec, -1
    s_barrier
    s_add_u32 s8, s84, 3145728
    s_addc_u32 s9, s85, 0
    s_mov_b32 s10, 1835008
    s_mov_b32 s11, 0x00020000
    s_mov_b32 s12, s72
    s_mov_b32 s13, s73
    s_mov_b32 s14, 401408
    s_mov_b32 s15, 0x00020000
    s_lshl_b32 s32, s86, 10
    s_and_b32 s40, s86, 1
    s_add_u32 s33, s40, 8
    s_mul_i32 s34, s86, 7168
    s_mul_i32 s35, s86, 7168
    s_mul_i32 s36, s88, 112
    v_lshrrev_b32 v5, 3, v1
    v_lshrrev_b32 v7, 4, v1
    s_lshl_b32 s37, s40, 2
    v_add_u32 v7, s37, v7
    v_and_b32 v6, 7, v1
    v_xor_b32 v6, v6, v7
    s_lshl_b32 s37, s87, 6
    s_lshl_b32 s38, s86, 3
    s_add_u32 s38, s38, 0
    s_add_u32 s38, s38, s37
    v_add_u32 v7, s38, v5
    s_mov_b32 s39, 896
    v_mul_lo_u32 v7, v7, s39
    v_lshl_add_u32 v9, v6, 4, v7
    s_lshl_b32 s38, s86, 3
    s_add_u32 s38, s38, 32
    s_add_u32 s38, s38, s37
    v_add_u32 v7, s38, v5
    s_mov_b32 s39, 896
    v_mul_lo_u32 v7, v7, s39
    v_lshl_add_u32 v10, v6, 4, v7
    v_bfe_u32 v7, v1, 4, 1
    v_lshlrev_b32 v7, 1, v7
    s_lshl_b32 s37, s40, 2
    v_add_u32 v7, s37, v7
    v_and_b32 v8, 7, v1
    v_xor_b32 v8, v8, v7
    s_mov_b32 s39, 896
    v_mul_lo_u32 v7, v5, s39
    v_lshl_add_u32 v11, v8, 4, v7
    s_add_u32 s42, s36, 0
    s_cmp_lg_u32 s86, 0
    s_cbranch_scc1 Lp12_skip
    v_lshrrev_b32 v13, 3, v1
    v_add_u32 v13, s87, v13
    v_add_u32 v13, 0, v13
    v_mov_b32 v14, s87
    v_cmp_gt_u32 vcc, 32, v13
    s_nop 1
    v_cndmask_b32 v13, v14, v13, vcc
    v_and_b32 v12, 7, v1
    v_lshlrev_b32 v12, 5, v12
    v_and_b32 v14, 3, v13
    v_lshl_add_u32 v12, v14, 3, v12
    v_lshrrev_b32 v14, 2, v13
    v_add_u32 v12, v12, v14
    v_lshlrev_b32 v12, 7, v12
    v_add_u32 v12, 0, v12
    v_mov_b32 v20, 0
    s_mov_b32 s52, 0
    s_mov_b32 s53, 3
    s_mov_b32 exec_lo, 255
    s_mov_b32 exec_hi, 0
Lp12_loop:
    buffer_load_dwordx4 v[16:19], v12, s[24:27], 0 offen sc1
    s_waitcnt vmcnt(0)
    v_min_u32 v16, v16, v17
    v_min_u32 v18, v18, v19
    v_min_u32 v16, v16, v18
    v_cmp_gt_u32 vcc, s53, v16
    s_cbranch_vccz Lp12_ok
Lp12_again:
    s_add_u32 s52, s52, 1
    s_cmp_lt_u32 s52, 20000
    s_cbranch_scc1 Lp12_loop
Lp12_ok:
    s_mov_b64 exec, -1
Lp12_skip:
    s_barrier
    s_add_u32 m0, s32, 0
    s_nop 0
    s_mov_b32 s37, 0
    buffer_load_dwordx4 v9, s[8:11], s37 offen lds
    s_add_u32 m0, s32, 4096
    s_nop 0
    s_mov_b32 s37, 0
    buffer_load_dwordx4 v10, s[8:11], s37 offen lds
    s_add_u32 m0, s32, 8192
    s_nop 0
    s_mov_b32 s37, 128
    buffer_load_dwordx4 v9, s[8:11], s37 offen lds
    s_add_u32 m0, s32, 12288
    s_nop 0
    s_mov_b32 s37, 128
    buffer_load_dwordx4 v10, s[8:11], s37 offen lds
    s_add_u32 m0, s32, 16384
    s_nop 0
    s_mov_b32 s37, 256
    buffer_load_dwordx4 v9, s[8:11], s37 offen lds
    s_add_u32 m0, s32, 20480
    s_nop 0
    s_mov_b32 s37, 256
    buffer_load_dwordx4 v10, s[8:11], s37 offen lds
    s_add_u32 m0, s32, 24576
    s_nop 0
    s_mov_b32 s37, 384
    buffer_load_dwordx4 v9, s[8:11], s37 offen lds
    s_add_u32 m0, s32, 28672
    s_nop 0
    s_mov_b32 s37, 384
    buffer_load_dwordx4 v10, s[8:11], s37 offen lds
    s_add_u32 m0, s32, 32768
    s_nop 0
    s_mov_b32 s37, 512
    buffer_load_dwordx4 v9, s[8:11], s37 offen lds
    s_add_u32 m0, s32, 36864
    s_nop 0
    s_mov_b32 s37, 512
    buffer_load_dwordx4 v10, s[8:11], s37 offen lds
    s_add_u32 m0, s32, 40960
    s_nop 0
    s_mov_b32 s37, 640
    buffer_load_dwordx4 v9, s[8:11], s37 offen lds
    s_add_u32 m0, s32, 45056
    s_nop 0
    s_mov_b32 s37, 640
    buffer_load_dwordx4 v10, s[8:11], s37 offen lds
    s_add_u32 m0, s32, 49152
    s_nop 0
    s_mov_b32 s37, 768
    buffer_load_dwordx4 v9, s[8:11], s37 offen lds
    s_add_u32 m0, s32, 53248
    s_nop 0
    s_mov_b32 s37, 768
    buffer_load_dwordx4 v10, s[8:11], s37 offen lds
    s_add_u32 s20, s84, 43253760
    s_addc_u32 s21, s85, 0
    s_mov_b32 s22, 262144
    s_mov_b32 s23, 0x00020000
    s_lshl_b32 s37, s87, 6
    s_lshr_b32 s38, s86, 1
    s_mul_i32 s38, s38, 32
    s_add_u32 s37, s37, s38
    v_add_u32 v12, s37, v2
    v_lshlrev_b32 v12, 7, v12
    v_lshl_add_u32 v12, v3, 5, v12
    buffer_load_dwordx4 v[16:19], v12, s[20:23], 0 offen
    buffer_load_dwordx4 v[20:23], v12, s[20:23], 0 offen offset:16
    v_add_u32 v12, 2048, v12
    buffer_load_dwordx4 v[24:27], v12, s[20:23], 0 offen
    buffer_load_dwordx4 v[28:31], v12, s[20:23], 0 offen offset:16
    v_lshrrev_b32 v7, 1, v2
    v_and_b32 v7, 7, v7
    v_add_u32 v8, 0, v3
    v_xor_b32 v8, v8, v7
    v_lshlrev_b32 v8, 4, v8
    v_lshl_add_u32 v32, v2, 7, v8
    v_add_u32 v8, 4, v3
    v_xor_b32 v8, v8, v7
    v_lshlrev_b32 v8, 4, v8
    v_lshl_add_u32 v33, v2, 7, v8
    s_lshl_b32 s37, s86, 11
    v_add_u32 v34, s37, v32
    v_add_u32 v35, s37, v33
    s_lshr_b32 s37, s86, 1
    s_mul_i32 s37, s37, 4096
    v_add_u32 v32, s37, v32
    v_add_u32 v33, s37, v33
    v_lshrrev_b32 v38, 2, v2
    v_lshl_add_u32 v38, v3, 3, v38
    v_lshlrev_b32 v38, 7, v38
    v_bfe_u32 v39, v2, 3, 1
    v_lshlrev_b32 v39, 2, v39
    v_and_b32 v7, 1, v3
    v_lshl_add_u32 v39, v7, 3, v39
    v_and_b32 v40, 3, v2
    s_and_b32 s37, s86, 1
    s_mul_i32 s37, s37, 2
    s_add_u32 s38, s37, 0
    s_and_b32 s39, s38, 3
    s_lshl_b32 s39, s39, 2
    v_add_u32 v7, s39, v40
    v_xor_b32 v7, v7, v39
    v_lshl_add_u32 v7, v7, 3, v38
    s_lshr_b32 s38, s38, 2
    s_lshl_b32 s38, s38, 13
    v_add_u32 v36, s38, v7
    s_add_u32 s38, s37, 1
    s_and_b32 s39, s38, 3
    s_lshl_b32 s39, s39, 2
    v_add_u32 v7, s39, v40
    v_xor_b32 v7, v7, v39
    v_lshl_add_u32 v7, v7, 3, v38
    s_lshr_b32 s38, s38, 2
    s_lshl_b32 s38, s38, 13
    v_add_u32 v37, s38, v7
    v_add_u32 v41, 65536, v32
    v_add_u32 v42, 65536, v33
    v_add_u32 v43, 65536, v34
    v_add_u32 v44, 65536, v35
    v_add_u32 v45, 65536, v36
    v_add_u32 v46, 65536, v37
    v_mov_b32 v48, 0
    v_mov_b32 v49, 0
    v_mov_b32 v50, 0
    v_mov_b32 v51, 0
    v_mov_b32 v52, 0
    v_mov_b32 v53, 0
    v_mov_b32 v54, 0
    v_mov_b32 v55, 0
    v_mov_b32 v56, 0
    v_mov_b32 v57, 0
    v_mov_b32 v58, 0
    v_mov_b32 v59, 0
    v_mov_b32 v60, 0
    v_mov_b32 v61, 0
    v_mov_b32 v62, 0
    v_mov_b32 v63, 0
    v_mov_b32 v64, 0
    v_mov_b32 v65, 0
    v_mov_b32 v66, 0
    v_mov_b32 v67, 0
    v_mov_b32 v68, 0
    v_mov_b32 v69, 0
    v_mov_b32 v70, 0
    v_mov_b32 v71, 0
    v_mov_b32 v72, 0x3f803f80
    v_mov_b32 v73, 0x3f803f80
    v_mov_b32 v74, 0x3f803f80
    v_mov_b32 v75, 0x3f803f80
    s_waitcnt vmcnt(29)
    s_waitcnt vmcnt(14)
    s_barrier
    ds_read_b128 v[76:79], v32 offset:0
    ds_read_b128 v[80:83], v32 offset:2048
    ds_read_b64_tr_b16 v[92:93], v36 offset:57344
    ds_read_b64_tr_b16 v[94:95], v36 offset:57856
    ds_read_b64_tr_b16 v[96:97], v37 offset:57344
    ds_read_b64_tr_b16 v[98:99], v37 offset:57856
    s_waitcnt lgkmcnt(0)
    v_mfma_f32_16x16x32_bf16 v[48:51], v[92:95], v[76:79], v[48:51]
    ds_read_b128 v[84:87], v33 offset:0
    ds_read_b128 v[88:91], v33 offset:2048
    v_mfma_f32_16x16x32_bf16 v[56:59], v[92:95], v[80:83], v[56:59]
    ds_read_b64_tr_b16 v[100:101], v36 offset:61440
    ds_read_b64_tr_b16 v[102:103], v36 offset:61952
    v_mfma_f32_16x16x32_bf16 v[64:67], v[92:95], v[72:75], v[64:67]
    ds_read_b64_tr_b16 v[104:105], v37 offset:61440
    ds_read_b64_tr_b16 v[106:107], v37 offset:61952
    v_mfma_f32_16x16x32_bf16 v[52:55], v[96:99], v[76:79], v[52:55]
    v_mfma_f32_16x16x32_bf16 v[60:63], v[96:99], v[80:83], v[60:63]
    v_mfma_f32_16x16x32_bf16 v[68:71], v[96:99], v[72:75], v[68:71]
    s_waitcnt lgkmcnt(0)
    v_mfma_f32_16x16x32_bf16 v[48:51], v[100:103], v[84:87], v[48:51]
    ds_read_b128 v[76:79], v32 offset:8192
    ds_read_b128 v[80:83], v32 offset:10240
    v_mfma_f32_16x16x32_bf16 v[56:59], v[100:103], v[88:91], v[56:59]
    ds_read_b64_tr_b16 v[92:93], v45 offset:0
    ds_read_b64_tr_b16 v[94:95], v45 offset:512
    v_mfma_f32_16x16x32_bf16 v[64:67], v[100:103], v[72:75], v[64:67]
    ds_read_b64_tr_b16 v[96:97], v46 offset:0
    ds_read_b64_tr_b16 v[98:99], v46 offset:512
    v_mfma_f32_16x16x32_bf16 v[52:55], v[104:107], v[84:87], v[52:55]
    v_mfma_f32_16x16x32_bf16 v[60:63], v[104:107], v[88:91], v[60:63]
    v_mfma_f32_16x16x32_bf16 v[68:71], v[104:107], v[72:75], v[68:71]
    s_waitcnt lgkmcnt(0)
    v_mfma_f32_16x16x32_bf16 v[48:51], v[92:95], v[76:79], v[48:51]
    ds_read_b128 v[84:87], v33 offset:8192
    ds_read_b128 v[88:91], v33 offset:10240
    v_mfma_f32_16x16x32_bf16 v[56:59], v[92:95], v[80:83], v[56:59]
    ds_read_b64_tr_b16 v[100:101], v45 offset:4096
    ds_read_b64_tr_b16 v[102:103], v45 offset:4608
    v_mfma_f32_16x16x32_bf16 v[64:67], v[92:95], v[72:75], v[64:67]
    ds_read_b64_tr_b16 v[104:105], v46 offset:4096
    ds_read_b64_tr_b16 v[106:107], v46 offset:4608
    v_mfma_f32_16x16x32_bf16 v[52:55], v[96:99], v[76:79], v[52:55]
    v_mfma_f32_16x16x32_bf16 v[60:63], v[96:99], v[80:83], v[60:63]
    v_mfma_f32_16x16x32_bf16 v[68:71], v[96:99], v[72:75], v[68:71]
    s_waitcnt lgkmcnt(0)
    s_waitcnt vmcnt(8)
    s_barrier
    v_mfma_f32_16x16x32_bf16 v[48:51], v[100:103], v[84:87], v[48:51]
    ds_read_b128 v[76:79], v32 offset:16384
    ds_read_b128 v[80:83], v32 offset:18432
    v_mfma_f32_16x16x32_bf16 v[56:59], v[100:103], v[88:91], v[56:59]
    ds_read_b64_tr_b16 v[92:93], v45 offset:8192
    ds_read_b64_tr_b16 v[94:95], v45 offset:8704
    v_mfma_f32_16x16x32_bf16 v[64:67], v[100:103], v[72:75], v[64:67]
    ds_read_b64_tr_b16 v[96:97], v46 offset:8192
    ds_read_b64_tr_b16 v[98:99], v46 offset:8704
    v_mfma_f32_16x16x32_bf16 v[52:55], v[104:107], v[84:87], v[52:55]
    v_mfma_f32_16x16x32_bf16 v[60:63], v[104:107], v[88:91], v[60:63]
    v_mfma_f32_16x16x32_bf16 v[68:71], v[104:107], v[72:75], v[68:71]
    s_waitcnt lgkmcnt(0)
    v_mfma_f32_16x16x32_bf16 v[48:51], v[92:95], v[76:79], v[48:51]
    ds_read_b128 v[84:87], v33 offset:16384
    ds_read_b128 v[88:91], v33 offset:18432
    v_mfma_f32_16x16x32_bf16 v[56:59], v[92:95], v[80:83], v[56:59]
    ds_read_b64_tr_b16 v[100:101], v45 offset:12288
    ds_read_b64_tr_b16 v[102:103], v45 offset:12800
    v_mfma_f32_16x16x32_bf16 v[64:67], v[92:95], v[72:75], v[64:67]
    ds_read_b64_tr_b16 v[104:105], v46 offset:12288
    ds_read_b64_tr_b16 v[106:107], v46 offset:12800
    v_mfma_f32_16x16x32_bf16 v[52:55], v[96:99], v[76:79], v[52:55]
    v_mfma_f32_16x16x32_bf16 v[60:63], v[96:99], v[80:83], v[60:63]
    v_mfma_f32_16x16x32_bf16 v[68:71], v[96:99], v[72:75], v[68:71]
    s_waitcnt lgkmcnt(0)
    v_mfma_f32_16x16x32_bf16 v[48:51], v[100:103], v[84:87], v[48:51]
    ds_read_b128 v[76:79], v32 offset:24576
    ds_read_b128 v[80:83], v32 offset:26624
    v_mfma_f32_16x16x32_bf16 v[56:59], v[100:103], v[88:91], v[56:59]
    ds_read_b64_tr_b16 v[92:93], v45 offset:16384
    ds_read_b64_tr_b16 v[94:95], v45 offset:16896
    v_mfma_f32_16x16x32_bf16 v[64:67], v[100:103], v[72:75], v[64:67]
    ds_read_b64_tr_b16 v[96:97], v46 offset:16384
    ds_read_b64_tr_b16 v[98:99], v46 offset:16896
    v_mfma_f32_16x16x32_bf16 v[52:55], v[104:107], v[84:87], v[52:55]
    v_mfma_f32_16x16x32_bf16 v[60:63], v[104:107], v[88:91], v[60:63]
    v_mfma_f32_16x16x32_bf16 v[68:71], v[104:107], v[72:75], v[68:71]
    s_waitcnt lgkmcnt(0)
    v_mfma_f32_16x16x32_bf16 v[48:51], v[92:95], v[76:79], v[48:51]
    ds_read_b128 v[84:87], v33 offset:24576
    ds_read_b128 v[88:91], v33 offset:26624
    v_mfma_f32_16x16x32_bf16 v[56:59], v[92:95], v[80:83], v[56:59]
    ds_read_b64_tr_b16 v[100:101], v45 offset:20480
    ds_read_b64_tr_b16 v[102:103], v45 offset:20992
    v_mfma_f32_16x16x32_bf16 v[64:67], v[92:95], v[72:75], v[64:67]
    ds_read_b64_tr_b16 v[104:105], v46 offset:20480
    ds_read_b64_tr_b16 v[106:107], v46 offset:20992
    v_mfma_f32_16x16x32_bf16 v[52:55], v[96:99], v[76:79], v[52:55]
    v_mfma_f32_16x16x32_bf16 v[60:63], v[96:99], v[80:83], v[60:63]
    v_mfma_f32_16x16x32_bf16 v[68:71], v[96:99], v[72:75], v[68:71]
    s_waitcnt lgkmcnt(0)
    v_mfma_f32_16x16x32_bf16 v[48:51], v[100:103], v[84:87], v[48:51]
    ds_read_b128 v[76:79], v32 offset:32768
    ds_read_b128 v[80:83], v32 offset:34816
    v_mfma_f32_16x16x32_bf16 v[56:59], v[100:103], v[88:91], v[56:59]
    ds_read_b64_tr_b16 v[92:93], v45 offset:24576
    ds_read_b64_tr_b16 v[94:95], v45 offset:25088
    v_mfma_f32_16x16x32_bf16 v[64:67], v[100:103], v[72:75], v[64:67]
    ds_read_b64_tr_b16 v[96:97], v46 offset:24576
    ds_read_b64_tr_b16 v[98:99], v46 offset:25088
    v_mfma_f32_16x16x32_bf16 v[52:55], v[104:107], v[84:87], v[52:55]
    v_mfma_f32_16x16x32_bf16 v[60:63], v[104:107], v[88:91], v[60:63]
    v_mfma_f32_16x16x32_bf16 v[68:71], v[104:107], v[72:75], v[68:71]
    s_waitcnt lgkmcnt(0)
    v_mfma_f32_16x16x32_bf16 v[48:51], v[92:95], v[76:79], v[48:51]
    ds_read_b128 v[84:87], v33 offset:32768
    ds_read_b128 v[88:91], v33 offset:34816
    v_mfma_f32_16x16x32_bf16 v[56:59], v[92:95], v[80:83], v[56:59]
    ds_read_b64_tr_b16 v[100:101], v45 offset:28672
    ds_read_b64_tr_b16 v[102:103], v45 offset:29184
    v_mfma_f32_16x16x32_bf16 v[64:67], v[92:95], v[72:75], v[64:67]
    ds_read_b64_tr_b16 v[104:105], v46 offset:28672
    ds_read_b64_tr_b16 v[106:107], v46 offset:29184
    v_mfma_f32_16x16x32_bf16 v[52:55], v[96:99], v[76:79], v[52:55]
    v_mfma_f32_16x16x32_bf16 v[60:63], v[96:99], v[80:83], v[60:63]
    v_mfma_f32_16x16x32_bf16 v[68:71], v[96:99], v[72:75], v[68:71]
    s_waitcnt lgkmcnt(0)
    s_waitcnt vmcnt(4)
    s_barrier
    v_mfma_f32_16x16x32_bf16 v[48:51], v[100:103], v[84:87], v[48:51]
    ds_read_b128 v[76:79], v32 offset:40960
    ds_read_b128 v[80:83], v32 offset:43008
    v_mfma_f32_16x16x32_bf16 v[56:59], v[100:103], v[88:91], v[56:59]
    ds_read_b64_tr_b16 v[92:93], v45 offset:32768
    ds_read_b64_tr_b16 v[94:95], v45 offset:33280
    v_mfma_f32_16x16x32_bf16 v[64:67], v[100:103], v[72:75], v[64:67]
    ds_read_b64_tr_b16 v[96:97], v46 offset:32768
    ds_read_b64_tr_b16 v[98:99], v46 offset:33280
    v_mfma_f32_16x16x32_bf16 v[52:55], v[104:107], v[84:87], v[52:55]
    v_mfma_f32_16x16x32_bf16 v[60:63], v[104:107], v[88:91], v[60:63]
    v_mfma_f32_16x16x32_bf16 v[68:71], v[104:107], v[72:75], v[68:71]
    s_waitcnt lgkmcnt(0)
    v_mfma_f32_16x16x32_bf16 v[48:51], v[92:95], v[76:79], v[48:51]
    ds_read_b128 v[84:87], v33 offset:40960
    ds_read_b128 v[88:91], v33 offset:43008
    v_mfma_f32_16x16x32_bf16 v[56:59], v[92:95], v[80:83], v[56:59]
    ds_read_b64_tr_b16 v[100:101], v45 offset:36864
    ds_read_b64_tr_b16 v[102:103], v45 offset:37376
    v_mfma_f32_16x16x32_bf16 v[64:67], v[92:95], v[72:75], v[64:67]
    ds_read_b64_tr_b16 v[104:105], v46 offset:36864
    ds_read_b64_tr_b16 v[106:107], v46 offset:37376
    v_mfma_f32_16x16x32_bf16 v[52:55], v[96:99], v[76:79], v[52:55]
    v_mfma_f32_16x16x32_bf16 v[60:63], v[96:99], v[80:83], v[60:63]
    v_mfma_f32_16x16x32_bf16 v[68:71], v[96:99], v[72:75], v[68:71]
    s_waitcnt lgkmcnt(0)
    v_mfma_f32_16x16x32_bf16 v[48:51], v[100:103], v[84:87], v[48:51]
    ds_read_b128 v[76:79], v32 offset:49152
    ds_read_b128 v[80:83], v32 offset:51200
    v_mfma_f32_16x16x32_bf16 v[56:59], v[100:103], v[88:91], v[56:59]
    ds_read_b64_tr_b16 v[92:93], v45 offset:40960
    ds_read_b64_tr_b16 v[94:95], v45 offset:41472
    v_mfma_f32_16x16x32_bf16 v[64:67], v[100:103], v[72:75], v[64:67]
    ds_read_b64_tr_b16 v[96:97], v46 offset:40960
    ds_read_b64_tr_b16 v[98:99], v46 offset:41472
    v_mfma_f32_16x16x32_bf16 v[52:55], v[104:107], v[84:87], v[52:55]
    v_mfma_f32_16x16x32_bf16 v[60:63], v[104:107], v[88:91], v[60:63]
    v_mfma_f32_16x16x32_bf16 v[68:71], v[104:107], v[72:75], v[68:71]
    s_waitcnt lgkmcnt(0)
    v_mfma_f32_16x16x32_bf16 v[48:51], v[92:95], v[76:79], v[48:51]
    ds_read_b128 v[84:87], v33 offset:49152
    ds_read_b128 v[88:91], v33 offset:51200
    v_mfma_f32_16x16x32_bf16 v[56:59], v[92:95], v[80:83], v[56:59]
    ds_read_b64_tr_b16 v[100:101], v45 offset:45056
    ds_read_b64_tr_b16 v[102:103], v45 offset:45568
    v_mfma_f32_16x16x32_bf16 v[64:67], v[92:95], v[72:75], v[64:67]
    ds_read_b64_tr_b16 v[104:105], v46 offset:45056
    ds_read_b64_tr_b16 v[106:107], v46 offset:45568
    v_mfma_f32_16x16x32_bf16 v[52:55], v[96:99], v[76:79], v[52:55]
    v_mfma_f32_16x16x32_bf16 v[60:63], v[96:99], v[80:83], v[60:63]
    v_mfma_f32_16x16x32_bf16 v[68:71], v[96:99], v[72:75], v[68:71]
    s_waitcnt lgkmcnt(0)
    v_mfma_f32_16x16x32_bf16 v[48:51], v[100:103], v[84:87], v[48:51]
    v_mfma_f32_16x16x32_bf16 v[56:59], v[100:103], v[88:91], v[56:59]
    v_mfma_f32_16x16x32_bf16 v[64:67], v[100:103], v[72:75], v[64:67]
    v_mfma_f32_16x16x32_bf16 v[52:55], v[104:107], v[84:87], v[52:55]
    v_mfma_f32_16x16x32_bf16 v[60:63], v[104:107], v[88:91], v[60:63]
    v_mfma_f32_16x16x32_bf16 v[68:71], v[104:107], v[72:75], v[68:71]
    s_nop 7
    s_nop 7
    s_barrier
    s_waitcnt vmcnt(0)
    v_add_f32 v80, v16, v18
    v_add_f32 v81, v17, v19
    v_add_f32 v76, v20, v22
    v_add_f32 v77, v21, v23
    v_add_f32 v80, v80, v76
    v_add_f32 v81, v81, v77
    v_mov_b32 v76, v80
    s_nop 1
    v_permlane16_swap_b32 v80, v76
    v_add_f32 v80, v80, v76
    v_mov_b32 v76, v80
    s_nop 1
    v_permlane32_swap_b32 v80, v76
    v_add_f32 v80, v80, v76
    v_mov_b32 v76, v81
    s_nop 1
    v_permlane16_swap_b32 v81, v76
    v_add_f32 v81, v81, v76
    v_mov_b32 v76, v81
    s_nop 1
    v_permlane32_swap_b32 v81, v76
    v_add_f32 v81, v81, v76
    v_mul_f32 v80, 991054117, v80
    v_mul_f32 v81, 991054117, v81
    v_fma_f32 v81, -v80, v80, v81
    v_max_f32 v81, 0, v81
    v_add_f32 v76, 925353388, v81
    v_rsq_f32 v77, v76
    s_nop 0
    v_mul_f32 v78, v77, v77
    s_mov_b32 s39, 925353388
    v_fma_f32 v78, v78, v81, s39
    v_rsq_f32 v78, v78
    s_nop 0
    v_mul_f32 v81, v77, v78
    v_mov_b32 v84, v80
    v_mov_b32 v85, v77
    s_add_u32 s20, s84, 11534336
    s_addc_u32 s21, s85, 0
    s_mov_b32 s22, 16384
    s_mov_b32 s23, 0x00020000
    s_lshl_b32 s37, s87, 6
    s_lshr_b32 s38, s86, 1
    s_mul_i32 s38, s38, 32
    s_add_u32 s37, s37, s38
    v_add_u32 v76, s37, v2
    v_lshlrev_b32 v76, 3, v76
    s_mov_b32 exec_lo, 0xffff
    s_mov_b32 exec_hi, 0
    buffer_store_dwordx2 v[84:85], v76, s[20:23], 0 offen offset:0
    s_mov_b64 exec, -1
    v_add_f32 v82, v24, v26
    v_add_f32 v83, v25, v27
    v_add_f32 v76, v28, v30
    v_add_f32 v77, v29, v31
    v_add_f32 v82, v82, v76
    v_add_f32 v83, v83, v77
    v_mov_b32 v76, v82
    s_nop 1
    v_permlane16_swap_b32 v82, v76
    v_add_f32 v82, v82, v76
    v_mov_b32 v76, v82
    s_nop 1
    v_permlane32_swap_b32 v82, v76
    v_add_f32 v82, v82, v76
    v_mov_b32 v76, v83
    s_nop 1
    v_permlane16_swap_b32 v83, v76
    v_add_f32 v83, v83, v76
    v_mov_b32 v76, v83
    s_nop 1
    v_permlane32_swap_b32 v83, v76
    v_add_f32 v83, v83, v76
    v_mul_f32 v82, 991054117, v82
    v_mul_f32 v83, 991054117, v83
    v_fma_f32 v83, -v82, v82, v83
    v_max_f32 v83, 0, v83
    v_add_f32 v76, 925353388, v83
    v_rsq_f32 v77, v76
    s_nop 0
    v_mul_f32 v78, v77, v77
    s_mov_b32 s39, 925353388
    v_fma_f32 v78, v78, v83, s39
    v_rsq_f32 v78, v78
    s_nop 0
    v_mul_f32 v83, v77, v78
    v_mov_b32 v86, v82
    v_mov_b32 v87, v77
    s_add_u32 s20, s84, 11534336
    s_addc_u32 s21, s85, 0
    s_mov_b32 s22, 16384
    s_mov_b32 s23, 0x00020000
    s_lshl_b32 s37, s87, 6
    s_lshr_b32 s38, s86, 1
    s_mul_i32 s38, s38, 32
    s_add_u32 s37, s37, s38
    v_add_u32 v76, s37, v2
    v_lshlrev_b32 v76, 3, v76
    s_mov_b32 exec_lo, 0xffff
    s_mov_b32 exec_hi, 0
    buffer_store_dwordx2 v[86:87], v76, s[20:23], 0 offen offset:128
    s_mov_b64 exec, -1
    s_mov_b32 s54, 1027024659
    s_mov_b32 s55, 3222493025
    s_add_u32 s16, s84, 5242880
    s_addc_u32 s17, s85, 0
    s_mov_b32 s18, 1835008
    s_mov_b32 s19, 0x00020000
    s_lshl_b32 s37, s87, 6
    s_lshr_b32 s38, s86, 1
    s_mul_i32 s38, s38, 32
    s_add_u32 s37, s37, s38
    v_add_u32 v76, s37, v2
    s_mov_b32 s38, 896
    v_mul_lo_u32 v92, v76, s38
    v_and_b32 v76, 1, v3
    v_lshl_add_u32 v92, v76, 5, v92
    v_lshrrev_b32 v76, 1, v3
    v_lshl_add_u32 v92, v76, 4, v92
    v_pk_fma_f32 v[48:49], v[64:65], v[80:81], v[48:49] op_sel_hi:[1,0,1] neg_lo:[0,1,0] neg_hi:[0,1,0]
    v_pk_mul_f32 v[48:49], v[48:49], v[80:81] op_sel:[0,1] op_sel_hi:[1,1]
    v_pk_mul_f32 v[88:89], v[48:49], v[48:49]
    v_pk_mul_f32 v[90:91], v[48:49], s[54:55] op_sel:[0,1] op_sel_hi:[1,1]
    v_pk_fma_f32 v[88:89], v[88:89], s[54:55], 1.0 op_sel_hi:[1,0,0]
    v_pk_mul_f32 v[88:89], v[88:89], v[90:91]
    v_exp_f32 v88, v88
    v_exp_f32 v89, v89
    s_nop 0
    v_pk_add_f32 v[88:89], v[88:89], 1.0 op_sel_hi:[1,0]
    v_rcp_f32 v88, v88
    v_rcp_f32 v89, v89
    s_nop 0
    v_pk_mul_f32 v[48:49], v[48:49], v[88:89]
    v_pk_fma_f32 v[50:51], v[66:67], v[80:81], v[50:51] op_sel_hi:[1,0,1] neg_lo:[0,1,0] neg_hi:[0,1,0]
    v_pk_mul_f32 v[50:51], v[50:51], v[80:81] op_sel:[0,1] op_sel_hi:[1,1]
    v_pk_mul_f32 v[88:89], v[50:51], v[50:51]
    v_pk_mul_f32 v[90:91], v[50:51], s[54:55] op_sel:[0,1] op_sel_hi:[1,1]
    v_pk_fma_f32 v[88:89], v[88:89], s[54:55], 1.0 op_sel_hi:[1,0,0]
    v_pk_mul_f32 v[88:89], v[88:89], v[90:91]
    v_exp_f32 v88, v88
    v_exp_f32 v89, v89
    s_nop 0
    v_pk_add_f32 v[88:89], v[88:89], 1.0 op_sel_hi:[1,0]
    v_rcp_f32 v88, v88
    v_rcp_f32 v89, v89
    s_nop 0
    v_pk_mul_f32 v[50:51], v[50:51], v[88:89]
    v_pk_fma_f32 v[52:53], v[68:69], v[80:81], v[52:53] op_sel_hi:[1,0,1] neg_lo:[0,1,0] neg_hi:[0,1,0]
    v_pk_mul_f32 v[52:53], v[52:53], v[80:81] op_sel:[0,1] op_sel_hi:[1,1]
    v_pk_mul_f32 v[88:89], v[52:53], v[52:53]
    v_pk_mul_f32 v[90:91], v[52:53], s[54:55] op_sel:[0,1] op_sel_hi:[1,1]
    v_pk_fma_f32 v[88:89], v[88:89], s[54:55], 1.0 op_sel_hi:[1,0,0]
    v_pk_mul_f32 v[88:89], v[88:89], v[90:91]
    v_exp_f32 v88, v88
    v_exp_f32 v89, v89
    s_nop 0
    v_pk_add_f32 v[88:89], v[88:89], 1.0 op_sel_hi:[1,0]
    v_rcp_f32 v88, v88
    v_rcp_f32 v89, v89
    s_nop 0
    v_pk_mul_f32 v[52:53], v[52:53], v[88:89]
    v_pk_fma_f32 v[54:55], v[70:71], v[80:81], v[54:55] op_sel_hi:[1,0,1] neg_lo:[0,1,0] neg_hi:[0,1,0]
    v_pk_mul_f32 v[54:55], v[54:55], v[80:81] op_sel:[0,1] op_sel_hi:[1,1]
    v_pk_mul_f32 v[88:89], v[54:55], v[54:55]
    v_pk_mul_f32 v[90:91], v[54:55], s[54:55] op_sel:[0,1] op_sel_hi:[1,1]
    v_pk_fma_f32 v[88:89], v[88:89], s[54:55], 1.0 op_sel_hi:[1,0,0]
    v_pk_mul_f32 v[88:89], v[88:89], v[90:91]
    v_exp_f32 v88, v88
    v_exp_f32 v89, v89
    s_nop 0
    v_pk_add_f32 v[88:89], v[88:89], 1.0 op_sel_hi:[1,0]
    v_rcp_f32 v88, v88
    v_rcp_f32 v89, v89
    s_nop 0
    v_pk_mul_f32 v[54:55], v[54:55], v[88:89]
    v_cvt_pk_bf16_f32 v96, v48, v49
    v_cvt_pk_bf16_f32 v97, v50, v51
    v_cvt_pk_bf16_f32 v98, v52, v53
    v_cvt_pk_bf16_f32 v99, v54, v55
    s_nop 1
    v_permlane16_swap_b32 v96, v98
    v_permlane16_swap_b32 v97, v99
    s_and_b32 s37, s86, 1
    s_lshl_b32 s37, s37, 6
    s_mul_i32 s38, s88, 112
    s_add_u32 s37, s37, s38
    s_add_u32 s37, s37, 0
    s_and_b32 s38, s86, 1
    s_cmp_eq_u32 s38, 1
    s_cselect_b32 exec_hi, 0xffff, -1
    s_lshr_b32 s57, s86, 1
    s_cmp_eq_u32 s57, 0
    s_cselect_b32 s57, s92, s91
    s_cmp_eq_u32 s57, 1
    s_cbranch_scc1 Ls13_p
    buffer_store_dwordx4 v[96:99], v92, s[16:19], s37 offen sc1
    s_branch Ls13_d
Ls13_p:
    buffer_store_dwordx4 v[96:99], v92, s[16:19], s37 offen
Ls13_d:
    s_mov_b64 exec, -1
    s_nop 1
    v_pk_fma_f32 v[56:57], v[64:65], v[82:83], v[56:57] op_sel_hi:[1,0,1] neg_lo:[0,1,0] neg_hi:[0,1,0]
    v_pk_mul_f32 v[56:57], v[56:57], v[82:83] op_sel:[0,1] op_sel_hi:[1,1]
    v_pk_mul_f32 v[88:89], v[56:57], v[56:57]
    v_pk_mul_f32 v[90:91], v[56:57], s[54:55] op_sel:[0,1] op_sel_hi:[1,1]
    v_pk_fma_f32 v[88:89], v[88:89], s[54:55], 1.0 op_sel_hi:[1,0,0]
    v_pk_mul_f32 v[88:89], v[88:89], v[90:91]
    v_exp_f32 v88, v88
    v_exp_f32 v89, v89
    s_nop 0
    v_pk_add_f32 v[88:89], v[88:89], 1.0 op_sel_hi:[1,0]
    v_rcp_f32 v88, v88
    v_rcp_f32 v89, v89
    s_nop 0
    v_pk_mul_f32 v[56:57], v[56:57], v[88:89]
    v_pk_fma_f32 v[58:59], v[66:67], v[82:83], v[58:59] op_sel_hi:[1,0,1] neg_lo:[0,1,0] neg_hi:[0,1,0]
    v_pk_mul_f32 v[58:59], v[58:59], v[82:83] op_sel:[0,1] op_sel_hi:[1,1]
    v_pk_mul_f32 v[88:89], v[58:59], v[58:59]
    v_pk_mul_f32 v[90:91], v[58:59], s[54:55] op_sel:[0,1] op_sel_hi:[1,1]
    v_pk_fma_f32 v[88:89], v[88:89], s[54:55], 1.0 op_sel_hi:[1,0,0]
    v_pk_mul_f32 v[88:89], v[88:89], v[90:91]
    v_exp_f32 v88, v88
    v_exp_f32 v89, v89
    s_nop 0
    v_pk_add_f32 v[88:89], v[88:89], 1.0 op_sel_hi:[1,0]
    v_rcp_f32 v88, v88
    v_rcp_f32 v89, v89
    s_nop 0
    v_pk_mul_f32 v[58:59], v[58:59], v[88:89]
    v_pk_fma_f32 v[60:61], v[68:69], v[82:83], v[60:61] op_sel_hi:[1,0,1] neg_lo:[0,1,0] neg_hi:[0,1,0]
    v_pk_mul_f32 v[60:61], v[60:61], v[82:83] op_sel:[0,1] op_sel_hi:[1,1]
    v_pk_mul_f32 v[88:89], v[60:61], v[60:61]
    v_pk_mul_f32 v[90:91], v[60:61], s[54:55] op_sel:[0,1] op_sel_hi:[1,1]
    v_pk_fma_f32 v[88:89], v[88:89], s[54:55], 1.0 op_sel_hi:[1,0,0]
    v_pk_mul_f32 v[88:89], v[88:89], v[90:91]
    v_exp_f32 v88, v88
    v_exp_f32 v89, v89
    s_nop 0
    v_pk_add_f32 v[88:89], v[88:89], 1.0 op_sel_hi:[1,0]
    v_rcp_f32 v88, v88
    v_rcp_f32 v89, v89
    s_nop 0
    v_pk_mul_f32 v[60:61], v[60:61], v[88:89]
    v_pk_fma_f32 v[62:63], v[70:71], v[82:83], v[62:63] op_sel_hi:[1,0,1] neg_lo:[0,1,0] neg_hi:[0,1,0]
    v_pk_mul_f32 v[62:63], v[62:63], v[82:83] op_sel:[0,1] op_sel_hi:[1,1]
    v_pk_mul_f32 v[88:89], v[62:63], v[62:63]
    v_pk_mul_f32 v[90:91], v[62:63], s[54:55] op_sel:[0,1] op_sel_hi:[1,1]
    v_pk_fma_f32 v[88:89], v[88:89], s[54:55], 1.0 op_sel_hi:[1,0,0]
    v_pk_mul_f32 v[88:89], v[88:89], v[90:91]
    v_exp_f32 v88, v88
    v_exp_f32 v89, v89
    s_nop 0
    v_pk_add_f32 v[88:89], v[88:89], 1.0 op_sel_hi:[1,0]
    v_rcp_f32 v88, v88
    v_rcp_f32 v89, v89
    s_nop 0
    v_pk_mul_f32 v[62:63], v[62:63], v[88:89]
    v_cvt_pk_bf16_f32 v96, v56, v57
    v_cvt_pk_bf16_f32 v97, v58, v59
    v_cvt_pk_bf16_f32 v98, v60, v61
    v_cvt_pk_bf16_f32 v99, v62, v63
    s_nop 1
    v_permlane16_swap_b32 v96, v98
    v_permlane16_swap_b32 v97, v99
    s_and_b32 s37, s86, 1
    s_lshl_b32 s37, s37, 6
    s_mul_i32 s38, s88, 112
    s_add_u32 s37, s37, s38
    s_add_u32 s37, s37, 14336
    s_and_b32 s38, s86, 1
    s_cmp_eq_u32 s38, 1
    s_cselect_b32 exec_hi, 0xffff, -1
    s_lshr_b32 s57, s86, 1
    s_cmp_eq_u32 s57, 1
    s_cselect_b32 s57, s93, s91
    s_cmp_eq_u32 s57, 1
    s_cbranch_scc1 Ls14_p
    buffer_store_dwordx4 v[96:99], v92, s[16:19], s37 offen sc1
    s_branch Ls14_d
Ls14_p:
    buffer_store_dwordx4 v[96:99], v92, s[16:19], s37 offen
Ls14_d:
    s_mov_b64 exec, -1
    s_nop 1
    s_mov_b32 s12, s74
    s_mov_b32 s13, s75
    s_mov_b32 s14, 401408
    s_mov_b32 s15, 0x00020000
    s_lshl_b32 s32, s86, 10
    s_and_b32 s40, s86, 1
    s_mul_i32 s35, s86, 7168
    v_lshrrev_b32 v95, 3, v1
    v_bfe_u32 v93, v1, 4, 1
    v_lshlrev_b32 v93, 1, v93
    s_lshl_b32 s37, s40, 2
    v_add_u32 v93, s37, v93
    v_and_b32 v94, 7, v1
    v_xor_b32 v94, v94, v93
    s_mov_b32 s39, 896
    v_mul_lo_u32 v93, v95, s39
    v_lshl_add_u32 v96, v94, 4, v93
    s_mul_i32 s42, s88, 112
    s_add_u32 s42, s42, 0
    s_add_u32 m0, s32, 57344
    s_add_u32 s37, s35, 0
    s_add_u32 s37, s37, s42
    buffer_load_dwordx4 v96, s[12:15], s37 offen lds
    s_add_u32 m0, s32, 61440
    s_add_u32 s37, s35, 28672
    s_add_u32 s37, s37, s42
    buffer_load_dwordx4 v96, s[12:15], s37 offen lds
    s_add_u32 m0, s32, 65536
    s_add_u32 s37, s35, 57344
    s_add_u32 s37, s37, s42
    buffer_load_dwordx4 v96, s[12:15], s37 offen lds
    s_add_u32 m0, s32, 69632
    s_add_u32 s37, s35, 86016
    s_add_u32 s37, s37, s42
    buffer_load_dwordx4 v96, s[12:15], s37 offen lds
    s_add_u32 m0, s32, 73728
    s_add_u32 s37, s35, 114688
    s_add_u32 s37, s37, s42
    buffer_load_dwordx4 v96, s[12:15], s37 offen lds
    s_add_u32 m0, s32, 77824
    s_add_u32 s37, s35, 143360
    s_add_u32 s37, s37, s42
    buffer_load_dwordx4 v96, s[12:15], s37 offen lds
    s_add_u32 m0, s32, 81920
    s_add_u32 s37, s35, 172032
    s_add_u32 s37, s37, s42
    buffer_load_dwordx4 v96, s[12:15], s37 offen lds
    s_add_u32 m0, s32, 86016
    s_add_u32 s37, s35, 200704
    s_add_u32 s37, s37, s42
    buffer_load_dwordx4 v96, s[12:15], s37 offen lds
    s_add_u32 m0, s32, 90112
    s_add_u32 s37, s35, 229376
    s_add_u32 s37, s37, s42
    buffer_load_dwordx4 v96, s[12:15], s37 offen lds
    s_add_u32 m0, s32, 94208
    s_add_u32 s37, s35, 258048
    s_add_u32 s37, s37, s42
    buffer_load_dwordx4 v96, s[12:15], s37 offen lds
    s_add_u32 m0, s32, 98304
    s_add_u32 s37, s35, 286720
    s_add_u32 s37, s37, s42
    buffer_load_dwordx4 v96, s[12:15], s37 offen lds
    s_add_u32 m0, s32, 102400
    s_add_u32 s37, s35, 315392
    s_add_u32 s37, s37, s42
    buffer_load_dwordx4 v96, s[12:15], s37 offen lds
    s_add_u32 m0, s32, 106496
    s_add_u32 s37, s35, 344064
    s_add_u32 s37, s37, s42
    buffer_load_dwordx4 v96, s[12:15], s37 offen lds
    s_add_u32 m0, s32, 110592
    s_add_u32 s37, s35, 372736
    s_add_u32 s37, s37, s42
    buffer_load_dwordx4 v96, s[12:15], s37 offen lds
    s_waitcnt vmcnt(14)
    s_lshl_b32 s32, s89, 7
    s_lshl_b32 s33, s86, 2
    s_add_u32 s32, s32, s33
    v_mov_b32 v93, s32
    v_mov_b32 v94, 4
    s_mov_b64 exec, 1
    s_and_b32 s57, s92, s93
    s_cmp_eq_u32 s57, 1
    s_cbranch_scc1 Ls15_p
    buffer_store_dword v94, v93, s[24:27], 0 offen sc1
    s_branch Ls15_d
Ls15_p:
    buffer_store_dword v94, v93, s[24:27], 0 offen
Ls15_d:
    s_mov_b64 exec, -1
    s_barrier
    s_add_u32 s8, s84, 5242880
    s_addc_u32 s9, s85, 0
    s_mov_b32 s10, 1835008
    s_mov_b32 s11, 0x00020000
    s_mov_b32 s12, s74
    s_mov_b32 s13, s75
    s_mov_b32 s14, 401408
    s_mov_b32 s15, 0x00020000
    s_lshl_b32 s32, s86, 10
    s_and_b32 s40, s86, 1
    s_add_u32 s33, s40, 8
    s_mul_i32 s34, s86, 7168
    s_mul_i32 s35, s86, 7168
    s_mul_i32 s36, s88, 112
    v_lshrrev_b32 v5, 3, v1
    v_lshrrev_b32 v7, 4, v1
    s_lshl_b32 s37, s40, 2
    v_add_u32 v7, s37, v7
    v_and_b32 v6, 7, v1
    v_xor_b32 v6, v6, v7
    s_lshl_b32 s37, s87, 6
    s_lshl_b32 s38, s86, 3
    s_add_u32 s38, s38, 0
    s_add_u32 s38, s38, s37
    v_add_u32 v7, s38, v5
    s_mov_b32 s39, 896
    v_mul_lo_u32 v7, v7, s39
    v_lshl_add_u32 v9, v6, 4, v7
    s_lshl_b32 s38, s86, 3
    s_add_u32 s38, s38, 32
    s_add_u32 s38, s38, s37
    v_add_u32 v7, s38, v5
    s_mov_b32 s39, 896
    v_mul_lo_u32 v7, v7, s39
    v_lshl_add_u32 v10, v6, 4, v7
    v_bfe_u32 v7, v1, 4, 1
    v_lshlrev_b32 v7, 1, v7
    s_lshl_b32 s37, s40, 2
    v_add_u32 v7, s37, v7
    v_and_b32 v8, 7, v1
    v_xor_b32 v8, v8, v7
    s_mov_b32 s39, 896
    v_mul_lo_u32 v7, v5, s39
    v_lshl_add_u32 v11, v8, 4, v7
    s_add_u32 s42, s36, 0
    s_cmp_lg_u32 s86, 0
    s_cbranch_scc1 Lp16_skip
    v_lshrrev_b32 v15, 3, v1
    v_add_u32 v15, s87, v15
    v_add_u32 v15, -1, v15
    v_mov_b32 v16, s87
    v_cmp_gt_u32 vcc, 32, v15
    s_nop 1
    v_cndmask_b32 v15, v16, v15, vcc
    v_and_b32 v14, 7, v1
    v_lshlrev_b32 v14, 5, v14
    v_and_b32 v16, 3, v15
    v_lshl_add_u32 v14, v16, 3, v14
    v_lshrrev_b32 v16, 2, v15
    v_add_u32 v14, v14, v16
    v_lshlrev_b32 v14, 7, v14
    v_add_u32 v14, 0, v14
    v_mov_b32 v24, 0
    s_mov_b32 s52, 0
    s_mov_b32 s53, 4
    s_mov_b32 exec_lo, 16777215
    s_mov_b32 exec_hi, 0
Lp16_loop:
    buffer_load_dwordx4 v[20:23], v14, s[24:27], 0 offen sc1
    s_waitcnt vmcnt(0)
    v_min_u32 v20, v20, v21
    v_min_u32 v22, v22, v23
    v_min_u32 v20, v20, v22
    v_cmp_gt_u32 vcc, s53, v20
    s_cbranch_vccz Lp16_ok
Lp16_again:
    s_add_u32 s52, s52, 1
    s_cmp_lt_u32 s52, 20000
    s_cbranch_scc1 Lp16_loop
Lp16_ok:
    s_mov_b64 exec, -1
Lp16_skip:
    s_barrier
    v_mov_b32 v12, -896
    s_add_u32 m0, s32, 0
    v_add_u32 v7, v12, v9
    s_mov_b32 s37, 0
    buffer_load_dwordx4 v7, s[8:11], s37 offen lds
    s_add_u32 m0, s32, 4096
    v_add_u32 v7, v12, v10
    s_mov_b32 s37, 0
    buffer_load_dwordx4 v7, s[8:11], s37 offen lds
    v_mov_b32 v13, 896
    v_mov_b32 v12, -896
    v_cmp_le_u32 vcc, 6, v6
    s_nop 1
    v_cndmask_b32 v12, v12, v13, vcc
    s_add_u32 m0, s32, 8192
    v_add_u32 v7, v12, v9
    s_mov_b32 s37, 128
    buffer_load_dwordx4 v7, s[8:11], s37 offen lds
    s_add_u32 m0, s32, 12288
    v_add_u32 v7, v12, v10
    s_mov_b32 s37, 128
    buffer_load_dwordx4 v7, s[8:11], s37 offen lds
    v_mov_b32 v12, 896
    s_add_u32 m0, s32, 16384
    v_add_u32 v7, v12, v9
    s_mov_b32 s37, 256
    buffer_load_dwordx4 v7, s[8:11], s37 offen lds
    s_add_u32 m0, s32, 20480
    v_add_u32 v7, v12, v10
    s_mov_b32 s37, 256
    buffer_load_dwordx4 v7, s[8:11], s37 offen lds
    v_mov_b32 v13, -1792
    v_mov_b32 v12, 896
    v_cmp_le_u32 vcc, 4, v6
    s_nop 1
    v_cndmask_b32 v12, v12, v13, vcc
    s_add_u32 m0, s32, 24576
    v_add_u32 v7, v12, v9
    s_mov_b32 s37, 384
    buffer_load_dwordx4 v7, s[8:11], s37 offen lds
    s_add_u32 m0, s32, 28672
    v_add_u32 v7, v12, v10
    s_mov_b32 s37, 384
    buffer_load_dwordx4 v7, s[8:11], s37 offen lds
    v_mov_b32 v12, -1792
    s_add_u32 m0, s32, 32768
    v_add_u32 v7, v12, v9
    s_mov_b32 s37, 512
    buffer_load_dwordx4 v7, s[8:11], s37 offen lds
    s_add_u32 m0, s32, 36864
    v_add_u32 v7, v12, v10
    s_mov_b32 s37, 512
    buffer_load_dwordx4 v7, s[8:11], s37 offen lds
    v_mov_b32 v13, 1792
    v_mov_b32 v12, -1792
    v_cmp_le_u32 vcc, 2, v6
    s_nop 1
    v_cndmask_b32 v12, v12, v13, vcc
    s_add_u32 m0, s32, 40960
    v_add_u32 v7, v12, v9
    s_mov_b32 s37, 640
    buffer_load_dwordx4 v7, s[8:11], s37 offen lds
    s_add_u32 m0, s32, 45056
    v_add_u32 v7, v12, v10
    s_mov_b32 s37, 640
    buffer_load_dwordx4 v7, s[8:11], s37 offen lds
    v_mov_b32 v12, 1792
    s_add_u32 m0, s32, 49152
    v_add_u32 v7, v12, v9
    s_mov_b32 s37, 768
    buffer_load_dwordx4 v7, s[8:11], s37 offen lds
    s_add_u32 m0, s32, 53248
    v_add_u32 v7, v12, v10
    s_mov_b32 s37, 768
    buffer_load_dwordx4 v7, s[8:11], s37 offen lds
    s_lshl_b32 s37, s87, 6
    s_lshr_b32 s38, s86, 1
    s_mul_i32 s38, s38, 32
    s_add_u32 s37, s37, s38
    v_add_u32 v15, s37, v2
    s_mov_b32 s38, 896
    v_mul_lo_u32 v15, v15, s38
    v_lshl_add_u32 v14, v3, 3, v15
    s_and_b32 s37, s86, 1
    s_lshl_b32 s37, s37, 6
    s_mul_i32 s38, s88, 112
    s_add_u32 s37, s37, s38
    v_add_u32 v14, s37, v14
    s_add_u32 s20, s84, 3145728
    s_addc_u32 s21, s85, 0
    s_mov_b32 s22, 1835008
    s_mov_b32 s23, 0x00020000
    s_mov_b32 s37, 0
    buffer_load_dwordx2 v[16:17], v14, s[20:23], s37 offen offset:0
    buffer_load_dwordx2 v[18:19], v14, s[20:23], s37 offen offset:32
    s_mov_b32 s37, 14336
    buffer_load_dwordx2 v[20:21], v14, s[20:23], s37 offen offset:0
    buffer_load_dwordx2 v[22:23], v14, s[20:23], s37 offen offset:32
    s_add_u32 s20, s84, 11534336
    s_addc_u32 s21, s85, 0
    s_mov_b32 s22, 16384
    s_mov_b32 s23, 0x00020000
    s_lshl_b32 s37, s87, 6
    s_lshr_b32 s38, s86, 1
    s_mul_i32 s38, s38, 32
    s_add_u32 s37, s37, s38
    v_add_u32 v24, s37, v2
    v_lshlrev_b32 v24, 3, v24
    buffer_load_dwordx2 v[26:27], v24, s[20:23], 0 offen offset:0
    buffer_load_dwordx2 v[28:29], v24, s[20:23], 0 offen offset:128
    v_lshrrev_b32 v7, 1, v2
    v_and_b32 v7, 7, v7
    v_add_u32 v8, 0, v3
    v_xor_b32 v8, v8, v7
    v_lshlrev_b32 v8, 4, v8
    v_lshl_add_u32 v30, v2, 7, v8
    v_add_u32 v8, 4, v3
    v_xor_b32 v8, v8, v7
    v_lshlrev_b32 v8, 4, v8
    v_lshl_add_u32 v31, v2, 7, v8
    s_lshr_b32 s37, s86, 1
    s_mul_i32 s37, s37, 4096
    v_add_u32 v30, s37, v30
    v_add_u32 v31, s37, v31
    v_lshrrev_b32 v34, 2, v2
    v_lshl_add_u32 v34, v3, 3, v34
    v_lshlrev_b32 v34, 7, v34
    v_bfe_u32 v35, v2, 3, 1
    v_lshlrev_b32 v35, 2, v35
    v_and_b32 v7, 1, v3
    v_lshl_add_u32 v35, v7, 3, v35
    v_and_b32 v36, 3, v2
    s_and_b32 s37, s86, 1
    s_mul_i32 s37, s37, 2
    s_add_u32 s38, s37, 0
    s_and_b32 s39, s38, 3
    s_lshl_b32 s39, s39, 2
    v_add_u32 v7, s39, v36
    v_xor_b32 v7, v7, v35
    v_lshl_add_u32 v7, v7, 3, v34
    s_lshr_b32 s38, s38, 2
    s_lshl_b32 s38, s38, 13
    v_add_u32 v32, s38, v7
    s_add_u32 s38, s37, 1
    s_and_b32 s39, s38, 3
    s_lshl_b32 s39, s39, 2
    v_add_u32 v7, s39, v36
    v_xor_b32 v7, v7, v35
    v_lshl_add_u32 v7, v7, 3, v34
    s_lshr_b32 s38, s38, 2
    s_lshl_b32 s38, s38, 13
    v_add_u32 v33, s38, v7
    v_add_u32 v37, 65536, v30
    v_add_u32 v38, 65536, v31
    v_add_u32 v39, 65536, v32
    v_add_u32 v40, 65536, v33
    v_mov_b32 v44, 0
    v_mov_b32 v45, 0
    v_mov_b32 v46, 0
    v_mov_b32 v47, 0
    v_mov_b32 v48, 0
    v_mov_b32 v49, 0
    v_mov_b32 v50, 0
    v_mov_b32 v51, 0
    v_mov_b32 v52, 0
    v_mov_b32 v53, 0
    v_mov_b32 v54, 0
    v_mov_b32 v55, 0
    v_mov_b32 v56, 0
    v_mov_b32 v57, 0
    v_mov_b32 v58, 0
    v_mov_b32 v59, 0
    s_waitcnt vmcnt(31)
    s_waitcnt vmcnt(16)
    s_barrier
    ds_read_b128 v[60:63], v30 offset:0
    ds_read_b128 v[64:67], v30 offset:2048
    ds_read_b64_tr_b16 v[76:77], v32 offset:57344
    ds_read_b64_tr_b16 v[78:79], v32 offset:57856
    ds_read_b64_tr_b16 v[80:81], v33 offset:57344
    ds_read_b64_tr_b16 v[82:83], v33 offset:57856
    s_waitcnt lgkmcnt(0)
    v_mfma_f32_16x16x32_bf16 v[44:47], v[76:79], v[60:63], v[44:47]
    ds_read_b128 v[68:71], v31 offset:0
    ds_read_b128 v[72:75], v31 offset:2048
    ds_read_b64_tr_b16 v[84:85], v32 offset:61440
    v_mfma_f32_16x16x32_bf16 v[52:55], v[76:79], v[64:67], v[52:55]
    ds_read_b64_tr_b16 v[86:87], v32 offset:61952
    ds_read_b64_tr_b16 v[88:89], v33 offset:61440
    ds_read_b64_tr_b16 v[90:91], v33 offset:61952
    v_mfma_f32_16x16x32_bf16 v[48:51], v[80:83], v[60:63], v[48:51]
    v_mfma_f32_16x16x32_bf16 v[56:59], v[80:83], v[64:67], v[56:59]
    s_waitcnt lgkmcnt(0)
    v_mfma_f32_16x16x32_bf16 v[44:47], v[84:87], v[68:71], v[44:47]
    ds_read_b128 v[60:63], v30 offset:8192
    ds_read_b128 v[64:67], v30 offset:10240
    ds_read_b64_tr_b16 v[76:77], v39 offset:0
    v_mfma_f32_16x16x32_bf16 v[52:55], v[84:87], v[72:75], v[52:55]
    ds_read_b64_tr_b16 v[78:79], v39 offset:512
    ds_read_b64_tr_b16 v[80:81], v40 offset:0
    ds_read_b64_tr_b16 v[82:83], v40 offset:512
    v_mfma_f32_16x16x32_bf16 v[48:51], v[88:91], v[68:71], v[48:51]
    v_mfma_f32_16x16x32_bf16 v[56:59], v[88:91], v[72:75], v[56:59]
    s_waitcnt lgkmcnt(0)
    v_mfma_f32_16x16x32_bf16 v[44:47], v[76:79], v[60:63], v[44:47]
    ds_read_b128 v[68:71], v31 offset:8192
    ds_read_b128 v[72:75], v31 offset:10240
    ds_read_b64_tr_b16 v[84:85], v39 offset:4096
    v_mfma_f32_16x16x32_bf16 v[52:55], v[76:79], v[64:67], v[52:55]
    ds_read_b64_tr_b16 v[86:87], v39 offset:4608
    ds_read_b64_tr_b16 v[88:89], v40 offset:4096
    ds_read_b64_tr_b16 v[90:91], v40 offset:4608
    v_mfma_f32_16x16x32_bf16 v[48:51], v[80:83], v[60:63], v[48:51]
    v_mfma_f32_16x16x32_bf16 v[56:59], v[80:83], v[64:67], v[56:59]
    s_waitcnt lgkmcnt(0)
    s_waitcnt vmcnt(10)
    s_barrier
    v_mfma_f32_16x16x32_bf16 v[44:47], v[84:87], v[68:71], v[44:47]
    ds_read_b128 v[60:63], v30 offset:16384
    ds_read_b128 v[64:67], v30 offset:18432
    ds_read_b64_tr_b16 v[76:77], v39 offset:8192
    v_mfma_f32_16x16x32_bf16 v[52:55], v[84:87], v[72:75], v[52:55]
    ds_read_b64_tr_b16 v[78:79], v39 offset:8704
    ds_read_b64_tr_b16 v[80:81], v40 offset:8192
    ds_read_b64_tr_b16 v[82:83], v40 offset:8704
    v_mfma_f32_16x16x32_bf16 v[48:51], v[88:91], v[68:71], v[48:51]
    v_mfma_f32_16x16x32_bf16 v[56:59], v[88:91], v[72:75], v[56:59]
    s_waitcnt lgkmcnt(0)
    v_mfma_f32_16x16x32_bf16 v[44:47], v[76:79], v[60:63], v[44:47]
    ds_read_b128 v[68:71], v31 offset:16384
    ds_read_b128 v[72:75], v31 offset:18432
    ds_read_b64_tr_b16 v[84:85], v39 offset:12288
    v_mfma_f32_16x16x32_bf16 v[52:55], v[76:79], v[64:67], v[52:55]
    ds_read_b64_tr_b16 v[86:87], v39 offset:12800
    ds_read_b64_tr_b16 v[88:89], v40 offset:12288
    ds_read_b64_tr_b16 v[90:91], v40 offset:12800
    v_mfma_f32_16x16x32_bf16 v[48:51], v[80:83], v[60:63], v[48:51]
    v_mfma_f32_16x16x32_bf16 v[56:59], v[80:83], v[64:67], v[56:59]
    s_waitcnt lgkmcnt(0)
    v_mfma_f32_16x16x32_bf16 v[44:47], v[84:87], v[68:71], v[44:47]
    ds_read_b128 v[60:63], v30 offset:24576
    ds_read_b128 v[64:67], v30 offset:26624
    ds_read_b64_tr_b16 v[76:77], v39 offset:16384
    v_mfma_f32_16x16x32_bf16 v[52:55], v[84:87], v[72:75], v[52:55]
    ds_read_b64_tr_b16 v[78:79], v39 offset:16896
    ds_read_b64_tr_b16 v[80:81], v40 offset:16384
    ds_read_b64_tr_b16 v[82:83], v40 offset:16896
    v_mfma_f32_16x16x32_bf16 v[48:51], v[88:91], v[68:71], v[48:51]
    v_mfma_f32_16x16x32_bf16 v[56:59], v[88:91], v[72:75], v[56:59]
    s_waitcnt lgkmcnt(0)
    v_mfma_f32_16x16x32_bf16 v[44:47], v[76:79], v[60:63], v[44:47]
    ds_read_b128 v[68:71], v31 offset:24576
    ds_read_b128 v[72:75], v31 offset:26624
    ds_read_b64_tr_b16 v[84:85], v39 offset:20480
    v_mfma_f32_16x16x32_bf16 v[52:55], v[76:79], v[64:67], v[52:55]
    ds_read_b64_tr_b16 v[86:87], v39 offset:20992
    ds_read_b64_tr_b16 v[88:89], v40 offset:20480
    ds_read_b64_tr_b16 v[90:91], v40 offset:20992
    v_mfma_f32_16x16x32_bf16 v[48:51], v[80:83], v[60:63], v[48:51]
    v_mfma_f32_16x16x32_bf16 v[56:59], v[80:83], v[64:67], v[56:59]
    s_waitcnt lgkmcnt(0)
    v_mfma_f32_16x16x32_bf16 v[44:47], v[84:87], v[68:71], v[44:47]
    ds_read_b128 v[60:63], v30 offset:32768
    ds_read_b128 v[64:67], v30 offset:34816
    ds_read_b64_tr_b16 v[76:77], v39 offset:24576
    v_mfma_f32_16x16x32_bf16 v[52:55], v[84:87], v[72:75], v[52:55]
    ds_read_b64_tr_b16 v[78:79], v39 offset:25088
    ds_read_b64_tr_b16 v[80:81], v40 offset:24576
    ds_read_b64_tr_b16 v[82:83], v40 offset:25088
    v_mfma_f32_16x16x32_bf16 v[48:51], v[88:91], v[68:71], v[48:51]
    v_mfma_f32_16x16x32_bf16 v[56:59], v[88:91], v[72:75], v[56:59]
    s_waitcnt lgkmcnt(0)
    v_mfma_f32_16x16x32_bf16 v[44:47], v[76:79], v[60:63], v[44:47]
    ds_read_b128 v[68:71], v31 offset:32768
    ds_read_b128 v[72:75], v31 offset:34816
    ds_read_b64_tr_b16 v[84:85], v39 offset:28672
    v_mfma_f32_16x16x32_bf16 v[52:55], v[76:79], v[64:67], v[52:55]
    ds_read_b64_tr_b16 v[86:87], v39 offset:29184
    ds_read_b64_tr_b16 v[88:89], v40 offset:28672
    ds_read_b64_tr_b16 v[90:91], v40 offset:29184
    v_mfma_f32_16x16x32_bf16 v[48:51], v[80:83], v[60:63], v[48:51]
    v_mfma_f32_16x16x32_bf16 v[56:59], v[80:83], v[64:67], v[56:59]
    s_waitcnt lgkmcnt(0)
    s_waitcnt vmcnt(6)
    s_barrier
    v_mfma_f32_16x16x32_bf16 v[44:47], v[84:87], v[68:71], v[44:47]
    ds_read_b128 v[60:63], v30 offset:40960
    ds_read_b128 v[64:67], v30 offset:43008
    ds_read_b64_tr_b16 v[76:77], v39 offset:32768
    v_mfma_f32_16x16x32_bf16 v[52:55], v[84:87], v[72:75], v[52:55]
    ds_read_b64_tr_b16 v[78:79], v39 offset:33280
    ds_read_b64_tr_b16 v[80:81], v40 offset:32768
    ds_read_b64_tr_b16 v[82:83], v40 offset:33280
    v_mfma_f32_16x16x32_bf16 v[48:51], v[88:91], v[68:71], v[48:51]
    v_mfma_f32_16x16x32_bf16 v[56:59], v[88:91], v[72:75], v[56:59]
    s_waitcnt lgkmcnt(0)
    v_mfma_f32_16x16x32_bf16 v[44:47], v[76:79], v[60:63], v[44:47]
    ds_read_b128 v[68:71], v31 offset:40960
    ds_read_b128 v[72:75], v31 offset:43008
    ds_read_b64_tr_b16 v[84:85], v39 offset:36864
    v_mfma_f32_16x16x32_bf16 v[52:55], v[76:79], v[64:67], v[52:55]
    ds_read_b64_tr_b16 v[86:87], v39 offset:37376
    ds_read_b64_tr_b16 v[88:89], v40 offset:36864
    ds_read_b64_tr_b16 v[90:91], v40 offset:37376
    v_mfma_f32_16x16x32_bf16 v[48:51], v[80:83], v[60:63], v[48:51]
    v_mfma_f32_16x16x32_bf16 v[56:59], v[80:83], v[64:67], v[56:59]
    s_waitcnt lgkmcnt(0)
    v_mfma_f32_16x16x32_bf16 v[44:47], v[84:87], v[68:71], v[44:47]
    ds_read_b128 v[60:63], v30 offset:49152
    ds_read_b128 v[64:67], v30 offset:51200
    ds_read_b64_tr_b16 v[76:77], v39 offset:40960
    v_mfma_f32_16x16x32_bf16 v[52:55], v[84:87], v[72:75], v[52:55]
    ds_read_b64_tr_b16 v[78:79], v39 offset:41472
    ds_read_b64_tr_b16 v[80:81], v40 offset:40960
    ds_read_b64_tr_b16 v[82:83], v40 offset:41472
    v_mfma_f32_16x16x32_bf16 v[48:51], v[88:91], v[68:71], v[48:51]
    v_mfma_f32_16x16x32_bf16 v[56:59], v[88:91], v[72:75], v[56:59]
    s_waitcnt lgkmcnt(0)
    v_mfma_f32_16x16x32_bf16 v[44:47], v[76:79], v[60:63], v[44:47]
    ds_read_b128 v[68:71], v31 offset:49152
    ds_read_b128 v[72:75], v31 offset:51200
    ds_read_b64_tr_b16 v[84:85], v39 offset:45056
    v_mfma_f32_16x16x32_bf16 v[52:55], v[76:79], v[64:67], v[52:55]
    ds_read_b64_tr_b16 v[86:87], v39 offset:45568
    ds_read_b64_tr_b16 v[88:89], v40 offset:45056
    ds_read_b64_tr_b16 v[90:91], v40 offset:45568
    v_mfma_f32_16x16x32_bf16 v[48:51], v[80:83], v[60:63], v[48:51]
    v_mfma_f32_16x16x32_bf16 v[56:59], v[80:83], v[64:67], v[56:59]
    s_waitcnt lgkmcnt(0)
    v_mfma_f32_16x16x32_bf16 v[44:47], v[84:87], v[68:71], v[44:47]
    v_mfma_f32_16x16x32_bf16 v[52:55], v[84:87], v[72:75], v[52:55]
    v_mfma_f32_16x16x32_bf16 v[48:51], v[88:91], v[68:71], v[48:51]
    v_mfma_f32_16x16x32_bf16 v[56:59], v[88:91], v[72:75], v[56:59]
    s_nop 7
    s_nop 7
    s_barrier
    s_mov_b32 s54, 1027024659
    s_mov_b32 s55, 3222493025
    s_waitcnt vmcnt(0)
    s_add_u32 s16, s84, 7340032
    s_addc_u32 s17, s85, 0
    s_mov_b32 s18, 1835008
    s_mov_b32 s19, 0x00020000
    s_lshl_b32 s37, s87, 6
    s_lshr_b32 s38, s86, 1
    s_mul_i32 s38, s38, 32
    s_add_u32 s37, s37, s38
    v_add_u32 v60, s37, v2
    s_mov_b32 s38, 896
    v_mul_lo_u32 v68, v60, s38
    v_and_b32 v60, 1, v3
    v_lshl_add_u32 v68, v60, 5, v68
    v_lshrrev_b32 v60, 1, v3
    v_lshl_add_u32 v68, v60, 4, v68
    v_lshlrev_b32 v60, 16, v16
    v_sub_f32 v60, v60, v26
    v_mul_f32 v60, v60, v27
    v_add_f32 v44, v44, v60
    v_and_b32 v60, 0xffff0000, v16
    v_sub_f32 v60, v60, v26
    v_mul_f32 v60, v60, v27
    v_add_f32 v45, v45, v60
    v_lshlrev_b32 v60, 16, v17
    v_sub_f32 v60, v60, v26
    v_mul_f32 v60, v60, v27
    v_add_f32 v46, v46, v60
    v_and_b32 v60, 0xffff0000, v17
    v_sub_f32 v60, v60, v26
    v_mul_f32 v60, v60, v27
    v_add_f32 v47, v47, v60
    v_lshlrev_b32 v60, 16, v18
    v_sub_f32 v60, v60, v26
    v_mul_f32 v60, v60, v27
    v_add_f32 v48, v48, v60
    v_and_b32 v60, 0xffff0000, v18
    v_sub_f32 v60, v60, v26
    v_mul_f32 v60, v60, v27
    v_add_f32 v49, v49, v60
    v_lshlrev_b32 v60, 16, v19
    v_sub_f32 v60, v60, v26
    v_mul_f32 v60, v60, v27
    v_add_f32 v50, v50, v60
    v_and_b32 v60, 0xffff0000, v19
    v_sub_f32 v60, v60, v26
    v_mul_f32 v60, v60, v27
    v_add_f32 v51, v51, v60
    v_cvt_pk_bf16_f32 v72, v44, v45
    v_cvt_pk_bf16_f32 v73, v46, v47
    v_cvt_pk_bf16_f32 v74, v48, v49
    v_cvt_pk_bf16_f32 v75, v50, v51
    s_nop 1
    v_permlane16_swap_b32 v72, v74
    v_permlane16_swap_b32 v73, v75
    s_and_b32 s37, s86, 1
    s_lshl_b32 s37, s37, 6
    s_mul_i32 s38, s88, 112
    s_add_u32 s37, s37, s38
    s_add_u32 s37, s37, 0
    s_and_b32 s38, s86, 1
    s_cmp_eq_u32 s38, 1
    s_cselect_b32 exec_hi, 0xffff, -1
    s_cmp_eq_u32 s91, 1
    s_cbranch_scc1 Ls17_p
    buffer_store_dwordx4 v[72:75], v68, s[16:19], s37 offen sc1
    s_branch Ls17_d
Ls17_p:
    buffer_store_dwordx4 v[72:75], v68, s[16:19], s37 offen
Ls17_d:
    s_mov_b64 exec, -1
    s_nop 1
    v_lshlrev_b32 v60, 16, v20
    v_sub_f32 v60, v60, v28
    v_mul_f32 v60, v60, v29
    v_add_f32 v52, v52, v60
    v_and_b32 v60, 0xffff0000, v20
    v_sub_f32 v60, v60, v28
    v_mul_f32 v60, v60, v29
    v_add_f32 v53, v53, v60
    v_lshlrev_b32 v60, 16, v21
    v_sub_f32 v60, v60, v28
    v_mul_f32 v60, v60, v29
    v_add_f32 v54, v54, v60
    v_and_b32 v60, 0xffff0000, v21
    v_sub_f32 v60, v60, v28
    v_mul_f32 v60, v60, v29
    v_add_f32 v55, v55, v60
    v_lshlrev_b32 v60, 16, v22
    v_sub_f32 v60, v60, v28
    v_mul_f32 v60, v60, v29
    v_add_f32 v56, v56, v60
    v_and_b32 v60, 0xffff0000, v22
    v_sub_f32 v60, v60, v28
    v_mul_f32 v60, v60, v29
    v_add_f32 v57, v57, v60
    v_lshlrev_b32 v60, 16, v23
    v_sub_f32 v60, v60, v28
    v_mul_f32 v60, v60, v29
    v_add_f32 v58, v58, v60
    v_and_b32 v60, 0xffff0000, v23
    v_sub_f32 v60, v60, v28
    v_mul_f32 v60, v60, v29
    v_add_f32 v59, v59, v60
    v_cvt_pk_bf16_f32 v72, v52, v53
    v_cvt_pk_bf16_f32 v73, v54, v55
    v_cvt_pk_bf16_f32 v74, v56, v57
    v_cvt_pk_bf16_f32 v75, v58, v59
    s_nop 1
    v_permlane16_swap_b32 v72, v74
    v_permlane16_swap_b32 v73, v75
    s_and_b32 s37, s86, 1
    s_lshl_b32 s37, s37, 6
    s_mul_i32 s38, s88, 112
    s_add_u32 s37, s37, s38
    s_add_u32 s37, s37, 14336
    s_and_b32 s38, s86, 1
    s_cmp_eq_u32 s38, 1
    s_cselect_b32 exec_hi, 0xffff, -1
    s_cmp_eq_u32 s91, 1
    s_cbranch_scc1 Ls18_p
    buffer_store_dwordx4 v[72:75], v68, s[16:19], s37 offen sc1
    s_branch Ls18_d
Ls18_p:
    buffer_store_dwordx4 v[72:75], v68, s[16:19], s37 offen
Ls18_d:
    s_mov_b64 exec, -1
    s_nop 1
    s_and_b32 s37, s86, 1
    s_cmp_eq_u32 s37, 1
    s_cselect_b32 s61, 0, -1
    s_mov_b32 s60, -1
    s_add_u32 s20, s84, 43515904
    s_addc_u32 s21, s85, 0
    s_mov_b32 s22, 262144
    s_mov_b32 s23, 0x00020000
    v_mov_b32 v72, 0
    s_lshl_b32 s37, s87, 6
    s_lshr_b32 s38, s86, 1
    s_mul_i32 s38, s38, 32
    s_add_u32 s37, s37, s38
    v_add_u32 v69, s37, v2
    v_lshlrev_b32 v69, 7, v69
    s_lshl_b32 s37, s88, 1
    s_and_b32 s38, s86, 1
    s_add_u32 s37, s37, s38
    s_lshl_b32 s37, s37, 3
    v_add_u32 v69, s37, v69
    v_mov_b32 v70, v44
    v_mul_f32 v71, v44, v44
    v_add_f32 v70, v70, v45
    v_fma_f32 v71, v45, v45, v71
    v_add_f32 v70, v70, v46
    v_fma_f32 v71, v46, v46, v71
    v_add_f32 v70, v70, v47
    v_fma_f32 v71, v47, v47, v71
    v_cndmask_b32 v60, v72, v48, s[60:61]
    v_add_f32 v70, v70, v60
    v_fma_f32 v71, v60, v60, v71
    v_cndmask_b32 v60, v72, v49, s[60:61]
    v_add_f32 v70, v70, v60
    v_fma_f32 v71, v60, v60, v71
    v_cndmask_b32 v60, v72, v50, s[60:61]
    v_add_f32 v70, v70, v60
    v_fma_f32 v71, v60, v60, v71
    v_cndmask_b32 v60, v72, v51, s[60:61]
    v_add_f32 v70, v70, v60
    v_fma_f32 v71, v60, v60, v71
    v_mov_b32 v60, v70
    s_nop 1
    v_permlane16_swap_b32 v70, v60
    v_add_f32 v70, v70, v60
    v_mov_b32 v60, v70
    s_nop 1
    v_permlane32_swap_b32 v70, v60
    v_add_f32 v70, v70, v60
    v_mov_b32 v60, v71
    s_nop 1
    v_permlane16_swap_b32 v71, v60
    v_add_f32 v71, v71, v60
    v_mov_b32 v60, v71
    s_nop 1
    v_permlane32_swap_b32 v71, v60
    v_add_f32 v71, v71, v60
    s_mov_b32 exec_lo, 0xffff
    s_mov_b32 exec_hi, 0
    s_cmp_eq_u32 s91, 1
    s_cbranch_scc1 Ls19_p
    buffer_store_dwordx2 v[70:71], v69, s[20:23], 0 offen offset:0 sc1
    s_branch Ls19_d
Ls19_p:
    buffer_store_dwordx2 v[70:71], v69, s[20:23], 0 offen offset:0
Ls19_d:
    s_mov_b64 exec, -1
    s_nop 1
    v_mov_b32 v70, v52
    v_mul_f32 v71, v52, v52
    v_add_f32 v70, v70, v53
    v_fma_f32 v71, v53, v53, v71
    v_add_f32 v70, v70, v54
    v_fma_f32 v71, v54, v54, v71
    v_add_f32 v70, v70, v55
    v_fma_f32 v71, v55, v55, v71
    v_cndmask_b32 v60, v72, v56, s[60:61]
    v_add_f32 v70, v70, v60
    v_fma_f32 v71, v60, v60, v71
    v_cndmask_b32 v60, v72, v57, s[60:61]
    v_add_f32 v70, v70, v60
    v_fma_f32 v71, v60, v60, v71
    v_cndmask_b32 v60, v72, v58, s[60:61]
    v_add_f32 v70, v70, v60
    v_fma_f32 v71, v60, v60, v71
    v_cndmask_b32 v60, v72, v59, s[60:61]
    v_add_f32 v70, v70, v60
    v_fma_f32 v71, v60, v60, v71
    v_mov_b32 v60, v70
    s_nop 1
    v_permlane16_swap_b32 v70, v60
    v_add_f32 v70, v70, v60
    v_mov_b32 v60, v70
    s_nop 1
    v_permlane32_swap_b32 v70, v60
    v_add_f32 v70, v70, v60
    v_mov_b32 v60, v71
    s_nop 1
    v_permlane16_swap_b32 v71, v60
    v_add_f32 v71, v71, v60
    v_mov_b32 v60, v71
    s_nop 1
    v_permlane32_swap_b32 v71, v60
    v_add_f32 v71, v71, v60
    s_mov_b32 exec_lo, 0xffff
    s_mov_b32 exec_hi, 0
    s_cmp_eq_u32 s91, 1
    s_cbranch_scc1 Ls20_p
    buffer_store_dwordx2 v[70:71], v69, s[20:23], 0 offen offset:2048 sc1
    s_branch Ls20_d
Ls20_p:
    buffer_store_dwordx2 v[70:71], v69, s[20:23], 0 offen offset:2048
Ls20_d:
    s_mov_b64 exec, -1
    s_nop 1
    s_mov_b32 s12, s76
    s_mov_b32 s13, s77
    s_mov_b32 s14, 1605632
    s_mov_b32 s15, 0x00020000
    s_lshl_b32 s32, s86, 10
    s_and_b32 s40, s86, 1
    s_mul_i32 s35, s86, 28672
    v_lshrrev_b32 v75, 3, v1
    v_bfe_u32 v73, v1, 4, 1
    v_lshlrev_b32 v73, 1, v73
    s_lshl_b32 s37, s40, 2
    v_add_u32 v73, s37, v73
    v_and_b32 v74, 7, v1
    v_xor_b32 v74, v74, v73
    s_mov_b32 s39, 3584
    v_mul_lo_u32 v73, v75, s39
    v_lshl_add_u32 v76, v74, 4, v73
    s_mul_i32 s42, s88, 448
    s_add_u32 s42, s42, 0
    s_mul_i32 s43, s88, 448
    s_add_u32 s43, s43, 112
    s_mul_i32 s44, s88, 448
    s_add_u32 s44, s44, 224
    s_mul_i32 s45, s88, 448
    s_add_u32 s45, s45, 336
    s_add_u32 m0, s32, 57344
    s_add_u32 s37, s35, 0
    s_add_u32 s37, s37, s42
    buffer_load_dwordx4 v76, s[12:15], s37 offen lds
    s_add_u32 m0, s32, 61440
    s_add_u32 s37, s35, 114688
    s_add_u32 s37, s37, s42
    buffer_load_dwordx4 v76, s[12:15], s37 offen lds
    s_add_u32 m0, s32, 65536
    s_add_u32 s37, s35, 0
    s_add_u32 s37, s37, s43
    buffer_load_dwordx4 v76, s[12:15], s37 offen lds
    s_add_u32 m0, s32, 69632
    s_add_u32 s37, s35, 114688
    s_add_u32 s37, s37, s43
    buffer_load_dwordx4 v76, s[12:15], s37 offen lds
    s_add_u32 m0, s32, 73728
    s_add_u32 s37, s35, 0
    s_add_u32 s37, s37, s44
    buffer_load_dwordx4 v76, s[12:15], s37 offen lds
    s_add_u32 m0, s32, 77824
    s_add_u32 s37, s35, 114688
    s_add_u32 s37, s37, s44
    buffer_load_dwordx4 v76, s[12:15], s37 offen lds
    s_add_u32 m0, s32, 81920
    s_add_u32 s37, s35, 0
    s_add_u32 s37, s37, s45
    buffer_load_dwordx4 v76, s[12:15], s37 offen lds
    s_add_u32 m0, s32, 86016
    s_add_u32 s37, s35, 114688
    s_add_u32 s37, s37, s45
    buffer_load_dwordx4 v76, s[12:15], s37 offen lds
    s_add_u32 m0, s32, 90112
    s_add_u32 s37, s35, 229376
    s_add_u32 s37, s37, s42
    buffer_load_dwordx4 v76, s[12:15], s37 offen lds
    s_add_u32 m0, s32, 94208
    s_add_u32 s37, s35, 344064
    s_add_u32 s37, s37, s42
    buffer_load_dwordx4 v76, s[12:15], s37 offen lds
    s_add_u32 m0, s32, 98304
    s_add_u32 s37, s35, 229376
    s_add_u32 s37, s37, s43
    buffer_load_dwordx4 v76, s[12:15], s37 offen lds
    s_add_u32 m0, s32, 102400
    s_add_u32 s37, s35, 344064
    s_add_u32 s37, s37, s43
    buffer_load_dwordx4 v76, s[12:15], s37 offen lds
    s_add_u32 m0, s32, 106496
    s_add_u32 s37, s35, 229376
    s_add_u32 s37, s37, s44
    buffer_load_dwordx4 v76, s[12:15], s37 offen lds
    s_add_u32 m0, s32, 110592
    s_add_u32 s37, s35, 344064
    s_add_u32 s37, s37, s44
    buffer_load_dwordx4 v76, s[12:15], s37 offen lds
    s_add_u32 m0, s32, 114688
    s_add_u32 s37, s35, 229376
    s_add_u32 s37, s37, s45
    buffer_load_dwordx4 v76, s[12:15], s37 offen lds
    s_add_u32 m0, s32, 118784
    s_add_u32 s37, s35, 344064
    s_add_u32 s37, s37, s45
    buffer_load_dwordx4 v76, s[12:15], s37 offen lds
    s_add_u32 m0, s32, 122880
    s_add_u32 s37, s35, 458752
    s_add_u32 s37, s37, s42
    buffer_load_dwordx4 v76, s[12:15], s37 offen lds
    s_add_u32 m0, s32, 126976
    s_add_u32 s37, s35, 573440
    s_add_u32 s37, s37, s42
    buffer_load_dwordx4 v76, s[12:15], s37 offen lds
    s_add_u32 m0, s32, 131072
    s_add_u32 s37, s35, 458752
    s_add_u32 s37, s37, s43
    buffer_load_dwordx4 v76, s[12:15], s37 offen lds
    s_add_u32 m0, s32, 135168
    s_add_u32 s37, s35, 573440
    s_add_u32 s37, s37, s43
    buffer_load_dwordx4 v76, s[12:15], s37 offen lds
    s_add_u32 m0, s32, 139264
    s_add_u32 s37, s35, 458752
    s_add_u32 s37, s37, s44
    buffer_load_dwordx4 v76, s[12:15], s37 offen lds
    s_add_u32 m0, s32, 143360
    s_add_u32 s37, s35, 573440
    s_add_u32 s37, s37, s44
    buffer_load_dwordx4 v76, s[12:15], s37 offen lds
    s_add_u32 m0, s32, 147456
    s_add_u32 s37, s35, 458752
    s_add_u32 s37, s37, s45
    buffer_load_dwordx4 v76, s[12:15], s37 offen lds
    s_add_u32 m0, s32, 151552
    s_add_u32 s37, s35, 573440
    s_add_u32 s37, s37, s45
    buffer_load_dwordx4 v76, s[12:15], s37 offen lds
    s_waitcnt vmcnt(24)
    s_lshl_b32 s32, s89, 7
    s_lshl_b32 s33, s86, 2
    s_add_u32 s32, s32, s33
    v_mov_b32 v73, s32
    v_mov_b32 v74, 5
    s_mov_b64 exec, 1
    s_mov_b32 s57, s91
    s_cmp_eq_u32 s57, 1
    s_cbranch_scc1 Ls21_p
    buffer_store_dword v74, v73, s[24:27], 0 offen sc1
    s_branch Ls21_d
Ls21_p:
    buffer_store_dword v74, v73, s[24:27], 0 offen
Ls21_d:
    s_mov_b64 exec, -1
    s_barrier
    s_add_u32 s8, s84, 7340032
    s_addc_u32 s9, s85, 0
    s_mov_b32 s10, 1835008
    s_mov_b32 s11, 0x00020000
    s_mov_b32 s12, s76
    s_mov_b32 s13, s77
    s_mov_b32 s14, 1605632
    s_mov_b32 s15, 0x00020000
    s_lshl_b32 s32, s86, 10
    s_and_b32 s40, s86, 1
    s_add_u32 s33, s40, 8
    s_mul_i32 s34, s86, 7168
    s_mul_i32 s35, s86, 28672
    s_mul_i32 s36, s88, 112
    v_lshrrev_b32 v5, 3, v1
    v_lshrrev_b32 v7, 4, v1
    s_lshl_b32 s37, s40, 2
    v_add_u32 v7, s37, v7
    v_and_b32 v6, 7, v1
    v_xor_b32 v6, v6, v7
    s_lshl_b32 s37, s87, 6
    s_lshl_b32 s38, s86, 3
    s_add_u32 s38, s38, 0
    s_add_u32 s38, s38, s37
    v_add_u32 v7, s38, v5
    s_mov_b32 s39, 896
    v_mul_lo_u32 v7, v7, s39
    v_lshl_add_u32 v9, v6, 4, v7
    s_lshl_b32 s38, s86, 3
    s_add_u32 s38, s38, 32
    s_add_u32 s38, s38, s37
    v_add_u32 v7, s38, v5
    s_mov_b32 s39, 896
    v_mul_lo_u32 v7, v7, s39
    v_lshl_add_u32 v10, v6, 4, v7
    v_bfe_u32 v7, v1, 4, 1
    v_lshlrev_b32 v7, 1, v7
    s_lshl_b32 s37, s40, 2
    v_add_u32 v7, s37, v7
    v_and_b32 v8, 7, v1
    v_xor_b32 v8, v8, v7
    s_mov_b32 s39, 3584
    v_mul_lo_u32 v7, v5, s39
    v_lshl_add_u32 v11, v8, 4, v7
    s_mul_i32 s42, s88, 448
    s_add_u32 s42, s42, 0
    s_mul_i32 s43, s88, 448
    s_add_u32 s43, s43, 112
    s_mul_i32 s44, s88, 448
    s_add_u32 s44, s44, 224
    s_mul_i32 s45, s88, 448
    s_add_u32 s45, s45, 336
    s_cmp_lg_u32 s86, 0
    s_cbranch_scc1 Lp22_skip
    v_lshrrev_b32 v13, 3, v1
    v_add_u32 v13, s87, v13
    v_add_u32 v13, 0, v13
    v_mov_b32 v14, s87
    v_cmp_gt_u32 vcc, 32, v13
    s_nop 1
    v_cndmask_b32 v13, v14, v13, vcc
    v_and_b32 v12, 7, v1
    v_lshlrev_b32 v12, 5, v12
    v_and_b32 v14, 3, v13
    v_lshl_add_u32 v12, v14, 3, v12
    v_lshrrev_b32 v14, 2, v13
    v_add_u32 v12, v12, v14
    v_lshlrev_b32 v12, 7, v12
    v_add_u32 v12, 0, v12
    v_mov_b32 v20, 0
    s_mov_b32 s52, 0
    s_mov_b32 s53, 5
    s_mov_b32 exec_lo, 255
    s_mov_b32 exec_hi, 0
Lp22_loop:
    buffer_load_dwordx4 v[16:19], v12, s[24:27], 0 offen sc1
    s_waitcnt vmcnt(0)
    v_min_u32 v16, v16, v17
    v_min_u32 v18, v18, v19
    v_min_u32 v16, v16, v18
    v_cmp_gt_u32 vcc, s53, v16
    s_cbranch_vccz Lp22_ok
Lp22_again:
    s_add_u32 s52, s52, 1
    s_cmp_lt_u32 s52, 20000
    s_cbranch_scc1 Lp22_loop
Lp22_ok:
    s_mov_b64 exec, -1
Lp22_skip:
    s_barrier
    s_add_u32 m0, s32, 0
    s_nop 0
    s_mov_b32 s37, 0
    buffer_load_dwordx4 v9, s[8:11], s37 offen lds
    s_add_u32 m0, s32, 4096
    s_nop 0
    s_mov_b32 s37, 0
    buffer_load_dwordx4 v10, s[8:11], s37 offen lds
    s_add_u32 m0, s32, 8192
    s_nop 0
    s_mov_b32 s37, 128
    buffer_load_dwordx4 v9, s[8:11], s37 offen lds
    s_add_u32 m0, s32, 12288
    s_nop 0
    s_mov_b32 s37, 128
    buffer_load_dwordx4 v10, s[8:11], s37 offen lds
    s_add_u32 m0, s32, 16384
    s_nop 0
    s_mov_b32 s37, 256
    buffer_load_dwordx4 v9, s[8:11], s37 offen lds
    s_add_u32 m0, s32, 20480
    s_nop 0
    s_mov_b32 s37, 256
    buffer_load_dwordx4 v10, s[8:11], s37 offen lds
    s_add_u32 m0, s32, 24576
    s_nop 0
    s_mov_b32 s37, 384
    buffer_load_dwordx4 v9, s[8:11], s37 offen lds
    s_add_u32 m0, s32, 28672
    s_nop 0
    s_mov_b32 s37, 384
    buffer_load_dwordx4 v10, s[8:11], s37 offen lds
    s_add_u32 m0, s32, 32768
    s_nop 0
    s_mov_b32 s37, 512
    buffer_load_dwordx4 v9, s[8:11], s37 offen lds
    s_add_u32 m0, s32, 36864
    s_nop 0
    s_mov_b32 s37, 512
    buffer_load_dwordx4 v10, s[8:11], s37 offen lds
    s_add_u32 m0, s32, 40960
    s_nop 0
    s_mov_b32 s37, 640
    buffer_load_dwordx4 v9, s[8:11], s37 offen lds
    s_add_u32 m0, s32, 45056
    s_nop 0
    s_mov_b32 s37, 640
    buffer_load_dwordx4 v10, s[8:11], s37 offen lds
    s_add_u32 m0, s32, 49152
    s_nop 0
    s_mov_b32 s37, 768
    buffer_load_dwordx4 v9, s[8:11], s37 offen lds
    s_add_u32 m0, s32, 53248
    s_nop 0
    s_mov_b32 s37, 768
    buffer_load_dwordx4 v10, s[8:11], s37 offen lds
    s_add_u32 s20, s84, 43515904
    s_addc_u32 s21, s85, 0
    s_mov_b32 s22, 262144
    s_mov_b32 s23, 0x00020000
    s_lshl_b32 s37, s87, 6
    s_lshr_b32 s38, s86, 1
    s_mul_i32 s38, s38, 32
    s_add_u32 s37, s37, s38
    v_add_u32 v12, s37, v2
    v_lshlrev_b32 v12, 7, v12
    v_lshl_add_u32 v12, v3, 5, v12
    buffer_load_dwordx4 v[16:19], v12, s[20:23], 0 offen
    buffer_load_dwordx4 v[20:23], v12, s[20:23], 0 offen offset:16
    v_add_u32 v12, 2048, v12
    buffer_load_dwordx4 v[24:27], v12, s[20:23], 0 offen
    buffer_load_dwordx4 v[28:31], v12, s[20:23], 0 offen offset:16
    v_lshrrev_b32 v7, 1, v2
    v_and_b32 v7, 7, v7
    v_add_u32 v8, 0, v3
    v_xor_b32 v8, v8, v7
    v_lshlrev_b32 v8, 4, v8
    v_lshl_add_u32 v32, v2, 7, v8
    v_add_u32 v8, 4, v3
    v_xor_b32 v8, v8, v7
    v_lshlrev_b32 v8, 4, v8
    v_lshl_add_u32 v33, v2, 7, v8
    s_lshl_b32 s37, s86, 11
    v_add_u32 v34, s37, v32
    v_add_u32 v35, s37, v33
    s_lshr_b32 s37, s86, 1
    s_mul_i32 s37, s37, 4096
    v_add_u32 v32, s37, v32
    v_add_u32 v33, s37, v33
    v_lshrrev_b32 v44, 2, v2
    v_lshl_add_u32 v44, v3, 3, v44
    v_lshlrev_b32 v44, 7, v44
    v_bfe_u32 v45, v2, 3, 1
    v_lshlrev_b32 v45, 2, v45
    v_and_b32 v7, 1, v3
    v_lshl_add_u32 v45, v7, 3, v45
    v_and_b32 v46, 3, v2
    s_and_b32 s37, s86, 1
    s_mul_i32 s37, s37, 8
    s_add_u32 s38, s37, 0
    s_and_b32 s39, s38, 3
    s_lshl_b32 s39, s39, 2
    v_add_u32 v7, s39, v46
    v_xor_b32 v7, v7, v45
    v_lshl_add_u32 v7, v7, 3, v44
    s_lshr_b32 s38, s38, 2
    s_lshl_b32 s38, s38, 13
    v_add_u32 v36, s38, v7
    s_add_u32 s38, s37, 1
    s_and_b32 s39, s38, 3
    s_lshl_b32 s39, s39, 2
    v_add_u32 v7, s39, v46
    v_xor_b32 v7, v7, v45
    v_lshl_add_u32 v7, v7, 3, v44
    s_lshr_b32 s38, s38, 2
    s_lshl_b32 s38, s38, 13
    v_add_u32 v37, s38, v7
    s_add_u32 s38, s37, 2
    s_and_b32 s39, s38, 3
    s_lshl_b32 s39, s39, 2
    v_add_u32 v7, s39, v46
    v_xor_b32 v7, v7, v45
    v_lshl_add_u32 v7, v7, 3, v44
    s_lshr_b32 s38, s38, 2
    s_lshl_b32 s38, s38, 13
    v_add_u32 v38, s38, v7
    s_add_u32 s38, s37, 3
    s_and_b32 s39, s38, 3
    s_lshl_b32 s39, s39, 2
    v_add_u32 v7, s39, v46
    v_xor_b32 v7, v7, v45
    v_lshl_add_u32 v7, v7, 3, v44
    s_lshr_b32 s38, s38, 2
    s_lshl_b32 s38, s38, 13
    v_add_u32 v39, s38, v7
    s_add_u32 s38, s37, 4
    s_and_b32 s39, s38, 3
    s_lshl_b32 s39, s39, 2
    v_add_u32 v7, s39, v46
    v_xor_b32 v7, v7, v45
    v_lshl_add_u32 v7, v7, 3, v44
    s_lshr_b32 s38, s38, 2
    s_lshl_b32 s38, s38, 13
    v_add_u32 v40, s38, v7
    s_add_u32 s38, s37, 5
    s_and_b32 s39, s38, 3
    s_lshl_b32 s39, s39, 2
    v_add_u32 v7, s39, v46
    v_xor_b32 v7, v7, v45
    v_lshl_add_u32 v7, v7, 3, v44
    s_lshr_b32 s38, s38, 2
    s_lshl_b32 s38, s38, 13
    v_add_u32 v41, s38, v7
    s_add_u32 s38, s37, 6
    s_and_b32 s39, s38, 3
    s_lshl_b32 s39, s39, 2
    v_add_u32 v7, s39, v46
    v_xor_b32 v7, v7, v45
    v_lshl_add_u32 v7, v7, 3, v44
    s_lshr_b32 s38, s38, 2
    s_lshl_b32 s38, s38, 13
    v_add_u32 v42, s38, v7
    s_add_u32 s38, s37, 7
    s_and_b32 s39, s38, 3
    s_lshl_b32 s39, s39, 2
    v_add_u32 v7, s39, v46
    v_xor_b32 v7, v7, v45
    v_lshl_add_u32 v7, v7, 3, v44
    s_lshr_b32 s38, s38, 2
    s_lshl_b32 s38, s38, 13
    v_add_u32 v43, s38, v7
    v_add_u32 v47, 65536, v32
    v_add_u32 v48, 65536, v33
    v_add_u32 v49, 65536, v34
    v_add_u32 v50, 65536, v35
    v_add_u32 v51, 65536, v36
    v_add_u32 v52, 131072, v36
    v_add_u32 v53, 65536, v37
    v_add_u32 v54, 131072, v37
    v_add_u32 v55, 65536, v38
    v_add_u32 v56, 131072, v38
    v_add_u32 v57, 65536, v39
    v_add_u32 v58, 131072, v39
    v_add_u32 v59, 65536, v40
    v_add_u32 v60, 131072, v40
    v_add_u32 v61, 65536, v41
    v_add_u32 v62, 131072, v41
    v_add_u32 v63, 65536, v42
    v_add_u32 v64, 131072, v42
    v_add_u32 v65, 65536, v43
    v_add_u32 v66, 131072, v43
    v_mov_b32 v68, 0
    v_mov_b32 v69, 0
    v_mov_b32 v70, 0
    v_mov_b32 v71, 0
    v_mov_b32 v72, 0
    v_mov_b32 v73, 0
    v_mov_b32 v74, 0
    v_mov_b32 v75, 0
    v_mov_b32 v76, 0
    v_mov_b32 v77, 0
    v_mov_b32 v78, 0
    v_mov_b32 v79, 0
    v_mov_b32 v80, 0
    v_mov_b32 v81, 0
    v_mov_b32 v82, 0
    v_mov_b32 v83, 0
    v_mov_b32 v84, 0
    v_mov_b32 v85, 0
    v_mov_b32 v86, 0
    v_mov_b32 v87, 0
    v_mov_b32 v88, 0
    v_mov_b32 v89, 0
    v_mov_b32 v90, 0
    v_mov_b32 v91, 0
    v_mov_b32 v92, 0
    v_mov_b32 v93, 0
    v_mov_b32 v94, 0
    v_mov_b32 v95, 0
    v_mov_b32 v96, 0
    v_mov_b32 v97, 0
    v_mov_b32 v98, 0
    v_mov_b32 v99, 0
    v_mov_b32 v100, 0
    v_mov_b32 v101, 0
    v_mov_b32 v102, 0
    v_mov_b32 v103, 0
    v_mov_b32 v104, 0
    v_mov_b32 v105, 0
    v_mov_b32 v106, 0
    v_mov_b32 v107, 0
    v_mov_b32 v108, 0
    v_mov_b32 v109, 0
    v_mov_b32 v110, 0
    v_mov_b32 v111, 0
    v_mov_b32 v112, 0
    v_mov_b32 v113, 0
    v_mov_b32 v114, 0
    v_mov_b32 v115, 0
    v_mov_b32 v116, 0
    v_mov_b32 v117, 0
    v_mov_b32 v118, 0
    v_mov_b32 v119, 0
    v_mov_b32 v120, 0
    v_mov_b32 v121, 0
    v_mov_b32 v122, 0
    v_mov_b32 v123, 0
    v_mov_b32 v124, 0
    v_mov_b32 v125, 0
    v_mov_b32 v126, 0
    v_mov_b32 v127, 0
    v_mov_b32 v128, 0
    v_mov_b32 v129, 0
    v_mov_b32 v130, 0
    v_mov_b32 v131, 0
    v_mov_b32 v132, 0
    v_mov_b32 v133, 0
    v_mov_b32 v134, 0
    v_mov_b32 v135, 0
    v_mov_b32 v136, 0
    v_mov_b32 v137, 0
    v_mov_b32 v138, 0
    v_mov_b32 v139, 0
    v_mov_b32 v140, 0
    v_mov_b32 v141, 0
    v_mov_b32 v142, 0
    v_mov_b32 v143, 0
    v_mov_b32 v144, 0
    v_mov_b32 v145, 0
    v_mov_b32 v146, 0
    v_mov_b32 v147, 0
    v_mov_b32 v148, 0
    v_mov_b32 v149, 0
    v_mov_b32 v150, 0
    v_mov_b32 v151, 0
    v_mov_b32 v152, 0
    v_mov_b32 v153, 0
    v_mov_b32 v154, 0
    v_mov_b32 v155, 0
    v_mov_b32 v156, 0
    v_mov_b32 v157, 0
    v_mov_b32 v158, 0
    v_mov_b32 v159, 0
    v_mov_b32 v160, 0
    v_mov_b32 v161, 0
    v_mov_b32 v162, 0
    v_mov_b32 v163, 0
    v_mov_b32 v164, 0x3f803f80
    v_mov_b32 v165, 0x3f803f80
    v_mov_b32 v166, 0x3f803f80
    v_mov_b32 v167, 0x3f803f80
    s_waitcnt vmcnt(35)
    s_waitcnt vmcnt(16)
    s_barrier
    ds_read_b128 v[168:171], v32 offset:0
    ds_read_b128 v[172:175], v32 offset:2048
    ds_read_b64_tr_b16 v[184:185], v36 offset:57344
    ds_read_b64_tr_b16 v[186:187], v36 offset:57856
    ds_read_b64_tr_b16 v[188:189], v37 offset:57344
    ds_read_b64_tr_b16 v[190:191], v37 offset:57856
    ds_read_b64_tr_b16 v[192:193], v38 offset:57344
    ds_read_b64_tr_b16 v[194:195], v38 offset:57856
    ds_read_b64_tr_b16 v[196:197], v39 offset:57344
    ds_read_b64_tr_b16 v[198:199], v39 offset:57856
    ds_read_b64_tr_b16 v[200:201], v40 offset:57344
    ds_read_b64_tr_b16 v[202:203], v40 offset:57856
    ds_read_b64_tr_b16 v[204:205], v41 offset:57344
    ds_read_b64_tr_b16 v[206:207], v41 offset:57856
    ds_read_b64_tr_b16 v[208:209], v42 offset:57344
    ds_read_b64_tr_b16 v[210:211], v42 offset:57856
    ds_read_b64_tr_b16 v[212:213], v43 offset:57344
    ds_read_b64_tr_b16 v[214:215], v43 offset:57856
    s_waitcnt lgkmcnt(0)
    v_mfma_f32_16x16x32_bf16 v[68:71], v[184:187], v[168:171], v[68:71]
    ds_read_b128 v[176:179], v33 offset:0
    ds_read_b128 v[180:183], v33 offset:2048
    v_mfma_f32_16x16x32_bf16 v[100:103], v[184:187], v[172:175], v[100:103]
    ds_read_b64_tr_b16 v[216:217], v36 offset:61440
    ds_read_b64_tr_b16 v[218:219], v36 offset:61952
    v_mfma_f32_16x16x32_bf16 v[132:135], v[184:187], v[164:167], v[132:135]
    ds_read_b64_tr_b16 v[220:221], v37 offset:61440
    ds_read_b64_tr_b16 v[222:223], v37 offset:61952
    v_mfma_f32_16x16x32_bf16 v[72:75], v[188:191], v[168:171], v[72:75]
    ds_read_b64_tr_b16 v[224:225], v38 offset:61440
    ds_read_b64_tr_b16 v[226:227], v38 offset:61952
    v_mfma_f32_16x16x32_bf16 v[104:107], v[188:191], v[172:175], v[104:107]
    ds_read_b64_tr_b16 v[228:229], v39 offset:61440
    ds_read_b64_tr_b16 v[230:231], v39 offset:61952
    v_mfma_f32_16x16x32_bf16 v[136:139], v[188:191], v[164:167], v[136:139]
    ds_read_b64_tr_b16 v[232:233], v40 offset:61440
    ds_read_b64_tr_b16 v[234:235], v40 offset:61952
    v_mfma_f32_16x16x32_bf16 v[76:79], v[192:195], v[168:171], v[76:79]
    ds_read_b64_tr_b16 v[236:237], v41 offset:61440
    ds_read_b64_tr_b16 v[238:239], v41 offset:61952
    v_mfma_f32_16x16x32_bf16 v[108:111], v[192:195], v[172:175], v[108:111]
    ds_read_b64_tr_b16 v[240:241], v42 offset:61440
    ds_read_b64_tr_b16 v[242:243], v42 offset:61952
    v_mfma_f32_16x16x32_bf16 v[140:143], v[192:195], v[164:167], v[140:143]
    ds_read_b64_tr_b16 v[244:245], v43 offset:61440
    ds_read_b64_tr_b16 v[246:247], v43 offset:61952
    v_mfma_f32_16x16x32_bf16 v[80:83], v[196:199], v[168:171], v[80:83]
    v_mfma_f32_16x16x32_bf16 v[112:115], v[196:199], v[172:175], v[112:115]
    v_mfma_f32_16x16x32_bf16 v[144:147], v[196:199], v[164:167], v[144:147]
    v_mfma_f32_16x16x32_bf16 v[84:87], v[200:203], v[168:171], v[84:87]
    v_mfma_f32_16x16x32_bf16 v[116:119], v[200:203], v[172:175], v[116:119]
    v_mfma_f32_16x16x32_bf16 v[148:151], v[200:203], v[164:167], v[148:151]
    v_mfma_f32_16x16x32_bf16 v[88:91], v[204:207], v[168:171], v[88:91]
    v_mfma_f32_16x16x32_bf16 v[120:123], v[204:207], v[172:175], v[120:123]
    v_mfma_f32_16x16x32_bf16 v[152:155], v[204:207], v[164:167], v[152:155]
    v_mfma_f32_16x16x32_bf16 v[92:95], v[208:211], v[168:171], v[92:95]
    v_mfma_f32_16x16x32_bf16 v[124:127], v[208:211], v[172:175], v[124:127]
    v_mfma_f32_16x16x32_bf16 v[156:159], v[208:211], v[164:167], v[156:159]
    v_mfma_f32_16x16x32_bf16 v[96:99], v[212:215], v[168:171], v[96:99]
    v_mfma_f32_16x16x32_bf16 v[128:131], v[212:215], v[172:175], v[128:131]
    v_mfma_f32_16x16x32_bf16 v[160:163], v[212:215], v[164:167], v[160:163]
    s_waitcnt lgkmcnt(0)
    s_waitcnt vmcnt(14)
    s_barrier
    s_add_u32 m0, s32, 57344
    s_add_u32 s37, s35, 688128
    s_add_u32 s37, s37, s42
    buffer_load_dwordx4 v11, s[12:15], s37 offen lds
    s_add_u32 m0, s32, 61440
    s_add_u32 s37, s35, 802816
    s_add_u32 s37, s37, s42
    buffer_load_dwordx4 v11, s[12:15], s37 offen lds
    s_add_u32 m0, s32, 65536
    s_add_u32 s37, s35, 688128
    s_add_u32 s37, s37, s43
    buffer_load_dwordx4 v11, s[12:15], s37 offen lds
    s_add_u32 m0, s32, 69632
    s_add_u32 s37, s35, 802816
    s_add_u32 s37, s37, s43
    buffer_load_dwordx4 v11, s[12:15], s37 offen lds
    s_add_u32 m0, s32, 73728
    s_add_u32 s37, s35, 688128
    s_add_u32 s37, s37, s44
    buffer_load_dwordx4 v11, s[12:15], s37 offen lds
    s_add_u32 m0, s32, 77824
    s_add_u32 s37, s35, 802816
    s_add_u32 s37, s37, s44
    buffer_load_dwordx4 v11, s[12:15], s37 offen lds
    s_add_u32 m0, s32, 81920
    s_add_u32 s37, s35, 688128
    s_add_u32 s37, s37, s45
    buffer_load_dwordx4 v11, s[12:15], s37 offen lds
    s_add_u32 m0, s32, 86016
    s_add_u32 s37, s35, 802816
    s_add_u32 s37, s37, s45
    buffer_load_dwordx4 v11, s[12:15], s37 offen lds
    v_mfma_f32_16x16x32_bf16 v[68:71], v[216:219], v[176:179], v[68:71]
    ds_read_b128 v[168:171], v32 offset:8192
    ds_read_b128 v[172:175], v32 offset:10240
    v_mfma_f32_16x16x32_bf16 v[100:103], v[216:219], v[180:183], v[100:103]
    ds_read_b64_tr_b16 v[184:185], v51 offset:24576
    ds_read_b64_tr_b16 v[186:187], v51 offset:25088
    v_mfma_f32_16x16x32_bf16 v[132:135], v[216:219], v[164:167], v[132:135]
    ds_read_b64_tr_b16 v[188:189], v53 offset:24576
    ds_read_b64_tr_b16 v[190:191], v53 offset:25088
    v_mfma_f32_16x16x32_bf16 v[72:75], v[220:223], v[176:179], v[72:75]
    ds_read_b64_tr_b16 v[192:193], v55 offset:24576
    ds_read_b64_tr_b16 v[194:195], v55 offset:25088
    v_mfma_f32_16x16x32_bf16 v[104:107], v[220:223], v[180:183], v[104:107]
    ds_read_b64_tr_b16 v[196:197], v57 offset:24576
    ds_read_b64_tr_b16 v[198:199], v57 offset:25088
    v_mfma_f32_16x16x32_bf16 v[136:139], v[220:223], v[164:167], v[136:139]
    ds_read_b64_tr_b16 v[200:201], v59 offset:24576
    ds_read_b64_tr_b16 v[202:203], v59 offset:25088
    v_mfma_f32_16x16x32_bf16 v[76:79], v[224:227], v[176:179], v[76:79]
    ds_read_b64_tr_b16 v[204:205], v61 offset:24576
    ds_read_b64_tr_b16 v[206:207], v61 offset:25088
    v_mfma_f32_16x16x32_bf16 v[108:111], v[224:227], v[180:183], v[108:111]
    ds_read_b64_tr_b16 v[208:209], v63 offset:24576
    ds_read_b64_tr_b16 v[210:211], v63 offset:25088
    v_mfma_f32_16x16x32_bf16 v[140:143], v[224:227], v[164:167], v[140:143]
    ds_read_b64_tr_b16 v[212:213], v65 offset:24576
    ds_read_b64_tr_b16 v[214:215], v65 offset:25088
    v_mfma_f32_16x16x32_bf16 v[80:83], v[228:231], v[176:179], v[80:83]
    v_mfma_f32_16x16x32_bf16 v[112:115], v[228:231], v[180:183], v[112:115]
    v_mfma_f32_16x16x32_bf16 v[144:147], v[228:231], v[164:167], v[144:147]
    v_mfma_f32_16x16x32_bf16 v[84:87], v[232:235], v[176:179], v[84:87]
    v_mfma_f32_16x16x32_bf16 v[116:119], v[232:235], v[180:183], v[116:119]
    v_mfma_f32_16x16x32_bf16 v[148:151], v[232:235], v[164:167], v[148:151]
    v_mfma_f32_16x16x32_bf16 v[88:91], v[236:239], v[176:179], v[88:91]
    v_mfma_f32_16x16x32_bf16 v[120:123], v[236:239], v[180:183], v[120:123]
    v_mfma_f32_16x16x32_bf16 v[152:155], v[236:239], v[164:167], v[152:155]
    v_mfma_f32_16x16x32_bf16 v[92:95], v[240:243], v[176:179], v[92:95]
    v_mfma_f32_16x16x32_bf16 v[124:127], v[240:243], v[180:183], v[124:127]
    v_mfma_f32_16x16x32_bf16 v[156:159], v[240:243], v[164:167], v[156:159]
    v_mfma_f32_16x16x32_bf16 v[96:99], v[244:247], v[176:179], v[96:99]
    v_mfma_f32_16x16x32_bf16 v[128:131], v[244:247], v[180:183], v[128:131]
    v_mfma_f32_16x16x32_bf16 v[160:163], v[244:247], v[164:167], v[160:163]
    s_waitcnt lgkmcnt(0)
    v_mfma_f32_16x16x32_bf16 v[68:71], v[184:187], v[168:171], v[68:71]
    ds_read_b128 v[176:179], v33 offset:8192
    ds_read_b128 v[180:183], v33 offset:10240
    v_mfma_f32_16x16x32_bf16 v[100:103], v[184:187], v[172:175], v[100:103]
    ds_read_b64_tr_b16 v[216:217], v51 offset:28672
    ds_read_b64_tr_b16 v[218:219], v51 offset:29184
    v_mfma_f32_16x16x32_bf16 v[132:135], v[184:187], v[164:167], v[132:135]
    ds_read_b64_tr_b16 v[220:221], v53 offset:28672
    ds_read_b64_tr_b16 v[222:223], v53 offset:29184
    v_mfma_f32_16x16x32_bf16 v[72:75], v[188:191], v[168:171], v[72:75]
    ds_read_b64_tr_b16 v[224:225], v55 offset:28672
    ds_read_b64_tr_b16 v[226:227], v55 offset:29184
    v_mfma_f32_16x16x32_bf16 v[104:107], v[188:191], v[172:175], v[104:107]
    ds_read_b64_tr_b16 v[228:229], v57 offset:28672
    ds_read_b64_tr_b16 v[230:231], v57 offset:29184
    v_mfma_f32_16x16x32_bf16 v[136:139], v[188:191], v[164:167], v[136:139]
    ds_read_b64_tr_b16 v[232:233], v59 offset:28672
    ds_read_b64_tr_b16 v[234:235], v59 offset:29184
    v_mfma_f32_16x16x32_bf16 v[76:79], v[192:195], v[168:171], v[76:79]
    ds_read_b64_tr_b16 v[236:237], v61 offset:28672
    ds_read_b64_tr_b16 v[238:239], v61 offset:29184
    v_mfma_f32_16x16x32_bf16 v[108:111], v[192:195], v[172:175], v[108:111]
    ds_read_b64_tr_b16 v[240:241], v63 offset:28672
    ds_read_b64_tr_b16 v[242:243], v63 offset:29184
    v_mfma_f32_16x16x32_bf16 v[140:143], v[192:195], v[164:167], v[140:143]
    ds_read_b64_tr_b16 v[244:245], v65 offset:28672
    ds_read_b64_tr_b16 v[246:247], v65 offset:29184
    v_mfma_f32_16x16x32_bf16 v[80:83], v[196:199], v[168:171], v[80:83]
    v_mfma_f32_16x16x32_bf16 v[112:115], v[196:199], v[172:175], v[112:115]
    v_mfma_f32_16x16x32_bf16 v[144:147], v[196:199], v[164:167], v[144:147]
    v_mfma_f32_16x16x32_bf16 v[84:87], v[200:203], v[168:171], v[84:87]
    v_mfma_f32_16x16x32_bf16 v[116:119], v[200:203], v[172:175], v[116:119]
    v_mfma_f32_16x16x32_bf16 v[148:151], v[200:203], v[164:167], v[148:151]
    v_mfma_f32_16x16x32_bf16 v[88:91], v[204:207], v[168:171], v[88:91]
    v_mfma_f32_16x16x32_bf16 v[120:123], v[204:207], v[172:175], v[120:123]
    v_mfma_f32_16x16x32_bf16 v[152:155], v[204:207], v[164:167], v[152:155]
    v_mfma_f32_16x16x32_bf16 v[92:95], v[208:211], v[168:171], v[92:95]
    v_mfma_f32_16x16x32_bf16 v[124:127], v[208:211], v[172:175], v[124:127]
    v_mfma_f32_16x16x32_bf16 v[156:159], v[208:211], v[164:167], v[156:159]
    v_mfma_f32_16x16x32_bf16 v[96:99], v[212:215], v[168:171], v[96:99]
    v_mfma_f32_16x16x32_bf16 v[128:131], v[212:215], v[172:175], v[128:131]
    v_mfma_f32_16x16x32_bf16 v[160:163], v[212:215], v[164:167], v[160:163]
    s_waitcnt lgkmcnt(0)
    s_waitcnt vmcnt(20)
    s_barrier
    s_add_u32 m0, s32, 90112
    s_add_u32 s37, s35, 917504
    s_add_u32 s37, s37, s42
    buffer_load_dwordx4 v11, s[12:15], s37 offen lds
    s_add_u32 m0, s32, 94208
    s_add_u32 s37, s35, 1032192
    s_add_u32 s37, s37, s42
    buffer_load_dwordx4 v11, s[12:15], s37 offen lds
    s_add_u32 m0, s32, 98304
    s_add_u32 s37, s35, 917504
    s_add_u32 s37, s37, s43
    buffer_load_dwordx4 v11, s[12:15], s37 offen lds
    s_add_u32 m0, s32, 102400
    s_add_u32 s37, s35, 1032192
    s_add_u32 s37, s37, s43
    buffer_load_dwordx4 v11, s[12:15], s37 offen lds
    s_add_u32 m0, s32, 106496
    s_add_u32 s37, s35, 917504
    s_add_u32 s37, s37, s44
    buffer_load_dwordx4 v11, s[12:15], s37 offen lds
    s_add_u32 m0, s32, 110592
    s_add_u32 s37, s35, 1032192
    s_add_u32 s37, s37, s44
    buffer_load_dwordx4 v11, s[12:15], s37 offen lds
    s_add_u32 m0, s32, 114688
    s_add_u32 s37, s35, 917504
    s_add_u32 s37, s37, s45
    buffer_load_dwordx4 v11, s[12:15], s37 offen lds
    s_add_u32 m0, s32, 118784
    s_add_u32 s37, s35, 1032192
    s_add_u32 s37, s37, s45
    buffer_load_dwordx4 v11, s[12:15], s37 offen lds
    v_mfma_f32_16x16x32_bf16 v[68:71], v[216:219], v[176:179], v[68:71]
    ds_read_b128 v[168:171], v32 offset:16384
    ds_read_b128 v[172:175], v32 offset:18432
    v_mfma_f32_16x16x32_bf16 v[100:103], v[216:219], v[180:183], v[100:103]
    ds_read_b64_tr_b16 v[184:185], v51 offset:57344
    ds_read_b64_tr_b16 v[186:187], v51 offset:57856
    v_mfma_f32_16x16x32_bf16 v[132:135], v[216:219], v[164:167], v[132:135]
    ds_read_b64_tr_b16 v[188:189], v53 offset:57344
    ds_read_b64_tr_b16 v[190:191], v53 offset:57856
    v_mfma_f32_16x16x32_bf16 v[72:75], v[220:223], v[176:179], v[72:75]
    ds_read_b64_tr_b16 v[192:193], v55 offset:57344
    ds_read_b64_tr_b16 v[194:195], v55 offset:57856
    v_mfma_f32_16x16x32_bf16 v[104:107], v[220:223], v[180:183], v[104:107]
    ds_read_b64_tr_b16 v[196:197], v57 offset:57344
    ds_read_b64_tr_b16 v[198:199], v57 offset:57856
    v_mfma_f32_16x16x32_bf16 v[136:139], v[220:223], v[164:167], v[136:139]
    ds_read_b64_tr_b16 v[200:201], v59 offset:57344
    ds_read_b64_tr_b16 v[202:203], v59 offset:57856
    v_mfma_f32_16x16x32_bf16 v[76:79], v[224:227], v[176:179], v[76:79]
    ds_read_b64_tr_b16 v[204:205], v61 offset:57344
    ds_read_b64_tr_b16 v[206:207], v61 offset:57856
    v_mfma_f32_16x16x32_bf16 v[108:111], v[224:227], v[180:183], v[108:111]
    ds_read_b64_tr_b16 v[208:209], v63 offset:57344
    ds_read_b64_tr_b16 v[210:211], v63 offset:57856
    v_mfma_f32_16x16x32_bf16 v[140:143], v[224:227], v[164:167], v[140:143]
    ds_read_b64_tr_b16 v[212:213], v65 offset:57344
    ds_read_b64_tr_b16 v[214:215], v65 offset:57856
    v_mfma_f32_16x16x32_bf16 v[80:83], v[228:231], v[176:179], v[80:83]
    v_mfma_f32_16x16x32_bf16 v[112:115], v[228:231], v[180:183], v[112:115]
    v_mfma_f32_16x16x32_bf16 v[144:147], v[228:231], v[164:167], v[144:147]
    v_mfma_f32_16x16x32_bf16 v[84:87], v[232:235], v[176:179], v[84:87]
    v_mfma_f32_16x16x32_bf16 v[116:119], v[232:235], v[180:183], v[116:119]
    v_mfma_f32_16x16x32_bf16 v[148:151], v[232:235], v[164:167], v[148:151]
    v_mfma_f32_16x16x32_bf16 v[88:91], v[236:239], v[176:179], v[88:91]
    v_mfma_f32_16x16x32_bf16 v[120:123], v[236:239], v[180:183], v[120:123]
    v_mfma_f32_16x16x32_bf16 v[152:155], v[236:239], v[164:167], v[152:155]
    v_mfma_f32_16x16x32_bf16 v[92:95], v[240:243], v[176:179], v[92:95]
    v_mfma_f32_16x16x32_bf16 v[124:127], v[240:243], v[180:183], v[124:127]
    v_mfma_f32_16x16x32_bf16 v[156:159], v[240:243], v[164:167], v[156:159]
    v_mfma_f32_16x16x32_bf16 v[96:99], v[244:247], v[176:179], v[96:99]
    v_mfma_f32_16x16x32_bf16 v[128:131], v[244:247], v[180:183], v[128:131]
    v_mfma_f32_16x16x32_bf16 v[160:163], v[244:247], v[164:167], v[160:163]
    s_waitcnt lgkmcnt(0)
    v_mfma_f32_16x16x32_bf16 v[68:71], v[184:187], v[168:171], v[68:71]
    ds_read_b128 v[176:179], v33 offset:16384
    ds_read_b128 v[180:183], v33 offset:18432
    v_mfma_f32_16x16x32_bf16 v[100:103], v[184:187], v[172:175], v[100:103]
    ds_read_b64_tr_b16 v[216:217], v51 offset:61440
    ds_read_b64_tr_b16 v[218:219], v51 offset:61952
    v_mfma_f32_16x16x32_bf16 v[132:135], v[184:187], v[164:167], v[132:135]
    ds_read_b64_tr_b16 v[220:221], v53 offset:61440
    ds_read_b64_tr_b16 v[222:223], v53 offset:61952
    v_mfma_f32_16x16x32_bf16 v[72:75], v[188:191], v[168:171], v[72:75]
    ds_read_b64_tr_b16 v[224:225], v55 offset:61440
    ds_read_b64_tr_b16 v[226:227], v55 offset:61952
    v_mfma_f32_16x16x32_bf16 v[104:107], v[188:191], v[172:175], v[104:107]
    ds_read_b64_tr_b16 v[228:229], v57 offset:61440
    ds_read_b64_tr_b16 v[230:231], v57 offset:61952
    v_mfma_f32_16x16x32_bf16 v[136:139], v[188:191], v[164:167], v[136:139]
    ds_read_b64_tr_b16 v[232:233], v59 offset:61440
    ds_read_b64_tr_b16 v[234:235], v59 offset:61952
    v_mfma_f32_16x16x32_bf16 v[76:79], v[192:195], v[168:171], v[76:79]
    ds_read_b64_tr_b16 v[236:237], v61 offset:61440
    ds_read_b64_tr_b16 v[238:239], v61 offset:61952
    v_mfma_f32_16x16x32_bf16 v[108:111], v[192:195], v[172:175], v[108:111]
    ds_read_b64_tr_b16 v[240:241], v63 offset:61440
    ds_read_b64_tr_b16 v[242:243], v63 offset:61952
    v_mfma_f32_16x16x32_bf16 v[140:143], v[192:195], v[164:167], v[140:143]
    ds_read_b64_tr_b16 v[244:245], v65 offset:61440
    ds_read_b64_tr_b16 v[246:247], v65 offset:61952
    v_mfma_f32_16x16x32_bf16 v[80:83], v[196:199], v[168:171], v[80:83]
    v_mfma_f32_16x16x32_bf16 v[112:115], v[196:199], v[172:175], v[112:115]
    v_mfma_f32_16x16x32_bf16 v[144:147], v[196:199], v[164:167], v[144:147]
    v_mfma_f32_16x16x32_bf16 v[84:87], v[200:203], v[168:171], v[84:87]
    v_mfma_f32_16x16x32_bf16 v[116:119], v[200:203], v[172:175], v[116:119]
    v_mfma_f32_16x16x32_bf16 v[148:151], v[200:203], v[164:167], v[148:151]
    v_mfma_f32_16x16x32_bf16 v[88:91], v[204:207], v[168:171], v[88:91]
    v_mfma_f32_16x16x32_bf16 v[120:123], v[204:207], v[172:175], v[120:123]
    v_mfma_f32_16x16x32_bf16 v[152:155], v[204:207], v[164:167], v[152:155]
    v_mfma_f32_16x16x32_bf16 v[92:95], v[208:211], v[168:171], v[92:95]
    v_mfma_f32_16x16x32_bf16 v[124:127], v[208:211], v[172:175], v[124:127]
    v_mfma_f32_16x16x32_bf16 v[156:159], v[208:211], v[164:167], v[156:159]
    v_mfma_f32_16x16x32_bf16 v[96:99], v[212:215], v[168:171], v[96:99]
    v_mfma_f32_16x16x32_bf16 v[128:131], v[212:215], v[172:175], v[128:131]
    v_mfma_f32_16x16x32_bf16 v[160:163], v[212:215], v[164:167], v[160:163]
    s_waitcnt lgkmcnt(0)
    s_waitcnt vmcnt(8)
    s_barrier
    s_add_u32 m0, s32, 122880
    s_add_u32 s37, s35, 1146880
    s_add_u32 s37, s37, s42
    buffer_load_dwordx4 v11, s[12:15], s37 offen lds
    s_add_u32 m0, s32, 126976
    s_add_u32 s37, s35, 1261568
    s_add_u32 s37, s37, s42
    buffer_load_dwordx4 v11, s[12:15], s37 offen lds
    s_add_u32 m0, s32, 131072
    s_add_u32 s37, s35, 1146880
    s_add_u32 s37, s37, s43
    buffer_load_dwordx4 v11, s[12:15], s37 offen lds
    s_add_u32 m0, s32, 135168
    s_add_u32 s37, s35, 1261568
    s_add_u32 s37, s37, s43
    buffer_load_dwordx4 v11, s[12:15], s37 offen lds
    s_add_u32 m0, s32, 139264
    s_add_u32 s37, s35, 1146880
    s_add_u32 s37, s37, s44
    buffer_load_dwordx4 v11, s[12:15], s37 offen lds
    s_add_u32 m0, s32, 143360
    s_add_u32 s37, s35, 1261568
    s_add_u32 s37, s37, s44
    buffer_load_dwordx4 v11, s[12:15], s37 offen lds
    s_add_u32 m0, s32, 147456
    s_add_u32 s37, s35, 1146880
    s_add_u32 s37, s37, s45
    buffer_load_dwordx4 v11, s[12:15], s37 offen lds
    s_add_u32 m0, s32, 151552
    s_add_u32 s37, s35, 1261568
    s_add_u32 s37, s37, s45
    buffer_load_dwordx4 v11, s[12:15], s37 offen lds
    v_mfma_f32_16x16x32_bf16 v[68:71], v[216:219], v[176:179], v[68:71]
    ds_read_b128 v[168:171], v32 offset:24576
    ds_read_b128 v[172:175], v32 offset:26624
    v_mfma_f32_16x16x32_bf16 v[100:103], v[216:219], v[180:183], v[100:103]
    ds_read_b64_tr_b16 v[184:185], v36 offset:57344
    ds_read_b64_tr_b16 v[186:187], v36 offset:57856
    v_mfma_f32_16x16x32_bf16 v[132:135], v[216:219], v[164:167], v[132:135]
    ds_read_b64_tr_b16 v[188:189], v37 offset:57344
    ds_read_b64_tr_b16 v[190:191], v37 offset:57856
    v_mfma_f32_16x16x32_bf16 v[72:75], v[220:223], v[176:179], v[72:75]
    ds_read_b64_tr_b16 v[192:193], v38 offset:57344
    ds_read_b64_tr_b16 v[194:195], v38 offset:57856
    v_mfma_f32_16x16x32_bf16 v[104:107], v[220:223], v[180:183], v[104:107]
    ds_read_b64_tr_b16 v[196:197], v39 offset:57344
    ds_read_b64_tr_b16 v[198:199], v39 offset:57856
    v_mfma_f32_16x16x32_bf16 v[136:139], v[220:223], v[164:167], v[136:139]
    ds_read_b64_tr_b16 v[200:201], v40 offset:57344
    ds_read_b64_tr_b16 v[202:203], v40 offset:57856
    v_mfma_f32_16x16x32_bf16 v[76:79], v[224:227], v[176:179], v[76:79]
    ds_read_b64_tr_b16 v[204:205], v41 offset:57344
    ds_read_b64_tr_b16 v[206:207], v41 offset:57856
    v_mfma_f32_16x16x32_bf16 v[108:111], v[224:227], v[180:183], v[108:111]
    ds_read_b64_tr_b16 v[208:209], v42 offset:57344
    ds_read_b64_tr_b16 v[210:211], v42 offset:57856
    v_mfma_f32_16x16x32_bf16 v[140:143], v[224:227], v[164:167], v[140:143]
    ds_read_b64_tr_b16 v[212:213], v43 offset:57344
    ds_read_b64_tr_b16 v[214:215], v43 offset:57856
    v_mfma_f32_16x16x32_bf16 v[80:83], v[228:231], v[176:179], v[80:83]
    v_mfma_f32_16x16x32_bf16 v[112:115], v[228:231], v[180:183], v[112:115]
    v_mfma_f32_16x16x32_bf16 v[144:147], v[228:231], v[164:167], v[144:147]
    v_mfma_f32_16x16x32_bf16 v[84:87], v[232:235], v[176:179], v[84:87]
    v_mfma_f32_16x16x32_bf16 v[116:119], v[232:235], v[180:183], v[116:119]
    v_mfma_f32_16x16x32_bf16 v[148:151], v[232:235], v[164:167], v[148:151]
    v_mfma_f32_16x16x32_bf16 v[88:91], v[236:239], v[176:179], v[88:91]
    v_mfma_f32_16x16x32_bf16 v[120:123], v[236:239], v[180:183], v[120:123]
    v_mfma_f32_16x16x32_bf16 v[152:155], v[236:239], v[164:167], v[152:155]
    v_mfma_f32_16x16x32_bf16 v[92:95], v[240:243], v[176:179], v[92:95]
    v_mfma_f32_16x16x32_bf16 v[124:127], v[240:243], v[180:183], v[124:127]
    v_mfma_f32_16x16x32_bf16 v[156:159], v[240:243], v[164:167], v[156:159]
    v_mfma_f32_16x16x32_bf16 v[96:99], v[244:247], v[176:179], v[96:99]
    v_mfma_f32_16x16x32_bf16 v[128:131], v[244:247], v[180:183], v[128:131]
    v_mfma_f32_16x16x32_bf16 v[160:163], v[244:247], v[164:167], v[160:163]
    s_waitcnt lgkmcnt(0)
    v_mfma_f32_16x16x32_bf16 v[68:71], v[184:187], v[168:171], v[68:71]
    ds_read_b128 v[176:179], v33 offset:24576
    ds_read_b128 v[180:183], v33 offset:26624
    v_mfma_f32_16x16x32_bf16 v[100:103], v[184:187], v[172:175], v[100:103]
    ds_read_b64_tr_b16 v[216:217], v36 offset:61440
    ds_read_b64_tr_b16 v[218:219], v36 offset:61952
    v_mfma_f32_16x16x32_bf16 v[132:135], v[184:187], v[164:167], v[132:135]
    ds_read_b64_tr_b16 v[220:221], v37 offset:61440
    ds_read_b64_tr_b16 v[222:223], v37 offset:61952
    v_mfma_f32_16x16x32_bf16 v[72:75], v[188:191], v[168:171], v[72:75]
    ds_read_b64_tr_b16 v[224:225], v38 offset:61440
    ds_read_b64_tr_b16 v[226:227], v38 offset:61952
    v_mfma_f32_16x16x32_bf16 v[104:107], v[188:191], v[172:175], v[104:107]
    ds_read_b64_tr_b16 v[228:229], v39 offset:61440
    ds_read_b64_tr_b16 v[230:231], v39 offset:61952
    v_mfma_f32_16x16x32_bf16 v[136:139], v[188:191], v[164:167], v[136:139]
    ds_read_b64_tr_b16 v[232:233], v40 offset:61440
    ds_read_b64_tr_b16 v[234:235], v40 offset:61952
    v_mfma_f32_16x16x32_bf16 v[76:79], v[192:195], v[168:171], v[76:79]
    ds_read_b64_tr_b16 v[236:237], v41 offset:61440
    ds_read_b64_tr_b16 v[238:239], v41 offset:61952
    v_mfma_f32_16x16x32_bf16 v[108:111], v[192:195], v[172:175], v[108:111]
    ds_read_b64_tr_b16 v[240:241], v42 offset:61440
    ds_read_b64_tr_b16 v[242:243], v42 offset:61952
    v_mfma_f32_16x16x32_bf16 v[140:143], v[192:195], v[164:167], v[140:143]
    ds_read_b64_tr_b16 v[244:245], v43 offset:61440
    ds_read_b64_tr_b16 v[246:247], v43 offset:61952
    v_mfma_f32_16x16x32_bf16 v[80:83], v[196:199], v[168:171], v[80:83]
    v_mfma_f32_16x16x32_bf16 v[112:115], v[196:199], v[172:175], v[112:115]
    v_mfma_f32_16x16x32_bf16 v[144:147], v[196:199], v[164:167], v[144:147]
    v_mfma_f32_16x16x32_bf16 v[84:87], v[200:203], v[168:171], v[84:87]
    v_mfma_f32_16x16x32_bf16 v[116:119], v[200:203], v[172:175], v[116:119]
    v_mfma_f32_16x16x32_bf16 v[148:151], v[200:203], v[164:167], v[148:151]
    v_mfma_f32_16x16x32_bf16 v[88:91], v[204:207], v[168:171], v[88:91]
    v_mfma_f32_16x16x32_bf16 v[120:123], v[204:207], v[172:175], v[120:123]
    v_mfma_f32_16x16x32_bf16 v[152:155], v[204:207], v[164:167], v[152:155]
    v_mfma_f32_16x16x32_bf16 v[92:95], v[208:211], v[168:171], v[92:95]
    v_mfma_f32_16x16x32_bf16 v[124:127], v[208:211], v[172:175], v[124:127]
    v_mfma_f32_16x16x32_bf16 v[156:159], v[208:211], v[164:167], v[156:159]
    v_mfma_f32_16x16x32_bf16 v[96:99], v[212:215], v[168:171], v[96:99]
    v_mfma_f32_16x16x32_bf16 v[128:131], v[212:215], v[172:175], v[128:131]
    v_mfma_f32_16x16x32_bf16 v[160:163], v[212:215], v[164:167], v[160:163]
    s_waitcnt lgkmcnt(0)
    s_waitcnt vmcnt(8)
    s_barrier
    s_add_u32 m0, s32, 57344
    s_add_u32 s37, s35, 1376256
    s_add_u32 s37, s37, s42
    buffer_load_dwordx4 v11, s[12:15], s37 offen lds
    s_add_u32 m0, s32, 61440
    s_add_u32 s37, s35, 1490944
    s_add_u32 s37, s37, s42
    buffer_load_dwordx4 v11, s[12:15], s37 offen lds
    s_add_u32 m0, s32, 65536
    s_add_u32 s37, s35, 1376256
    s_add_u32 s37, s37, s43
    buffer_load_dwordx4 v11, s[12:15], s37 offen lds
    s_add_u32 m0, s32, 69632
    s_add_u32 s37, s35, 1490944
    s_add_u32 s37, s37, s43
    buffer_load_dwordx4 v11, s[12:15], s37 offen lds
    s_add_u32 m0, s32, 73728
    s_add_u32 s37, s35, 1376256
    s_add_u32 s37, s37, s44
    buffer_load_dwordx4 v11, s[12:15], s37 offen lds
    s_add_u32 m0, s32, 77824
    s_add_u32 s37, s35, 1490944
    s_add_u32 s37, s37, s44
    buffer_load_dwordx4 v11, s[12:15], s37 offen lds
    s_add_u32 m0, s32, 81920
    s_add_u32 s37, s35, 1376256
    s_add_u32 s37, s37, s45
    buffer_load_dwordx4 v11, s[12:15], s37 offen lds
    s_add_u32 m0, s32, 86016
    s_add_u32 s37, s35, 1490944
    s_add_u32 s37, s37, s45
    buffer_load_dwordx4 v11, s[12:15], s37 offen lds
    v_mfma_f32_16x16x32_bf16 v[68:71], v[216:219], v[176:179], v[68:71]
    ds_read_b128 v[168:171], v32 offset:32768
    ds_read_b128 v[172:175], v32 offset:34816
    v_mfma_f32_16x16x32_bf16 v[100:103], v[216:219], v[180:183], v[100:103]
    ds_read_b64_tr_b16 v[184:185], v51 offset:24576
    ds_read_b64_tr_b16 v[186:187], v51 offset:25088
    v_mfma_f32_16x16x32_bf16 v[132:135], v[216:219], v[164:167], v[132:135]
    ds_read_b64_tr_b16 v[188:189], v53 offset:24576
    ds_read_b64_tr_b16 v[190:191], v53 offset:25088
    v_mfma_f32_16x16x32_bf16 v[72:75], v[220:223], v[176:179], v[72:75]
    ds_read_b64_tr_b16 v[192:193], v55 offset:24576
    ds_read_b64_tr_b16 v[194:195], v55 offset:25088
    v_mfma_f32_16x16x32_bf16 v[104:107], v[220:223], v[180:183], v[104:107]
    ds_read_b64_tr_b16 v[196:197], v57 offset:24576
    ds_read_b64_tr_b16 v[198:199], v57 offset:25088
    v_mfma_f32_16x16x32_bf16 v[136:139], v[220:223], v[164:167], v[136:139]
    ds_read_b64_tr_b16 v[200:201], v59 offset:24576
    ds_read_b64_tr_b16 v[202:203], v59 offset:25088
    v_mfma_f32_16x16x32_bf16 v[76:79], v[224:227], v[176:179], v[76:79]
    ds_read_b64_tr_b16 v[204:205], v61 offset:24576
    ds_read_b64_tr_b16 v[206:207], v61 offset:25088
    v_mfma_f32_16x16x32_bf16 v[108:111], v[224:227], v[180:183], v[108:111]
    ds_read_b64_tr_b16 v[208:209], v63 offset:24576
    ds_read_b64_tr_b16 v[210:211], v63 offset:25088
    v_mfma_f32_16x16x32_bf16 v[140:143], v[224:227], v[164:167], v[140:143]
    ds_read_b64_tr_b16 v[212:213], v65 offset:24576
    ds_read_b64_tr_b16 v[214:215], v65 offset:25088
    v_mfma_f32_16x16x32_bf16 v[80:83], v[228:231], v[176:179], v[80:83]
    v_mfma_f32_16x16x32_bf16 v[112:115], v[228:231], v[180:183], v[112:115]
    v_mfma_f32_16x16x32_bf16 v[144:147], v[228:231], v[164:167], v[144:147]
    v_mfma_f32_16x16x32_bf16 v[84:87], v[232:235], v[176:179], v[84:87]
    v_mfma_f32_16x16x32_bf16 v[116:119], v[232:235], v[180:183], v[116:119]
    v_mfma_f32_16x16x32_bf16 v[148:151], v[232:235], v[164:167], v[148:151]
    v_mfma_f32_16x16x32_bf16 v[88:91], v[236:239], v[176:179], v[88:91]
    v_mfma_f32_16x16x32_bf16 v[120:123], v[236:239], v[180:183], v[120:123]
    v_mfma_f32_16x16x32_bf16 v[152:155], v[236:239], v[164:167], v[152:155]
    v_mfma_f32_16x16x32_bf16 v[92:95], v[240:243], v[176:179], v[92:95]
    v_mfma_f32_16x16x32_bf16 v[124:127], v[240:243], v[180:183], v[124:127]
    v_mfma_f32_16x16x32_bf16 v[156:159], v[240:243], v[164:167], v[156:159]
    v_mfma_f32_16x16x32_bf16 v[96:99], v[244:247], v[176:179], v[96:99]
    v_mfma_f32_16x16x32_bf16 v[128:131], v[244:247], v[180:183], v[128:131]
    v_mfma_f32_16x16x32_bf16 v[160:163], v[244:247], v[164:167], v[160:163]
    s_waitcnt lgkmcnt(0)
    v_mfma_f32_16x16x32_bf16 v[68:71], v[184:187], v[168:171], v[68:71]
    ds_read_b128 v[176:179], v33 offset:32768
    ds_read_b128 v[180:183], v33 offset:34816
    v_mfma_f32_16x16x32_bf16 v[100:103], v[184:187], v[172:175], v[100:103]
    ds_read_b64_tr_b16 v[216:217], v51 offset:28672
    ds_read_b64_tr_b16 v[218:219], v51 offset:29184
    v_mfma_f32_16x16x32_bf16 v[132:135], v[184:187], v[164:167], v[132:135]
    ds_read_b64_tr_b16 v[220:221], v53 offset:28672
    ds_read_b64_tr_b16 v[222:223], v53 offset:29184
    v_mfma_f32_16x16x32_bf16 v[72:75], v[188:191], v[168:171], v[72:75]
    ds_read_b64_tr_b16 v[224:225], v55 offset:28672
    ds_read_b64_tr_b16 v[226:227], v55 offset:29184
    v_mfma_f32_16x16x32_bf16 v[104:107], v[188:191], v[172:175], v[104:107]
    ds_read_b64_tr_b16 v[228:229], v57 offset:28672
    ds_read_b64_tr_b16 v[230:231], v57 offset:29184
    v_mfma_f32_16x16x32_bf16 v[136:139], v[188:191], v[164:167], v[136:139]
    ds_read_b64_tr_b16 v[232:233], v59 offset:28672
    ds_read_b64_tr_b16 v[234:235], v59 offset:29184
    v_mfma_f32_16x16x32_bf16 v[76:79], v[192:195], v[168:171], v[76:79]
    ds_read_b64_tr_b16 v[236:237], v61 offset:28672
    ds_read_b64_tr_b16 v[238:239], v61 offset:29184
    v_mfma_f32_16x16x32_bf16 v[108:111], v[192:195], v[172:175], v[108:111]
    ds_read_b64_tr_b16 v[240:241], v63 offset:28672
    ds_read_b64_tr_b16 v[242:243], v63 offset:29184
    v_mfma_f32_16x16x32_bf16 v[140:143], v[192:195], v[164:167], v[140:143]
    ds_read_b64_tr_b16 v[244:245], v65 offset:28672
    ds_read_b64_tr_b16 v[246:247], v65 offset:29184
    v_mfma_f32_16x16x32_bf16 v[80:83], v[196:199], v[168:171], v[80:83]
    v_mfma_f32_16x16x32_bf16 v[112:115], v[196:199], v[172:175], v[112:115]
    v_mfma_f32_16x16x32_bf16 v[144:147], v[196:199], v[164:167], v[144:147]
    v_mfma_f32_16x16x32_bf16 v[84:87], v[200:203], v[168:171], v[84:87]
    v_mfma_f32_16x16x32_bf16 v[116:119], v[200:203], v[172:175], v[116:119]
    v_mfma_f32_16x16x32_bf16 v[148:151], v[200:203], v[164:167], v[148:151]
    v_mfma_f32_16x16x32_bf16 v[88:91], v[204:207], v[168:171], v[88:91]
    v_mfma_f32_16x16x32_bf16 v[120:123], v[204:207], v[172:175], v[120:123]
    v_mfma_f32_16x16x32_bf16 v[152:155], v[204:207], v[164:167], v[152:155]
    v_mfma_f32_16x16x32_bf16 v[92:95], v[208:211], v[168:171], v[92:95]
    v_mfma_f32_16x16x32_bf16 v[124:127], v[208:211], v[172:175], v[124:127]
    v_mfma_f32_16x16x32_bf16 v[156:159], v[208:211], v[164:167], v[156:159]
    v_mfma_f32_16x16x32_bf16 v[96:99], v[212:215], v[168:171], v[96:99]
    v_mfma_f32_16x16x32_bf16 v[128:131], v[212:215], v[172:175], v[128:131]
    v_mfma_f32_16x16x32_bf16 v[160:163], v[212:215], v[164:167], v[160:163]
    s_waitcnt lgkmcnt(0)
    s_waitcnt vmcnt(8)
    s_barrier
    v_mfma_f32_16x16x32_bf16 v[68:71], v[216:219], v[176:179], v[68:71]
    ds_read_b128 v[168:171], v32 offset:40960
    ds_read_b128 v[172:175], v32 offset:43008
    v_mfma_f32_16x16x32_bf16 v[100:103], v[216:219], v[180:183], v[100:103]
    ds_read_b64_tr_b16 v[184:185], v51 offset:57344
    ds_read_b64_tr_b16 v[186:187], v51 offset:57856
    v_mfma_f32_16x16x32_bf16 v[132:135], v[216:219], v[164:167], v[132:135]
    ds_read_b64_tr_b16 v[188:189], v53 offset:57344
    ds_read_b64_tr_b16 v[190:191], v53 offset:57856
    v_mfma_f32_16x16x32_bf16 v[72:75], v[220:223], v[176:179], v[72:75]
    ds_read_b64_tr_b16 v[192:193], v55 offset:57344
    ds_read_b64_tr_b16 v[194:195], v55 offset:57856
    v_mfma_f32_16x16x32_bf16 v[104:107], v[220:223], v[180:183], v[104:107]
    ds_read_b64_tr_b16 v[196:197], v57 offset:57344
    ds_read_b64_tr_b16 v[198:199], v57 offset:57856
    v_mfma_f32_16x16x32_bf16 v[136:139], v[220:223], v[164:167], v[136:139]
    ds_read_b64_tr_b16 v[200:201], v59 offset:57344
    ds_read_b64_tr_b16 v[202:203], v59 offset:57856
    v_mfma_f32_16x16x32_bf16 v[76:79], v[224:227], v[176:179], v[76:79]
    ds_read_b64_tr_b16 v[204:205], v61 offset:57344
    ds_read_b64_tr_b16 v[206:207], v61 offset:57856
    v_mfma_f32_16x16x32_bf16 v[108:111], v[224:227], v[180:183], v[108:111]
    ds_read_b64_tr_b16 v[208:209], v63 offset:57344
    ds_read_b64_tr_b16 v[210:211], v63 offset:57856
    v_mfma_f32_16x16x32_bf16 v[140:143], v[224:227], v[164:167], v[140:143]
    ds_read_b64_tr_b16 v[212:213], v65 offset:57344
    ds_read_b64_tr_b16 v[214:215], v65 offset:57856
    v_mfma_f32_16x16x32_bf16 v[80:83], v[228:231], v[176:179], v[80:83]
    v_mfma_f32_16x16x32_bf16 v[112:115], v[228:231], v[180:183], v[112:115]
    v_mfma_f32_16x16x32_bf16 v[144:147], v[228:231], v[164:167], v[144:147]
    v_mfma_f32_16x16x32_bf16 v[84:87], v[232:235], v[176:179], v[84:87]
    v_mfma_f32_16x16x32_bf16 v[116:119], v[232:235], v[180:183], v[116:119]
    v_mfma_f32_16x16x32_bf16 v[148:151], v[232:235], v[164:167], v[148:151]
    v_mfma_f32_16x16x32_bf16 v[88:91], v[236:239], v[176:179], v[88:91]
    v_mfma_f32_16x16x32_bf16 v[120:123], v[236:239], v[180:183], v[120:123]
    v_mfma_f32_16x16x32_bf16 v[152:155], v[236:239], v[164:167], v[152:155]
    v_mfma_f32_16x16x32_bf16 v[92:95], v[240:243], v[176:179], v[92:95]
    v_mfma_f32_16x16x32_bf16 v[124:127], v[240:243], v[180:183], v[124:127]
    v_mfma_f32_16x16x32_bf16 v[156:159], v[240:243], v[164:167], v[156:159]
    v_mfma_f32_16x16x32_bf16 v[96:99], v[244:247], v[176:179], v[96:99]
    v_mfma_f32_16x16x32_bf16 v[128:131], v[244:247], v[180:183], v[128:131]
    v_mfma_f32_16x16x32_bf16 v[160:163], v[244:247], v[164:167], v[160:163]
    s_waitcnt lgkmcnt(0)
    v_mfma_f32_16x16x32_bf16 v[68:71], v[184:187], v[168:171], v[68:71]
    ds_read_b128 v[176:179], v33 offset:40960
    ds_read_b128 v[180:183], v33 offset:43008
    v_mfma_f32_16x16x32_bf16 v[100:103], v[184:187], v[172:175], v[100:103]
    ds_read_b64_tr_b16 v[216:217], v51 offset:61440
    ds_read_b64_tr_b16 v[218:219], v51 offset:61952
    v_mfma_f32_16x16x32_bf16 v[132:135], v[184:187], v[164:167], v[132:135]
    ds_read_b64_tr_b16 v[220:221], v53 offset:61440
    ds_read_b64_tr_b16 v[222:223], v53 offset:61952
    v_mfma_f32_16x16x32_bf16 v[72:75], v[188:191], v[168:171], v[72:75]
    ds_read_b64_tr_b16 v[224:225], v55 offset:61440
    ds_read_b64_tr_b16 v[226:227], v55 offset:61952
    v_mfma_f32_16x16x32_bf16 v[104:107], v[188:191], v[172:175], v[104:107]
    ds_read_b64_tr_b16 v[228:229], v57 offset:61440
    ds_read_b64_tr_b16 v[230:231], v57 offset:61952
    v_mfma_f32_16x16x32_bf16 v[136:139], v[188:191], v[164:167], v[136:139]
    ds_read_b64_tr_b16 v[232:233], v59 offset:61440
    ds_read_b64_tr_b16 v[234:235], v59 offset:61952
    v_mfma_f32_16x16x32_bf16 v[76:79], v[192:195], v[168:171], v[76:79]
    ds_read_b64_tr_b16 v[236:237], v61 offset:61440
    ds_read_b64_tr_b16 v[238:239], v61 offset:61952
    v_mfma_f32_16x16x32_bf16 v[108:111], v[192:195], v[172:175], v[108:111]
    ds_read_b64_tr_b16 v[240:241], v63 offset:61440
    ds_read_b64_tr_b16 v[242:243], v63 offset:61952
    v_mfma_f32_16x16x32_bf16 v[140:143], v[192:195], v[164:167], v[140:143]
    ds_read_b64_tr_b16 v[244:245], v65 offset:61440
    ds_read_b64_tr_b16 v[246:247], v65 offset:61952
    v_mfma_f32_16x16x32_bf16 v[80:83], v[196:199], v[168:171], v[80:83]
    v_mfma_f32_16x16x32_bf16 v[112:115], v[196:199], v[172:175], v[112:115]
    v_mfma_f32_16x16x32_bf16 v[144:147], v[196:199], v[164:167], v[144:147]
    v_mfma_f32_16x16x32_bf16 v[84:87], v[200:203], v[168:171], v[84:87]
    v_mfma_f32_16x16x32_bf16 v[116:119], v[200:203], v[172:175], v[116:119]
    v_mfma_f32_16x16x32_bf16 v[148:151], v[200:203], v[164:167], v[148:151]
    v_mfma_f32_16x16x32_bf16 v[88:91], v[204:207], v[168:171], v[88:91]
    v_mfma_f32_16x16x32_bf16 v[120:123], v[204:207], v[172:175], v[120:123]
    v_mfma_f32_16x16x32_bf16 v[152:155], v[204:207], v[164:167], v[152:155]
    v_mfma_f32_16x16x32_bf16 v[92:95], v[208:211], v[168:171], v[92:95]
    v_mfma_f32_16x16x32_bf16 v[124:127], v[208:211], v[172:175], v[124:127]
    v_mfma_f32_16x16x32_bf16 v[156:159], v[208:211], v[164:167], v[156:159]
    v_mfma_f32_16x16x32_bf16 v[96:99], v[212:215], v[168:171], v[96:99]
    v_mfma_f32_16x16x32_bf16 v[128:131], v[212:215], v[172:175], v[128:131]
    v_mfma_f32_16x16x32_bf16 v[160:163], v[212:215], v[164:167], v[160:163]
    s_waitcnt lgkmcnt(0)
    s_waitcnt vmcnt(0)
    s_barrier
    v_mfma_f32_16x16x32_bf16 v[68:71], v[216:219], v[176:179], v[68:71]
    ds_read_b128 v[168:171], v32 offset:49152
    ds_read_b128 v[172:175], v32 offset:51200
    v_mfma_f32_16x16x32_bf16 v[100:103], v[216:219], v[180:183], v[100:103]
    ds_read_b64_tr_b16 v[184:185], v36 offset:57344
    ds_read_b64_tr_b16 v[186:187], v36 offset:57856
    v_mfma_f32_16x16x32_bf16 v[132:135], v[216:219], v[164:167], v[132:135]
    ds_read_b64_tr_b16 v[188:189], v37 offset:57344
    ds_read_b64_tr_b16 v[190:191], v37 offset:57856
    v_mfma_f32_16x16x32_bf16 v[72:75], v[220:223], v[176:179], v[72:75]
    ds_read_b64_tr_b16 v[192:193], v38 offset:57344
    ds_read_b64_tr_b16 v[194:195], v38 offset:57856
    v_mfma_f32_16x16x32_bf16 v[104:107], v[220:223], v[180:183], v[104:107]
    ds_read_b64_tr_b16 v[196:197], v39 offset:57344
    ds_read_b64_tr_b16 v[198:199], v39 offset:57856
    v_mfma_f32_16x16x32_bf16 v[136:139], v[220:223], v[164:167], v[136:139]
    ds_read_b64_tr_b16 v[200:201], v40 offset:57344
    ds_read_b64_tr_b16 v[202:203], v40 offset:57856
    v_mfma_f32_16x16x32_bf16 v[76:79], v[224:227], v[176:179], v[76:79]
    ds_read_b64_tr_b16 v[204:205], v41 offset:57344
    ds_read_b64_tr_b16 v[206:207], v41 offset:57856
    v_mfma_f32_16x16x32_bf16 v[108:111], v[224:227], v[180:183], v[108:111]
    ds_read_b64_tr_b16 v[208:209], v42 offset:57344
    ds_read_b64_tr_b16 v[210:211], v42 offset:57856
    v_mfma_f32_16x16x32_bf16 v[140:143], v[224:227], v[164:167], v[140:143]
    ds_read_b64_tr_b16 v[212:213], v43 offset:57344
    ds_read_b64_tr_b16 v[214:215], v43 offset:57856
    v_mfma_f32_16x16x32_bf16 v[80:83], v[228:231], v[176:179], v[80:83]
    v_mfma_f32_16x16x32_bf16 v[112:115], v[228:231], v[180:183], v[112:115]
    v_mfma_f32_16x16x32_bf16 v[144:147], v[228:231], v[164:167], v[144:147]
    v_mfma_f32_16x16x32_bf16 v[84:87], v[232:235], v[176:179], v[84:87]
    v_mfma_f32_16x16x32_bf16 v[116:119], v[232:235], v[180:183], v[116:119]
    v_mfma_f32_16x16x32_bf16 v[148:151], v[232:235], v[164:167], v[148:151]
    v_mfma_f32_16x16x32_bf16 v[88:91], v[236:239], v[176:179], v[88:91]
    v_mfma_f32_16x16x32_bf16 v[120:123], v[236:239], v[180:183], v[120:123]
    v_mfma_f32_16x16x32_bf16 v[152:155], v[236:239], v[164:167], v[152:155]
    v_mfma_f32_16x16x32_bf16 v[92:95], v[240:243], v[176:179], v[92:95]
    v_mfma_f32_16x16x32_bf16 v[124:127], v[240:243], v[180:183], v[124:127]
    v_mfma_f32_16x16x32_bf16 v[156:159], v[240:243], v[164:167], v[156:159]
    v_mfma_f32_16x16x32_bf16 v[96:99], v[244:247], v[176:179], v[96:99]
    v_mfma_f32_16x16x32_bf16 v[128:131], v[244:247], v[180:183], v[128:131]
    v_mfma_f32_16x16x32_bf16 v[160:163], v[244:247], v[164:167], v[160:163]
    s_waitcnt lgkmcnt(0)
    v_mfma_f32_16x16x32_bf16 v[68:71], v[184:187], v[168:171], v[68:71]
    ds_read_b128 v[176:179], v33 offset:49152
    ds_read_b128 v[180:183], v33 offset:51200
    v_mfma_f32_16x16x32_bf16 v[100:103], v[184:187], v[172:175], v[100:103]
    ds_read_b64_tr_b16 v[216:217], v36 offset:61440
    ds_read_b64_tr_b16 v[218:219], v36 offset:61952
    v_mfma_f32_16x16x32_bf16 v[132:135], v[184:187], v[164:167], v[132:135]
    ds_read_b64_tr_b16 v[220:221], v37 offset:61440
    ds_read_b64_tr_b16 v[222:223], v37 offset:61952
    v_mfma_f32_16x16x32_bf16 v[72:75], v[188:191], v[168:171], v[72:75]
    ds_read_b64_tr_b16 v[224:225], v38 offset:61440
    ds_read_b64_tr_b16 v[226:227], v38 offset:61952
    v_mfma_f32_16x16x32_bf16 v[104:107], v[188:191], v[172:175], v[104:107]
    ds_read_b64_tr_b16 v[228:229], v39 offset:61440
    ds_read_b64_tr_b16 v[230:231], v39 offset:61952
    v_mfma_f32_16x16x32_bf16 v[136:139], v[188:191], v[164:167], v[136:139]
    ds_read_b64_tr_b16 v[232:233], v40 offset:61440
    ds_read_b64_tr_b16 v[234:235], v40 offset:61952
    v_mfma_f32_16x16x32_bf16 v[76:79], v[192:195], v[168:171], v[76:79]
    ds_read_b64_tr_b16 v[236:237], v41 offset:61440
    ds_read_b64_tr_b16 v[238:239], v41 offset:61952
    v_mfma_f32_16x16x32_bf16 v[108:111], v[192:195], v[172:175], v[108:111]
    ds_read_b64_tr_b16 v[240:241], v42 offset:61440
    ds_read_b64_tr_b16 v[242:243], v42 offset:61952
    v_mfma_f32_16x16x32_bf16 v[140:143], v[192:195], v[164:167], v[140:143]
    ds_read_b64_tr_b16 v[244:245], v43 offset:61440
    ds_read_b64_tr_b16 v[246:247], v43 offset:61952
    v_mfma_f32_16x16x32_bf16 v[80:83], v[196:199], v[168:171], v[80:83]
    v_mfma_f32_16x16x32_bf16 v[112:115], v[196:199], v[172:175], v[112:115]
    v_mfma_f32_16x16x32_bf16 v[144:147], v[196:199], v[164:167], v[144:147]
    v_mfma_f32_16x16x32_bf16 v[84:87], v[200:203], v[168:171], v[84:87]
    v_mfma_f32_16x16x32_bf16 v[116:119], v[200:203], v[172:175], v[116:119]
    v_mfma_f32_16x16x32_bf16 v[148:151], v[200:203], v[164:167], v[148:151]
    v_mfma_f32_16x16x32_bf16 v[88:91], v[204:207], v[168:171], v[88:91]
    v_mfma_f32_16x16x32_bf16 v[120:123], v[204:207], v[172:175], v[120:123]
    v_mfma_f32_16x16x32_bf16 v[152:155], v[204:207], v[164:167], v[152:155]
    v_mfma_f32_16x16x32_bf16 v[92:95], v[208:211], v[168:171], v[92:95]
    v_mfma_f32_16x16x32_bf16 v[124:127], v[208:211], v[172:175], v[124:127]
    v_mfma_f32_16x16x32_bf16 v[156:159], v[208:211], v[164:167], v[156:159]
    v_mfma_f32_16x16x32_bf16 v[96:99], v[212:215], v[168:171], v[96:99]
    v_mfma_f32_16x16x32_bf16 v[128:131], v[212:215], v[172:175], v[128:131]
    v_mfma_f32_16x16x32_bf16 v[160:163], v[212:215], v[164:167], v[160:163]
    s_waitcnt lgkmcnt(0)
    v_mfma_f32_16x16x32_bf16 v[68:71], v[216:219], v[176:179], v[68:71]
    v_mfma_f32_16x16x32_bf16 v[100:103], v[216:219], v[180:183], v[100:103]
    v_mfma_f32_16x16x32_bf16 v[132:135], v[216:219], v[164:167], v[132:135]
    v_mfma_f32_16x16x32_bf16 v[72:75], v[220:223], v[176:179], v[72:75]
    v_mfma_f32_16x16x32_bf16 v[104:107], v[220:223], v[180:183], v[104:107]
    v_mfma_f32_16x16x32_bf16 v[136:139], v[220:223], v[164:167], v[136:139]
    v_mfma_f32_16x16x32_bf16 v[76:79], v[224:227], v[176:179], v[76:79]
    v_mfma_f32_16x16x32_bf16 v[108:111], v[224:227], v[180:183], v[108:111]
    v_mfma_f32_16x16x32_bf16 v[140:143], v[224:227], v[164:167], v[140:143]
    v_mfma_f32_16x16x32_bf16 v[80:83], v[228:231], v[176:179], v[80:83]
    v_mfma_f32_16x16x32_bf16 v[112:115], v[228:231], v[180:183], v[112:115]
    v_mfma_f32_16x16x32_bf16 v[144:147], v[228:231], v[164:167], v[144:147]
    v_mfma_f32_16x16x32_bf16 v[84:87], v[232:235], v[176:179], v[84:87]
    v_mfma_f32_16x16x32_bf16 v[116:119], v[232:235], v[180:183], v[116:119]
    v_mfma_f32_16x16x32_bf16 v[148:151], v[232:235], v[164:167], v[148:151]
    v_mfma_f32_16x16x32_bf16 v[88:91], v[236:239], v[176:179], v[88:91]
    v_mfma_f32_16x16x32_bf16 v[120:123], v[236:239], v[180:183], v[120:123]
    v_mfma_f32_16x16x32_bf16 v[152:155], v[236:239], v[164:167], v[152:155]
    v_mfma_f32_16x16x32_bf16 v[92:95], v[240:243], v[176:179], v[92:95]
    v_mfma_f32_16x16x32_bf16 v[124:127], v[240:243], v[180:183], v[124:127]
    v_mfma_f32_16x16x32_bf16 v[156:159], v[240:243], v[164:167], v[156:159]
    v_mfma_f32_16x16x32_bf16 v[96:99], v[244:247], v[176:179], v[96:99]
    v_mfma_f32_16x16x32_bf16 v[128:131], v[244:247], v[180:183], v[128:131]
    v_mfma_f32_16x16x32_bf16 v[160:163], v[244:247], v[164:167], v[160:163]
    s_nop 7
    s_nop 7
    s_barrier
    s_mov_b32 s12, s78
    s_mov_b32 s13, s79
    s_mov_b32 s14, 1605632
    s_mov_b32 s15, 0x00020000
    s_lshl_b32 s32, s86, 10
    s_and_b32 s40, s86, 1
    s_mul_i32 s35, s86, 7168
    v_lshrrev_b32 v170, 3, v1
    v_bfe_u32 v168, v1, 4, 1
    v_lshlrev_b32 v168, 1, v168
    s_lshl_b32 s37, s40, 2
    v_add_u32 v168, s37, v168
    v_and_b32 v169, 7, v1
    v_xor_b32 v169, v169, v168
    s_mov_b32 s39, 896
    v_mul_lo_u32 v168, v170, s39
    v_lshl_add_u32 v171, v169, 4, v168
    s_mul_i32 s42, s88, 112
    s_add_u32 s42, s42, 0
    s_add_u32 m0, s32, 73728
    s_add_u32 s37, s35, 0
    s_add_u32 s37, s37, s42
    buffer_load_dwordx4 v171, s[12:15], s37 offen lds
    s_add_u32 m0, s32, 77824
    s_add_u32 s37, s35, 28672
    s_add_u32 s37, s37, s42
    buffer_load_dwordx4 v171, s[12:15], s37 offen lds
    s_add_u32 m0, s32, 81920
    s_add_u32 s37, s35, 57344
    s_add_u32 s37, s37, s42
    buffer_load_dwordx4 v171, s[12:15], s37 offen lds
    s_add_u32 m0, s32, 86016
    s_add_u32 s37, s35, 86016
    s_add_u32 s37, s37, s42
    buffer_load_dwordx4 v171, s[12:15], s37 offen lds
    s_add_u32 m0, s32, 90112
    s_add_u32 s37, s35, 114688
    s_add_u32 s37, s37, s42
    buffer_load_dwordx4 v171, s[12:15], s37 offen lds
    s_add_u32 m0, s32, 94208
    s_add_u32 s37, s35, 143360
    s_add_u32 s37, s37, s42
    buffer_load_dwordx4 v171, s[12:15], s37 offen lds
    s_add_u32 m0, s32, 98304
    s_add_u32 s37, s35, 172032
    s_add_u32 s37, s37, s42
    buffer_load_dwordx4 v171, s[12:15], s37 offen lds
    s_add_u32 m0, s32, 102400
    s_add_u32 s37, s35, 200704
    s_add_u32 s37, s37, s42
    buffer_load_dwordx4 v171, s[12:15], s37 offen lds
    s_add_u32 m0, s32, 106496
    s_add_u32 s37, s35, 229376
    s_add_u32 s37, s37, s42
    buffer_load_dwordx4 v171, s[12:15], s37 offen lds
    s_add_u32 m0, s32, 110592
    s_add_u32 s37, s35, 258048
    s_add_u32 s37, s37, s42
    buffer_load_dwordx4 v171, s[12:15], s37 offen lds
    s_add_u32 m0, s32, 114688
    s_add_u32 s37, s35, 286720
    s_add_u32 s37, s37, s42
    buffer_load_dwordx4 v171, s[12:15], s37 offen lds
    s_add_u32 m0, s32, 118784
    s_add_u32 s37, s35, 315392
    s_add_u32 s37, s37, s42
    buffer_load_dwordx4 v171, s[12:15], s37 offen lds
    s_add_u32 m0, s32, 122880
    s_add_u32 s37, s35, 344064
    s_add_u32 s37, s37, s42
    buffer_load_dwordx4 v171, s[12:15], s37 offen lds
    s_add_u32 m0, s32, 126976
    s_add_u32 s37, s35, 372736
    s_add_u32 s37, s37, s42
    buffer_load_dwordx4 v171, s[12:15], s37 offen lds
    s_add_u32 m0, s32, 131072
    s_add_u32 s37, s35, 401408
    s_add_u32 s37, s37, s42
    buffer_load_dwordx4 v171, s[12:15], s37 offen lds
    s_add_u32 m0, s32, 135168
    s_add_u32 s37, s35, 430080
    s_add_u32 s37, s37, s42
    buffer_load_dwordx4 v171, s[12:15], s37 offen lds
    s_add_u32 m0, s32, 139264
    s_add_u32 s37, s35, 458752
    s_add_u32 s37, s37, s42
    buffer_load_dwordx4 v171, s[12:15], s37 offen lds
    s_add_u32 m0, s32, 143360
    s_add_u32 s37, s35, 487424
    s_add_u32 s37, s37, s42
    buffer_load_dwordx4 v171, s[12:15], s37 offen lds
    v_add_f32 v172, v16, v18
    v_add_f32 v173, v17, v19
    v_add_f32 v168, v20, v22
    v_add_f32 v169, v21, v23
    v_add_f32 v172, v172, v168
    v_add_f32 v173, v173, v169
    v_mov_b32 v168, v172
    s_nop 1
    v_permlane16_swap_b32 v172, v168
    v_add_f32 v172, v172, v168
    v_mov_b32 v168, v172
    s_nop 1
    v_permlane32_swap_b32 v172, v168
    v_add_f32 v172, v172, v168
    v_mov_b32 v168, v173
    s_nop 1
    v_permlane16_swap_b32 v173, v168
    v_add_f32 v173, v173, v168
    v_mov_b32 v168, v173
    s_nop 1
    v_permlane32_swap_b32 v173, v168
    v_add_f32 v173, v173, v168
    v_mul_f32 v172, 991054117, v172
    v_mul_f32 v173, 991054117, v173
    v_fma_f32 v173, -v172, v172, v173
    v_max_f32 v173, 0, v173
    v_add_f32 v168, 925353388, v173
    v_rsq_f32 v169, v168
    s_nop 0
    v_mov_b32 v173, v169
    v_add_f32 v174, v24, v26
    v_add_f32 v175, v25, v27
    v_add_f32 v168, v28, v30
    v_add_f32 v169, v29, v31
    v_add_f32 v174, v174, v168
    v_add_f32 v175, v175, v169
    v_mov_b32 v168, v174
    s_nop 1
    v_permlane16_swap_b32 v174, v168
    v_add_f32 v174, v174, v168
    v_mov_b32 v168, v174
    s_nop 1
    v_permlane32_swap_b32 v174, v168
    v_add_f32 v174, v174, v168
    v_mov_b32 v168, v175
    s_nop 1
    v_permlane16_swap_b32 v175, v168
    v_add_f32 v175, v175, v168
    v_mov_b32 v168, v175
    s_nop 1
    v_permlane32_swap_b32 v175, v168
    v_add_f32 v175, v175, v168
    v_mul_f32 v174, 991054117, v174
    v_mul_f32 v175, 991054117, v175
    v_fma_f32 v175, -v174, v174, v175
    v_max_f32 v175, 0, v175
    v_add_f32 v168, 925353388, v175
    v_rsq_f32 v169, v168
    s_nop 0
    v_mov_b32 v175, v169
    s_mov_b32 s54, 1027024659
    s_mov_b32 s55, 3222493025
    s_add_u32 s16, s84, 26214400
    s_addc_u32 s17, s85, 0
    s_mov_b32 s18, 7340032
    s_mov_b32 s19, 0x00020000
    s_lshl_b32 s37, s87, 6
    s_lshr_b32 s38, s86, 1
    s_mul_i32 s38, s38, 32
    s_add_u32 s37, s37, s38
    v_add_u32 v168, s37, v2
    s_mov_b32 s38, 3584
    v_mul_lo_u32 v180, v168, s38
    v_and_b32 v168, 1, v3
    v_lshl_add_u32 v180, v168, 5, v180
    v_lshrrev_b32 v168, 1, v3
    v_lshl_add_u32 v180, v168, 4, v180
    v_pk_fma_f32 v[68:69], v[132:133], v[172:173], v[68:69] op_sel_hi:[1,0,1] neg_lo:[0,1,0] neg_hi:[0,1,0]
    v_pk_mul_f32 v[68:69], v[68:69], v[172:173] op_sel:[0,1] op_sel_hi:[1,1]
    v_pk_mul_f32 v[176:177], v[68:69], v[68:69]
    v_pk_mul_f32 v[178:179], v[68:69], s[54:55] op_sel:[0,1] op_sel_hi:[1,1]
    v_pk_fma_f32 v[176:177], v[176:177], s[54:55], 1.0 op_sel_hi:[1,0,0]
    v_pk_mul_f32 v[176:177], v[176:177], v[178:179]
    v_exp_f32 v176, v176
    v_exp_f32 v177, v177
    s_nop 0
    v_pk_add_f32 v[176:177], v[176:177], 1.0 op_sel_hi:[1,0]
    v_rcp_f32 v176, v176
    v_rcp_f32 v177, v177
    s_nop 0
    v_pk_mul_f32 v[68:69], v[68:69], v[176:177]
    v_pk_fma_f32 v[70:71], v[134:135], v[172:173], v[70:71] op_sel_hi:[1,0,1] neg_lo:[0,1,0] neg_hi:[0,1,0]
    v_pk_mul_f32 v[70:71], v[70:71], v[172:173] op_sel:[0,1] op_sel_hi:[1,1]
    v_pk_mul_f32 v[176:177], v[70:71], v[70:71]
    v_pk_mul_f32 v[178:179], v[70:71], s[54:55] op_sel:[0,1] op_sel_hi:[1,1]
    v_pk_fma_f32 v[176:177], v[176:177], s[54:55], 1.0 op_sel_hi:[1,0,0]
    v_pk_mul_f32 v[176:177], v[176:177], v[178:179]
    v_exp_f32 v176, v176
    v_exp_f32 v177, v177
    s_nop 0
    v_pk_add_f32 v[176:177], v[176:177], 1.0 op_sel_hi:[1,0]
    v_rcp_f32 v176, v176
    v_rcp_f32 v177, v177
    s_nop 0
    v_pk_mul_f32 v[70:71], v[70:71], v[176:177]
    v_pk_fma_f32 v[72:73], v[136:137], v[172:173], v[72:73] op_sel_hi:[1,0,1] neg_lo:[0,1,0] neg_hi:[0,1,0]
    v_pk_mul_f32 v[72:73], v[72:73], v[172:173] op_sel:[0,1] op_sel_hi:[1,1]
    v_pk_mul_f32 v[176:177], v[72:73], v[72:73]
    v_pk_mul_f32 v[178:179], v[72:73], s[54:55] op_sel:[0,1] op_sel_hi:[1,1]
    v_pk_fma_f32 v[176:177], v[176:177], s[54:55], 1.0 op_sel_hi:[1,0,0]
    v_pk_mul_f32 v[176:177], v[176:177], v[178:179]
    v_exp_f32 v176, v176
    v_exp_f32 v177, v177
    s_nop 0
    v_pk_add_f32 v[176:177], v[176:177], 1.0 op_sel_hi:[1,0]
    v_rcp_f32 v176, v176
    v_rcp_f32 v177, v177
    s_nop 0
    v_pk_mul_f32 v[72:73], v[72:73], v[176:177]
    v_pk_fma_f32 v[74:75], v[138:139], v[172:173], v[74:75] op_sel_hi:[1,0,1] neg_lo:[0,1,0] neg_hi:[0,1,0]
    v_pk_mul_f32 v[74:75], v[74:75], v[172:173] op_sel:[0,1] op_sel_hi:[1,1]
    v_pk_mul_f32 v[176:177], v[74:75], v[74:75]
    v_pk_mul_f32 v[178:179], v[74:75], s[54:55] op_sel:[0,1] op_sel_hi:[1,1]
    v_pk_fma_f32 v[176:177], v[176:177], s[54:55], 1.0 op_sel_hi:[1,0,0]
    v_pk_mul_f32 v[176:177], v[176:177], v[178:179]
    v_exp_f32 v176, v176
    v_exp_f32 v177, v177
    s_nop 0
    v_pk_add_f32 v[176:177], v[176:177], 1.0 op_sel_hi:[1,0]
    v_rcp_f32 v176, v176
    v_rcp_f32 v177, v177
    s_nop 0
    v_pk_mul_f32 v[74:75], v[74:75], v[176:177]
    v_pk_fma_f32 v[76:77], v[140:141], v[172:173], v[76:77] op_sel_hi:[1,0,1] neg_lo:[0,1,0] neg_hi:[0,1,0]
    v_pk_mul_f32 v[76:77], v[76:77], v[172:173] op_sel:[0,1] op_sel_hi:[1,1]
    v_pk_mul_f32 v[176:177], v[76:77], v[76:77]
    v_pk_mul_f32 v[178:179], v[76:77], s[54:55] op_sel:[0,1] op_sel_hi:[1,1]
    v_pk_fma_f32 v[176:177], v[176:177], s[54:55], 1.0 op_sel_hi:[1,0,0]
    v_pk_mul_f32 v[176:177], v[176:177], v[178:179]
    v_exp_f32 v176, v176
    v_exp_f32 v177, v177
    s_nop 0
    v_pk_add_f32 v[176:177], v[176:177], 1.0 op_sel_hi:[1,0]
    v_rcp_f32 v176, v176
    v_rcp_f32 v177, v177
    s_nop 0
    v_pk_mul_f32 v[76:77], v[76:77], v[176:177]
    v_pk_fma_f32 v[78:79], v[142:143], v[172:173], v[78:79] op_sel_hi:[1,0,1] neg_lo:[0,1,0] neg_hi:[0,1,0]
    v_pk_mul_f32 v[78:79], v[78:79], v[172:173] op_sel:[0,1] op_sel_hi:[1,1]
    v_pk_mul_f32 v[176:177], v[78:79], v[78:79]
    v_pk_mul_f32 v[178:179], v[78:79], s[54:55] op_sel:[0,1] op_sel_hi:[1,1]
    v_pk_fma_f32 v[176:177], v[176:177], s[54:55], 1.0 op_sel_hi:[1,0,0]
    v_pk_mul_f32 v[176:177], v[176:177], v[178:179]
    v_exp_f32 v176, v176
    v_exp_f32 v177, v177
    s_nop 0
    v_pk_add_f32 v[176:177], v[176:177], 1.0 op_sel_hi:[1,0]
    v_rcp_f32 v176, v176
    v_rcp_f32 v177, v177
    s_nop 0
    v_pk_mul_f32 v[78:79], v[78:79], v[176:177]
    v_pk_fma_f32 v[80:81], v[144:145], v[172:173], v[80:81] op_sel_hi:[1,0,1] neg_lo:[0,1,0] neg_hi:[0,1,0]
    v_pk_mul_f32 v[80:81], v[80:81], v[172:173] op_sel:[0,1] op_sel_hi:[1,1]
    v_pk_mul_f32 v[176:177], v[80:81], v[80:81]
    v_pk_mul_f32 v[178:179], v[80:81], s[54:55] op_sel:[0,1] op_sel_hi:[1,1]
    v_pk_fma_f32 v[176:177], v[176:177], s[54:55], 1.0 op_sel_hi:[1,0,0]
    v_pk_mul_f32 v[176:177], v[176:177], v[178:179]
    v_exp_f32 v176, v176
    v_exp_f32 v177, v177
    s_nop 0
    v_pk_add_f32 v[176:177], v[176:177], 1.0 op_sel_hi:[1,0]
    v_rcp_f32 v176, v176
    v_rcp_f32 v177, v177
    s_nop 0
    v_pk_mul_f32 v[80:81], v[80:81], v[176:177]
    v_pk_fma_f32 v[82:83], v[146:147], v[172:173], v[82:83] op_sel_hi:[1,0,1] neg_lo:[0,1,0] neg_hi:[0,1,0]
    v_pk_mul_f32 v[82:83], v[82:83], v[172:173] op_sel:[0,1] op_sel_hi:[1,1]
    v_pk_mul_f32 v[176:177], v[82:83], v[82:83]
    v_pk_mul_f32 v[178:179], v[82:83], s[54:55] op_sel:[0,1] op_sel_hi:[1,1]
    v_pk_fma_f32 v[176:177], v[176:177], s[54:55], 1.0 op_sel_hi:[1,0,0]
    v_pk_mul_f32 v[176:177], v[176:177], v[178:179]
    v_exp_f32 v176, v176
    v_exp_f32 v177, v177
    s_nop 0
    v_pk_add_f32 v[176:177], v[176:177], 1.0 op_sel_hi:[1,0]
    v_rcp_f32 v176, v176
    v_rcp_f32 v177, v177
    s_nop 0
    v_pk_mul_f32 v[82:83], v[82:83], v[176:177]
    v_pk_fma_f32 v[84:85], v[148:149], v[172:173], v[84:85] op_sel_hi:[1,0,1] neg_lo:[0,1,0] neg_hi:[0,1,0]
    v_pk_mul_f32 v[84:85], v[84:85], v[172:173] op_sel:[0,1] op_sel_hi:[1,1]
    v_pk_mul_f32 v[176:177], v[84:85], v[84:85]
    v_pk_mul_f32 v[178:179], v[84:85], s[54:55] op_sel:[0,1] op_sel_hi:[1,1]
    v_pk_fma_f32 v[176:177], v[176:177], s[54:55], 1.0 op_sel_hi:[1,0,0]
    v_pk_mul_f32 v[176:177], v[176:177], v[178:179]
    v_exp_f32 v176, v176
    v_exp_f32 v177, v177
    s_nop 0
    v_pk_add_f32 v[176:177], v[176:177], 1.0 op_sel_hi:[1,0]
    v_rcp_f32 v176, v176
    v_rcp_f32 v177, v177
    s_nop 0
    v_pk_mul_f32 v[84:85], v[84:85], v[176:177]
    v_pk_fma_f32 v[86:87], v[150:151], v[172:173], v[86:87] op_sel_hi:[1,0,1] neg_lo:[0,1,0] neg_hi:[0,1,0]
    v_pk_mul_f32 v[86:87], v[86:87], v[172:173] op_sel:[0,1] op_sel_hi:[1,1]
    v_pk_mul_f32 v[176:177], v[86:87], v[86:87]
    v_pk_mul_f32 v[178:179], v[86:87], s[54:55] op_sel:[0,1] op_sel_hi:[1,1]
    v_pk_fma_f32 v[176:177], v[176:177], s[54:55], 1.0 op_sel_hi:[1,0,0]
    v_pk_mul_f32 v[176:177], v[176:177], v[178:179]
    v_exp_f32 v176, v176
    v_exp_f32 v177, v177
    s_nop 0
    v_pk_add_f32 v[176:177], v[176:177], 1.0 op_sel_hi:[1,0]
    v_rcp_f32 v176, v176
    v_rcp_f32 v177, v177
    s_nop 0
    v_pk_mul_f32 v[86:87], v[86:87], v[176:177]
    v_pk_fma_f32 v[88:89], v[152:153], v[172:173], v[88:89] op_sel_hi:[1,0,1] neg_lo:[0,1,0] neg_hi:[0,1,0]
    v_pk_mul_f32 v[88:89], v[88:89], v[172:173] op_sel:[0,1] op_sel_hi:[1,1]
    v_pk_mul_f32 v[176:177], v[88:89], v[88:89]
    v_pk_mul_f32 v[178:179], v[88:89], s[54:55] op_sel:[0,1] op_sel_hi:[1,1]
    v_pk_fma_f32 v[176:177], v[176:177], s[54:55], 1.0 op_sel_hi:[1,0,0]
    v_pk_mul_f32 v[176:177], v[176:177], v[178:179]
    v_exp_f32 v176, v176
    v_exp_f32 v177, v177
    s_nop 0
    v_pk_add_f32 v[176:177], v[176:177], 1.0 op_sel_hi:[1,0]
    v_rcp_f32 v176, v176
    v_rcp_f32 v177, v177
    s_nop 0
    v_pk_mul_f32 v[88:89], v[88:89], v[176:177]
    v_pk_fma_f32 v[90:91], v[154:155], v[172:173], v[90:91] op_sel_hi:[1,0,1] neg_lo:[0,1,0] neg_hi:[0,1,0]
    v_pk_mul_f32 v[90:91], v[90:91], v[172:173] op_sel:[0,1] op_sel_hi:[1,1]
    v_pk_mul_f32 v[176:177], v[90:91], v[90:91]
    v_pk_mul_f32 v[178:179], v[90:91], s[54:55] op_sel:[0,1] op_sel_hi:[1,1]
    v_pk_fma_f32 v[176:177], v[176:177], s[54:55], 1.0 op_sel_hi:[1,0,0]
    v_pk_mul_f32 v[176:177], v[176:177], v[178:179]
    v_exp_f32 v176, v176
    v_exp_f32 v177, v177
    s_nop 0
    v_pk_add_f32 v[176:177], v[176:177], 1.0 op_sel_hi:[1,0]
    v_rcp_f32 v176, v176
    v_rcp_f32 v177, v177
    s_nop 0
    v_pk_mul_f32 v[90:91], v[90:91], v[176:177]
    v_pk_fma_f32 v[92:93], v[156:157], v[172:173], v[92:93] op_sel_hi:[1,0,1] neg_lo:[0,1,0] neg_hi:[0,1,0]
    v_pk_mul_f32 v[92:93], v[92:93], v[172:173] op_sel:[0,1] op_sel_hi:[1,1]
    v_pk_mul_f32 v[176:177], v[92:93], v[92:93]
    v_pk_mul_f32 v[178:179], v[92:93], s[54:55] op_sel:[0,1] op_sel_hi:[1,1]
    v_pk_fma_f32 v[176:177], v[176:177], s[54:55], 1.0 op_sel_hi:[1,0,0]
    v_pk_mul_f32 v[176:177], v[176:177], v[178:179]
    v_exp_f32 v176, v176
    v_exp_f32 v177, v177
    s_nop 0
    v_pk_add_f32 v[176:177], v[176:177], 1.0 op_sel_hi:[1,0]
    v_rcp_f32 v176, v176
    v_rcp_f32 v177, v177
    s_nop 0
    v_pk_mul_f32 v[92:93], v[92:93], v[176:177]
    v_pk_fma_f32 v[94:95], v[158:159], v[172:173], v[94:95] op_sel_hi:[1,0,1] neg_lo:[0,1,0] neg_hi:[0,1,0]
    v_pk_mul_f32 v[94:95], v[94:95], v[172:173] op_sel:[0,1] op_sel_hi:[1,1]
    v_pk_mul_f32 v[176:177], v[94:95], v[94:95]
    v_pk_mul_f32 v[178:179], v[94:95], s[54:55] op_sel:[0,1] op_sel_hi:[1,1]
    v_pk_fma_f32 v[176:177], v[176:177], s[54:55], 1.0 op_sel_hi:[1,0,0]
    v_pk_mul_f32 v[176:177], v[176:177], v[178:179]
    v_exp_f32 v176, v176
    v_exp_f32 v177, v177
    s_nop 0
    v_pk_add_f32 v[176:177], v[176:177], 1.0 op_sel_hi:[1,0]
    v_rcp_f32 v176, v176
    v_rcp_f32 v177, v177
    s_nop 0
    v_pk_mul_f32 v[94:95], v[94:95], v[176:177]
    v_pk_fma_f32 v[96:97], v[160:161], v[172:173], v[96:97] op_sel_hi:[1,0,1] neg_lo:[0,1,0] neg_hi:[0,1,0]
    v_pk_mul_f32 v[96:97], v[96:97], v[172:173] op_sel:[0,1] op_sel_hi:[1,1]
    v_pk_mul_f32 v[176:177], v[96:97], v[96:97]
    v_pk_mul_f32 v[178:179], v[96:97], s[54:55] op_sel:[0,1] op_sel_hi:[1,1]
    v_pk_fma_f32 v[176:177], v[176:177], s[54:55], 1.0 op_sel_hi:[1,0,0]
    v_pk_mul_f32 v[176:177], v[176:177], v[178:179]
    v_exp_f32 v176, v176
    v_exp_f32 v177, v177
    s_nop 0
    v_pk_add_f32 v[176:177], v[176:177], 1.0 op_sel_hi:[1,0]
    v_rcp_f32 v176, v176
    v_rcp_f32 v177, v177
    s_nop 0
    v_pk_mul_f32 v[96:97], v[96:97], v[176:177]
    v_pk_fma_f32 v[98:99], v[162:163], v[172:173], v[98:99] op_sel_hi:[1,0,1] neg_lo:[0,1,0] neg_hi:[0,1,0]
    v_pk_mul_f32 v[98:99], v[98:99], v[172:173] op_sel:[0,1] op_sel_hi:[1,1]
    v_pk_mul_f32 v[176:177], v[98:99], v[98:99]
    v_pk_mul_f32 v[178:179], v[98:99], s[54:55] op_sel:[0,1] op_sel_hi:[1,1]
    v_pk_fma_f32 v[176:177], v[176:177], s[54:55], 1.0 op_sel_hi:[1,0,0]
    v_pk_mul_f32 v[176:177], v[176:177], v[178:179]
    v_exp_f32 v176, v176
    v_exp_f32 v177, v177
    s_nop 0
    v_pk_add_f32 v[176:177], v[176:177], 1.0 op_sel_hi:[1,0]
    v_rcp_f32 v176, v176
    v_rcp_f32 v177, v177
    s_nop 0
    v_pk_mul_f32 v[98:99], v[98:99], v[176:177]
    v_cvt_pk_bf16_f32 v184, v68, v69
    v_cvt_pk_bf16_f32 v185, v70, v71
    v_cvt_pk_bf16_f32 v186, v72, v73
    v_cvt_pk_bf16_f32 v187, v74, v75
    s_nop 1
    v_permlane16_swap_b32 v184, v186
    v_permlane16_swap_b32 v185, v187
    s_and_b32 s37, s86, 1
    s_mul_i32 s37, s37, 224
    s_mul_i32 s38, s88, 448
    s_add_u32 s37, s37, s38
    s_add_u32 s37, s37, 0
    s_cmp_eq_u32 s91, 1
    s_cbranch_scc1 Ls23_p
    buffer_store_dwordx4 v[184:187], v180, s[16:19], s37 offen sc1
    s_branch Ls23_d
Ls23_p:
    buffer_store_dwordx4 v[184:187], v180, s[16:19], s37 offen
Ls23_d:
    s_nop 1
    v_cvt_pk_bf16_f32 v184, v76, v77
    v_cvt_pk_bf16_f32 v185, v78, v79
    v_cvt_pk_bf16_f32 v186, v80, v81
    v_cvt_pk_bf16_f32 v187, v82, v83
    s_nop 1
    v_permlane16_swap_b32 v184, v186
    v_permlane16_swap_b32 v185, v187
    s_and_b32 s37, s86, 1
    s_mul_i32 s37, s37, 224
    s_mul_i32 s38, s88, 448
    s_add_u32 s37, s37, s38
    s_add_u32 s37, s37, 64
    s_mov_b32 exec_hi, 0xffff
    s_cmp_eq_u32 s91, 1
    s_cbranch_scc1 Ls24_p
    buffer_store_dwordx4 v[184:187], v180, s[16:19], s37 offen sc1
    s_branch Ls24_d
Ls24_p:
    buffer_store_dwordx4 v[184:187], v180, s[16:19], s37 offen
Ls24_d:
    s_mov_b64 exec, -1
    s_nop 1
    v_cvt_pk_bf16_f32 v184, v84, v85
    v_cvt_pk_bf16_f32 v185, v86, v87
    v_cvt_pk_bf16_f32 v186, v88, v89
    v_cvt_pk_bf16_f32 v187, v90, v91
    s_nop 1
    v_permlane16_swap_b32 v184, v186
    v_permlane16_swap_b32 v185, v187
    s_and_b32 s37, s86, 1
    s_mul_i32 s37, s37, 224
    s_mul_i32 s38, s88, 448
    s_add_u32 s37, s37, s38
    s_add_u32 s37, s37, 112
    s_cmp_eq_u32 s91, 1
    s_cbranch_scc1 Ls25_p
    buffer_store_dwordx4 v[184:187], v180, s[16:19], s37 offen sc1
    s_branch Ls25_d
Ls25_p:
    buffer_store_dwordx4 v[184:187], v180, s[16:19], s37 offen
Ls25_d:
    s_nop 1
    v_cvt_pk_bf16_f32 v184, v92, v93
    v_cvt_pk_bf16_f32 v185, v94, v95
    v_cvt_pk_bf16_f32 v186, v96, v97
    v_cvt_pk_bf16_f32 v187, v98, v99
    s_nop 1
    v_permlane16_swap_b32 v184, v186
    v_permlane16_swap_b32 v185, v187
    s_and_b32 s37, s86, 1
    s_mul_i32 s37, s37, 224
    s_mul_i32 s38, s88, 448
    s_add_u32 s37, s37, s38
    s_add_u32 s37, s37, 176
    s_mov_b32 exec_hi, 0xffff
    s_cmp_eq_u32 s91, 1
    s_cbranch_scc1 Ls26_p
    buffer_store_dwordx4 v[184:187], v180, s[16:19], s37 offen sc1
    s_branch Ls26_d
Ls26_p:
    buffer_store_dwordx4 v[184:187], v180, s[16:19], s37 offen
Ls26_d:
    s_mov_b64 exec, -1
    s_nop 1
    v_pk_fma_f32 v[100:101], v[132:133], v[174:175], v[100:101] op_sel_hi:[1,0,1] neg_lo:[0,1,0] neg_hi:[0,1,0]
    v_pk_mul_f32 v[100:101], v[100:101], v[174:175] op_sel:[0,1] op_sel_hi:[1,1]
    v_pk_mul_f32 v[176:177], v[100:101], v[100:101]
    v_pk_mul_f32 v[178:179], v[100:101], s[54:55] op_sel:[0,1] op_sel_hi:[1,1]
    v_pk_fma_f32 v[176:177], v[176:177], s[54:55], 1.0 op_sel_hi:[1,0,0]
    v_pk_mul_f32 v[176:177], v[176:177], v[178:179]
    v_exp_f32 v176, v176
    v_exp_f32 v177, v177
    s_nop 0
    v_pk_add_f32 v[176:177], v[176:177], 1.0 op_sel_hi:[1,0]
    v_rcp_f32 v176, v176
    v_rcp_f32 v177, v177
    s_nop 0
    v_pk_mul_f32 v[100:101], v[100:101], v[176:177]
    v_pk_fma_f32 v[102:103], v[134:135], v[174:175], v[102:103] op_sel_hi:[1,0,1] neg_lo:[0,1,0] neg_hi:[0,1,0]
    v_pk_mul_f32 v[102:103], v[102:103], v[174:175] op_sel:[0,1] op_sel_hi:[1,1]
    v_pk_mul_f32 v[176:177], v[102:103], v[102:103]
    v_pk_mul_f32 v[178:179], v[102:103], s[54:55] op_sel:[0,1] op_sel_hi:[1,1]
    v_pk_fma_f32 v[176:177], v[176:177], s[54:55], 1.0 op_sel_hi:[1,0,0]
    v_pk_mul_f32 v[176:177], v[176:177], v[178:179]
    v_exp_f32 v176, v176
    v_exp_f32 v177, v177
    s_nop 0
    v_pk_add_f32 v[176:177], v[176:177], 1.0 op_sel_hi:[1,0]
    v_rcp_f32 v176, v176
    v_rcp_f32 v177, v177
    s_nop 0
    v_pk_mul_f32 v[102:103], v[102:103], v[176:177]
    v_pk_fma_f32 v[104:105], v[136:137], v[174:175], v[104:105] op_sel_hi:[1,0,1] neg_lo:[0,1,0] neg_hi:[0,1,0]
    v_pk_mul_f32 v[104:105], v[104:105], v[174:175] op_sel:[0,1] op_sel_hi:[1,1]
    v_pk_mul_f32 v[176:177], v[104:105], v[104:105]
    v_pk_mul_f32 v[178:179], v[104:105], s[54:55] op_sel:[0,1] op_sel_hi:[1,1]
    v_pk_fma_f32 v[176:177], v[176:177], s[54:55], 1.0 op_sel_hi:[1,0,0]
    v_pk_mul_f32 v[176:177], v[176:177], v[178:179]
    v_exp_f32 v176, v176
    v_exp_f32 v177, v177
    s_nop 0
    v_pk_add_f32 v[176:177], v[176:177], 1.0 op_sel_hi:[1,0]
    v_rcp_f32 v176, v176
    v_rcp_f32 v177, v177
    s_nop 0
    v_pk_mul_f32 v[104:105], v[104:105], v[176:177]
    v_pk_fma_f32 v[106:107], v[138:139], v[174:175], v[106:107] op_sel_hi:[1,0,1] neg_lo:[0,1,0] neg_hi:[0,1,0]
    v_pk_mul_f32 v[106:107], v[106:107], v[174:175] op_sel:[0,1] op_sel_hi:[1,1]
    v_pk_mul_f32 v[176:177], v[106:107], v[106:107]
    v_pk_mul_f32 v[178:179], v[106:107], s[54:55] op_sel:[0,1] op_sel_hi:[1,1]
    v_pk_fma_f32 v[176:177], v[176:177], s[54:55], 1.0 op_sel_hi:[1,0,0]
    v_pk_mul_f32 v[176:177], v[176:177], v[178:179]
    v_exp_f32 v176, v176
    v_exp_f32 v177, v177
    s_nop 0
    v_pk_add_f32 v[176:177], v[176:177], 1.0 op_sel_hi:[1,0]
    v_rcp_f32 v176, v176
    v_rcp_f32 v177, v177
    s_nop 0
    v_pk_mul_f32 v[106:107], v[106:107], v[176:177]
    v_pk_fma_f32 v[108:109], v[140:141], v[174:175], v[108:109] op_sel_hi:[1,0,1] neg_lo:[0,1,0] neg_hi:[0,1,0]
    v_pk_mul_f32 v[108:109], v[108:109], v[174:175] op_sel:[0,1] op_sel_hi:[1,1]
    v_pk_mul_f32 v[176:177], v[108:109], v[108:109]
    v_pk_mul_f32 v[178:179], v[108:109], s[54:55] op_sel:[0,1] op_sel_hi:[1,1]
    v_pk_fma_f32 v[176:177], v[176:177], s[54:55], 1.0 op_sel_hi:[1,0,0]
    v_pk_mul_f32 v[176:177], v[176:177], v[178:179]
    v_exp_f32 v176, v176
    v_exp_f32 v177, v177
    s_nop 0
    v_pk_add_f32 v[176:177], v[176:177], 1.0 op_sel_hi:[1,0]
    v_rcp_f32 v176, v176
    v_rcp_f32 v177, v177
    s_nop 0
    v_pk_mul_f32 v[108:109], v[108:109], v[176:177]
    v_pk_fma_f32 v[110:111], v[142:143], v[174:175], v[110:111] op_sel_hi:[1,0,1] neg_lo:[0,1,0] neg_hi:[0,1,0]
    v_pk_mul_f32 v[110:111], v[110:111], v[174:175] op_sel:[0,1] op_sel_hi:[1,1]
    v_pk_mul_f32 v[176:177], v[110:111], v[110:111]
    v_pk_mul_f32 v[178:179], v[110:111], s[54:55] op_sel:[0,1] op_sel_hi:[1,1]
    v_pk_fma_f32 v[176:177], v[176:177], s[54:55], 1.0 op_sel_hi:[1,0,0]
    v_pk_mul_f32 v[176:177], v[176:177], v[178:179]
    v_exp_f32 v176, v176
    v_exp_f32 v177, v177
    s_nop 0
    v_pk_add_f32 v[176:177], v[176:177], 1.0 op_sel_hi:[1,0]
    v_rcp_f32 v176, v176
    v_rcp_f32 v177, v177
    s_nop 0
    v_pk_mul_f32 v[110:111], v[110:111], v[176:177]
    v_pk_fma_f32 v[112:113], v[144:145], v[174:175], v[112:113] op_sel_hi:[1,0,1] neg_lo:[0,1,0] neg_hi:[0,1,0]
    v_pk_mul_f32 v[112:113], v[112:113], v[174:175] op_sel:[0,1] op_sel_hi:[1,1]
    v_pk_mul_f32 v[176:177], v[112:113], v[112:113]
    v_pk_mul_f32 v[178:179], v[112:113], s[54:55] op_sel:[0,1] op_sel_hi:[1,1]
    v_pk_fma_f32 v[176:177], v[176:177], s[54:55], 1.0 op_sel_hi:[1,0,0]
    v_pk_mul_f32 v[176:177], v[176:177], v[178:179]
    v_exp_f32 v176, v176
    v_exp_f32 v177, v177
    s_nop 0
    v_pk_add_f32 v[176:177], v[176:177], 1.0 op_sel_hi:[1,0]
    v_rcp_f32 v176, v176
    v_rcp_f32 v177, v177
    s_nop 0
    v_pk_mul_f32 v[112:113], v[112:113], v[176:177]
    v_pk_fma_f32 v[114:115], v[146:147], v[174:175], v[114:115] op_sel_hi:[1,0,1] neg_lo:[0,1,0] neg_hi:[0,1,0]
    v_pk_mul_f32 v[114:115], v[114:115], v[174:175] op_sel:[0,1] op_sel_hi:[1,1]
    v_pk_mul_f32 v[176:177], v[114:115], v[114:115]
    v_pk_mul_f32 v[178:179], v[114:115], s[54:55] op_sel:[0,1] op_sel_hi:[1,1]
    v_pk_fma_f32 v[176:177], v[176:177], s[54:55], 1.0 op_sel_hi:[1,0,0]
    v_pk_mul_f32 v[176:177], v[176:177], v[178:179]
    v_exp_f32 v176, v176
    v_exp_f32 v177, v177
    s_nop 0
    v_pk_add_f32 v[176:177], v[176:177], 1.0 op_sel_hi:[1,0]
    v_rcp_f32 v176, v176
    v_rcp_f32 v177, v177
    s_nop 0
    v_pk_mul_f32 v[114:115], v[114:115], v[176:177]
    v_pk_fma_f32 v[116:117], v[148:149], v[174:175], v[116:117] op_sel_hi:[1,0,1] neg_lo:[0,1,0] neg_hi:[0,1,0]
    v_pk_mul_f32 v[116:117], v[116:117], v[174:175] op_sel:[0,1] op_sel_hi:[1,1]
    v_pk_mul_f32 v[176:177], v[116:117], v[116:117]
    v_pk_mul_f32 v[178:179], v[116:117], s[54:55] op_sel:[0,1] op_sel_hi:[1,1]
    v_pk_fma_f32 v[176:177], v[176:177], s[54:55], 1.0 op_sel_hi:[1,0,0]
    v_pk_mul_f32 v[176:177], v[176:177], v[178:179]
    v_exp_f32 v176, v176
    v_exp_f32 v177, v177
    s_nop 0
    v_pk_add_f32 v[176:177], v[176:177], 1.0 op_sel_hi:[1,0]
    v_rcp_f32 v176, v176
    v_rcp_f32 v177, v177
    s_nop 0
    v_pk_mul_f32 v[116:117], v[116:117], v[176:177]
    v_pk_fma_f32 v[118:119], v[150:151], v[174:175], v[118:119] op_sel_hi:[1,0,1] neg_lo:[0,1,0] neg_hi:[0,1,0]
    v_pk_mul_f32 v[118:119], v[118:119], v[174:175] op_sel:[0,1] op_sel_hi:[1,1]
    v_pk_mul_f32 v[176:177], v[118:119], v[118:119]
    v_pk_mul_f32 v[178:179], v[118:119], s[54:55] op_sel:[0,1] op_sel_hi:[1,1]
    v_pk_fma_f32 v[176:177], v[176:177], s[54:55], 1.0 op_sel_hi:[1,0,0]
    v_pk_mul_f32 v[176:177], v[176:177], v[178:179]
    v_exp_f32 v176, v176
    v_exp_f32 v177, v177
    s_nop 0
    v_pk_add_f32 v[176:177], v[176:177], 1.0 op_sel_hi:[1,0]
    v_rcp_f32 v176, v176
    v_rcp_f32 v177, v177
    s_nop 0
    v_pk_mul_f32 v[118:119], v[118:119], v[176:177]
    v_pk_fma_f32 v[120:121], v[152:153], v[174:175], v[120:121] op_sel_hi:[1,0,1] neg_lo:[0,1,0] neg_hi:[0,1,0]
    v_pk_mul_f32 v[120:121], v[120:121], v[174:175] op_sel:[0,1] op_sel_hi:[1,1]
    v_pk_mul_f32 v[176:177], v[120:121], v[120:121]
    v_pk_mul_f32 v[178:179], v[120:121], s[54:55] op_sel:[0,1] op_sel_hi:[1,1]
    v_pk_fma_f32 v[176:177], v[176:177], s[54:55], 1.0 op_sel_hi:[1,0,0]
    v_pk_mul_f32 v[176:177], v[176:177], v[178:179]
    v_exp_f32 v176, v176
    v_exp_f32 v177, v177
    s_nop 0
    v_pk_add_f32 v[176:177], v[176:177], 1.0 op_sel_hi:[1,0]
    v_rcp_f32 v176, v176
    v_rcp_f32 v177, v177
    s_nop 0
    v_pk_mul_f32 v[120:121], v[120:121], v[176:177]
    v_pk_fma_f32 v[122:123], v[154:155], v[174:175], v[122:123] op_sel_hi:[1,0,1] neg_lo:[0,1,0] neg_hi:[0,1,0]
    v_pk_mul_f32 v[122:123], v[122:123], v[174:175] op_sel:[0,1] op_sel_hi:[1,1]
    v_pk_mul_f32 v[176:177], v[122:123], v[122:123]
    v_pk_mul_f32 v[178:179], v[122:123], s[54:55] op_sel:[0,1] op_sel_hi:[1,1]
    v_pk_fma_f32 v[176:177], v[176:177], s[54:55], 1.0 op_sel_hi:[1,0,0]
    v_pk_mul_f32 v[176:177], v[176:177], v[178:179]
    v_exp_f32 v176, v176
    v_exp_f32 v177, v177
    s_nop 0
    v_pk_add_f32 v[176:177], v[176:177], 1.0 op_sel_hi:[1,0]
    v_rcp_f32 v176, v176
    v_rcp_f32 v177, v177
    s_nop 0
    v_pk_mul_f32 v[122:123], v[122:123], v[176:177]
    v_pk_fma_f32 v[124:125], v[156:157], v[174:175], v[124:125] op_sel_hi:[1,0,1] neg_lo:[0,1,0] neg_hi:[0,1,0]
    v_pk_mul_f32 v[124:125], v[124:125], v[174:175] op_sel:[0,1] op_sel_hi:[1,1]
    v_pk_mul_f32 v[176:177], v[124:125], v[124:125]
    v_pk_mul_f32 v[178:179], v[124:125], s[54:55] op_sel:[0,1] op_sel_hi:[1,1]
    v_pk_fma_f32 v[176:177], v[176:177], s[54:55], 1.0 op_sel_hi:[1,0,0]
    v_pk_mul_f32 v[176:177], v[176:177], v[178:179]
    v_exp_f32 v176, v176
    v_exp_f32 v177, v177
    s_nop 0
    v_pk_add_f32 v[176:177], v[176:177], 1.0 op_sel_hi:[1,0]
    v_rcp_f32 v176, v176
    v_rcp_f32 v177, v177
    s_nop 0
    v_pk_mul_f32 v[124:125], v[124:125], v[176:177]
    v_pk_fma_f32 v[126:127], v[158:159], v[174:175], v[126:127] op_sel_hi:[1,0,1] neg_lo:[0,1,0] neg_hi:[0,1,0]
    v_pk_mul_f32 v[126:127], v[126:127], v[174:175] op_sel:[0,1] op_sel_hi:[1,1]
    v_pk_mul_f32 v[176:177], v[126:127], v[126:127]
    v_pk_mul_f32 v[178:179], v[126:127], s[54:55] op_sel:[0,1] op_sel_hi:[1,1]
    v_pk_fma_f32 v[176:177], v[176:177], s[54:55], 1.0 op_sel_hi:[1,0,0]
    v_pk_mul_f32 v[176:177], v[176:177], v[178:179]
    v_exp_f32 v176, v176
    v_exp_f32 v177, v177
    s_nop 0
    v_pk_add_f32 v[176:177], v[176:177], 1.0 op_sel_hi:[1,0]
    v_rcp_f32 v176, v176
    v_rcp_f32 v177, v177
    s_nop 0
    v_pk_mul_f32 v[126:127], v[126:127], v[176:177]
    v_pk_fma_f32 v[128:129], v[160:161], v[174:175], v[128:129] op_sel_hi:[1,0,1] neg_lo:[0,1,0] neg_hi:[0,1,0]
    v_pk_mul_f32 v[128:129], v[128:129], v[174:175] op_sel:[0,1] op_sel_hi:[1,1]
    v_pk_mul_f32 v[176:177], v[128:129], v[128:129]
    v_pk_mul_f32 v[178:179], v[128:129], s[54:55] op_sel:[0,1] op_sel_hi:[1,1]
    v_pk_fma_f32 v[176:177], v[176:177], s[54:55], 1.0 op_sel_hi:[1,0,0]
    v_pk_mul_f32 v[176:177], v[176:177], v[178:179]
    v_exp_f32 v176, v176
    v_exp_f32 v177, v177
    s_nop 0
    v_pk_add_f32 v[176:177], v[176:177], 1.0 op_sel_hi:[1,0]
    v_rcp_f32 v176, v176
    v_rcp_f32 v177, v177
    s_nop 0
    v_pk_mul_f32 v[128:129], v[128:129], v[176:177]
    v_pk_fma_f32 v[130:131], v[162:163], v[174:175], v[130:131] op_sel_hi:[1,0,1] neg_lo:[0,1,0] neg_hi:[0,1,0]
    v_pk_mul_f32 v[130:131], v[130:131], v[174:175] op_sel:[0,1] op_sel_hi:[1,1]
    v_pk_mul_f32 v[176:177], v[130:131], v[130:131]
    v_pk_mul_f32 v[178:179], v[130:131], s[54:55] op_sel:[0,1] op_sel_hi:[1,1]
    v_pk_fma_f32 v[176:177], v[176:177], s[54:55], 1.0 op_sel_hi:[1,0,0]
    v_pk_mul_f32 v[176:177], v[176:177], v[178:179]
    v_exp_f32 v176, v176
    v_exp_f32 v177, v177
    s_nop 0
    v_pk_add_f32 v[176:177], v[176:177], 1.0 op_sel_hi:[1,0]
    v_rcp_f32 v176, v176
    v_rcp_f32 v177, v177
    s_nop 0
    v_pk_mul_f32 v[130:131], v[130:131], v[176:177]
    v_cvt_pk_bf16_f32 v184, v100, v101
    v_cvt_pk_bf16_f32 v185, v102, v103
    v_cvt_pk_bf16_f32 v186, v104, v105
    v_cvt_pk_bf16_f32 v187, v106, v107
    s_nop 1
    v_permlane16_swap_b32 v184, v186
    v_permlane16_swap_b32 v185, v187
    s_and_b32 s37, s86, 1
    s_mul_i32 s37, s37, 224
    s_mul_i32 s38, s88, 448
    s_add_u32 s37, s37, s38
    s_add_u32 s37, s37, 57344
    s_cmp_eq_u32 s91, 1
    s_cbranch_scc1 Ls27_p
    buffer_store_dwordx4 v[184:187], v180, s[16:19], s37 offen sc1
    s_branch Ls27_d
Ls27_p:
    buffer_store_dwordx4 v[184:187], v180, s[16:19], s37 offen
Ls27_d:
    s_nop 1
    v_cvt_pk_bf16_f32 v184, v108, v109
    v_cvt_pk_bf16_f32 v185, v110, v111
    v_cvt_pk_bf16_f32 v186, v112, v113
    v_cvt_pk_bf16_f32 v187, v114, v115
    s_nop 1
    v_permlane16_swap_b32 v184, v186
    v_permlane16_swap_b32 v185, v187
    s_and_b32 s37, s86, 1
    s_mul_i32 s37, s37, 224
    s_mul_i32 s38, s88, 448
    s_add_u32 s37, s37, s38
    s_add_u32 s37, s37, 57408
    s_mov_b32 exec_hi, 0xffff
    s_cmp_eq_u32 s91, 1
    s_cbranch_scc1 Ls28_p
    buffer_store_dwordx4 v[184:187], v180, s[16:19], s37 offen sc1
    s_branch Ls28_d
Ls28_p:
    buffer_store_dwordx4 v[184:187], v180, s[16:19], s37 offen
Ls28_d:
    s_mov_b64 exec, -1
    s_nop 1
    v_cvt_pk_bf16_f32 v184, v116, v117
    v_cvt_pk_bf16_f32 v185, v118, v119
    v_cvt_pk_bf16_f32 v186, v120, v121
    v_cvt_pk_bf16_f32 v187, v122, v123
    s_nop 1
    v_permlane16_swap_b32 v184, v186
    v_permlane16_swap_b32 v185, v187
    s_and_b32 s37, s86, 1
    s_mul_i32 s37, s37, 224
    s_mul_i32 s38, s88, 448
    s_add_u32 s37, s37, s38
    s_add_u32 s37, s37, 57456
    s_cmp_eq_u32 s91, 1
    s_cbranch_scc1 Ls29_p
    buffer_store_dwordx4 v[184:187], v180, s[16:19], s37 offen sc1
    s_branch Ls29_d
Ls29_p:
    buffer_store_dwordx4 v[184:187], v180, s[16:19], s37 offen
Ls29_d:
    s_nop 1
    v_cvt_pk_bf16_f32 v184, v124, v125
    v_cvt_pk_bf16_f32 v185, v126, v127
    v_cvt_pk_bf16_f32 v186, v128, v129
    v_cvt_pk_bf16_f32 v187, v130, v131
    s_nop 1
    v_permlane16_swap_b32 v184, v186
    v_permlane16_swap_b32 v185, v187
    s_and_b32 s37, s86, 1
    s_mul_i32 s37, s37, 224
    s_mul_i32 s38, s88, 448
    s_add_u32 s37, s37, s38
    s_add_u32 s37, s37, 57520
    s_mov_b32 exec_hi, 0xffff
    s_cmp_eq_u32 s91, 1
    s_cbranch_scc1 Ls30_p
    buffer_store_dwordx4 v[184:187], v180, s[16:19], s37 offen sc1
    s_branch Ls30_d
Ls30_p:
    buffer_store_dwordx4 v[184:187], v180, s[16:19], s37 offen
Ls30_d:
    s_mov_b64 exec, -1
    s_nop 1
    s_waitcnt vmcnt(0)
    s_lshl_b32 s32, s89, 7
    s_lshl_b32 s33, s86, 2
    s_add_u32 s32, s32, s33
    v_mov_b32 v181, s32
    v_mov_b32 v182, 6
    s_mov_b64 exec, 1
    s_mov_b32 s57, s91
    s_cmp_eq_u32 s57, 1
    s_cbranch_scc1 Ls31_p
    buffer_store_dword v182, v181, s[24:27], 0 offen sc1
    s_branch Ls31_d
Ls31_p:
    buffer_store_dword v182, v181, s[24:27], 0 offen
Ls31_d:
    s_mov_b64 exec, -1
    s_barrier
    s_add_u32 s8, s84, 26214400
    s_addc_u32 s9, s85, 0
    s_mov_b32 s10, 7340032
    s_mov_b32 s11, 0x00020000
    s_mov_b32 s12, s78
    s_mov_b32 s13, s79
    s_mov_b32 s14, 1605632
    s_mov_b32 s15, 0x00020000
    s_lshl_b32 s32, s86, 10
    s_and_b32 s40, s86, 1
    s_add_u32 s33, s40, 8
    s_mul_i32 s34, s86, 28672
    s_mul_i32 s35, s86, 7168
    s_mul_i32 s36, s88, 112
    v_lshrrev_b32 v5, 3, v1
    v_lshrrev_b32 v7, 4, v1
    s_lshl_b32 s37, s40, 2
    v_add_u32 v7, s37, v7
    v_and_b32 v6, 7, v1
    v_xor_b32 v6, v6, v7
    s_lshl_b32 s37, s87, 6
    s_lshl_b32 s38, s86, 3
    s_add_u32 s38, s38, 0
    s_add_u32 s38, s38, s37
    v_add_u32 v7, s38, v5
    s_mov_b32 s39, 3584
    v_mul_lo_u32 v7, v7, s39
    v_lshl_add_u32 v9, v6, 4, v7
    s_lshl_b32 s38, s86, 3
    s_add_u32 s38, s38, 32
    s_add_u32 s38, s38, s37
    v_add_u32 v7, s38, v5
    s_mov_b32 s39, 3584
    v_mul_lo_u32 v7, v7, s39
    v_lshl_add_u32 v10, v6, 4, v7
    v_bfe_u32 v7, v1, 4, 1
    v_lshlrev_b32 v7, 1, v7
    s_lshl_b32 s37, s40, 2
    v_add_u32 v7, s37, v7
    v_and_b32 v8, 7, v1
    v_xor_b32 v8, v8, v7
    s_mov_b32 s39, 896
    v_mul_lo_u32 v7, v5, s39
    v_lshl_add_u32 v11, v8, 4, v7
    s_add_u32 s42, s36, 0
    s_cmp_lg_u32 s86, 0
    s_cbranch_scc1 Lp32_skip
    v_lshrrev_b32 v13, 3, v1
    v_add_u32 v13, s87, v13
    v_add_u32 v13, 0, v13
    v_mov_b32 v14, s87
    v_cmp_gt_u32 vcc, 32, v13
    s_nop 1
    v_cndmask_b32 v13, v14, v13, vcc
    v_and_b32 v12, 7, v1
    v_lshlrev_b32 v12, 5, v12
    v_and_b32 v14, 3, v13
    v_lshl_add_u32 v12, v14, 3, v12
    v_lshrrev_b32 v14, 2, v13
    v_add_u32 v12, v12, v14
    v_lshlrev_b32 v12, 7, v12
    v_add_u32 v12, 0, v12
    v_mov_b32 v20, 0
    s_mov_b32 s52, 0
    s_mov_b32 s53, 6
    s_mov_b32 exec_lo, 255
    s_mov_b32 exec_hi, 0
Lp32_loop:
    buffer_load_dwordx4 v[16:19], v12, s[24:27], 0 offen sc1
    s_waitcnt vmcnt(0)
    v_min_u32 v16, v16, v17
    v_min_u32 v18, v18, v19
    v_min_u32 v16, v16, v18
    v_cmp_gt_u32 vcc, s53, v16
    s_cbranch_vccz Lp32_ok
Lp32_again:
    s_add_u32 s52, s52, 1
    s_cmp_lt_u32 s52, 20000
    s_cbranch_scc1 Lp32_loop
Lp32_ok:
    s_mov_b64 exec, -1
Lp32_skip:
    s_barrier
    s_add_u32 m0, s32, 0
    s_nop 0
    s_mov_b32 s37, 0
    buffer_load_dwordx4 v9, s[8:11], s37 offen lds
    s_add_u32 m0, s32, 4096
    s_nop 0
    s_mov_b32 s37, 0
    buffer_load_dwordx4 v10, s[8:11], s37 offen lds
    s_add_u32 m0, s32, 8192
    s_nop 0
    s_mov_b32 s37, 128
    buffer_load_dwordx4 v9, s[8:11], s37 offen lds
    s_add_u32 m0, s32, 12288
    s_nop 0
    s_mov_b32 s37, 128
    buffer_load_dwordx4 v10, s[8:11], s37 offen lds
    s_add_u32 m0, s32, 16384
    s_nop 0
    s_mov_b32 s37, 256
    buffer_load_dwordx4 v9, s[8:11], s37 offen lds
    s_add_u32 m0, s32, 20480
    s_nop 0
    s_mov_b32 s37, 256
    buffer_load_dwordx4 v10, s[8:11], s37 offen lds
    s_add_u32 m0, s32, 24576
    s_nop 0
    s_mov_b32 s37, 384
    buffer_load_dwordx4 v9, s[8:11], s37 offen lds
    s_add_u32 m0, s32, 28672
    s_nop 0
    s_mov_b32 s37, 384
    buffer_load_dwordx4 v10, s[8:11], s37 offen lds
    s_add_u32 m0, s32, 32768
    s_nop 0
    s_mov_b32 s37, 512
    buffer_load_dwordx4 v9, s[8:11], s37 offen lds
    s_add_u32 m0, s32, 36864
    s_nop 0
    s_mov_b32 s37, 512
    buffer_load_dwordx4 v10, s[8:11], s37 offen lds
    s_add_u32 m0, s32, 40960
    s_nop 0
    s_mov_b32 s37, 640
    buffer_load_dwordx4 v9, s[8:11], s37 offen lds
    s_add_u32 m0, s32, 45056
    s_nop 0
    s_mov_b32 s37, 640
    buffer_load_dwordx4 v10, s[8:11], s37 offen lds
    s_add_u32 m0, s32, 49152
    s_nop 0
    s_mov_b32 s37, 768
    buffer_load_dwordx4 v9, s[8:11], s37 offen lds
    s_add_u32 m0, s32, 53248
    s_nop 0
    s_mov_b32 s37, 768
    buffer_load_dwordx4 v10, s[8:11], s37 offen lds
    s_add_u32 m0, s32, 57344
    s_nop 0
    s_mov_b32 s37, 896
    buffer_load_dwordx4 v9, s[8:11], s37 offen lds
    s_add_u32 m0, s32, 61440
    s_nop 0
    s_mov_b32 s37, 896
    buffer_load_dwordx4 v10, s[8:11], s37 offen lds
    s_add_u32 m0, s32, 65536
    s_nop 0
    s_mov_b32 s37, 1024
    buffer_load_dwordx4 v9, s[8:11], s37 offen lds
    s_add_u32 m0, s32, 69632
    s_nop 0
    s_mov_b32 s37, 1024
    buffer_load_dwordx4 v10, s[8:11], s37 offen lds
    s_lshl_b32 s37, s87, 6
    s_lshr_b32 s38, s86, 1
    s_mul_i32 s38, s38, 32
    s_add_u32 s37, s37, s38
    v_add_u32 v13, s37, v2
    s_mov_b32 s38, 896
    v_mul_lo_u32 v13, v13, s38
    v_lshl_add_u32 v12, v3, 3, v13
    s_and_b32 s37, s86, 1
    s_lshl_b32 s37, s37, 6
    s_mul_i32 s38, s88, 112
    s_add_u32 s37, s37, s38
    v_add_u32 v12, s37, v12
    s_add_u32 s20, s84, 3145728
    s_addc_u32 s21, s85, 0
    s_mov_b32 s22, 1835008
    s_mov_b32 s23, 0x00020000
    s_mov_b32 s37, 0
    buffer_load_dwordx2 v[14:15], v12, s[20:23], s37 offen offset:0
    buffer_load_dwordx2 v[16:17], v12, s[20:23], s37 offen offset:32
    s_mov_b32 s37, 14336
    buffer_load_dwordx2 v[18:19], v12, s[20:23], s37 offen offset:0
    buffer_load_dwordx2 v[20:21], v12, s[20:23], s37 offen offset:32
    s_add_u32 s20, s84, 7340032
    s_addc_u32 s21, s85, 0
    s_mov_b32 s22, 1835008
    s_mov_b32 s23, 0x00020000
    s_mov_b32 s37, 0
    buffer_load_dwordx2 v[22:23], v12, s[20:23], s37 offen offset:0
    buffer_load_dwordx2 v[24:25], v12, s[20:23], s37 offen offset:32
    s_mov_b32 s37, 14336
    buffer_load_dwordx2 v[26:27], v12, s[20:23], s37 offen offset:0
    buffer_load_dwordx2 v[28:29], v12, s[20:23], s37 offen offset:32
    v_lshrrev_b32 v7, 1, v2
    v_and_b32 v7, 7, v7
    v_add_u32 v8, 0, v3
    v_xor_b32 v8, v8, v7
    v_lshlrev_b32 v8, 4, v8
    v_lshl_add_u32 v30, v2, 7, v8
    v_add_u32 v8, 4, v3
    v_xor_b32 v8, v8, v7
    v_lshlrev_b32 v8, 4, v8
    v_lshl_add_u32 v31, v2, 7, v8
    s_lshr_b32 s37, s86, 1
    s_mul_i32 s37, s37, 4096
    v_add_u32 v30, s37, v30
    v_add_u32 v31, s37, v31
    v_lshrrev_b32 v34, 2, v2
    v_lshl_add_u32 v34, v3, 3, v34
    v_lshlrev_b32 v34, 7, v34
    v_bfe_u32 v35, v2, 3, 1
    v_lshlrev_b32 v35, 2, v35
    v_and_b32 v7, 1, v3
    v_lshl_add_u32 v35, v7, 3, v35
    v_and_b32 v36, 3, v2
    s_and_b32 s37, s86, 1
    s_mul_i32 s37, s37, 2
    s_add_u32 s38, s37, 0
    s_and_b32 s39, s38, 3
    s_lshl_b32 s39, s39, 2
    v_add_u32 v7, s39, v36
    v_xor_b32 v7, v7, v35
    v_lshl_add_u32 v7, v7, 3, v34
    s_lshr_b32 s38, s38, 2
    s_lshl_b32 s38, s38, 13
    v_add_u32 v32, s38, v7
    s_add_u32 s38, s37, 1
    s_and_b32 s39, s38, 3
    s_lshl_b32 s39, s39, 2
    v_add_u32 v7, s39, v36
    v_xor_b32 v7, v7, v35
    v_lshl_add_u32 v7, v7, 3, v34
    s_lshr_b32 s38, s38, 2
    s_lshl_b32 s38, s38, 13
    v_add_u32 v33, s38, v7
    v_add_u32 v37, 65536, v30
    v_add_u32 v38, 65536, v31
    v_add_u32 v39, 65536, v32
    v_add_u32 v40, 131072, v32
    v_add_u32 v41, 65536, v33
    v_add_u32 v42, 131072, v33
    v_mov_b32 v44, 0
    v_mov_b32 v45, 0
    v_mov_b32 v46, 0
    v_mov_b32 v47, 0
    v_mov_b32 v48, 0
    v_mov_b32 v49, 0
    v_mov_b32 v50, 0
    v_mov_b32 v51, 0
    v_mov_b32 v52, 0
    v_mov_b32 v53, 0
    v_mov_b32 v54, 0
    v_mov_b32 v55, 0
    v_mov_b32 v56, 0
    v_mov_b32 v57, 0
    v_mov_b32 v58, 0
    v_mov_b32 v59, 0
    s_waitcnt vmcnt(24)
    s_barrier
    ds_read_b128 v[60:63], v30 offset:0
    ds_read_b128 v[64:67], v30 offset:2048
    ds_read_b64_tr_b16 v[76:77], v39 offset:8192
    ds_read_b64_tr_b16 v[78:79], v39 offset:8704
    ds_read_b64_tr_b16 v[80:81], v41 offset:8192
    ds_read_b64_tr_b16 v[82:83], v41 offset:8704
    s_waitcnt lgkmcnt(0)
    v_mfma_f32_16x16x32_bf16 v[44:47], v[76:79], v[60:63], v[44:47]
    ds_read_b128 v[68:71], v31 offset:0
    ds_read_b128 v[72:75], v31 offset:2048
    ds_read_b64_tr_b16 v[84:85], v39 offset:12288
    v_mfma_f32_16x16x32_bf16 v[52:55], v[76:79], v[64:67], v[52:55]
    ds_read_b64_tr_b16 v[86:87], v39 offset:12800
    ds_read_b64_tr_b16 v[88:89], v41 offset:12288
    ds_read_b64_tr_b16 v[90:91], v41 offset:12800
    v_mfma_f32_16x16x32_bf16 v[48:51], v[80:83], v[60:63], v[48:51]
    v_mfma_f32_16x16x32_bf16 v[56:59], v[80:83], v[64:67], v[56:59]
    s_waitcnt lgkmcnt(0)
    s_waitcnt vmcnt(22)
    s_barrier
    s_add_u32 m0, s32, 73728
    s_add_u32 s37, s35, 516096
    s_add_u32 s37, s37, s42
    buffer_load_dwordx4 v11, s[12:15], s37 offen lds
    s_add_u32 m0, s32, 77824
    s_add_u32 s37, s35, 544768
    s_add_u32 s37, s37, s42
    buffer_load_dwordx4 v11, s[12:15], s37 offen lds
    s_add_u32 m0, s32, 0
    s_nop 0
    s_mov_b32 s37, 1152
    buffer_load_dwordx4 v9, s[8:11], s37 offen lds
    s_add_u32 m0, s32, 4096
    s_nop 0
    s_mov_b32 s37, 1152
    buffer_load_dwordx4 v10, s[8:11], s37 offen lds
    v_mfma_f32_16x16x32_bf16 v[44:47], v[84:87], v[68:71], v[44:47]
    ds_read_b128 v[60:63], v30 offset:8192
    ds_read_b128 v[64:67], v30 offset:10240
    ds_read_b64_tr_b16 v[76:77], v39 offset:16384
    v_mfma_f32_16x16x32_bf16 v[52:55], v[84:87], v[72:75], v[52:55]
    ds_read_b64_tr_b16 v[78:79], v39 offset:16896
    ds_read_b64_tr_b16 v[80:81], v41 offset:16384
    ds_read_b64_tr_b16 v[82:83], v41 offset:16896
    v_mfma_f32_16x16x32_bf16 v[48:51], v[88:91], v[68:71], v[48:51]
    v_mfma_f32_16x16x32_bf16 v[56:59], v[88:91], v[72:75], v[56:59]
    s_waitcnt lgkmcnt(0)
    v_mfma_f32_16x16x32_bf16 v[44:47], v[76:79], v[60:63], v[44:47]
    ds_read_b128 v[68:71], v31 offset:8192
    ds_read_b128 v[72:75], v31 offset:10240
    ds_read_b64_tr_b16 v[84:85], v39 offset:20480
    v_mfma_f32_16x16x32_bf16 v[52:55], v[76:79], v[64:67], v[52:55]
    ds_read_b64_tr_b16 v[86:87], v39 offset:20992
    ds_read_b64_tr_b16 v[88:89], v41 offset:20480
    ds_read_b64_tr_b16 v[90:91], v41 offset:20992
    v_mfma_f32_16x16x32_bf16 v[48:51], v[80:83], v[60:63], v[48:51]
    v_mfma_f32_16x16x32_bf16 v[56:59], v[80:83], v[64:67], v[56:59]
    s_waitcnt lgkmcnt(0)
    s_waitcnt vmcnt(24)
    s_barrier
    s_add_u32 m0, s32, 81920
    s_add_u32 s37, s35, 573440
    s_add_u32 s37, s37, s42
    buffer_load_dwordx4 v11, s[12:15], s37 offen lds
    s_add_u32 m0, s32, 86016
    s_add_u32 s37, s35, 602112
    s_add_u32 s37, s37, s42
    buffer_load_dwordx4 v11, s[12:15], s37 offen lds
    s_add_u32 m0, s32, 8192
    s_nop 0
    s_mov_b32 s37, 1280
    buffer_load_dwordx4 v9, s[8:11], s37 offen lds
    s_add_u32 m0, s32, 12288
    s_nop 0
    s_mov_b32 s37, 1280
    buffer_load_dwordx4 v10, s[8:11], s37 offen lds
    v_mfma_f32_16x16x32_bf16 v[44:47], v[84:87], v[68:71], v[44:47]
    ds_read_b128 v[60:63], v30 offset:16384
    ds_read_b128 v[64:67], v30 offset:18432
    ds_read_b64_tr_b16 v[76:77], v39 offset:24576
    v_mfma_f32_16x16x32_bf16 v[52:55], v[84:87], v[72:75], v[52:55]
    ds_read_b64_tr_b16 v[78:79], v39 offset:25088
    ds_read_b64_tr_b16 v[80:81], v41 offset:24576
    ds_read_b64_tr_b16 v[82:83], v41 offset:25088
    v_mfma_f32_16x16x32_bf16 v[48:51], v[88:91], v[68:71], v[48:51]
    v_mfma_f32_16x16x32_bf16 v[56:59], v[88:91], v[72:75], v[56:59]
    s_waitcnt lgkmcnt(0)
    v_mfma_f32_16x16x32_bf16 v[44:47], v[76:79], v[60:63], v[44:47]
    ds_read_b128 v[68:71], v31 offset:16384
    ds_read_b128 v[72:75], v31 offset:18432
    ds_read_b64_tr_b16 v[84:85], v39 offset:28672
    v_mfma_f32_16x16x32_bf16 v[52:55], v[76:79], v[64:67], v[52:55]
    ds_read_b64_tr_b16 v[86:87], v39 offset:29184
    ds_read_b64_tr_b16 v[88:89], v41 offset:28672
    ds_read_b64_tr_b16 v[90:91], v41 offset:29184
    v_mfma_f32_16x16x32_bf16 v[48:51], v[80:83], v[60:63], v[48:51]
    v_mfma_f32_16x16x32_bf16 v[56:59], v[80:83], v[64:67], v[56:59]
    s_waitcnt lgkmcnt(0)
    s_waitcnt vmcnt(26)
    s_barrier
    s_add_u32 m0, s32, 90112
    s_add_u32 s37, s35, 630784
    s_add_u32 s37, s37, s42
    buffer_load_dwordx4 v11, s[12:15], s37 offen lds
    s_add_u32 m0, s32, 94208
    s_add_u32 s37, s35, 659456
    s_add_u32 s37, s37, s42
    buffer_load_dwordx4 v11, s[12:15], s37 offen lds
    s_add_u32 m0, s32, 16384
    s_nop 0
    s_mov_b32 s37, 1408
    buffer_load_dwordx4 v9, s[8:11], s37 offen lds
    s_add_u32 m0, s32, 20480
    s_nop 0
    s_mov_b32 s37, 1408
    buffer_load_dwordx4 v10, s[8:11], s37 offen lds
    v_mfma_f32_16x16x32_bf16 v[44:47], v[84:87], v[68:71], v[44:47]
    ds_read_b128 v[60:63], v30 offset:24576
    ds_read_b128 v[64:67], v30 offset:26624
    ds_read_b64_tr_b16 v[76:77], v39 offset:32768
    v_mfma_f32_16x16x32_bf16 v[52:55], v[84:87], v[72:75], v[52:55]
    ds_read_b64_tr_b16 v[78:79], v39 offset:33280
    ds_read_b64_tr_b16 v[80:81], v41 offset:32768
    ds_read_b64_tr_b16 v[82:83], v41 offset:33280
    v_mfma_f32_16x16x32_bf16 v[48:51], v[88:91], v[68:71], v[48:51]
    v_mfma_f32_16x16x32_bf16 v[56:59], v[88:91], v[72:75], v[56:59]
    s_waitcnt lgkmcnt(0)
    v_mfma_f32_16x16x32_bf16 v[44:47], v[76:79], v[60:63], v[44:47]
    ds_read_b128 v[68:71], v31 offset:24576
    ds_read_b128 v[72:75], v31 offset:26624
    ds_read_b64_tr_b16 v[84:85], v39 offset:36864
    v_mfma_f32_16x16x32_bf16 v[52:55], v[76:79], v[64:67], v[52:55]
    ds_read_b64_tr_b16 v[86:87], v39 offset:37376
    ds_read_b64_tr_b16 v[88:89], v41 offset:36864
    ds_read_b64_tr_b16 v[90:91], v41 offset:37376
    v_mfma_f32_16x16x32_bf16 v[48:51], v[80:83], v[60:63], v[48:51]
    v_mfma_f32_16x16x32_bf16 v[56:59], v[80:83], v[64:67], v[56:59]
    s_waitcnt lgkmcnt(0)
    s_waitcnt vmcnt(28)
    s_barrier
    s_add_u32 m0, s32, 98304
    s_add_u32 s37, s35, 688128
    s_add_u32 s37, s37, s42
    buffer_load_dwordx4 v11, s[12:15], s37 offen lds
    s_add_u32 m0, s32, 102400
    s_add_u32 s37, s35, 716800
    s_add_u32 s37, s37, s42
    buffer_load_dwordx4 v11, s[12:15], s37 offen lds
    s_add_u32 m0, s32, 24576
    s_nop 0
    s_mov_b32 s37, 1536
    buffer_load_dwordx4 v9, s[8:11], s37 offen lds
    s_add_u32 m0, s32, 28672
    s_nop 0
    s_mov_b32 s37, 1536
    buffer_load_dwordx4 v10, s[8:11], s37 offen lds
    v_mfma_f32_16x16x32_bf16 v[44:47], v[84:87], v[68:71], v[44:47]
    ds_read_b128 v[60:63], v30 offset:32768
    ds_read_b128 v[64:67], v30 offset:34816
    ds_read_b64_tr_b16 v[76:77], v39 offset:40960
    v_mfma_f32_16x16x32_bf16 v[52:55], v[84:87], v[72:75], v[52:55]
    ds_read_b64_tr_b16 v[78:79], v39 offset:41472
    ds_read_b64_tr_b16 v[80:81], v41 offset:40960
    ds_read_b64_tr_b16 v[82:83], v41 offset:41472
    v_mfma_f32_16x16x32_bf16 v[48:51], v[88:91], v[68:71], v[48:51]
    v_mfma_f32_16x16x32_bf16 v[56:59], v[88:91], v[72:75], v[56:59]
    s_waitcnt lgkmcnt(0)
    v_mfma_f32_16x16x32_bf16 v[44:47], v[76:79], v[60:63], v[44:47]
    ds_read_b128 v[68:71], v31 offset:32768
    ds_read_b128 v[72:75], v31 offset:34816
    ds_read_b64_tr_b16 v[84:85], v39 offset:45056
    v_mfma_f32_16x16x32_bf16 v[52:55], v[76:79], v[64:67], v[52:55]
    ds_read_b64_tr_b16 v[86:87], v39 offset:45568
    ds_read_b64_tr_b16 v[88:89], v41 offset:45056
    ds_read_b64_tr_b16 v[90:91], v41 offset:45568
    v_mfma_f32_16x16x32_bf16 v[48:51], v[80:83], v[60:63], v[48:51]
    v_mfma_f32_16x16x32_bf16 v[56:59], v[80:83], v[64:67], v[56:59]
    s_waitcnt lgkmcnt(0)
    s_waitcnt vmcnt(30)
    s_barrier
    s_add_u32 m0, s32, 106496
    s_add_u32 s37, s35, 745472
    s_add_u32 s37, s37, s42
    buffer_load_dwordx4 v11, s[12:15], s37 offen lds
    s_add_u32 m0, s32, 110592
    s_add_u32 s37, s35, 774144
    s_add_u32 s37, s37, s42
    buffer_load_dwordx4 v11, s[12:15], s37 offen lds
    s_add_u32 m0, s32, 32768
    s_nop 0
    s_mov_b32 s37, 1664
    buffer_load_dwordx4 v9, s[8:11], s37 offen lds
    s_add_u32 m0, s32, 36864
    s_nop 0
    s_mov_b32 s37, 1664
    buffer_load_dwordx4 v10, s[8:11], s37 offen lds
    v_mfma_f32_16x16x32_bf16 v[44:47], v[84:87], v[68:71], v[44:47]
    ds_read_b128 v[60:63], v30 offset:40960
    ds_read_b128 v[64:67], v30 offset:43008
    ds_read_b64_tr_b16 v[76:77], v39 offset:49152
    v_mfma_f32_16x16x32_bf16 v[52:55], v[84:87], v[72:75], v[52:55]
    ds_read_b64_tr_b16 v[78:79], v39 offset:49664
    ds_read_b64_tr_b16 v[80:81], v41 offset:49152
    ds_read_b64_tr_b16 v[82:83], v41 offset:49664
    v_mfma_f32_16x16x32_bf16 v[48:51], v[88:91], v[68:71], v[48:51]
    v_mfma_f32_16x16x32_bf16 v[56:59], v[88:91], v[72:75], v[56:59]
    s_waitcnt lgkmcnt(0)
    v_mfma_f32_16x16x32_bf16 v[44:47], v[76:79], v[60:63], v[44:47]
    ds_read_b128 v[68:71], v31 offset:40960
    ds_read_b128 v[72:75], v31 offset:43008
    ds_read_b64_tr_b16 v[84:85], v39 offset:53248
    v_mfma_f32_16x16x32_bf16 v[52:55], v[76:79], v[64:67], v[52:55]
    ds_read_b64_tr_b16 v[86:87], v39 offset:53760
    ds_read_b64_tr_b16 v[88:89], v41 offset:53248
    ds_read_b64_tr_b16 v[90:91], v41 offset:53760
    v_mfma_f32_16x16x32_bf16 v[48:51], v[80:83], v[60:63], v[48:51]
    v_mfma_f32_16x16x32_bf16 v[56:59], v[80:83], v[64:67], v[56:59]
    s_waitcnt lgkmcnt(0)
    s_waitcnt vmcnt(32)
    s_barrier
    s_add_u32 m0, s32, 114688
    s_add_u32 s37, s35, 802816
    s_add_u32 s37, s37, s42
    buffer_load_dwordx4 v11, s[12:15], s37 offen lds
    s_add_u32 m0, s32, 118784
    s_add_u32 s37, s35, 831488
    s_add_u32 s37, s37, s42
    buffer_load_dwordx4 v11, s[12:15], s37 offen lds
    s_add_u32 m0, s32, 40960
    s_nop 0
    s_mov_b32 s37, 1792
    buffer_load_dwordx4 v9, s[8:11], s37 offen lds
    s_add_u32 m0, s32, 45056
    s_nop 0
    s_mov_b32 s37, 1792
    buffer_load_dwordx4 v10, s[8:11], s37 offen lds
    v_mfma_f32_16x16x32_bf16 v[44:47], v[84:87], v[68:71], v[44:47]
    ds_read_b128 v[60:63], v30 offset:49152
    ds_read_b128 v[64:67], v30 offset:51200
    ds_read_b64_tr_b16 v[76:77], v39 offset:57344
    v_mfma_f32_16x16x32_bf16 v[52:55], v[84:87], v[72:75], v[52:55]
    ds_read_b64_tr_b16 v[78:79], v39 offset:57856
    ds_read_b64_tr_b16 v[80:81], v41 offset:57344
    ds_read_b64_tr_b16 v[82:83], v41 offset:57856
    v_mfma_f32_16x16x32_bf16 v[48:51], v[88:91], v[68:71], v[48:51]
    v_mfma_f32_16x16x32_bf16 v[56:59], v[88:91], v[72:75], v[56:59]
    s_waitcnt lgkmcnt(0)
    v_mfma_f32_16x16x32_bf16 v[44:47], v[76:79], v[60:63], v[44:47]
    ds_read_b128 v[68:71], v31 offset:49152
    ds_read_b128 v[72:75], v31 offset:51200
    ds_read_b64_tr_b16 v[84:85], v39 offset:61440
    v_mfma_f32_16x16x32_bf16 v[52:55], v[76:79], v[64:67], v[52:55]
    ds_read_b64_tr_b16 v[86:87], v39 offset:61952
    ds_read_b64_tr_b16 v[88:89], v41 offset:61440
    ds_read_b64_tr_b16 v[90:91], v41 offset:61952
    v_mfma_f32_16x16x32_bf16 v[48:51], v[80:83], v[60:63], v[48:51]
    v_mfma_f32_16x16x32_bf16 v[56:59], v[80:83], v[64:67], v[56:59]
    s_waitcnt lgkmcnt(0)
    s_waitcnt vmcnt(34)
    s_barrier
    s_add_u32 m0, s32, 122880
    s_add_u32 s37, s35, 860160
    s_add_u32 s37, s37, s42
    buffer_load_dwordx4 v11, s[12:15], s37 offen lds
    s_add_u32 m0, s32, 126976
    s_add_u32 s37, s35, 888832
    s_add_u32 s37, s37, s42
    buffer_load_dwordx4 v11, s[12:15], s37 offen lds
    s_add_u32 m0, s32, 49152
    s_nop 0
    s_mov_b32 s37, 1920
    buffer_load_dwordx4 v9, s[8:11], s37 offen lds
    s_add_u32 m0, s32, 53248
    s_nop 0
    s_mov_b32 s37, 1920
    buffer_load_dwordx4 v10, s[8:11], s37 offen lds
    v_mfma_f32_16x16x32_bf16 v[44:47], v[84:87], v[68:71], v[44:47]
    ds_read_b128 v[60:63], v30 offset:57344
    ds_read_b128 v[64:67], v30 offset:59392
    ds_read_b64_tr_b16 v[76:77], v40 offset:0
    v_mfma_f32_16x16x32_bf16 v[52:55], v[84:87], v[72:75], v[52:55]
    ds_read_b64_tr_b16 v[78:79], v40 offset:512
    ds_read_b64_tr_b16 v[80:81], v42 offset:0
    ds_read_b64_tr_b16 v[82:83], v42 offset:512
    v_mfma_f32_16x16x32_bf16 v[48:51], v[88:91], v[68:71], v[48:51]
    v_mfma_f32_16x16x32_bf16 v[56:59], v[88:91], v[72:75], v[56:59]
    s_waitcnt lgkmcnt(0)
    v_mfma_f32_16x16x32_bf16 v[44:47], v[76:79], v[60:63], v[44:47]
    ds_read_b128 v[68:71], v31 offset:57344
    ds_read_b128 v[72:75], v31 offset:59392
    ds_read_b64_tr_b16 v[84:85], v40 offset:4096
    v_mfma_f32_16x16x32_bf16 v[52:55], v[76:79], v[64:67], v[52:55]
    ds_read_b64_tr_b16 v[86:87], v40 offset:4608
    ds_read_b64_tr_b16 v[88:89], v42 offset:4096
    ds_read_b64_tr_b16 v[90:91], v42 offset:4608
    v_mfma_f32_16x16x32_bf16 v[48:51], v[80:83], v[60:63], v[48:51]
    v_mfma_f32_16x16x32_bf16 v[56:59], v[80:83], v[64:67], v[56:59]
    s_waitcnt lgkmcnt(0)
    s_waitcnt vmcnt(36)
    s_barrier
    s_add_u32 m0, s32, 131072
    s_add_u32 s37, s35, 917504
    s_add_u32 s37, s37, s42
    buffer_load_dwordx4 v11, s[12:15], s37 offen lds
    s_add_u32 m0, s32, 135168
    s_add_u32 s37, s35, 946176
    s_add_u32 s37, s37, s42
    buffer_load_dwordx4 v11, s[12:15], s37 offen lds
    s_add_u32 m0, s32, 57344
    s_nop 0
    s_mov_b32 s37, 2048
    buffer_load_dwordx4 v9, s[8:11], s37 offen lds
    s_add_u32 m0, s32, 61440
    s_nop 0
    s_mov_b32 s37, 2048
    buffer_load_dwordx4 v10, s[8:11], s37 offen lds
    v_mfma_f32_16x16x32_bf16 v[44:47], v[84:87], v[68:71], v[44:47]
    ds_read_b128 v[60:63], v37 offset:0
    ds_read_b128 v[64:67], v37 offset:2048
    ds_read_b64_tr_b16 v[76:77], v40 offset:8192
    v_mfma_f32_16x16x32_bf16 v[52:55], v[84:87], v[72:75], v[52:55]
    ds_read_b64_tr_b16 v[78:79], v40 offset:8704
    ds_read_b64_tr_b16 v[80:81], v42 offset:8192
    ds_read_b64_tr_b16 v[82:83], v42 offset:8704
    v_mfma_f32_16x16x32_bf16 v[48:51], v[88:91], v[68:71], v[48:51]
    v_mfma_f32_16x16x32_bf16 v[56:59], v[88:91], v[72:75], v[56:59]
    s_waitcnt lgkmcnt(0)
    v_mfma_f32_16x16x32_bf16 v[44:47], v[76:79], v[60:63], v[44:47]
    ds_read_b128 v[68:71], v38 offset:0
    ds_read_b128 v[72:75], v38 offset:2048
    ds_read_b64_tr_b16 v[84:85], v40 offset:12288
    v_mfma_f32_16x16x32_bf16 v[52:55], v[76:79], v[64:67], v[52:55]
    ds_read_b64_tr_b16 v[86:87], v40 offset:12800
    ds_read_b64_tr_b16 v[88:89], v42 offset:12288
    ds_read_b64_tr_b16 v[90:91], v42 offset:12800
    v_mfma_f32_16x16x32_bf16 v[48:51], v[80:83], v[60:63], v[48:51]
    v_mfma_f32_16x16x32_bf16 v[56:59], v[80:83], v[64:67], v[56:59]
    s_waitcnt lgkmcnt(0)
    s_waitcnt vmcnt(30)
    s_waitcnt vmcnt(28)
    s_barrier
    s_add_u32 m0, s32, 139264
    s_add_u32 s37, s35, 974848
    s_add_u32 s37, s37, s42
    buffer_load_dwordx4 v11, s[12:15], s37 offen lds
    s_add_u32 m0, s32, 143360
    s_add_u32 s37, s35, 1003520
    s_add_u32 s37, s37, s42
    buffer_load_dwordx4 v11, s[12:15], s37 offen lds
    s_add_u32 m0, s32, 65536
    s_nop 0
    s_mov_b32 s37, 2176
    buffer_load_dwordx4 v9, s[8:11], s37 offen lds
    s_add_u32 m0, s32, 69632
    s_nop 0
    s_mov_b32 s37, 2176
    buffer_load_dwordx4 v10, s[8:11], s37 offen lds
    v_mfma_f32_16x16x32_bf16 v[44:47], v[84:87], v[68:71], v[44:47]
    ds_read_b128 v[60:63], v30 offset:0
    ds_read_b128 v[64:67], v30 offset:2048
    ds_read_b64_tr_b16 v[76:77], v39 offset:8192
    v_mfma_f32_16x16x32_bf16 v[52:55], v[84:87], v[72:75], v[52:55]
    ds_read_b64_tr_b16 v[78:79], v39 offset:8704
    ds_read_b64_tr_b16 v[80:81], v41 offset:8192
    ds_read_b64_tr_b16 v[82:83], v41 offset:8704
    v_mfma_f32_16x16x32_bf16 v[48:51], v[88:91], v[68:71], v[48:51]
    v_mfma_f32_16x16x32_bf16 v[56:59], v[88:91], v[72:75], v[56:59]
    s_waitcnt lgkmcnt(0)
    v_mfma_f32_16x16x32_bf16 v[44:47], v[76:79], v[60:63], v[44:47]
    ds_read_b128 v[68:71], v31 offset:0
    ds_read_b128 v[72:75], v31 offset:2048
    ds_read_b64_tr_b16 v[84:85], v39 offset:12288
    v_mfma_f32_16x16x32_bf16 v[52:55], v[76:79], v[64:67], v[52:55]
    ds_read_b64_tr_b16 v[86:87], v39 offset:12800
    ds_read_b64_tr_b16 v[88:89], v41 offset:12288
    ds_read_b64_tr_b16 v[90:91], v41 offset:12800
    v_mfma_f32_16x16x32_bf16 v[48:51], v[80:83], v[60:63], v[48:51]
    v_mfma_f32_16x16x32_bf16 v[56:59], v[80:83], v[64:67], v[56:59]
    s_waitcnt lgkmcnt(0)
    s_waitcnt vmcnt(30)
    s_waitcnt vmcnt(28)
    s_barrier
    s_add_u32 m0, s32, 73728
    s_add_u32 s37, s35, 1032192
    s_add_u32 s37, s37, s42
    buffer_load_dwordx4 v11, s[12:15], s37 offen lds
    s_add_u32 m0, s32, 77824
    s_add_u32 s37, s35, 1060864
    s_add_u32 s37, s37, s42
    buffer_load_dwordx4 v11, s[12:15], s37 offen lds
    s_add_u32 m0, s32, 0
    s_nop 0
    s_mov_b32 s37, 2304
    buffer_load_dwordx4 v9, s[8:11], s37 offen lds
    s_add_u32 m0, s32, 4096
    s_nop 0
    s_mov_b32 s37, 2304
    buffer_load_dwordx4 v10, s[8:11], s37 offen lds
    v_mfma_f32_16x16x32_bf16 v[44:47], v[84:87], v[68:71], v[44:47]
    ds_read_b128 v[60:63], v30 offset:8192
    ds_read_b128 v[64:67], v30 offset:10240
    ds_read_b64_tr_b16 v[76:77], v39 offset:16384
    v_mfma_f32_16x16x32_bf16 v[52:55], v[84:87], v[72:75], v[52:55]
    ds_read_b64_tr_b16 v[78:79], v39 offset:16896
    ds_read_b64_tr_b16 v[80:81], v41 offset:16384
    ds_read_b64_tr_b16 v[82:83], v41 offset:16896
    v_mfma_f32_16x16x32_bf16 v[48:51], v[88:91], v[68:71], v[48:51]
    v_mfma_f32_16x16x32_bf16 v[56:59], v[88:91], v[72:75], v[56:59]
    s_waitcnt lgkmcnt(0)
    v_mfma_f32_16x16x32_bf16 v[44:47], v[76:79], v[60:63], v[44:47]
    ds_read_b128 v[68:71], v31 offset:8192
    ds_read_b128 v[72:75], v31 offset:10240
    ds_read_b64_tr_b16 v[84:85], v39 offset:20480
    v_mfma_f32_16x16x32_bf16 v[52:55], v[76:79], v[64:67], v[52:55]
    ds_read_b64_tr_b16 v[86:87], v39 offset:20992
    ds_read_b64_tr_b16 v[88:89], v41 offset:20480
    ds_read_b64_tr_b16 v[90:91], v41 offset:20992
    v_mfma_f32_16x16x32_bf16 v[48:51], v[80:83], v[60:63], v[48:51]
    v_mfma_f32_16x16x32_bf16 v[56:59], v[80:83], v[64:67], v[56:59]
    s_waitcnt lgkmcnt(0)
    s_waitcnt vmcnt(30)
    s_waitcnt vmcnt(28)
    s_barrier
    s_add_u32 m0, s32, 81920
    s_add_u32 s37, s35, 1089536
    s_add_u32 s37, s37, s42
    buffer_load_dwordx4 v11, s[12:15], s37 offen lds
    s_add_u32 m0, s32, 86016
    s_add_u32 s37, s35, 1118208
    s_add_u32 s37, s37, s42
    buffer_load_dwordx4 v11, s[12:15], s37 offen lds
    s_add_u32 m0, s32, 8192
    s_nop 0
    s_mov_b32 s37, 2432
    buffer_load_dwordx4 v9, s[8:11], s37 offen lds
    s_add_u32 m0, s32, 12288
    s_nop 0
    s_mov_b32 s37, 2432
    buffer_load_dwordx4 v10, s[8:11], s37 offen lds
    v_mfma_f32_16x16x32_bf16 v[44:47], v[84:87], v[68:71], v[44:47]
    ds_read_b128 v[60:63], v30 offset:16384
    ds_read_b128 v[64:67], v30 offset:18432
    ds_read_b64_tr_b16 v[76:77], v39 offset:24576
    v_mfma_f32_16x16x32_bf16 v[52:55], v[84:87], v[72:75], v[52:55]
    ds_read_b64_tr_b16 v[78:79], v39 offset:25088
    ds_read_b64_tr_b16 v[80:81], v41 offset:24576
    ds_read_b64_tr_b16 v[82:83], v41 offset:25088
    v_mfma_f32_16x16x32_bf16 v[48:51], v[88:91], v[68:71], v[48:51]
    v_mfma_f32_16x16x32_bf16 v[56:59], v[88:91], v[72:75], v[56:59]
    s_waitcnt lgkmcnt(0)
    v_mfma_f32_16x16x32_bf16 v[44:47], v[76:79], v[60:63], v[44:47]
    ds_read_b128 v[68:71], v31 offset:16384
    ds_read_b128 v[72:75], v31 offset:18432
    ds_read_b64_tr_b16 v[84:85], v39 offset:28672
    v_mfma_f32_16x16x32_bf16 v[52:55], v[76:79], v[64:67], v[52:55]
    ds_read_b64_tr_b16 v[86:87], v39 offset:29184
    ds_read_b64_tr_b16 v[88:89], v41 offset:28672
    ds_read_b64_tr_b16 v[90:91], v41 offset:29184
    v_mfma_f32_16x16x32_bf16 v[48:51], v[80:83], v[60:63], v[48:51]
    v_mfma_f32_16x16x32_bf16 v[56:59], v[80:83], v[64:67], v[56:59]
    s_waitcnt lgkmcnt(0)
    s_waitcnt vmcnt(30)
    s_waitcnt vmcnt(28)
    s_barrier
    s_add_u32 m0, s32, 90112
    s_add_u32 s37, s35, 1146880
    s_add_u32 s37, s37, s42
    buffer_load_dwordx4 v11, s[12:15], s37 offen lds
    s_add_u32 m0, s32, 94208
    s_add_u32 s37, s35, 1175552
    s_add_u32 s37, s37, s42
    buffer_load_dwordx4 v11, s[12:15], s37 offen lds
    s_add_u32 m0, s32, 16384
    s_nop 0
    s_mov_b32 s37, 2560
    buffer_load_dwordx4 v9, s[8:11], s37 offen lds
    s_add_u32 m0, s32, 20480
    s_nop 0
    s_mov_b32 s37, 2560
    buffer_load_dwordx4 v10, s[8:11], s37 offen lds
    v_mfma_f32_16x16x32_bf16 v[44:47], v[84:87], v[68:71], v[44:47]
    ds_read_b128 v[60:63], v30 offset:24576
    ds_read_b128 v[64:67], v30 offset:26624
    ds_read_b64_tr_b16 v[76:77], v39 offset:32768
    v_mfma_f32_16x16x32_bf16 v[52:55], v[84:87], v[72:75], v[52:55]
    ds_read_b64_tr_b16 v[78:79], v39 offset:33280
    ds_read_b64_tr_b16 v[80:81], v41 offset:32768
    ds_read_b64_tr_b16 v[82:83], v41 offset:33280
    v_mfma_f32_16x16x32_bf16 v[48:51], v[88:91], v[68:71], v[48:51]
    v_mfma_f32_16x16x32_bf16 v[56:59], v[88:91], v[72:75], v[56:59]
    s_waitcnt lgkmcnt(0)
    v_mfma_f32_16x16x32_bf16 v[44:47], v[76:79], v[60:63], v[44:47]
    ds_read_b128 v[68:71], v31 offset:24576
    ds_read_b128 v[72:75], v31 offset:26624
    ds_read_b64_tr_b16 v[84:85], v39 offset:36864
    v_mfma_f32_16x16x32_bf16 v[52:55], v[76:79], v[64:67], v[52:55]
    ds_read_b64_tr_b16 v[86:87], v39 offset:37376
    ds_read_b64_tr_b16 v[88:89], v41 offset:36864
    ds_read_b64_tr_b16 v[90:91], v41 offset:37376
    v_mfma_f32_16x16x32_bf16 v[48:51], v[80:83], v[60:63], v[48:51]
    v_mfma_f32_16x16x32_bf16 v[56:59], v[80:83], v[64:67], v[56:59]
    s_waitcnt lgkmcnt(0)
    s_waitcnt vmcnt(30)
    s_waitcnt vmcnt(28)
    s_barrier
    s_add_u32 m0, s32, 98304
    s_add_u32 s37, s35, 1204224
    s_add_u32 s37, s37, s42
    buffer_load_dwordx4 v11, s[12:15], s37 offen lds
    s_add_u32 m0, s32, 102400
    s_add_u32 s37, s35, 1232896
    s_add_u32 s37, s37, s42
    buffer_load_dwordx4 v11, s[12:15], s37 offen lds
    s_add_u32 m0, s32, 24576
    s_nop 0
    s_mov_b32 s37, 2688
    buffer_load_dwordx4 v9, s[8:11], s37 offen lds
    s_add_u32 m0, s32, 28672
    s_nop 0
    s_mov_b32 s37, 2688
    buffer_load_dwordx4 v10, s[8:11], s37 offen lds
    v_mfma_f32_16x16x32_bf16 v[44:47], v[84:87], v[68:71], v[44:47]
    ds_read_b128 v[60:63], v30 offset:32768
    ds_read_b128 v[64:67], v30 offset:34816
    ds_read_b64_tr_b16 v[76:77], v39 offset:40960
    v_mfma_f32_16x16x32_bf16 v[52:55], v[84:87], v[72:75], v[52:55]
    ds_read_b64_tr_b16 v[78:79], v39 offset:41472
    ds_read_b64_tr_b16 v[80:81], v41 offset:40960
    ds_read_b64_tr_b16 v[82:83], v41 offset:41472
    v_mfma_f32_16x16x32_bf16 v[48:51], v[88:91], v[68:71], v[48:51]
    v_mfma_f32_16x16x32_bf16 v[56:59], v[88:91], v[72:75], v[56:59]
    s_waitcnt lgkmcnt(0)
    v_mfma_f32_16x16x32_bf16 v[44:47], v[76:79], v[60:63], v[44:47]
    ds_read_b128 v[68:71], v31 offset:32768
    ds_read_b128 v[72:75], v31 offset:34816
    ds_read_b64_tr_b16 v[84:85], v39 offset:45056
    v_mfma_f32_16x16x32_bf16 v[52:55], v[76:79], v[64:67], v[52:55]
    ds_read_b64_tr_b16 v[86:87], v39 offset:45568
    ds_read_b64_tr_b16 v[88:89], v41 offset:45056
    ds_read_b64_tr_b16 v[90:91], v41 offset:45568
    v_mfma_f32_16x16x32_bf16 v[48:51], v[80:83], v[60:63], v[48:51]
    v_mfma_f32_16x16x32_bf16 v[56:59], v[80:83], v[64:67], v[56:59]
    s_waitcnt lgkmcnt(0)
    s_waitcnt vmcnt(30)
    s_waitcnt vmcnt(28)
    s_barrier
    s_add_u32 m0, s32, 106496
    s_add_u32 s37, s35, 1261568
    s_add_u32 s37, s37, s42
    buffer_load_dwordx4 v11, s[12:15], s37 offen lds
    s_add_u32 m0, s32, 110592
    s_add_u32 s37, s35, 1290240
    s_add_u32 s37, s37, s42
    buffer_load_dwordx4 v11, s[12:15], s37 offen lds
    s_add_u32 m0, s32, 32768
    s_nop 0
    s_mov_b32 s37, 2816
    buffer_load_dwordx4 v9, s[8:11], s37 offen lds
    s_add_u32 m0, s32, 36864
    s_nop 0
    s_mov_b32 s37, 2816
    buffer_load_dwordx4 v10, s[8:11], s37 offen lds
    v_mfma_f32_16x16x32_bf16 v[44:47], v[84:87], v[68:71], v[44:47]
    ds_read_b128 v[60:63], v30 offset:40960
    ds_read_b128 v[64:67], v30 offset:43008
    ds_read_b64_tr_b16 v[76:77], v39 offset:49152
    v_mfma_f32_16x16x32_bf16 v[52:55], v[84:87], v[72:75], v[52:55]
    ds_read_b64_tr_b16 v[78:79], v39 offset:49664
    ds_read_b64_tr_b16 v[80:81], v41 offset:49152
    ds_read_b64_tr_b16 v[82:83], v41 offset:49664
    v_mfma_f32_16x16x32_bf16 v[48:51], v[88:91], v[68:71], v[48:51]
    v_mfma_f32_16x16x32_bf16 v[56:59], v[88:91], v[72:75], v[56:59]
    s_waitcnt lgkmcnt(0)
    v_mfma_f32_16x16x32_bf16 v[44:47], v[76:79], v[60:63], v[44:47]
    ds_read_b128 v[68:71], v31 offset:40960
    ds_read_b128 v[72:75], v31 offset:43008
    ds_read_b64_tr_b16 v[84:85], v39 offset:53248
    v_mfma_f32_16x16x32_bf16 v[52:55], v[76:79], v[64:67], v[52:55]
    ds_read_b64_tr_b16 v[86:87], v39 offset:53760
    ds_read_b64_tr_b16 v[88:89], v41 offset:53248
    ds_read_b64_tr_b16 v[90:91], v41 offset:53760
    v_mfma_f32_16x16x32_bf16 v[48:51], v[80:83], v[60:63], v[48:51]
    v_mfma_f32_16x16x32_bf16 v[56:59], v[80:83], v[64:67], v[56:59]
    s_waitcnt lgkmcnt(0)
    s_waitcnt vmcnt(30)
    s_waitcnt vmcnt(28)
    s_barrier
    s_add_u32 m0, s32, 114688
    s_add_u32 s37, s35, 1318912
    s_add_u32 s37, s37, s42
    buffer_load_dwordx4 v11, s[12:15], s37 offen lds
    s_add_u32 m0, s32, 118784
    s_add_u32 s37, s35, 1347584
    s_add_u32 s37, s37, s42
    buffer_load_dwordx4 v11, s[12:15], s37 offen lds
    s_add_u32 m0, s32, 40960
    s_nop 0
    s_mov_b32 s37, 2944
    buffer_load_dwordx4 v9, s[8:11], s37 offen lds
    s_add_u32 m0, s32, 45056
    s_nop 0
    s_mov_b32 s37, 2944
    buffer_load_dwordx4 v10, s[8:11], s37 offen lds
    v_mfma_f32_16x16x32_bf16 v[44:47], v[84:87], v[68:71], v[44:47]
    ds_read_b128 v[60:63], v30 offset:49152
    ds_read_b128 v[64:67], v30 offset:51200
    ds_read_b64_tr_b16 v[76:77], v39 offset:57344
    v_mfma_f32_16x16x32_bf16 v[52:55], v[84:87], v[72:75], v[52:55]
    ds_read_b64_tr_b16 v[78:79], v39 offset:57856
    ds_read_b64_tr_b16 v[80:81], v41 offset:57344
    ds_read_b64_tr_b16 v[82:83], v41 offset:57856
    v_mfma_f32_16x16x32_bf16 v[48:51], v[88:91], v[68:71], v[48:51]
    v_mfma_f32_16x16x32_bf16 v[56:59], v[88:91], v[72:75], v[56:59]
    s_waitcnt lgkmcnt(0)
    v_mfma_f32_16x16x32_bf16 v[44:47], v[76:79], v[60:63], v[44:47]
    ds_read_b128 v[68:71], v31 offset:49152
    ds_read_b128 v[72:75], v31 offset:51200
    ds_read_b64_tr_b16 v[84:85], v39 offset:61440
    v_mfma_f32_16x16x32_bf16 v[52:55], v[76:79], v[64:67], v[52:55]
    ds_read_b64_tr_b16 v[86:87], v39 offset:61952
    ds_read_b64_tr_b16 v[88:89], v41 offset:61440
    ds_read_b64_tr_b16 v[90:91], v41 offset:61952
    v_mfma_f32_16x16x32_bf16 v[48:51], v[80:83], v[60:63], v[48:51]
    v_mfma_f32_16x16x32_bf16 v[56:59], v[80:83], v[64:67], v[56:59]
    s_waitcnt lgkmcnt(0)
    s_waitcnt vmcnt(30)
    s_waitcnt vmcnt(28)
    s_barrier
    s_add_u32 m0, s32, 122880
    s_add_u32 s37, s35, 1376256
    s_add_u32 s37, s37, s42
    buffer_load_dwordx4 v11, s[12:15], s37 offen lds
    s_add_u32 m0, s32, 126976
    s_add_u32 s37, s35, 1404928
    s_add_u32 s37, s37, s42
    buffer_load_dwordx4 v11, s[12:15], s37 offen lds
    s_add_u32 m0, s32, 49152
    s_nop 0
    s_mov_b32 s37, 3072
    buffer_load_dwordx4 v9, s[8:11], s37 offen lds
    s_add_u32 m0, s32, 53248
    s_nop 0
    s_mov_b32 s37, 3072
    buffer_load_dwordx4 v10, s[8:11], s37 offen lds
    v_mfma_f32_16x16x32_bf16 v[44:47], v[84:87], v[68:71], v[44:47]
    ds_read_b128 v[60:63], v30 offset:57344
    ds_read_b128 v[64:67], v30 offset:59392
    ds_read_b64_tr_b16 v[76:77], v40 offset:0
    v_mfma_f32_16x16x32_bf16 v[52:55], v[84:87], v[72:75], v[52:55]
    ds_read_b64_tr_b16 v[78:79], v40 offset:512
    ds_read_b64_tr_b16 v[80:81], v42 offset:0
    ds_read_b64_tr_b16 v[82:83], v42 offset:512
    v_mfma_f32_16x16x32_bf16 v[48:51], v[88:91], v[68:71], v[48:51]
    v_mfma_f32_16x16x32_bf16 v[56:59], v[88:91], v[72:75], v[56:59]
    s_waitcnt lgkmcnt(0)
    v_mfma_f32_16x16x32_bf16 v[44:47], v[76:79], v[60:63], v[44:47]
    ds_read_b128 v[68:71], v31 offset:57344
    ds_read_b128 v[72:75], v31 offset:59392
    ds_read_b64_tr_b16 v[84:85], v40 offset:4096
    v_mfma_f32_16x16x32_bf16 v[52:55], v[76:79], v[64:67], v[52:55]
    ds_read_b64_tr_b16 v[86:87], v40 offset:4608
    ds_read_b64_tr_b16 v[88:89], v42 offset:4096
    ds_read_b64_tr_b16 v[90:91], v42 offset:4608
    v_mfma_f32_16x16x32_bf16 v[48:51], v[80:83], v[60:63], v[48:51]
    v_mfma_f32_16x16x32_bf16 v[56:59], v[80:83], v[64:67], v[56:59]
    s_waitcnt lgkmcnt(0)
    s_waitcnt vmcnt(30)
    s_waitcnt vmcnt(28)
    s_barrier
    s_add_u32 m0, s32, 131072
    s_add_u32 s37, s35, 1433600
    s_add_u32 s37, s37, s42
    buffer_load_dwordx4 v11, s[12:15], s37 offen lds
    s_add_u32 m0, s32, 135168
    s_add_u32 s37, s35, 1462272
    s_add_u32 s37, s37, s42
    buffer_load_dwordx4 v11, s[12:15], s37 offen lds
    s_add_u32 m0, s32, 57344
    s_nop 0
    s_mov_b32 s37, 3200
    buffer_load_dwordx4 v9, s[8:11], s37 offen lds
    s_add_u32 m0, s32, 61440
    s_nop 0
    s_mov_b32 s37, 3200
    buffer_load_dwordx4 v10, s[8:11], s37 offen lds
    v_mfma_f32_16x16x32_bf16 v[44:47], v[84:87], v[68:71], v[44:47]
    ds_read_b128 v[60:63], v37 offset:0
    ds_read_b128 v[64:67], v37 offset:2048
    ds_read_b64_tr_b16 v[76:77], v40 offset:8192
    v_mfma_f32_16x16x32_bf16 v[52:55], v[84:87], v[72:75], v[52:55]
    ds_read_b64_tr_b16 v[78:79], v40 offset:8704
    ds_read_b64_tr_b16 v[80:81], v42 offset:8192
    ds_read_b64_tr_b16 v[82:83], v42 offset:8704
    v_mfma_f32_16x16x32_bf16 v[48:51], v[88:91], v[68:71], v[48:51]
    v_mfma_f32_16x16x32_bf16 v[56:59], v[88:91], v[72:75], v[56:59]
    s_waitcnt lgkmcnt(0)
    v_mfma_f32_16x16x32_bf16 v[44:47], v[76:79], v[60:63], v[44:47]
    ds_read_b128 v[68:71], v38 offset:0
    ds_read_b128 v[72:75], v38 offset:2048
    ds_read_b64_tr_b16 v[84:85], v40 offset:12288
    v_mfma_f32_16x16x32_bf16 v[52:55], v[76:79], v[64:67], v[52:55]
    ds_read_b64_tr_b16 v[86:87], v40 offset:12800
    ds_read_b64_tr_b16 v[88:89], v42 offset:12288
    ds_read_b64_tr_b16 v[90:91], v42 offset:12800
    v_mfma_f32_16x16x32_bf16 v[48:51], v[80:83], v[60:63], v[48:51]
    v_mfma_f32_16x16x32_bf16 v[56:59], v[80:83], v[64:67], v[56:59]
    s_waitcnt lgkmcnt(0)
    s_waitcnt vmcnt(30)
    s_waitcnt vmcnt(28)
    s_barrier
    s_add_u32 m0, s32, 139264
    s_add_u32 s37, s35, 1490944
    s_add_u32 s37, s37, s42
    buffer_load_dwordx4 v11, s[12:15], s37 offen lds
    s_add_u32 m0, s32, 143360
    s_add_u32 s37, s35, 1519616
    s_add_u32 s37, s37, s42
    buffer_load_dwordx4 v11, s[12:15], s37 offen lds
    s_add_u32 m0, s32, 65536
    s_nop 0
    s_mov_b32 s37, 3328
    buffer_load_dwordx4 v9, s[8:11], s37 offen lds
    s_add_u32 m0, s32, 69632
    s_nop 0
    s_mov_b32 s37, 3328
    buffer_load_dwordx4 v10, s[8:11], s37 offen lds
    v_mfma_f32_16x16x32_bf16 v[44:47], v[84:87], v[68:71], v[44:47]
    ds_read_b128 v[60:63], v30 offset:0
    ds_read_b128 v[64:67], v30 offset:2048
    ds_read_b64_tr_b16 v[76:77], v39 offset:8192
    v_mfma_f32_16x16x32_bf16 v[52:55], v[84:87], v[72:75], v[52:55]
    ds_read_b64_tr_b16 v[78:79], v39 offset:8704
    ds_read_b64_tr_b16 v[80:81], v41 offset:8192
    ds_read_b64_tr_b16 v[82:83], v41 offset:8704
    v_mfma_f32_16x16x32_bf16 v[48:51], v[88:91], v[68:71], v[48:51]
    v_mfma_f32_16x16x32_bf16 v[56:59], v[88:91], v[72:75], v[56:59]
    s_waitcnt lgkmcnt(0)
    v_mfma_f32_16x16x32_bf16 v[44:47], v[76:79], v[60:63], v[44:47]
    ds_read_b128 v[68:71], v31 offset:0
    ds_read_b128 v[72:75], v31 offset:2048
    ds_read_b64_tr_b16 v[84:85], v39 offset:12288
    v_mfma_f32_16x16x32_bf16 v[52:55], v[76:79], v[64:67], v[52:55]
    ds_read_b64_tr_b16 v[86:87], v39 offset:12800
    ds_read_b64_tr_b16 v[88:89], v41 offset:12288
    ds_read_b64_tr_b16 v[90:91], v41 offset:12800
    v_mfma_f32_16x16x32_bf16 v[48:51], v[80:83], v[60:63], v[48:51]
    v_mfma_f32_16x16x32_bf16 v[56:59], v[80:83], v[64:67], v[56:59]
    s_waitcnt lgkmcnt(0)
    s_waitcnt vmcnt(30)
    s_waitcnt vmcnt(28)
    s_barrier
    s_add_u32 m0, s32, 73728
    s_add_u32 s37, s35, 1548288
    s_add_u32 s37, s37, s42
    buffer_load_dwordx4 v11, s[12:15], s37 offen lds
    s_add_u32 m0, s32, 77824
    s_add_u32 s37, s35, 1576960
    s_add_u32 s37, s37, s42
    buffer_load_dwordx4 v11, s[12:15], s37 offen lds
    s_add_u32 m0, s32, 0
    s_nop 0
    s_mov_b32 s37, 3456
    buffer_load_dwordx4 v9, s[8:11], s37 offen lds
    s_add_u32 m0, s32, 4096
    s_nop 0
    s_mov_b32 s37, 3456
    buffer_load_dwordx4 v10, s[8:11], s37 offen lds
    v_mfma_f32_16x16x32_bf16 v[44:47], v[84:87], v[68:71], v[44:47]
    ds_read_b128 v[60:63], v30 offset:8192
    ds_read_b128 v[64:67], v30 offset:10240
    ds_read_b64_tr_b16 v[76:77], v39 offset:16384
    v_mfma_f32_16x16x32_bf16 v[52:55], v[84:87], v[72:75], v[52:55]
    ds_read_b64_tr_b16 v[78:79], v39 offset:16896
    ds_read_b64_tr_b16 v[80:81], v41 offset:16384
    ds_read_b64_tr_b16 v[82:83], v41 offset:16896
    v_mfma_f32_16x16x32_bf16 v[48:51], v[88:91], v[68:71], v[48:51]
    v_mfma_f32_16x16x32_bf16 v[56:59], v[88:91], v[72:75], v[56:59]
    s_waitcnt lgkmcnt(0)
    v_mfma_f32_16x16x32_bf16 v[44:47], v[76:79], v[60:63], v[44:47]
    ds_read_b128 v[68:71], v31 offset:8192
    ds_read_b128 v[72:75], v31 offset:10240
    ds_read_b64_tr_b16 v[84:85], v39 offset:20480
    v_mfma_f32_16x16x32_bf16 v[52:55], v[76:79], v[64:67], v[52:55]
    ds_read_b64_tr_b16 v[86:87], v39 offset:20992
    ds_read_b64_tr_b16 v[88:89], v41 offset:20480
    ds_read_b64_tr_b16 v[90:91], v41 offset:20992
    v_mfma_f32_16x16x32_bf16 v[48:51], v[80:83], v[60:63], v[48:51]
    v_mfma_f32_16x16x32_bf16 v[56:59], v[80:83], v[64:67], v[56:59]
    s_waitcnt lgkmcnt(0)
    s_waitcnt vmcnt(30)
    s_waitcnt vmcnt(28)
    s_barrier
    v_mfma_f32_16x16x32_bf16 v[44:47], v[84:87], v[68:71], v[44:47]
    ds_read_b128 v[60:63], v30 offset:16384
    ds_read_b128 v[64:67], v30 offset:18432
    ds_read_b64_tr_b16 v[76:77], v39 offset:24576
    v_mfma_f32_16x16x32_bf16 v[52:55], v[84:87], v[72:75], v[52:55]
    ds_read_b64_tr_b16 v[78:79], v39 offset:25088
    ds_read_b64_tr_b16 v[80:81], v41 offset:24576
    ds_read_b64_tr_b16 v[82:83], v41 offset:25088
    v_mfma_f32_16x16x32_bf16 v[48:51], v[88:91], v[68:71], v[48:51]
    v_mfma_f32_16x16x32_bf16 v[56:59], v[88:91], v[72:75], v[56:59]
    s_waitcnt lgkmcnt(0)
    v_mfma_f32_16x16x32_bf16 v[44:47], v[76:79], v[60:63], v[44:47]
    ds_read_b128 v[68:71], v31 offset:16384
    ds_read_b128 v[72:75], v31 offset:18432
    ds_read_b64_tr_b16 v[84:85], v39 offset:28672
    v_mfma_f32_16x16x32_bf16 v[52:55], v[76:79], v[64:67], v[52:55]
    ds_read_b64_tr_b16 v[86:87], v39 offset:29184
    ds_read_b64_tr_b16 v[88:89], v41 offset:28672
    ds_read_b64_tr_b16 v[90:91], v41 offset:29184
    v_mfma_f32_16x16x32_bf16 v[48:51], v[80:83], v[60:63], v[48:51]
    v_mfma_f32_16x16x32_bf16 v[56:59], v[80:83], v[64:67], v[56:59]
    s_waitcnt lgkmcnt(0)
    s_waitcnt vmcnt(26)
    s_waitcnt vmcnt(24)
    s_barrier
    v_mfma_f32_16x16x32_bf16 v[44:47], v[84:87], v[68:71], v[44:47]
    ds_read_b128 v[60:63], v30 offset:24576
    ds_read_b128 v[64:67], v30 offset:26624
    ds_read_b64_tr_b16 v[76:77], v39 offset:32768
    v_mfma_f32_16x16x32_bf16 v[52:55], v[84:87], v[72:75], v[52:55]
    ds_read_b64_tr_b16 v[78:79], v39 offset:33280
    ds_read_b64_tr_b16 v[80:81], v41 offset:32768
    ds_read_b64_tr_b16 v[82:83], v41 offset:33280
    v_mfma_f32_16x16x32_bf16 v[48:51], v[88:91], v[68:71], v[48:51]
    v_mfma_f32_16x16x32_bf16 v[56:59], v[88:91], v[72:75], v[56:59]
    s_waitcnt lgkmcnt(0)
    v_mfma_f32_16x16x32_bf16 v[44:47], v[76:79], v[60:63], v[44:47]
    ds_read_b128 v[68:71], v31 offset:24576
    ds_read_b128 v[72:75], v31 offset:26624
    ds_read_b64_tr_b16 v[84:85], v39 offset:36864
    v_mfma_f32_16x16x32_bf16 v[52:55], v[76:79], v[64:67], v[52:55]
    ds_read_b64_tr_b16 v[86:87], v39 offset:37376
    ds_read_b64_tr_b16 v[88:89], v41 offset:36864
    ds_read_b64_tr_b16 v[90:91], v41 offset:37376
    v_mfma_f32_16x16x32_bf16 v[48:51], v[80:83], v[60:63], v[48:51]
    v_mfma_f32_16x16x32_bf16 v[56:59], v[80:83], v[64:67], v[56:59]
    s_waitcnt lgkmcnt(0)
    s_waitcnt vmcnt(22)
    s_waitcnt vmcnt(20)
    s_barrier
    v_mfma_f32_16x16x32_bf16 v[44:47], v[84:87], v[68:71], v[44:47]
    ds_read_b128 v[60:63], v30 offset:32768
    ds_read_b128 v[64:67], v30 offset:34816
    ds_read_b64_tr_b16 v[76:77], v39 offset:40960
    v_mfma_f32_16x16x32_bf16 v[52:55], v[84:87], v[72:75], v[52:55]
    ds_read_b64_tr_b16 v[78:79], v39 offset:41472
    ds_read_b64_tr_b16 v[80:81], v41 offset:40960
    ds_read_b64_tr_b16 v[82:83], v41 offset:41472
    v_mfma_f32_16x16x32_bf16 v[48:51], v[88:91], v[68:71], v[48:51]
    v_mfma_f32_16x16x32_bf16 v[56:59], v[88:91], v[72:75], v[56:59]
    s_waitcnt lgkmcnt(0)
    v_mfma_f32_16x16x32_bf16 v[44:47], v[76:79], v[60:63], v[44:47]
    ds_read_b128 v[68:71], v31 offset:32768
    ds_read_b128 v[72:75], v31 offset:34816
    ds_read_b64_tr_b16 v[84:85], v39 offset:45056
    v_mfma_f32_16x16x32_bf16 v[52:55], v[76:79], v[64:67], v[52:55]
    ds_read_b64_tr_b16 v[86:87], v39 offset:45568
    ds_read_b64_tr_b16 v[88:89], v41 offset:45056
    ds_read_b64_tr_b16 v[90:91], v41 offset:45568
    v_mfma_f32_16x16x32_bf16 v[48:51], v[80:83], v[60:63], v[48:51]
    v_mfma_f32_16x16x32_bf16 v[56:59], v[80:83], v[64:67], v[56:59]
    s_waitcnt lgkmcnt(0)
    s_waitcnt vmcnt(18)
    s_waitcnt vmcnt(16)
    s_barrier
    v_mfma_f32_16x16x32_bf16 v[44:47], v[84:87], v[68:71], v[44:47]
    ds_read_b128 v[60:63], v30 offset:40960
    ds_read_b128 v[64:67], v30 offset:43008
    ds_read_b64_tr_b16 v[76:77], v39 offset:49152
    v_mfma_f32_16x16x32_bf16 v[52:55], v[84:87], v[72:75], v[52:55]
    ds_read_b64_tr_b16 v[78:79], v39 offset:49664
    ds_read_b64_tr_b16 v[80:81], v41 offset:49152
    ds_read_b64_tr_b16 v[82:83], v41 offset:49664
    v_mfma_f32_16x16x32_bf16 v[48:51], v[88:91], v[68:71], v[48:51]
    v_mfma_f32_16x16x32_bf16 v[56:59], v[88:91], v[72:75], v[56:59]
    s_waitcnt lgkmcnt(0)
    v_mfma_f32_16x16x32_bf16 v[44:47], v[76:79], v[60:63], v[44:47]
    ds_read_b128 v[68:71], v31 offset:40960
    ds_read_b128 v[72:75], v31 offset:43008
    ds_read_b64_tr_b16 v[84:85], v39 offset:53248
    v_mfma_f32_16x16x32_bf16 v[52:55], v[76:79], v[64:67], v[52:55]
    ds_read_b64_tr_b16 v[86:87], v39 offset:53760
    ds_read_b64_tr_b16 v[88:89], v41 offset:53248
    ds_read_b64_tr_b16 v[90:91], v41 offset:53760
    v_mfma_f32_16x16x32_bf16 v[48:51], v[80:83], v[60:63], v[48:51]
    v_mfma_f32_16x16x32_bf16 v[56:59], v[80:83], v[64:67], v[56:59]
    s_waitcnt lgkmcnt(0)
    s_waitcnt vmcnt(14)
    s_waitcnt vmcnt(12)
    s_barrier
    v_mfma_f32_16x16x32_bf16 v[44:47], v[84:87], v[68:71], v[44:47]
    ds_read_b128 v[60:63], v30 offset:49152
    ds_read_b128 v[64:67], v30 offset:51200
    ds_read_b64_tr_b16 v[76:77], v39 offset:57344
    v_mfma_f32_16x16x32_bf16 v[52:55], v[84:87], v[72:75], v[52:55]
    ds_read_b64_tr_b16 v[78:79], v39 offset:57856
    ds_read_b64_tr_b16 v[80:81], v41 offset:57344
    ds_read_b64_tr_b16 v[82:83], v41 offset:57856
    v_mfma_f32_16x16x32_bf16 v[48:51], v[88:91], v[68:71], v[48:51]
    v_mfma_f32_16x16x32_bf16 v[56:59], v[88:91], v[72:75], v[56:59]
    s_waitcnt lgkmcnt(0)
    v_mfma_f32_16x16x32_bf16 v[44:47], v[76:79], v[60:63], v[44:47]
    ds_read_b128 v[68:71], v31 offset:49152
    ds_read_b128 v[72:75], v31 offset:51200
    ds_read_b64_tr_b16 v[84:85], v39 offset:61440
    v_mfma_f32_16x16x32_bf16 v[52:55], v[76:79], v[64:67], v[52:55]
    ds_read_b64_tr_b16 v[86:87], v39 offset:61952
    ds_read_b64_tr_b16 v[88:89], v41 offset:61440
    ds_read_b64_tr_b16 v[90:91], v41 offset:61952
    v_mfma_f32_16x16x32_bf16 v[48:51], v[80:83], v[60:63], v[48:51]
    v_mfma_f32_16x16x32_bf16 v[56:59], v[80:83], v[64:67], v[56:59]
    s_waitcnt lgkmcnt(0)
    s_waitcnt vmcnt(10)
    s_waitcnt vmcnt(8)
    s_barrier
    v_mfma_f32_16x16x32_bf16 v[44:47], v[84:87], v[68:71], v[44:47]
    ds_read_b128 v[60:63], v30 offset:57344
    ds_read_b128 v[64:67], v30 offset:59392
    ds_read_b64_tr_b16 v[76:77], v40 offset:0
    v_mfma_f32_16x16x32_bf16 v[52:55], v[84:87], v[72:75], v[52:55]
    ds_read_b64_tr_b16 v[78:79], v40 offset:512
    ds_read_b64_tr_b16 v[80:81], v42 offset:0
    ds_read_b64_tr_b16 v[82:83], v42 offset:512
    v_mfma_f32_16x16x32_bf16 v[48:51], v[88:91], v[68:71], v[48:51]
    v_mfma_f32_16x16x32_bf16 v[56:59], v[88:91], v[72:75], v[56:59]
    s_waitcnt lgkmcnt(0)
    v_mfma_f32_16x16x32_bf16 v[44:47], v[76:79], v[60:63], v[44:47]
    ds_read_b128 v[68:71], v31 offset:57344
    ds_read_b128 v[72:75], v31 offset:59392
    ds_read_b64_tr_b16 v[84:85], v40 offset:4096
    v_mfma_f32_16x16x32_bf16 v[52:55], v[76:79], v[64:67], v[52:55]
    ds_read_b64_tr_b16 v[86:87], v40 offset:4608
    ds_read_b64_tr_b16 v[88:89], v42 offset:4096
    ds_read_b64_tr_b16 v[90:91], v42 offset:4608
    v_mfma_f32_16x16x32_bf16 v[48:51], v[80:83], v[60:63], v[48:51]
    v_mfma_f32_16x16x32_bf16 v[56:59], v[80:83], v[64:67], v[56:59]
    s_waitcnt lgkmcnt(0)
    s_waitcnt vmcnt(6)
    s_waitcnt vmcnt(4)
    s_barrier
    v_mfma_f32_16x16x32_bf16 v[44:47], v[84:87], v[68:71], v[44:47]
    ds_read_b128 v[60:63], v37 offset:0
    ds_read_b128 v[64:67], v37 offset:2048
    ds_read_b64_tr_b16 v[76:77], v40 offset:8192
    v_mfma_f32_16x16x32_bf16 v[52:55], v[84:87], v[72:75], v[52:55]
    ds_read_b64_tr_b16 v[78:79], v40 offset:8704
    ds_read_b64_tr_b16 v[80:81], v42 offset:8192
    ds_read_b64_tr_b16 v[82:83], v42 offset:8704
    v_mfma_f32_16x16x32_bf16 v[48:51], v[88:91], v[68:71], v[48:51]
    v_mfma_f32_16x16x32_bf16 v[56:59], v[88:91], v[72:75], v[56:59]
    s_waitcnt lgkmcnt(0)
    v_mfma_f32_16x16x32_bf16 v[44:47], v[76:79], v[60:63], v[44:47]
    ds_read_b128 v[68:71], v38 offset:0
    ds_read_b128 v[72:75], v38 offset:2048
    ds_read_b64_tr_b16 v[84:85], v40 offset:12288
    v_mfma_f32_16x16x32_bf16 v[52:55], v[76:79], v[64:67], v[52:55]
    ds_read_b64_tr_b16 v[86:87], v40 offset:12800
    ds_read_b64_tr_b16 v[88:89], v42 offset:12288
    ds_read_b64_tr_b16 v[90:91], v42 offset:12800
    v_mfma_f32_16x16x32_bf16 v[48:51], v[80:83], v[60:63], v[48:51]
    v_mfma_f32_16x16x32_bf16 v[56:59], v[80:83], v[64:67], v[56:59]
    s_waitcnt lgkmcnt(0)
    s_waitcnt vmcnt(2)
    s_waitcnt vmcnt(0)
    s_barrier
    v_mfma_f32_16x16x32_bf16 v[44:47], v[84:87], v[68:71], v[44:47]
    ds_read_b128 v[60:63], v30 offset:0
    ds_read_b128 v[64:67], v30 offset:2048
    ds_read_b64_tr_b16 v[76:77], v39 offset:8192
    v_mfma_f32_16x16x32_bf16 v[52:55], v[84:87], v[72:75], v[52:55]
    ds_read_b64_tr_b16 v[78:79], v39 offset:8704
    ds_read_b64_tr_b16 v[80:81], v41 offset:8192
    ds_read_b64_tr_b16 v[82:83], v41 offset:8704
    v_mfma_f32_16x16x32_bf16 v[48:51], v[88:91], v[68:71], v[48:51]
    v_mfma_f32_16x16x32_bf16 v[56:59], v[88:91], v[72:75], v[56:59]
    s_waitcnt lgkmcnt(0)
    v_mfma_f32_16x16x32_bf16 v[44:47], v[76:79], v[60:63], v[44:47]
    ds_read_b128 v[68:71], v31 offset:0
    ds_read_b128 v[72:75], v31 offset:2048
    ds_read_b64_tr_b16 v[84:85], v39 offset:12288
    v_mfma_f32_16x16x32_bf16 v[52:55], v[76:79], v[64:67], v[52:55]
    ds_read_b64_tr_b16 v[86:87], v39 offset:12800
    ds_read_b64_tr_b16 v[88:89], v41 offset:12288
    ds_read_b64_tr_b16 v[90:91], v41 offset:12800
    v_mfma_f32_16x16x32_bf16 v[48:51], v[80:83], v[60:63], v[48:51]
    v_mfma_f32_16x16x32_bf16 v[56:59], v[80:83], v[64:67], v[56:59]
    s_waitcnt lgkmcnt(0)
    v_mfma_f32_16x16x32_bf16 v[44:47], v[84:87], v[68:71], v[44:47]
    v_mfma_f32_16x16x32_bf16 v[52:55], v[84:87], v[72:75], v[52:55]
    v_mfma_f32_16x16x32_bf16 v[48:51], v[88:91], v[68:71], v[48:51]
    v_mfma_f32_16x16x32_bf16 v[56:59], v[88:91], v[72:75], v[56:59]
    s_nop 7
    s_nop 7
    s_barrier
    s_mov_b32 s54, 1027024659
    s_mov_b32 s55, 3222493025
    s_add_u32 s16, s84, 9437184
    s_addc_u32 s17, s85, 0
    s_mov_b32 s18, 1835008
    s_mov_b32 s19, 0x00020000
    s_lshl_b32 s37, s87, 6
    s_lshr_b32 s38, s86, 1
    s_mul_i32 s38, s38, 32
    s_add_u32 s37, s37, s38
    v_add_u32 v60, s37, v2
    s_mov_b32 s38, 896
    v_mul_lo_u32 v68, v60, s38
    v_and_b32 v60, 1, v3
    v_lshl_add_u32 v68, v60, 5, v68
    v_lshrrev_b32 v60, 1, v3
    v_lshl_add_u32 v68, v60, 4, v68
    v_lshlrev_b32 v60, 16, v22
    v_add_f32 v44, v44, v60
    v_lshlrev_b32 v60, 16, v14
    v_add_f32 v44, v44, v60
    v_and_b32 v60, 0xffff0000, v22
    v_add_f32 v45, v45, v60
    v_and_b32 v60, 0xffff0000, v14
    v_add_f32 v45, v45, v60
    v_lshlrev_b32 v60, 16, v23
    v_add_f32 v46, v46, v60
    v_lshlrev_b32 v60, 16, v15
    v_add_f32 v46, v46, v60
    v_and_b32 v60, 0xffff0000, v23
    v_add_f32 v47, v47, v60
    v_and_b32 v60, 0xffff0000, v15
    v_add_f32 v47, v47, v60
    v_lshlrev_b32 v60, 16, v24
    v_add_f32 v48, v48, v60
    v_lshlrev_b32 v60, 16, v16
    v_add_f32 v48, v48, v60
    v_and_b32 v60, 0xffff0000, v24
    v_add_f32 v49, v49, v60
    v_and_b32 v60, 0xffff0000, v16
    v_add_f32 v49, v49, v60
    v_lshlrev_b32 v60, 16, v25
    v_add_f32 v50, v50, v60
    v_lshlrev_b32 v60, 16, v17
    v_add_f32 v50, v50, v60
    v_and_b32 v60, 0xffff0000, v25
    v_add_f32 v51, v51, v60
    v_and_b32 v60, 0xffff0000, v17
    v_add_f32 v51, v51, v60
    v_cvt_pk_bf16_f32 v72, v44, v45
    v_cvt_pk_bf16_f32 v73, v46, v47
    v_cvt_pk_bf16_f32 v74, v48, v49
    v_cvt_pk_bf16_f32 v75, v50, v51
    s_nop 1
    v_permlane16_swap_b32 v72, v74
    v_permlane16_swap_b32 v73, v75
    s_and_b32 s37, s86, 1
    s_lshl_b32 s37, s37, 6
    s_mul_i32 s38, s88, 112
    s_add_u32 s37, s37, s38
    s_add_u32 s37, s37, 0
    s_and_b32 s38, s86, 1
    s_cmp_eq_u32 s38, 1
    s_cselect_b32 exec_hi, 0xffff, -1
    s_lshr_b32 s57, s86, 1
    s_cmp_eq_u32 s91, 1
    s_cbranch_scc1 Ls33_p
    buffer_store_dwordx4 v[72:75], v68, s[16:19], s37 offen sc1
    s_branch Ls33_d
Ls33_p:
    buffer_store_dwordx4 v[72:75], v68, s[16:19], s37 offen
Ls33_d:
    s_mov_b64 exec, -1
    s_nop 1
    v_lshlrev_b32 v60, 16, v26
    v_add_f32 v52, v52, v60
    v_lshlrev_b32 v60, 16, v18
    v_add_f32 v52, v52, v60
    v_and_b32 v60, 0xffff0000, v26
    v_add_f32 v53, v53, v60
    v_and_b32 v60, 0xffff0000, v18
    v_add_f32 v53, v53, v60
    v_lshlrev_b32 v60, 16, v27
    v_add_f32 v54, v54, v60
    v_lshlrev_b32 v60, 16, v19
    v_add_f32 v54, v54, v60
    v_and_b32 v60, 0xffff0000, v27
    v_add_f32 v55, v55, v60
    v_and_b32 v60, 0xffff0000, v19
    v_add_f32 v55, v55, v60
    v_lshlrev_b32 v60, 16, v28
    v_add_f32 v56, v56, v60
    v_lshlrev_b32 v60, 16, v20
    v_add_f32 v56, v56, v60
    v_and_b32 v60, 0xffff0000, v28
    v_add_f32 v57, v57, v60
    v_and_b32 v60, 0xffff0000, v20
    v_add_f32 v57, v57, v60
    v_lshlrev_b32 v60, 16, v29
    v_add_f32 v58, v58, v60
    v_lshlrev_b32 v60, 16, v21
    v_add_f32 v58, v58, v60
    v_and_b32 v60, 0xffff0000, v29
    v_add_f32 v59, v59, v60
    v_and_b32 v60, 0xffff0000, v21
    v_add_f32 v59, v59, v60
    v_cvt_pk_bf16_f32 v72, v52, v53
    v_cvt_pk_bf16_f32 v73, v54, v55
    v_cvt_pk_bf16_f32 v74, v56, v57
    v_cvt_pk_bf16_f32 v75, v58, v59
    s_nop 1
    v_permlane16_swap_b32 v72, v74
    v_permlane16_swap_b32 v73, v75
    s_and_b32 s37, s86, 1
    s_lshl_b32 s37, s37, 6
    s_mul_i32 s38, s88, 112
    s_add_u32 s37, s37, s38
    s_add_u32 s37, s37, 14336
    s_and_b32 s38, s86, 1
    s_cmp_eq_u32 s38, 1
    s_cselect_b32 exec_hi, 0xffff, -1
    s_lshr_b32 s57, s86, 1
    s_cmp_eq_u32 s57, 1
    s_cselect_b32 s57, s93, s91
    s_cmp_eq_u32 s57, 1
    s_cbranch_scc1 Ls34_p
    buffer_store_dwordx4 v[72:75], v68, s[16:19], s37 offen sc1
    s_branch Ls34_d
Ls34_p:
    buffer_store_dwordx4 v[72:75], v68, s[16:19], s37 offen
Ls34_d:
    s_mov_b64 exec, -1
    s_nop 1
    s_and_b32 s37, s86, 1
    s_cmp_eq_u32 s37, 1
    s_cselect_b32 s61, 0, -1
    s_mov_b32 s60, -1
    s_add_u32 s20, s84, 43778048
    s_addc_u32 s21, s85, 0
    s_mov_b32 s22, 262144
    s_mov_b32 s23, 0x00020000
    v_mov_b32 v72, 0
    s_lshl_b32 s37, s87, 6
    s_lshr_b32 s38, s86, 1
    s_mul_i32 s38, s38, 32
    s_add_u32 s37, s37, s38
    v_add_u32 v69, s37, v2
    v_lshlrev_b32 v69, 7, v69
    s_lshl_b32 s37, s88, 1
    s_and_b32 s38, s86, 1
    s_add_u32 s37, s37, s38
    s_lshl_b32 s37, s37, 3
    v_add_u32 v69, s37, v69
    v_mov_b32 v70, v44
    v_mul_f32 v71, v44, v44
    v_add_f32 v70, v70, v45
    v_fma_f32 v71, v45, v45, v71
    v_add_f32 v70, v70, v46
    v_fma_f32 v71, v46, v46, v71
    v_add_f32 v70, v70, v47
    v_fma_f32 v71, v47, v47, v71
    v_cndmask_b32 v60, v72, v48, s[60:61]
    v_add_f32 v70, v70, v60
    v_fma_f32 v71, v60, v60, v71
    v_cndmask_b32 v60, v72, v49, s[60:61]
    v_add_f32 v70, v70, v60
    v_fma_f32 v71, v60, v60, v71
    v_cndmask_b32 v60, v72, v50, s[60:61]
    v_add_f32 v70, v70, v60
    v_fma_f32 v71, v60, v60, v71
    v_cndmask_b32 v60, v72, v51, s[60:61]
    v_add_f32 v70, v70, v60
    v_fma_f32 v71, v60, v60, v71
    v_mov_b32 v60, v70
    s_nop 1
    v_permlane16_swap_b32 v70, v60
    v_add_f32 v70, v70, v60
    v_mov_b32 v60, v70
    s_nop 1
    v_permlane32_swap_b32 v70, v60
    v_add_f32 v70, v70, v60
    v_mov_b32 v60, v71
    s_nop 1
    v_permlane16_swap_b32 v71, v60
    v_add_f32 v71, v71, v60
    v_mov_b32 v60, v71
    s_nop 1
    v_permlane32_swap_b32 v71, v60
    v_add_f32 v71, v71, v60
    s_mov_b32 exec_lo, 0xffff
    s_mov_b32 exec_hi, 0
    s_lshr_b32 s57, s86, 1
    s_cmp_eq_u32 s91, 1
    s_cbranch_scc1 Ls35_p
    buffer_store_dwordx2 v[70:71], v69, s[20:23], 0 offen offset:0 sc1
    s_branch Ls35_d
Ls35_p:
    buffer_store_dwordx2 v[70:71], v69, s[20:23], 0 offen offset:0
Ls35_d:
    s_mov_b64 exec, -1
    s_nop 1
    v_mov_b32 v70, v52
    v_mul_f32 v71, v52, v52
    v_add_f32 v70, v70, v53
    v_fma_f32 v71, v53, v53, v71
    v_add_f32 v70, v70, v54
    v_fma_f32 v71, v54, v54, v71
    v_add_f32 v70, v70, v55
    v_fma_f32 v71, v55, v55, v71
    v_cndmask_b32 v60, v72, v56, s[60:61]
    v_add_f32 v70, v70, v60
    v_fma_f32 v71, v60, v60, v71
    v_cndmask_b32 v60, v72, v57, s[60:61]
    v_add_f32 v70, v70, v60
    v_fma_f32 v71, v60, v60, v71
    v_cndmask_b32 v60, v72, v58, s[60:61]
    v_add_f32 v70, v70, v60
    v_fma_f32 v71, v60, v60, v71
    v_cndmask_b32 v60, v72, v59, s[60:61]
    v_add_f32 v70, v70, v60
    v_fma_f32 v71, v60, v60, v71
    v_mov_b32 v60, v70
    s_nop 1
    v_permlane16_swap_b32 v70, v60
    v_add_f32 v70, v70, v60
    v_mov_b32 v60, v70
    s_nop 1
    v_permlane32_swap_b32 v70, v60
    v_add_f32 v70, v70, v60
    v_mov_b32 v60, v71
    s_nop 1
    v_permlane16_swap_b32 v71, v60
    v_add_f32 v71, v71, v60
    v_mov_b32 v60, v71
    s_nop 1
    v_permlane32_swap_b32 v71, v60
    v_add_f32 v71, v71, v60
    s_mov_b32 exec_lo, 0xffff
    s_mov_b32 exec_hi, 0
    s_lshr_b32 s57, s86, 1
    s_cmp_eq_u32 s57, 1
    s_cselect_b32 s57, s93, s91
    s_cmp_eq_u32 s57, 1
    s_cbranch_scc1 Ls36_p
    buffer_store_dwordx2 v[70:71], v69, s[20:23], 0 offen offset:2048 sc1
    s_branch Ls36_d
Ls36_p:
    buffer_store_dwordx2 v[70:71], v69, s[20:23], 0 offen offset:2048
Ls36_d:
    s_mov_b64 exec, -1
    s_nop 1
    s_mov_b32 s12, s66
    s_mov_b32 s13, s67
    s_mov_b32 s14, 1204224
    s_mov_b32 s15, 0x00020000
    s_lshl_b32 s32, s86, 10
    s_and_b32 s40, s86, 1
    s_mul_i32 s35, s86, 21504
    v_lshrrev_b32 v75, 3, v1
    v_bfe_u32 v73, v1, 4, 1
    v_lshlrev_b32 v73, 1, v73
    s_lshl_b32 s37, s40, 2
    v_add_u32 v73, s37, v73
    v_and_b32 v74, 7, v1
    v_xor_b32 v74, v74, v73
    s_mov_b32 s39, 2688
    v_mul_lo_u32 v73, v75, s39
    v_lshl_add_u32 v76, v74, 4, v73
    s_mul_i32 s42, s88, 112
    s_add_u32 s42, s42, 0
    s_mul_i32 s43, s88, 112
    s_add_u32 s43, s43, 896
    s_mul_i32 s44, s88, 112
    s_add_u32 s44, s44, 1792
    s_add_u32 m0, s32, 71680
    s_add_u32 s37, s35, 0
    s_add_u32 s37, s37, s42
    buffer_load_dwordx4 v76, s[12:15], s37 offen lds
    s_add_u32 m0, s32, 75776
    s_add_u32 s37, s35, 86016
    s_add_u32 s37, s37, s42
    buffer_load_dwordx4 v76, s[12:15], s37 offen lds
    s_add_u32 m0, s32, 79872
    s_add_u32 s37, s35, 0
    s_add_u32 s37, s37, s43
    buffer_load_dwordx4 v76, s[12:15], s37 offen lds
    s_add_u32 m0, s32, 83968
    s_add_u32 s37, s35, 86016
    s_add_u32 s37, s37, s43
    buffer_load_dwordx4 v76, s[12:15], s37 offen lds
    s_add_u32 m0, s32, 88064
    s_add_u32 s37, s35, 0
    s_add_u32 s37, s37, s44
    buffer_load_dwordx4 v76, s[12:15], s37 offen lds
    s_add_u32 m0, s32, 92160
    s_add_u32 s37, s35, 86016
    s_add_u32 s37, s37, s44
    buffer_load_dwordx4 v76, s[12:15], s37 offen lds
    s_add_u32 m0, s32, 96256
    s_add_u32 s37, s35, 172032
    s_add_u32 s37, s37, s42
    buffer_load_dwordx4 v76, s[12:15], s37 offen lds
    s_add_u32 m0, s32, 100352
    s_add_u32 s37, s35, 258048
    s_add_u32 s37, s37, s42
    buffer_load_dwordx4 v76, s[12:15], s37 offen lds
    s_add_u32 m0, s32, 104448
    s_add_u32 s37, s35, 172032
    s_add_u32 s37, s37, s43
    buffer_load_dwordx4 v76, s[12:15], s37 offen lds
    s_add_u32 m0, s32, 108544
    s_add_u32 s37, s35, 258048
    s_add_u32 s37, s37, s43
    buffer_load_dwordx4 v76, s[12:15], s37 offen lds
    s_add_u32 m0, s32, 112640
    s_add_u32 s37, s35, 172032
    s_add_u32 s37, s37, s44
    buffer_load_dwordx4 v76, s[12:15], s37 offen lds
    s_add_u32 m0, s32, 116736
    s_add_u32 s37, s35, 258048
    s_add_u32 s37, s37, s44
    buffer_load_dwordx4 v76, s[12:15], s37 offen lds
    s_add_u32 m0, s32, 120832
    s_add_u32 s37, s35, 344064
    s_add_u32 s37, s37, s42
    buffer_load_dwordx4 v76, s[12:15], s37 offen lds
    s_add_u32 m0, s32, 124928
    s_add_u32 s37, s35, 430080
    s_add_u32 s37, s37, s42
    buffer_load_dwordx4 v76, s[12:15], s37 offen lds
    s_add_u32 m0, s32, 129024
    s_add_u32 s37, s35, 344064
    s_add_u32 s37, s37, s43
    buffer_load_dwordx4 v76, s[12:15], s37 offen lds
    s_add_u32 m0, s32, 133120
    s_add_u32 s37, s35, 430080
    s_add_u32 s37, s37, s43
    buffer_load_dwordx4 v76, s[12:15], s37 offen lds
    s_add_u32 m0, s32, 137216
    s_add_u32 s37, s35, 344064
    s_add_u32 s37, s37, s44
    buffer_load_dwordx4 v76, s[12:15], s37 offen lds
    s_add_u32 m0, s32, 141312
    s_add_u32 s37, s35, 430080
    s_add_u32 s37, s37, s44
    buffer_load_dwordx4 v76, s[12:15], s37 offen lds
    s_waitcnt vmcnt(18)
    s_lshl_b32 s32, s89, 7
    s_lshl_b32 s33, s86, 2
    s_add_u32 s32, s32, s33
    v_mov_b32 v73, s32
    v_mov_b32 v74, 7
    s_mov_b64 exec, 1
    s_mov_b32 s57, s93
    s_cmp_eq_u32 s57, 1
    s_cbranch_scc1 Ls37_p
    buffer_store_dword v74, v73, s[24:27], 0 offen sc1
    s_branch Ls37_d
Ls37_p:
    buffer_store_dword v74, v73, s[24:27], 0 offen
Ls37_d:
    s_mov_b64 exec, -1
    s_barrier
    s_add_u32 s8, s84, 9437184
    s_addc_u32 s9, s85, 0
    s_mov_b32 s10, 1835008
    s_mov_b32 s11, 0x00020000
    s_mov_b32 s12, s66
    s_mov_b32 s13, s67
    s_mov_b32 s14, 1204224
    s_mov_b32 s15, 0x00020000
    s_lshl_b32 s32, s86, 10
    s_and_b32 s40, s86, 1
    s_add_u32 s33, s40, 8
    s_mul_i32 s34, s86, 7168
    s_mul_i32 s35, s86, 21504
    s_mul_i32 s36, s88, 112
    v_lshrrev_b32 v5, 3, v1
    v_lshrrev_b32 v7, 4, v1
    s_lshl_b32 s37, s40, 2
    v_add_u32 v7, s37, v7
    v_and_b32 v6, 7, v1
    v_xor_b32 v6, v6, v7
    s_lshl_b32 s37, s87, 6
    s_sub_u32 s37, s37, 16
    s_lshl_b32 s38, s86, 3
    s_add_u32 s38, s38, 0
    s_add_u32 s38, s38, s37
    v_add_u32 v7, s38, v5
    s_mov_b32 s39, 896
    v_mul_lo_u32 v7, v7, s39
    v_lshl_add_u32 v9, v6, 4, v7
    s_lshl_b32 s38, s86, 3
    s_add_u32 s38, s38, 32
    s_add_u32 s38, s38, s37
    v_add_u32 v7, s38, v5
    s_mov_b32 s39, 896
    v_mul_lo_u32 v7, v7, s39
    v_lshl_add_u32 v10, v6, 4, v7
    s_lshl_b32 s38, s33, 3
    s_add_u32 s38, s38, s37
    v_add_u32 v7, s38, v5
    s_mov_b32 s39, 896
    v_mul_lo_u32 v7, v7, s39
    v_lshl_add_u32 v11, v6, 4, v7
    v_bfe_u32 v7, v1, 4, 1
    v_lshlrev_b32 v7, 1, v7
    s_lshl_b32 s37, s40, 2
    v_add_u32 v7, s37, v7
    v_and_b32 v8, 7, v1
    v_xor_b32 v8, v8, v7
    s_mov_b32 s39, 2688
    v_mul_lo_u32 v7, v5, s39
    v_lshl_add_u32 v12, v8, 4, v7
    s_add_u32 s42, s36, 0
    s_add_u32 s43, s36, 896
    s_add_u32 s44, s36, 1792
    s_cmp_lg_u32 s86, 0
    s_cbranch_scc1 Lp38_skip
    v_lshrrev_b32 v14, 3, v1
    v_add_u32 v14, s87, v14
    v_add_u32 v14, -1, v14
    v_mov_b32 v15, s87
    v_cmp_gt_u32 vcc, 32, v14
    s_nop 1
    v_cndmask_b32 v14, v15, v14, vcc
    v_and_b32 v13, 7, v1
    v_lshlrev_b32 v13, 5, v13
    v_and_b32 v15, 3, v14
    v_lshl_add_u32 v13, v15, 3, v13
    v_lshrrev_b32 v15, 2, v14
    v_add_u32 v13, v13, v15
    v_lshlrev_b32 v13, 7, v13
    v_add_u32 v13, 0, v13
    v_mov_b32 v20, 0
    s_mov_b32 s52, 0
    s_mov_b32 s53, 7
    s_mov_b32 exec_lo, 65535
    s_mov_b32 exec_hi, 0
Lp38_loop:
    buffer_load_dwordx4 v[16:19], v13, s[24:27], 0 offen sc1
    s_waitcnt vmcnt(0)
    v_min_u32 v16, v16, v17
    v_min_u32 v18, v18, v19
    v_min_u32 v16, v16, v18
    v_cmp_gt_u32 vcc, s53, v16
    s_cbranch_vccz Lp38_ok
Lp38_again:
    s_add_u32 s52, s52, 1
    s_cmp_lt_u32 s52, 20000
    s_cbranch_scc1 Lp38_loop
Lp38_ok:
    s_mov_b64 exec, -1
Lp38_skip:
    s_barrier
    s_add_u32 m0, s32, 0
    s_nop 0
    s_mov_b32 s37, 0
    buffer_load_dwordx4 v9, s[8:11], s37 offen lds
    s_add_u32 m0, s32, 4096
    s_nop 0
    s_mov_b32 s37, 0
    buffer_load_dwordx4 v10, s[8:11], s37 offen lds
    s_lshl_b32 s38, s33, 10
    s_add_u32 m0, s38, 0
    s_nop 0
    s_mov_b32 s37, 0
    buffer_load_dwordx4 v11, s[8:11], s37 offen lds
    s_add_u32 m0, s32, 10240
    s_nop 0
    s_mov_b32 s37, 128
    buffer_load_dwordx4 v9, s[8:11], s37 offen lds
    s_add_u32 m0, s32, 14336
    s_nop 0
    s_mov_b32 s37, 128
    buffer_load_dwordx4 v10, s[8:11], s37 offen lds
    s_lshl_b32 s38, s33, 10
    s_add_u32 m0, s38, 10240
    s_nop 0
    s_mov_b32 s37, 128
    buffer_load_dwordx4 v11, s[8:11], s37 offen lds
    s_add_u32 m0, s32, 20480
    s_nop 0
    s_mov_b32 s37, 256
    buffer_load_dwordx4 v9, s[8:11], s37 offen lds
    s_add_u32 m0, s32, 24576
    s_nop 0
    s_mov_b32 s37, 256
    buffer_load_dwordx4 v10, s[8:11], s37 offen lds
    s_lshl_b32 s38, s33, 10
    s_add_u32 m0, s38, 20480
    s_nop 0
    s_mov_b32 s37, 256
    buffer_load_dwordx4 v11, s[8:11], s37 offen lds
    s_add_u32 m0, s32, 30720
    s_nop 0
    s_mov_b32 s37, 384
    buffer_load_dwordx4 v9, s[8:11], s37 offen lds
    s_add_u32 m0, s32, 34816
    s_nop 0
    s_mov_b32 s37, 384
    buffer_load_dwordx4 v10, s[8:11], s37 offen lds
    s_lshl_b32 s38, s33, 10
    s_add_u32 m0, s38, 30720
    s_nop 0
    s_mov_b32 s37, 384
    buffer_load_dwordx4 v11, s[8:11], s37 offen lds
    s_add_u32 m0, s32, 40960
    s_nop 0
    s_mov_b32 s37, 512
    buffer_load_dwordx4 v9, s[8:11], s37 offen lds
    s_add_u32 m0, s32, 45056
    s_nop 0
    s_mov_b32 s37, 512
    buffer_load_dwordx4 v10, s[8:11], s37 offen lds
    s_lshl_b32 s38, s33, 10
    s_add_u32 m0, s38, 40960
    s_nop 0
    s_mov_b32 s37, 512
    buffer_load_dwordx4 v11, s[8:11], s37 offen lds
    s_add_u32 m0, s32, 51200
    s_nop 0
    s_mov_b32 s37, 640
    buffer_load_dwordx4 v9, s[8:11], s37 offen lds
    s_add_u32 m0, s32, 55296
    s_nop 0
    s_mov_b32 s37, 640
    buffer_load_dwordx4 v10, s[8:11], s37 offen lds
    s_lshl_b32 s38, s33, 10
    s_add_u32 m0, s38, 51200
    s_nop 0
    s_mov_b32 s37, 640
    buffer_load_dwordx4 v11, s[8:11], s37 offen lds
    s_add_u32 m0, s32, 61440
    s_nop 0
    s_mov_b32 s37, 768
    buffer_load_dwordx4 v9, s[8:11], s37 offen lds
    s_add_u32 m0, s32, 65536
    s_nop 0
    s_mov_b32 s37, 768
    buffer_load_dwordx4 v10, s[8:11], s37 offen lds
    s_lshl_b32 s38, s33, 10
    s_add_u32 m0, s38, 61440
    s_nop 0
    s_mov_b32 s37, 768
    buffer_load_dwordx4 v11, s[8:11], s37 offen lds
    s_add_u32 s20, s84, 43778048
    s_addc_u32 s21, s85, 0
    s_mov_b32 s22, 262144
    s_mov_b32 s23, 0x00020000
    s_lshl_b32 s37, s87, 6
    s_sub_u32 s37, s37, 16
    v_add_u32 v13, s37, v2
    v_lshlrev_b32 v13, 7, v13
    v_lshl_add_u32 v13, v3, 5, v13
    buffer_load_dwordx4 v[16:19], v13, s[20:23], 0 offen
    buffer_load_dwordx4 v[20:23], v13, s[20:23], 0 offen offset:16
    v_add_u32 v13, 2048, v13
    buffer_load_dwordx4 v[24:27], v13, s[20:23], 0 offen
    buffer_load_dwordx4 v[28:31], v13, s[20:23], 0 offen offset:16
    v_add_u32 v13, 2048, v13
    buffer_load_dwordx4 v[32:35], v13, s[20:23], 0 offen
    buffer_load_dwordx4 v[36:39], v13, s[20:23], 0 offen offset:16
    v_add_u32 v13, 2048, v13
    buffer_load_dwordx4 v[40:43], v13, s[20:23], 0 offen
    buffer_load_dwordx4 v[44:47], v13, s[20:23], 0 offen offset:16
    v_add_u32 v13, 2048, v13
    buffer_load_dwordx4 v[48:51], v13, s[20:23], 0 offen
    buffer_load_dwordx4 v[52:55], v13, s[20:23], 0 offen offset:16
    v_lshrrev_b32 v7, 1, v2
    v_and_b32 v7, 7, v7
    v_add_u32 v8, 0, v3
    v_xor_b32 v8, v8, v7
    v_lshlrev_b32 v8, 4, v8
    v_lshl_add_u32 v56, v2, 7, v8
    v_add_u32 v8, 4, v3
    v_xor_b32 v8, v8, v7
    v_lshlrev_b32 v8, 4, v8
    v_lshl_add_u32 v57, v2, 7, v8
    s_lshl_b32 s37, s86, 11
    v_add_u32 v58, s37, v56
    v_add_u32 v59, s37, v57
    v_lshrrev_b32 v63, 2, v2
    v_lshl_add_u32 v63, v3, 3, v63
    v_lshlrev_b32 v63, 7, v63
    v_bfe_u32 v64, v2, 3, 1
    v_lshlrev_b32 v64, 2, v64
    v_and_b32 v7, 1, v3
    v_lshl_add_u32 v64, v7, 3, v64
    v_and_b32 v65, 3, v2
    s_mul_i32 s37, s86, 3
    s_add_u32 s38, s37, 0
    s_and_b32 s39, s38, 3
    s_lshl_b32 s39, s39, 2
    v_add_u32 v7, s39, v65
    v_xor_b32 v7, v7, v64
    v_lshl_add_u32 v7, v7, 3, v63
    s_lshr_b32 s38, s38, 2
    s_lshl_b32 s38, s38, 13
    v_add_u32 v60, s38, v7
    s_add_u32 s38, s37, 1
    s_and_b32 s39, s38, 3
    s_lshl_b32 s39, s39, 2
    v_add_u32 v7, s39, v65
    v_xor_b32 v7, v7, v64
    v_lshl_add_u32 v7, v7, 3, v63
    s_lshr_b32 s38, s38, 2
    s_lshl_b32 s38, s38, 13
    v_add_u32 v61, s38, v7
    s_add_u32 s38, s37, 2
    s_and_b32 s39, s38, 3
    s_lshl_b32 s39, s39, 2
    v_add_u32 v7, s39, v65
    v_xor_b32 v7, v7, v64
    v_lshl_add_u32 v7, v7, 3, v63
    s_lshr_b32 s38, s38, 2
    s_lshl_b32 s38, s38, 13
    v_add_u32 v62, s38, v7
    v_add_u32 v66, 65536, v56
    v_add_u32 v67, 65536, v57
    v_add_u32 v68, 65536, v58
    v_add_u32 v69, 65536, v59
    v_add_u32 v70, 65536, v60
    v_add_u32 v71, 131072, v60
    v_add_u32 v72, 65536, v61
    v_add_u32 v73, 131072, v61
    v_add_u32 v74, 65536, v62
    v_add_u32 v75, 131072, v62
    v_mov_b32 v76, 0
    v_mov_b32 v77, 0
    v_mov_b32 v78, 0
    v_mov_b32 v79, 0
    v_mov_b32 v80, 0
    v_mov_b32 v81, 0
    v_mov_b32 v82, 0
    v_mov_b32 v83, 0
    v_mov_b32 v84, 0
    v_mov_b32 v85, 0
    v_mov_b32 v86, 0
    v_mov_b32 v87, 0
    v_mov_b32 v88, 0
    v_mov_b32 v89, 0
    v_mov_b32 v90, 0
    v_mov_b32 v91, 0
    v_mov_b32 v92, 0
    v_mov_b32 v93, 0
    v_mov_b32 v94, 0
    v_mov_b32 v95, 0
    v_mov_b32 v96, 0
    v_mov_b32 v97, 0
    v_mov_b32 v98, 0
    v_mov_b32 v99, 0
    v_mov_b32 v100, 0
    v_mov_b32 v101, 0
    v_mov_b32 v102, 0
    v_mov_b32 v103, 0
    v_mov_b32 v104, 0
    v_mov_b32 v105, 0
    v_mov_b32 v106, 0
    v_mov_b32 v107, 0
    v_mov_b32 v108, 0
    v_mov_b32 v109, 0
    v_mov_b32 v110, 0
    v_mov_b32 v111, 0
    v_mov_b32 v112, 0
    v_mov_b32 v113, 0
    v_mov_b32 v114, 0
    v_mov_b32 v115, 0
    v_mov_b32 v116, 0
    v_mov_b32 v117, 0
    v_mov_b32 v118, 0
    v_mov_b32 v119, 0
    v_mov_b32 v120, 0
    v_mov_b32 v121, 0
    v_mov_b32 v122, 0
    v_mov_b32 v123, 0
    v_mov_b32 v124, 0
    v_mov_b32 v125, 0
    v_mov_b32 v126, 0
    v_mov_b32 v127, 0
    v_mov_b32 v128, 0
    v_mov_b32 v129, 0
    v_mov_b32 v130, 0
    v_mov_b32 v131, 0
    v_mov_b32 v132, 0
    v_mov_b32 v133, 0
    v_mov_b32 v134, 0
    v_mov_b32 v135, 0
    v_mov_b32 v136, 0
    v_mov_b32 v137, 0
    v_mov_b32 v138, 0
    v_mov_b32 v139, 0
    v_mov_b32 v140, 0
    v_mov_b32 v141, 0
    v_mov_b32 v142, 0
    v_mov_b32 v143, 0
    v_mov_b32 v144, 0
    v_mov_b32 v145, 0
    v_mov_b32 v146, 0
    v_mov_b32 v147, 0
    v_mov_b32 v148, 0x3f803f80
    v_mov_b32 v149, 0x3f803f80
    v_mov_b32 v150, 0x3f803f80
    v_mov_b32 v151, 0x3f803f80
    s_waitcnt vmcnt(44)
    s_waitcnt vmcnt(28)
    s_barrier
    ds_read_b128 v[152:155], v56 offset:0
    ds_read_b128 v[156:159], v56 offset:2048
    ds_read_b128 v[160:163], v56 offset:4096
    ds_read_b128 v[164:167], v56 offset:6144
    ds_read_b128 v[168:171], v56 offset:8192
    ds_read_b64_tr_b16 v[192:193], v70 offset:6144
    ds_read_b64_tr_b16 v[194:195], v70 offset:6656
    ds_read_b64_tr_b16 v[196:197], v72 offset:6144
    ds_read_b64_tr_b16 v[198:199], v72 offset:6656
    ds_read_b64_tr_b16 v[200:201], v74 offset:6144
    ds_read_b64_tr_b16 v[202:203], v74 offset:6656
    s_waitcnt lgkmcnt(0)
    v_mfma_f32_16x16x32_bf16 v[76:79], v[192:195], v[152:155], v[76:79]
    ds_read_b128 v[172:175], v57 offset:0
    ds_read_b128 v[176:179], v57 offset:2048
    v_mfma_f32_16x16x32_bf16 v[88:91], v[192:195], v[156:159], v[88:91]
    ds_read_b128 v[180:183], v57 offset:4096
    ds_read_b128 v[184:187], v57 offset:6144
    v_mfma_f32_16x16x32_bf16 v[100:103], v[192:195], v[160:163], v[100:103]
    ds_read_b128 v[188:191], v57 offset:8192
    ds_read_b64_tr_b16 v[204:205], v70 offset:10240
    v_mfma_f32_16x16x32_bf16 v[112:115], v[192:195], v[164:167], v[112:115]
    ds_read_b64_tr_b16 v[206:207], v70 offset:10752
    ds_read_b64_tr_b16 v[208:209], v72 offset:10240
    v_mfma_f32_16x16x32_bf16 v[124:127], v[192:195], v[168:171], v[124:127]
    ds_read_b64_tr_b16 v[210:211], v72 offset:10752
    ds_read_b64_tr_b16 v[212:213], v74 offset:10240
    v_mfma_f32_16x16x32_bf16 v[136:139], v[192:195], v[148:151], v[136:139]
    ds_read_b64_tr_b16 v[214:215], v74 offset:10752
    v_mfma_f32_16x16x32_bf16 v[80:83], v[196:199], v[152:155], v[80:83]
    v_mfma_f32_16x16x32_bf16 v[92:95], v[196:199], v[156:159], v[92:95]
    v_mfma_f32_16x16x32_bf16 v[104:107], v[196:199], v[160:163], v[104:107]
    v_mfma_f32_16x16x32_bf16 v[116:119], v[196:199], v[164:167], v[116:119]
    v_mfma_f32_16x16x32_bf16 v[128:131], v[196:199], v[168:171], v[128:131]
    v_mfma_f32_16x16x32_bf16 v[140:143], v[196:199], v[148:151], v[140:143]
    v_mfma_f32_16x16x32_bf16 v[84:87], v[200:203], v[152:155], v[84:87]
    v_mfma_f32_16x16x32_bf16 v[96:99], v[200:203], v[156:159], v[96:99]
    v_mfma_f32_16x16x32_bf16 v[108:111], v[200:203], v[160:163], v[108:111]
    v_mfma_f32_16x16x32_bf16 v[120:123], v[200:203], v[164:167], v[120:123]
    v_mfma_f32_16x16x32_bf16 v[132:135], v[200:203], v[168:171], v[132:135]
    v_mfma_f32_16x16x32_bf16 v[144:147], v[200:203], v[148:151], v[144:147]
    s_waitcnt lgkmcnt(0)
    s_waitcnt vmcnt(25)
    s_barrier
    s_add_u32 m0, s32, 71680
    s_add_u32 s37, s35, 516096
    s_add_u32 s37, s37, s42
    buffer_load_dwordx4 v12, s[12:15], s37 offen lds
    s_add_u32 m0, s32, 75776
    s_add_u32 s37, s35, 602112
    s_add_u32 s37, s37, s42
    buffer_load_dwordx4 v12, s[12:15], s37 offen lds
    s_add_u32 m0, s32, 79872
    s_add_u32 s37, s35, 516096
    s_add_u32 s37, s37, s43
    buffer_load_dwordx4 v12, s[12:15], s37 offen lds
    s_add_u32 m0, s32, 83968
    s_add_u32 s37, s35, 602112
    s_add_u32 s37, s37, s43
    buffer_load_dwordx4 v12, s[12:15], s37 offen lds
    s_add_u32 m0, s32, 88064
    s_add_u32 s37, s35, 516096
    s_add_u32 s37, s37, s44
    buffer_load_dwordx4 v12, s[12:15], s37 offen lds
    s_add_u32 m0, s32, 92160
    s_add_u32 s37, s35, 602112
    s_add_u32 s37, s37, s44
    buffer_load_dwordx4 v12, s[12:15], s37 offen lds
    v_mfma_f32_16x16x32_bf16 v[76:79], v[204:207], v[172:175], v[76:79]
    ds_read_b128 v[152:155], v56 offset:10240
    ds_read_b128 v[156:159], v56 offset:12288
    v_mfma_f32_16x16x32_bf16 v[88:91], v[204:207], v[176:179], v[88:91]
    ds_read_b128 v[160:163], v56 offset:14336
    ds_read_b128 v[164:167], v56 offset:16384
    v_mfma_f32_16x16x32_bf16 v[100:103], v[204:207], v[180:183], v[100:103]
    ds_read_b128 v[168:171], v56 offset:18432
    ds_read_b64_tr_b16 v[192:193], v70 offset:30720
    v_mfma_f32_16x16x32_bf16 v[112:115], v[204:207], v[184:187], v[112:115]
    ds_read_b64_tr_b16 v[194:195], v70 offset:31232
    ds_read_b64_tr_b16 v[196:197], v72 offset:30720
    v_mfma_f32_16x16x32_bf16 v[124:127], v[204:207], v[188:191], v[124:127]
    ds_read_b64_tr_b16 v[198:199], v72 offset:31232
    ds_read_b64_tr_b16 v[200:201], v74 offset:30720
    v_mfma_f32_16x16x32_bf16 v[136:139], v[204:207], v[148:151], v[136:139]
    ds_read_b64_tr_b16 v[202:203], v74 offset:31232
    v_mfma_f32_16x16x32_bf16 v[80:83], v[208:211], v[172:175], v[80:83]
    v_mfma_f32_16x16x32_bf16 v[92:95], v[208:211], v[176:179], v[92:95]
    v_mfma_f32_16x16x32_bf16 v[104:107], v[208:211], v[180:183], v[104:107]
    v_mfma_f32_16x16x32_bf16 v[116:119], v[208:211], v[184:187], v[116:119]
    v_mfma_f32_16x16x32_bf16 v[128:131], v[208:211], v[188:191], v[128:131]
    v_mfma_f32_16x16x32_bf16 v[140:143], v[208:211], v[148:151], v[140:143]
    v_mfma_f32_16x16x32_bf16 v[84:87], v[212:215], v[172:175], v[84:87]
    v_mfma_f32_16x16x32_bf16 v[96:99], v[212:215], v[176:179], v[96:99]
    v_mfma_f32_16x16x32_bf16 v[108:111], v[212:215], v[180:183], v[108:111]
    v_mfma_f32_16x16x32_bf16 v[120:123], v[212:215], v[184:187], v[120:123]
    v_mfma_f32_16x16x32_bf16 v[132:135], v[212:215], v[188:191], v[132:135]
    v_mfma_f32_16x16x32_bf16 v[144:147], v[212:215], v[148:151], v[144:147]
    s_waitcnt lgkmcnt(0)
    v_mfma_f32_16x16x32_bf16 v[76:79], v[192:195], v[152:155], v[76:79]
    ds_read_b128 v[172:175], v57 offset:10240
    ds_read_b128 v[176:179], v57 offset:12288
    v_mfma_f32_16x16x32_bf16 v[88:91], v[192:195], v[156:159], v[88:91]
    ds_read_b128 v[180:183], v57 offset:14336
    ds_read_b128 v[184:187], v57 offset:16384
    v_mfma_f32_16x16x32_bf16 v[100:103], v[192:195], v[160:163], v[100:103]
    ds_read_b128 v[188:191], v57 offset:18432
    ds_read_b64_tr_b16 v[204:205], v70 offset:34816
    v_mfma_f32_16x16x32_bf16 v[112:115], v[192:195], v[164:167], v[112:115]
    ds_read_b64_tr_b16 v[206:207], v70 offset:35328
    ds_read_b64_tr_b16 v[208:209], v72 offset:34816
    v_mfma_f32_16x16x32_bf16 v[124:127], v[192:195], v[168:171], v[124:127]
    ds_read_b64_tr_b16 v[210:211], v72 offset:35328
    ds_read_b64_tr_b16 v[212:213], v74 offset:34816
    v_mfma_f32_16x16x32_bf16 v[136:139], v[192:195], v[148:151], v[136:139]
    ds_read_b64_tr_b16 v[214:215], v74 offset:35328
    v_mfma_f32_16x16x32_bf16 v[80:83], v[196:199], v[152:155], v[80:83]
    v_mfma_f32_16x16x32_bf16 v[92:95], v[196:199], v[156:159], v[92:95]
    v_mfma_f32_16x16x32_bf16 v[104:107], v[196:199], v[160:163], v[104:107]
    v_mfma_f32_16x16x32_bf16 v[116:119], v[196:199], v[164:167], v[116:119]
    v_mfma_f32_16x16x32_bf16 v[128:131], v[196:199], v[168:171], v[128:131]
    v_mfma_f32_16x16x32_bf16 v[140:143], v[196:199], v[148:151], v[140:143]
    v_mfma_f32_16x16x32_bf16 v[84:87], v[200:203], v[152:155], v[84:87]
    v_mfma_f32_16x16x32_bf16 v[96:99], v[200:203], v[156:159], v[96:99]
    v_mfma_f32_16x16x32_bf16 v[108:111], v[200:203], v[160:163], v[108:111]
    v_mfma_f32_16x16x32_bf16 v[120:123], v[200:203], v[164:167], v[120:123]
    v_mfma_f32_16x16x32_bf16 v[132:135], v[200:203], v[168:171], v[132:135]
    v_mfma_f32_16x16x32_bf16 v[144:147], v[200:203], v[148:151], v[144:147]
    s_waitcnt lgkmcnt(0)
    s_waitcnt vmcnt(28)
    s_barrier
    s_add_u32 m0, s32, 96256
    s_add_u32 s37, s35, 688128
    s_add_u32 s37, s37, s42
    buffer_load_dwordx4 v12, s[12:15], s37 offen lds
    s_add_u32 m0, s32, 100352
    s_add_u32 s37, s35, 774144
    s_add_u32 s37, s37, s42
    buffer_load_dwordx4 v12, s[12:15], s37 offen lds
    s_add_u32 m0, s32, 104448
    s_add_u32 s37, s35, 688128
    s_add_u32 s37, s37, s43
    buffer_load_dwordx4 v12, s[12:15], s37 offen lds
    s_add_u32 m0, s32, 108544
    s_add_u32 s37, s35, 774144
    s_add_u32 s37, s37, s43
    buffer_load_dwordx4 v12, s[12:15], s37 offen lds
    s_add_u32 m0, s32, 112640
    s_add_u32 s37, s35, 688128
    s_add_u32 s37, s37, s44
    buffer_load_dwordx4 v12, s[12:15], s37 offen lds
    s_add_u32 m0, s32, 116736
    s_add_u32 s37, s35, 774144
    s_add_u32 s37, s37, s44
    buffer_load_dwordx4 v12, s[12:15], s37 offen lds
    v_mfma_f32_16x16x32_bf16 v[76:79], v[204:207], v[172:175], v[76:79]
    ds_read_b128 v[152:155], v56 offset:20480
    ds_read_b128 v[156:159], v56 offset:22528
    v_mfma_f32_16x16x32_bf16 v[88:91], v[204:207], v[176:179], v[88:91]
    ds_read_b128 v[160:163], v56 offset:24576
    ds_read_b128 v[164:167], v56 offset:26624
    v_mfma_f32_16x16x32_bf16 v[100:103], v[204:207], v[180:183], v[100:103]
    ds_read_b128 v[168:171], v56 offset:28672
    ds_read_b64_tr_b16 v[192:193], v70 offset:55296
    v_mfma_f32_16x16x32_bf16 v[112:115], v[204:207], v[184:187], v[112:115]
    ds_read_b64_tr_b16 v[194:195], v70 offset:55808
    ds_read_b64_tr_b16 v[196:197], v72 offset:55296
    v_mfma_f32_16x16x32_bf16 v[124:127], v[204:207], v[188:191], v[124:127]
    ds_read_b64_tr_b16 v[198:199], v72 offset:55808
    ds_read_b64_tr_b16 v[200:201], v74 offset:55296
    v_mfma_f32_16x16x32_bf16 v[136:139], v[204:207], v[148:151], v[136:139]
    ds_read_b64_tr_b16 v[202:203], v74 offset:55808
    v_mfma_f32_16x16x32_bf16 v[80:83], v[208:211], v[172:175], v[80:83]
    v_mfma_f32_16x16x32_bf16 v[92:95], v[208:211], v[176:179], v[92:95]
    v_mfma_f32_16x16x32_bf16 v[104:107], v[208:211], v[180:183], v[104:107]
    v_mfma_f32_16x16x32_bf16 v[116:119], v[208:211], v[184:187], v[116:119]
    v_mfma_f32_16x16x32_bf16 v[128:131], v[208:211], v[188:191], v[128:131]
    v_mfma_f32_16x16x32_bf16 v[140:143], v[208:211], v[148:151], v[140:143]
    v_mfma_f32_16x16x32_bf16 v[84:87], v[212:215], v[172:175], v[84:87]
    v_mfma_f32_16x16x32_bf16 v[96:99], v[212:215], v[176:179], v[96:99]
    v_mfma_f32_16x16x32_bf16 v[108:111], v[212:215], v[180:183], v[108:111]
    v_mfma_f32_16x16x32_bf16 v[120:123], v[212:215], v[184:187], v[120:123]
    v_mfma_f32_16x16x32_bf16 v[132:135], v[212:215], v[188:191], v[132:135]
    v_mfma_f32_16x16x32_bf16 v[144:147], v[212:215], v[148:151], v[144:147]
    s_waitcnt lgkmcnt(0)
    v_mfma_f32_16x16x32_bf16 v[76:79], v[192:195], v[152:155], v[76:79]
    ds_read_b128 v[172:175], v57 offset:20480
    ds_read_b128 v[176:179], v57 offset:22528
    v_mfma_f32_16x16x32_bf16 v[88:91], v[192:195], v[156:159], v[88:91]
    ds_read_b128 v[180:183], v57 offset:24576
    ds_read_b128 v[184:187], v57 offset:26624
    v_mfma_f32_16x16x32_bf16 v[100:103], v[192:195], v[160:163], v[100:103]
    ds_read_b128 v[188:191], v57 offset:28672
    ds_read_b64_tr_b16 v[204:205], v70 offset:59392
    v_mfma_f32_16x16x32_bf16 v[112:115], v[192:195], v[164:167], v[112:115]
    ds_read_b64_tr_b16 v[206:207], v70 offset:59904
    ds_read_b64_tr_b16 v[208:209], v72 offset:59392
    v_mfma_f32_16x16x32_bf16 v[124:127], v[192:195], v[168:171], v[124:127]
    ds_read_b64_tr_b16 v[210:211], v72 offset:59904
    ds_read_b64_tr_b16 v[212:213], v74 offset:59392
    v_mfma_f32_16x16x32_bf16 v[136:139], v[192:195], v[148:151], v[136:139]
    ds_read_b64_tr_b16 v[214:215], v74 offset:59904
    v_mfma_f32_16x16x32_bf16 v[80:83], v[196:199], v[152:155], v[80:83]
    v_mfma_f32_16x16x32_bf16 v[92:95], v[196:199], v[156:159], v[92:95]
    v_mfma_f32_16x16x32_bf16 v[104:107], v[196:199], v[160:163], v[104:107]
    v_mfma_f32_16x16x32_bf16 v[116:119], v[196:199], v[164:167], v[116:119]
    v_mfma_f32_16x16x32_bf16 v[128:131], v[196:199], v[168:171], v[128:131]
    v_mfma_f32_16x16x32_bf16 v[140:143], v[196:199], v[148:151], v[140:143]
    v_mfma_f32_16x16x32_bf16 v[84:87], v[200:203], v[152:155], v[84:87]
    v_mfma_f32_16x16x32_bf16 v[96:99], v[200:203], v[156:159], v[96:99]
    v_mfma_f32_16x16x32_bf16 v[108:111], v[200:203], v[160:163], v[108:111]
    v_mfma_f32_16x16x32_bf16 v[120:123], v[200:203], v[164:167], v[120:123]
    v_mfma_f32_16x16x32_bf16 v[132:135], v[200:203], v[168:171], v[132:135]
    v_mfma_f32_16x16x32_bf16 v[144:147], v[200:203], v[148:151], v[144:147]
    s_waitcnt lgkmcnt(0)
    s_waitcnt vmcnt(6)
    s_barrier
    s_add_u32 m0, s32, 120832
    s_add_u32 s37, s35, 860160
    s_add_u32 s37, s37, s42
    buffer_load_dwordx4 v12, s[12:15], s37 offen lds
    s_add_u32 m0, s32, 124928
    s_add_u32 s37, s35, 946176
    s_add_u32 s37, s37, s42
    buffer_load_dwordx4 v12, s[12:15], s37 offen lds
    s_add_u32 m0, s32, 129024
    s_add_u32 s37, s35, 860160
    s_add_u32 s37, s37, s43
    buffer_load_dwordx4 v12, s[12:15], s37 offen lds
    s_add_u32 m0, s32, 133120
    s_add_u32 s37, s35, 946176
    s_add_u32 s37, s37, s43
    buffer_load_dwordx4 v12, s[12:15], s37 offen lds
    s_add_u32 m0, s32, 137216
    s_add_u32 s37, s35, 860160
    s_add_u32 s37, s37, s44
    buffer_load_dwordx4 v12, s[12:15], s37 offen lds
    s_add_u32 m0, s32, 141312
    s_add_u32 s37, s35, 946176
    s_add_u32 s37, s37, s44
    buffer_load_dwordx4 v12, s[12:15], s37 offen lds
    v_mfma_f32_16x16x32_bf16 v[76:79], v[204:207], v[172:175], v[76:79]
    ds_read_b128 v[152:155], v56 offset:30720
    ds_read_b128 v[156:159], v56 offset:32768
    v_mfma_f32_16x16x32_bf16 v[88:91], v[204:207], v[176:179], v[88:91]
    ds_read_b128 v[160:163], v56 offset:34816
    ds_read_b128 v[164:167], v56 offset:36864
    v_mfma_f32_16x16x32_bf16 v[100:103], v[204:207], v[180:183], v[100:103]
    ds_read_b128 v[168:171], v56 offset:38912
    ds_read_b64_tr_b16 v[192:193], v70 offset:6144
    v_mfma_f32_16x16x32_bf16 v[112:115], v[204:207], v[184:187], v[112:115]
    ds_read_b64_tr_b16 v[194:195], v70 offset:6656
    ds_read_b64_tr_b16 v[196:197], v72 offset:6144
    v_mfma_f32_16x16x32_bf16 v[124:127], v[204:207], v[188:191], v[124:127]
    ds_read_b64_tr_b16 v[198:199], v72 offset:6656
    ds_read_b64_tr_b16 v[200:201], v74 offset:6144
    v_mfma_f32_16x16x32_bf16 v[136:139], v[204:207], v[148:151], v[136:139]
    ds_read_b64_tr_b16 v[202:203], v74 offset:6656
    v_mfma_f32_16x16x32_bf16 v[80:83], v[208:211], v[172:175], v[80:83]
    v_mfma_f32_16x16x32_bf16 v[92:95], v[208:211], v[176:179], v[92:95]
    v_mfma_f32_16x16x32_bf16 v[104:107], v[208:211], v[180:183], v[104:107]
    v_mfma_f32_16x16x32_bf16 v[116:119], v[208:211], v[184:187], v[116:119]
    v_mfma_f32_16x16x32_bf16 v[128:131], v[208:211], v[188:191], v[128:131]
    v_mfma_f32_16x16x32_bf16 v[140:143], v[208:211], v[148:151], v[140:143]
    v_mfma_f32_16x16x32_bf16 v[84:87], v[212:215], v[172:175], v[84:87]
    v_mfma_f32_16x16x32_bf16 v[96:99], v[212:215], v[176:179], v[96:99]
    v_mfma_f32_16x16x32_bf16 v[108:111], v[212:215], v[180:183], v[108:111]
    v_mfma_f32_16x16x32_bf16 v[120:123], v[212:215], v[184:187], v[120:123]
    v_mfma_f32_16x16x32_bf16 v[132:135], v[212:215], v[188:191], v[132:135]
    v_mfma_f32_16x16x32_bf16 v[144:147], v[212:215], v[148:151], v[144:147]
    s_waitcnt lgkmcnt(0)
    v_mfma_f32_16x16x32_bf16 v[76:79], v[192:195], v[152:155], v[76:79]
    ds_read_b128 v[172:175], v57 offset:30720
    ds_read_b128 v[176:179], v57 offset:32768
    v_mfma_f32_16x16x32_bf16 v[88:91], v[192:195], v[156:159], v[88:91]
    ds_read_b128 v[180:183], v57 offset:34816
    ds_read_b128 v[184:187], v57 offset:36864
    v_mfma_f32_16x16x32_bf16 v[100:103], v[192:195], v[160:163], v[100:103]
    ds_read_b128 v[188:191], v57 offset:38912
    ds_read_b64_tr_b16 v[204:205], v70 offset:10240
    v_mfma_f32_16x16x32_bf16 v[112:115], v[192:195], v[164:167], v[112:115]
    ds_read_b64_tr_b16 v[206:207], v70 offset:10752
    ds_read_b64_tr_b16 v[208:209], v72 offset:10240
    v_mfma_f32_16x16x32_bf16 v[124:127], v[192:195], v[168:171], v[124:127]
    ds_read_b64_tr_b16 v[210:211], v72 offset:10752
    ds_read_b64_tr_b16 v[212:213], v74 offset:10240
    v_mfma_f32_16x16x32_bf16 v[136:139], v[192:195], v[148:151], v[136:139]
    ds_read_b64_tr_b16 v[214:215], v74 offset:10752
    v_mfma_f32_16x16x32_bf16 v[80:83], v[196:199], v[152:155], v[80:83]
    v_mfma_f32_16x16x32_bf16 v[92:95], v[196:199], v[156:159], v[92:95]
    v_mfma_f32_16x16x32_bf16 v[104:107], v[196:199], v[160:163], v[104:107]
    v_mfma_f32_16x16x32_bf16 v[116:119], v[196:199], v[164:167], v[116:119]
    v_mfma_f32_16x16x32_bf16 v[128:131], v[196:199], v[168:171], v[128:131]
    v_mfma_f32_16x16x32_bf16 v[140:143], v[196:199], v[148:151], v[140:143]
    v_mfma_f32_16x16x32_bf16 v[84:87], v[200:203], v[152:155], v[84:87]
    v_mfma_f32_16x16x32_bf16 v[96:99], v[200:203], v[156:159], v[96:99]
    v_mfma_f32_16x16x32_bf16 v[108:111], v[200:203], v[160:163], v[108:111]
    v_mfma_f32_16x16x32_bf16 v[120:123], v[200:203], v[164:167], v[120:123]
    v_mfma_f32_16x16x32_bf16 v[132:135], v[200:203], v[168:171], v[132:135]
    v_mfma_f32_16x16x32_bf16 v[144:147], v[200:203], v[148:151], v[144:147]
    s_waitcnt lgkmcnt(0)
    s_waitcnt vmcnt(6)
    s_barrier
    s_add_u32 m0, s32, 71680
    s_add_u32 s37, s35, 1032192
    s_add_u32 s37, s37, s42
    buffer_load_dwordx4 v12, s[12:15], s37 offen lds
    s_add_u32 m0, s32, 75776
    s_add_u32 s37, s35, 1118208
    s_add_u32 s37, s37, s42
    buffer_load_dwordx4 v12, s[12:15], s37 offen lds
    s_add_u32 m0, s32, 79872
    s_add_u32 s37, s35, 1032192
    s_add_u32 s37, s37, s43
    buffer_load_dwordx4 v12, s[12:15], s37 offen lds
    s_add_u32 m0, s32, 83968
    s_add_u32 s37, s35, 1118208
    s_add_u32 s37, s37, s43
    buffer_load_dwordx4 v12, s[12:15], s37 offen lds
    s_add_u32 m0, s32, 88064
    s_add_u32 s37, s35, 1032192
    s_add_u32 s37, s37, s44
    buffer_load_dwordx4 v12, s[12:15], s37 offen lds
    s_add_u32 m0, s32, 92160
    s_add_u32 s37, s35, 1118208
    s_add_u32 s37, s37, s44
    buffer_load_dwordx4 v12, s[12:15], s37 offen lds
    v_mfma_f32_16x16x32_bf16 v[76:79], v[204:207], v[172:175], v[76:79]
    ds_read_b128 v[152:155], v56 offset:40960
    ds_read_b128 v[156:159], v56 offset:43008
    v_mfma_f32_16x16x32_bf16 v[88:91], v[204:207], v[176:179], v[88:91]
    ds_read_b128 v[160:163], v56 offset:45056
    ds_read_b128 v[164:167], v56 offset:47104
    v_mfma_f32_16x16x32_bf16 v[100:103], v[204:207], v[180:183], v[100:103]
    ds_read_b128 v[168:171], v56 offset:49152
    ds_read_b64_tr_b16 v[192:193], v70 offset:30720
    v_mfma_f32_16x16x32_bf16 v[112:115], v[204:207], v[184:187], v[112:115]
    ds_read_b64_tr_b16 v[194:195], v70 offset:31232
    ds_read_b64_tr_b16 v[196:197], v72 offset:30720
    v_mfma_f32_16x16x32_bf16 v[124:127], v[204:207], v[188:191], v[124:127]
    ds_read_b64_tr_b16 v[198:199], v72 offset:31232
    ds_read_b64_tr_b16 v[200:201], v74 offset:30720
    v_mfma_f32_16x16x32_bf16 v[136:139], v[204:207], v[148:151], v[136:139]
    ds_read_b64_tr_b16 v[202:203], v74 offset:31232
    v_mfma_f32_16x16x32_bf16 v[80:83], v[208:211], v[172:175], v[80:83]
    v_mfma_f32_16x16x32_bf16 v[92:95], v[208:211], v[176:179], v[92:95]
    v_mfma_f32_16x16x32_bf16 v[104:107], v[208:211], v[180:183], v[104:107]
    v_mfma_f32_16x16x32_bf16 v[116:119], v[208:211], v[184:187], v[116:119]
    v_mfma_f32_16x16x32_bf16 v[128:131], v[208:211], v[188:191], v[128:131]
    v_mfma_f32_16x16x32_bf16 v[140:143], v[208:211], v[148:151], v[140:143]
    v_mfma_f32_16x16x32_bf16 v[84:87], v[212:215], v[172:175], v[84:87]
    v_mfma_f32_16x16x32_bf16 v[96:99], v[212:215], v[176:179], v[96:99]
    v_mfma_f32_16x16x32_bf16 v[108:111], v[212:215], v[180:183], v[108:111]
    v_mfma_f32_16x16x32_bf16 v[120:123], v[212:215], v[184:187], v[120:123]
    v_mfma_f32_16x16x32_bf16 v[132:135], v[212:215], v[188:191], v[132:135]
    v_mfma_f32_16x16x32_bf16 v[144:147], v[212:215], v[148:151], v[144:147]
    s_waitcnt lgkmcnt(0)
    v_mfma_f32_16x16x32_bf16 v[76:79], v[192:195], v[152:155], v[76:79]
    ds_read_b128 v[172:175], v57 offset:40960
    ds_read_b128 v[176:179], v57 offset:43008
    v_mfma_f32_16x16x32_bf16 v[88:91], v[192:195], v[156:159], v[88:91]
    ds_read_b128 v[180:183], v57 offset:45056
    ds_read_b128 v[184:187], v57 offset:47104
    v_mfma_f32_16x16x32_bf16 v[100:103], v[192:195], v[160:163], v[100:103]
    ds_read_b128 v[188:191], v57 offset:49152
    ds_read_b64_tr_b16 v[204:205], v70 offset:34816
    v_mfma_f32_16x16x32_bf16 v[112:115], v[192:195], v[164:167], v[112:115]
    ds_read_b64_tr_b16 v[206:207], v70 offset:35328
    ds_read_b64_tr_b16 v[208:209], v72 offset:34816
    v_mfma_f32_16x16x32_bf16 v[124:127], v[192:195], v[168:171], v[124:127]
    ds_read_b64_tr_b16 v[210:211], v72 offset:35328
    ds_read_b64_tr_b16 v[212:213], v74 offset:34816
    v_mfma_f32_16x16x32_bf16 v[136:139], v[192:195], v[148:151], v[136:139]
    ds_read_b64_tr_b16 v[214:215], v74 offset:35328
    v_mfma_f32_16x16x32_bf16 v[80:83], v[196:199], v[152:155], v[80:83]
    v_mfma_f32_16x16x32_bf16 v[92:95], v[196:199], v[156:159], v[92:95]
    v_mfma_f32_16x16x32_bf16 v[104:107], v[196:199], v[160:163], v[104:107]
    v_mfma_f32_16x16x32_bf16 v[116:119], v[196:199], v[164:167], v[116:119]
    v_mfma_f32_16x16x32_bf16 v[128:131], v[196:199], v[168:171], v[128:131]
    v_mfma_f32_16x16x32_bf16 v[140:143], v[196:199], v[148:151], v[140:143]
    v_mfma_f32_16x16x32_bf16 v[84:87], v[200:203], v[152:155], v[84:87]
    v_mfma_f32_16x16x32_bf16 v[96:99], v[200:203], v[156:159], v[96:99]
    v_mfma_f32_16x16x32_bf16 v[108:111], v[200:203], v[160:163], v[108:111]
    v_mfma_f32_16x16x32_bf16 v[120:123], v[200:203], v[164:167], v[120:123]
    v_mfma_f32_16x16x32_bf16 v[132:135], v[200:203], v[168:171], v[132:135]
    v_mfma_f32_16x16x32_bf16 v[144:147], v[200:203], v[148:151], v[144:147]
    s_waitcnt lgkmcnt(0)
    s_waitcnt vmcnt(6)
    s_barrier
    v_mfma_f32_16x16x32_bf16 v[76:79], v[204:207], v[172:175], v[76:79]
    ds_read_b128 v[152:155], v56 offset:51200
    ds_read_b128 v[156:159], v56 offset:53248
    v_mfma_f32_16x16x32_bf16 v[88:91], v[204:207], v[176:179], v[88:91]
    ds_read_b128 v[160:163], v56 offset:55296
    ds_read_b128 v[164:167], v56 offset:57344
    v_mfma_f32_16x16x32_bf16 v[100:103], v[204:207], v[180:183], v[100:103]
    ds_read_b128 v[168:171], v56 offset:59392
    ds_read_b64_tr_b16 v[192:193], v70 offset:55296
    v_mfma_f32_16x16x32_bf16 v[112:115], v[204:207], v[184:187], v[112:115]
    ds_read_b64_tr_b16 v[194:195], v70 offset:55808
    ds_read_b64_tr_b16 v[196:197], v72 offset:55296
    v_mfma_f32_16x16x32_bf16 v[124:127], v[204:207], v[188:191], v[124:127]
    ds_read_b64_tr_b16 v[198:199], v72 offset:55808
    ds_read_b64_tr_b16 v[200:201], v74 offset:55296
    v_mfma_f32_16x16x32_bf16 v[136:139], v[204:207], v[148:151], v[136:139]
    ds_read_b64_tr_b16 v[202:203], v74 offset:55808
    v_mfma_f32_16x16x32_bf16 v[80:83], v[208:211], v[172:175], v[80:83]
    v_mfma_f32_16x16x32_bf16 v[92:95], v[208:211], v[176:179], v[92:95]
    v_mfma_f32_16x16x32_bf16 v[104:107], v[208:211], v[180:183], v[104:107]
    v_mfma_f32_16x16x32_bf16 v[116:119], v[208:211], v[184:187], v[116:119]
    v_mfma_f32_16x16x32_bf16 v[128:131], v[208:211], v[188:191], v[128:131]
    v_mfma_f32_16x16x32_bf16 v[140:143], v[208:211], v[148:151], v[140:143]
    v_mfma_f32_16x16x32_bf16 v[84:87], v[212:215], v[172:175], v[84:87]
    v_mfma_f32_16x16x32_bf16 v[96:99], v[212:215], v[176:179], v[96:99]
    v_mfma_f32_16x16x32_bf16 v[108:111], v[212:215], v[180:183], v[108:111]
    v_mfma_f32_16x16x32_bf16 v[120:123], v[212:215], v[184:187], v[120:123]
    v_mfma_f32_16x16x32_bf16 v[132:135], v[212:215], v[188:191], v[132:135]
    v_mfma_f32_16x16x32_bf16 v[144:147], v[212:215], v[148:151], v[144:147]
    s_waitcnt lgkmcnt(0)
    v_mfma_f32_16x16x32_bf16 v[76:79], v[192:195], v[152:155], v[76:79]
    ds_read_b128 v[172:175], v57 offset:51200
    ds_read_b128 v[176:179], v57 offset:53248
    v_mfma_f32_16x16x32_bf16 v[88:91], v[192:195], v[156:159], v[88:91]
    ds_read_b128 v[180:183], v57 offset:55296
    ds_read_b128 v[184:187], v57 offset:57344
    v_mfma_f32_16x16x32_bf16 v[100:103], v[192:195], v[160:163], v[100:103]
    ds_read_b128 v[188:191], v57 offset:59392
    ds_read_b64_tr_b16 v[204:205], v70 offset:59392
    v_mfma_f32_16x16x32_bf16 v[112:115], v[192:195], v[164:167], v[112:115]
    ds_read_b64_tr_b16 v[206:207], v70 offset:59904
    ds_read_b64_tr_b16 v[208:209], v72 offset:59392
    v_mfma_f32_16x16x32_bf16 v[124:127], v[192:195], v[168:171], v[124:127]
    ds_read_b64_tr_b16 v[210:211], v72 offset:59904
    ds_read_b64_tr_b16 v[212:213], v74 offset:59392
    v_mfma_f32_16x16x32_bf16 v[136:139], v[192:195], v[148:151], v[136:139]
    ds_read_b64_tr_b16 v[214:215], v74 offset:59904
    v_mfma_f32_16x16x32_bf16 v[80:83], v[196:199], v[152:155], v[80:83]
    v_mfma_f32_16x16x32_bf16 v[92:95], v[196:199], v[156:159], v[92:95]
    v_mfma_f32_16x16x32_bf16 v[104:107], v[196:199], v[160:163], v[104:107]
    v_mfma_f32_16x16x32_bf16 v[116:119], v[196:199], v[164:167], v[116:119]
    v_mfma_f32_16x16x32_bf16 v[128:131], v[196:199], v[168:171], v[128:131]
    v_mfma_f32_16x16x32_bf16 v[140:143], v[196:199], v[148:151], v[140:143]
    v_mfma_f32_16x16x32_bf16 v[84:87], v[200:203], v[152:155], v[84:87]
    v_mfma_f32_16x16x32_bf16 v[96:99], v[200:203], v[156:159], v[96:99]
    v_mfma_f32_16x16x32_bf16 v[108:111], v[200:203], v[160:163], v[108:111]
    v_mfma_f32_16x16x32_bf16 v[120:123], v[200:203], v[164:167], v[120:123]
    v_mfma_f32_16x16x32_bf16 v[132:135], v[200:203], v[168:171], v[132:135]
    v_mfma_f32_16x16x32_bf16 v[144:147], v[200:203], v[148:151], v[144:147]
    s_waitcnt lgkmcnt(0)
    s_waitcnt vmcnt(0)
    s_barrier
    v_mfma_f32_16x16x32_bf16 v[76:79], v[204:207], v[172:175], v[76:79]
    ds_read_b128 v[152:155], v56 offset:61440
    ds_read_b128 v[156:159], v56 offset:63488
    v_mfma_f32_16x16x32_bf16 v[88:91], v[204:207], v[176:179], v[88:91]
    ds_read_b128 v[160:163], v66 offset:0
    ds_read_b128 v[164:167], v66 offset:2048
    v_mfma_f32_16x16x32_bf16 v[100:103], v[204:207], v[180:183], v[100:103]
    ds_read_b128 v[168:171], v66 offset:4096
    ds_read_b64_tr_b16 v[192:193], v70 offset:6144
    v_mfma_f32_16x16x32_bf16 v[112:115], v[204:207], v[184:187], v[112:115]
    ds_read_b64_tr_b16 v[194:195], v70 offset:6656
    ds_read_b64_tr_b16 v[196:197], v72 offset:6144
    v_mfma_f32_16x16x32_bf16 v[124:127], v[204:207], v[188:191], v[124:127]
    ds_read_b64_tr_b16 v[198:199], v72 offset:6656
    ds_read_b64_tr_b16 v[200:201], v74 offset:6144
    v_mfma_f32_16x16x32_bf16 v[136:139], v[204:207], v[148:151], v[136:139]
    ds_read_b64_tr_b16 v[202:203], v74 offset:6656
    v_mfma_f32_16x16x32_bf16 v[80:83], v[208:211], v[172:175], v[80:83]
    v_mfma_f32_16x16x32_bf16 v[92:95], v[208:211], v[176:179], v[92:95]
    v_mfma_f32_16x16x32_bf16 v[104:107], v[208:211], v[180:183], v[104:107]
    v_mfma_f32_16x16x32_bf16 v[116:119], v[208:211], v[184:187], v[116:119]
    v_mfma_f32_16x16x32_bf16 v[128:131], v[208:211], v[188:191], v[128:131]
    v_mfma_f32_16x16x32_bf16 v[140:143], v[208:211], v[148:151], v[140:143]
    v_mfma_f32_16x16x32_bf16 v[84:87], v[212:215], v[172:175], v[84:87]
    v_mfma_f32_16x16x32_bf16 v[96:99], v[212:215], v[176:179], v[96:99]
    v_mfma_f32_16x16x32_bf16 v[108:111], v[212:215], v[180:183], v[108:111]
    v_mfma_f32_16x16x32_bf16 v[120:123], v[212:215], v[184:187], v[120:123]
    v_mfma_f32_16x16x32_bf16 v[132:135], v[212:215], v[188:191], v[132:135]
    v_mfma_f32_16x16x32_bf16 v[144:147], v[212:215], v[148:151], v[144:147]
    s_waitcnt lgkmcnt(0)
    v_mfma_f32_16x16x32_bf16 v[76:79], v[192:195], v[152:155], v[76:79]
    ds_read_b128 v[172:175], v57 offset:61440
    ds_read_b128 v[176:179], v57 offset:63488
    v_mfma_f32_16x16x32_bf16 v[88:91], v[192:195], v[156:159], v[88:91]
    ds_read_b128 v[180:183], v67 offset:0
    ds_read_b128 v[184:187], v67 offset:2048
    v_mfma_f32_16x16x32_bf16 v[100:103], v[192:195], v[160:163], v[100:103]
    ds_read_b128 v[188:191], v67 offset:4096
    ds_read_b64_tr_b16 v[204:205], v70 offset:10240
    v_mfma_f32_16x16x32_bf16 v[112:115], v[192:195], v[164:167], v[112:115]
    ds_read_b64_tr_b16 v[206:207], v70 offset:10752
    ds_read_b64_tr_b16 v[208:209], v72 offset:10240
    v_mfma_f32_16x16x32_bf16 v[124:127], v[192:195], v[168:171], v[124:127]
    ds_read_b64_tr_b16 v[210:211], v72 offset:10752
    ds_read_b64_tr_b16 v[212:213], v74 offset:10240
    v_mfma_f32_16x16x32_bf16 v[136:139], v[192:195], v[148:151], v[136:139]
    ds_read_b64_tr_b16 v[214:215], v74 offset:10752
    v_mfma_f32_16x16x32_bf16 v[80:83], v[196:199], v[152:155], v[80:83]
    v_mfma_f32_16x16x32_bf16 v[92:95], v[196:199], v[156:159], v[92:95]
    v_mfma_f32_16x16x32_bf16 v[104:107], v[196:199], v[160:163], v[104:107]
    v_mfma_f32_16x16x32_bf16 v[116:119], v[196:199], v[164:167], v[116:119]
    v_mfma_f32_16x16x32_bf16 v[128:131], v[196:199], v[168:171], v[128:131]
    v_mfma_f32_16x16x32_bf16 v[140:143], v[196:199], v[148:151], v[140:143]
    v_mfma_f32_16x16x32_bf16 v[84:87], v[200:203], v[152:155], v[84:87]
    v_mfma_f32_16x16x32_bf16 v[96:99], v[200:203], v[156:159], v[96:99]
    v_mfma_f32_16x16x32_bf16 v[108:111], v[200:203], v[160:163], v[108:111]
    v_mfma_f32_16x16x32_bf16 v[120:123], v[200:203], v[164:167], v[120:123]
    v_mfma_f32_16x16x32_bf16 v[132:135], v[200:203], v[168:171], v[132:135]
    v_mfma_f32_16x16x32_bf16 v[144:147], v[200:203], v[148:151], v[144:147]
    s_waitcnt lgkmcnt(0)
    v_mfma_f32_16x16x32_bf16 v[76:79], v[204:207], v[172:175], v[76:79]
    v_mfma_f32_16x16x32_bf16 v[88:91], v[204:207], v[176:179], v[88:91]
    v_mfma_f32_16x16x32_bf16 v[100:103], v[204:207], v[180:183], v[100:103]
    v_mfma_f32_16x16x32_bf16 v[112:115], v[204:207], v[184:187], v[112:115]
    v_mfma_f32_16x16x32_bf16 v[124:127], v[204:207], v[188:191], v[124:127]
    v_mfma_f32_16x16x32_bf16 v[136:139], v[204:207], v[148:151], v[136:139]
    v_mfma_f32_16x16x32_bf16 v[80:83], v[208:211], v[172:175], v[80:83]
    v_mfma_f32_16x16x32_bf16 v[92:95], v[208:211], v[176:179], v[92:95]
    v_mfma_f32_16x16x32_bf16 v[104:107], v[208:211], v[180:183], v[104:107]
    v_mfma_f32_16x16x32_bf16 v[116:119], v[208:211], v[184:187], v[116:119]
    v_mfma_f32_16x16x32_bf16 v[128:131], v[208:211], v[188:191], v[128:131]
    v_mfma_f32_16x16x32_bf16 v[140:143], v[208:211], v[148:151], v[140:143]
    v_mfma_f32_16x16x32_bf16 v[84:87], v[212:215], v[172:175], v[84:87]
    v_mfma_f32_16x16x32_bf16 v[96:99], v[212:215], v[176:179], v[96:99]
    v_mfma_f32_16x16x32_bf16 v[108:111], v[212:215], v[180:183], v[108:111]
    v_mfma_f32_16x16x32_bf16 v[120:123], v[212:215], v[184:187], v[120:123]
    v_mfma_f32_16x16x32_bf16 v[132:135], v[212:215], v[188:191], v[132:135]
    v_mfma_f32_16x16x32_bf16 v[144:147], v[212:215], v[148:151], v[144:147]
    s_nop 7
    s_nop 7
    s_barrier
    s_mov_b32 s12, s68
    s_mov_b32 s13, s69
    s_mov_b32 s14, 401408
    s_mov_b32 s15, 0x00020000
    s_lshl_b32 s32, s86, 10
    s_and_b32 s40, s86, 1
    s_mul_i32 s35, s86, 7168
    v_lshrrev_b32 v154, 3, v1
    v_bfe_u32 v152, v1, 4, 1
    v_lshlrev_b32 v152, 1, v152
    s_lshl_b32 s37, s40, 2
    v_add_u32 v152, s37, v152
    v_and_b32 v153, 7, v1
    v_xor_b32 v153, v153, v152
    s_mov_b32 s39, 896
    v_mul_lo_u32 v152, v154, s39
    v_lshl_add_u32 v155, v153, 4, v152
    s_mul_i32 s42, s88, 112
    s_add_u32 s42, s42, 0
    s_add_u32 m0, s32, 57344
    s_add_u32 s37, s35, 0
    s_add_u32 s37, s37, s42
    buffer_load_dwordx4 v155, s[12:15], s37 offen lds
    s_add_u32 m0, s32, 61440
    s_add_u32 s37, s35, 28672
    s_add_u32 s37, s37, s42
    buffer_load_dwordx4 v155, s[12:15], s37 offen lds
    s_add_u32 m0, s32, 65536
    s_add_u32 s37, s35, 57344
    s_add_u32 s37, s37, s42
    buffer_load_dwordx4 v155, s[12:15], s37 offen lds
    s_add_u32 m0, s32, 69632
    s_add_u32 s37, s35, 86016
    s_add_u32 s37, s37, s42
    buffer_load_dwordx4 v155, s[12:15], s37 offen lds
    s_add_u32 m0, s32, 73728
    s_add_u32 s37, s35, 114688
    s_add_u32 s37, s37, s42
    buffer_load_dwordx4 v155, s[12:15], s37 offen lds
    s_add_u32 m0, s32, 77824
    s_add_u32 s37, s35, 143360
    s_add_u32 s37, s37, s42
    buffer_load_dwordx4 v155, s[12:15], s37 offen lds
    s_add_u32 m0, s32, 81920
    s_add_u32 s37, s35, 172032
    s_add_u32 s37, s37, s42
    buffer_load_dwordx4 v155, s[12:15], s37 offen lds
    s_add_u32 m0, s32, 86016
    s_add_u32 s37, s35, 200704
    s_add_u32 s37, s37, s42
    buffer_load_dwordx4 v155, s[12:15], s37 offen lds
    s_add_u32 m0, s32, 90112
    s_add_u32 s37, s35, 229376
    s_add_u32 s37, s37, s42
    buffer_load_dwordx4 v155, s[12:15], s37 offen lds
    s_add_u32 m0, s32, 94208
    s_add_u32 s37, s35, 258048
    s_add_u32 s37, s37, s42
    buffer_load_dwordx4 v155, s[12:15], s37 offen lds
    s_add_u32 m0, s32, 98304
    s_add_u32 s37, s35, 286720
    s_add_u32 s37, s37, s42
    buffer_load_dwordx4 v155, s[12:15], s37 offen lds
    s_add_u32 m0, s32, 102400
    s_add_u32 s37, s35, 315392
    s_add_u32 s37, s37, s42
    buffer_load_dwordx4 v155, s[12:15], s37 offen lds
    s_add_u32 m0, s32, 106496
    s_add_u32 s37, s35, 344064
    s_add_u32 s37, s37, s42
    buffer_load_dwordx4 v155, s[12:15], s37 offen lds
    s_add_u32 m0, s32, 110592
    s_add_u32 s37, s35, 372736
    s_add_u32 s37, s37, s42
    buffer_load_dwordx4 v155, s[12:15], s37 offen lds
    v_add_f32 v156, v16, v18
    v_add_f32 v157, v17, v19
    v_add_f32 v152, v20, v22
    v_add_f32 v153, v21, v23
    v_add_f32 v156, v156, v152
    v_add_f32 v157, v157, v153
    v_mov_b32 v152, v156
    s_nop 1
    v_permlane16_swap_b32 v156, v152
    v_add_f32 v156, v156, v152
    v_mov_b32 v152, v156
    s_nop 1
    v_permlane32_swap_b32 v156, v152
    v_add_f32 v156, v156, v152
    v_mov_b32 v152, v157
    s_nop 1
    v_permlane16_swap_b32 v157, v152
    v_add_f32 v157, v157, v152
    v_mov_b32 v152, v157
    s_nop 1
    v_permlane32_swap_b32 v157, v152
    v_add_f32 v157, v157, v152
    v_mul_f32 v156, 991054117, v156
    v_mul_f32 v157, 991054117, v157
    v_fma_f32 v157, -v156, v156, v157
    v_max_f32 v157, 0, v157
    v_add_f32 v152, 925353388, v157
    v_rsq_f32 v153, v152
    s_nop 0
    v_mov_b32 v157, v153
    v_add_f32 v158, v24, v26
    v_add_f32 v159, v25, v27
    v_add_f32 v152, v28, v30
    v_add_f32 v153, v29, v31
    v_add_f32 v158, v158, v152
    v_add_f32 v159, v159, v153
    v_mov_b32 v152, v158
    s_nop 1
    v_permlane16_swap_b32 v158, v152
    v_add_f32 v158, v158, v152
    v_mov_b32 v152, v158
    s_nop 1
    v_permlane32_swap_b32 v158, v152
    v_add_f32 v158, v158, v152
    v_mov_b32 v152, v159
    s_nop 1
    v_permlane16_swap_b32 v159, v152
    v_add_f32 v159, v159, v152
    v_mov_b32 v152, v159
    s_nop 1
    v_permlane32_swap_b32 v159, v152
    v_add_f32 v159, v159, v152
    v_mul_f32 v158, 991054117, v158
    v_mul_f32 v159, 991054117, v159
    v_fma_f32 v159, -v158, v158, v159
    v_max_f32 v159, 0, v159
    v_add_f32 v152, 925353388, v159
    v_rsq_f32 v153, v152
    s_nop 0
    v_mov_b32 v159, v153
    v_add_f32 v160, v32, v34
    v_add_f32 v161, v33, v35
    v_add_f32 v152, v36, v38
    v_add_f32 v153, v37, v39
    v_add_f32 v160, v160, v152
    v_add_f32 v161, v161, v153
    v_mov_b32 v152, v160
    s_nop 1
    v_permlane16_swap_b32 v160, v152
    v_add_f32 v160, v160, v152
    v_mov_b32 v152, v160
    s_nop 1
    v_permlane32_swap_b32 v160, v152
    v_add_f32 v160, v160, v152
    v_mov_b32 v152, v161
    s_nop 1
    v_permlane16_swap_b32 v161, v152
    v_add_f32 v161, v161, v152
    v_mov_b32 v152, v161
    s_nop 1
    v_permlane32_swap_b32 v161, v152
    v_add_f32 v161, v161, v152
    v_mul_f32 v160, 991054117, v160
    v_mul_f32 v161, 991054117, v161
    v_fma_f32 v161, -v160, v160, v161
    v_max_f32 v161, 0, v161
    v_add_f32 v152, 925353388, v161
    v_rsq_f32 v153, v152
    s_nop 0
    v_mov_b32 v161, v153
    v_add_f32 v162, v40, v42
    v_add_f32 v163, v41, v43
    v_add_f32 v152, v44, v46
    v_add_f32 v153, v45, v47
    v_add_f32 v162, v162, v152
    v_add_f32 v163, v163, v153
    v_mov_b32 v152, v162
    s_nop 1
    v_permlane16_swap_b32 v162, v152
    v_add_f32 v162, v162, v152
    v_mov_b32 v152, v162
    s_nop 1
    v_permlane32_swap_b32 v162, v152
    v_add_f32 v162, v162, v152
    v_mov_b32 v152, v163
    s_nop 1
    v_permlane16_swap_b32 v163, v152
    v_add_f32 v163, v163, v152
    v_mov_b32 v152, v163
    s_nop 1
    v_permlane32_swap_b32 v163, v152
    v_add_f32 v163, v163, v152
    v_mul_f32 v162, 991054117, v162
    v_mul_f32 v163, 991054117, v163
    v_fma_f32 v163, -v162, v162, v163
    v_max_f32 v163, 0, v163
    v_add_f32 v152, 925353388, v163
    v_rsq_f32 v153, v152
    s_nop 0
    v_mov_b32 v163, v153
    v_add_f32 v164, v48, v50
    v_add_f32 v165, v49, v51
    v_add_f32 v152, v52, v54
    v_add_f32 v153, v53, v55
    v_add_f32 v164, v164, v152
    v_add_f32 v165, v165, v153
    v_mov_b32 v152, v164
    s_nop 1
    v_permlane16_swap_b32 v164, v152
    v_add_f32 v164, v164, v152
    v_mov_b32 v152, v164
    s_nop 1
    v_permlane32_swap_b32 v164, v152
    v_add_f32 v164, v164, v152
    v_mov_b32 v152, v165
    s_nop 1
    v_permlane16_swap_b32 v165, v152
    v_add_f32 v165, v165, v152
    v_mov_b32 v152, v165
    s_nop 1
    v_permlane32_swap_b32 v165, v152
    v_add_f32 v165, v165, v152
    v_mul_f32 v164, 991054117, v164
    v_mul_f32 v165, 991054117, v165
    v_fma_f32 v165, -v164, v164, v165
    v_max_f32 v165, 0, v165
    v_add_f32 v152, 925353388, v165
    v_rsq_f32 v153, v152
    s_nop 0
    v_mov_b32 v165, v153
    s_mov_b32 s54, 1027024659
    s_mov_b32 s55, 3222493025
    s_barrier
    s_mov_b32 s38, 400
    v_mul_lo_u32 v170, v2, s38
    s_mul_i32 s37, s86, 3
    s_add_u32 s37, s37, 0
    s_and_b32 s39, s37, 3
    s_lshl_b32 s39, s39, 4
    v_lshl_add_u32 v171, v3, 2, s39
    s_lshr_b32 s37, s37, 2
    s_lshl_b32 s37, s37, 7
    v_lshlrev_b32 v172, 1, v171
    v_add_u32 v172, s37, v172
    v_add_u32 v173, 8, v172
    v_cmp_le_u32 vcc, 28, v171
    s_nop 1
    v_cndmask_b32 v173, v172, v173, vcc
    v_add_u32 v173, v173, v170
    v_mov_b32 v172, 162816
    v_cmp_le_u32 vcc, 56, v171
    s_nop 1
    v_cndmask_b32 v173, v173, v172, vcc
    s_mul_i32 s37, s86, 3
    s_add_u32 s37, s37, 1
    s_and_b32 s39, s37, 3
    s_lshl_b32 s39, s39, 4
    v_lshl_add_u32 v171, v3, 2, s39
    s_lshr_b32 s37, s37, 2
    s_lshl_b32 s37, s37, 7
    v_lshlrev_b32 v172, 1, v171
    v_add_u32 v172, s37, v172
    v_add_u32 v174, 8, v172
    v_cmp_le_u32 vcc, 28, v171
    s_nop 1
    v_cndmask_b32 v174, v172, v174, vcc
    v_add_u32 v174, v174, v170
    v_mov_b32 v172, 162816
    v_cmp_le_u32 vcc, 56, v171
    s_nop 1
    v_cndmask_b32 v174, v174, v172, vcc
    s_mul_i32 s37, s86, 3
    s_add_u32 s37, s37, 2
    s_and_b32 s39, s37, 3
    s_lshl_b32 s39, s39, 4
    v_lshl_add_u32 v171, v3, 2, s39
    s_lshr_b32 s37, s37, 2
    s_lshl_b32 s37, s37, 7
    v_lshlrev_b32 v172, 1, v171
    v_add_u32 v172, s37, v172
    v_add_u32 v175, 8, v172
    v_cmp_le_u32 vcc, 28, v171
    s_nop 1
    v_cndmask_b32 v175, v172, v175, vcc
    v_add_u32 v175, v175, v170
    v_mov_b32 v172, 162816
    v_cmp_le_u32 vcc, 56, v171
    s_nop 1
    v_cndmask_b32 v175, v175, v172, vcc
    v_mov_b32 v176, 0
    v_mov_b32 v177, 0
    v_mul_u32_u24 v171, 43, v0
    v_lshrrev_b32 v171, 8, v171
    v_mul_u32_u24 v172, 6, v171
    v_sub_u32 v172, v0, v172
    v_lshlrev_b32 v172, 6, v172
    v_add_u32 v172, 56, v172
    v_add_u32 v170, 0, v171
    v_mul_u32_u24 v170, 400, v170
    v_add_u32 v170, v170, v172
    ds_write_b64 v170, v[176:177]
    v_add_u32 v170, 42, v171
    v_mul_u32_u24 v170, 400, v170
    v_add_u32 v170, v170, v172
    ds_write_b64 v170, v[176:177]
    v_pk_fma_f32 v[76:77], v[136:137], v[156:157], v[76:77] op_sel_hi:[1,0,1] neg_lo:[0,1,0] neg_hi:[0,1,0]
    v_pk_mul_f32 v[76:77], v[76:77], v[156:157] op_sel:[0,1] op_sel_hi:[1,1]
    v_pk_fma_f32 v[78:79], v[138:139], v[156:157], v[78:79] op_sel_hi:[1,0,1] neg_lo:[0,1,0] neg_hi:[0,1,0]
    v_pk_mul_f32 v[78:79], v[78:79], v[156:157] op_sel:[0,1] op_sel_hi:[1,1]
    v_cvt_pk_bf16_f32 v178, v76, v77
    v_cvt_pk_bf16_f32 v179, v78, v79
    ds_write_b64 v173, v[178:179] offset:0
    v_pk_fma_f32 v[80:81], v[140:141], v[156:157], v[80:81] op_sel_hi:[1,0,1] neg_lo:[0,1,0] neg_hi:[0,1,0]
    v_pk_mul_f32 v[80:81], v[80:81], v[156:157] op_sel:[0,1] op_sel_hi:[1,1]
    v_pk_fma_f32 v[82:83], v[142:143], v[156:157], v[82:83] op_sel_hi:[1,0,1] neg_lo:[0,1,0] neg_hi:[0,1,0]
    v_pk_mul_f32 v[82:83], v[82:83], v[156:157] op_sel:[0,1] op_sel_hi:[1,1]
    v_cvt_pk_bf16_f32 v180, v80, v81
    v_cvt_pk_bf16_f32 v181, v82, v83
    ds_write_b64 v174, v[180:181] offset:0
    v_pk_fma_f32 v[84:85], v[144:145], v[156:157], v[84:85] op_sel_hi:[1,0,1] neg_lo:[0,1,0] neg_hi:[0,1,0]
    v_pk_mul_f32 v[84:85], v[84:85], v[156:157] op_sel:[0,1] op_sel_hi:[1,1]
    v_pk_fma_f32 v[86:87], v[146:147], v[156:157], v[86:87] op_sel_hi:[1,0,1] neg_lo:[0,1,0] neg_hi:[0,1,0]
    v_pk_mul_f32 v[86:87], v[86:87], v[156:157] op_sel:[0,1] op_sel_hi:[1,1]
    v_cvt_pk_bf16_f32 v182, v84, v85
    v_cvt_pk_bf16_f32 v183, v86, v87
    ds_write_b64 v175, v[182:183] offset:0
    v_pk_fma_f32 v[88:89], v[136:137], v[158:159], v[88:89] op_sel_hi:[1,0,1] neg_lo:[0,1,0] neg_hi:[0,1,0]
    v_pk_mul_f32 v[88:89], v[88:89], v[158:159] op_sel:[0,1] op_sel_hi:[1,1]
    v_pk_fma_f32 v[90:91], v[138:139], v[158:159], v[90:91] op_sel_hi:[1,0,1] neg_lo:[0,1,0] neg_hi:[0,1,0]
    v_pk_mul_f32 v[90:91], v[90:91], v[158:159] op_sel:[0,1] op_sel_hi:[1,1]
    s_waitcnt lgkmcnt(0)
    v_cvt_pk_bf16_f32 v178, v88, v89
    v_cvt_pk_bf16_f32 v179, v90, v91
    ds_write_b64 v173, v[178:179] offset:6400
    v_pk_fma_f32 v[92:93], v[140:141], v[158:159], v[92:93] op_sel_hi:[1,0,1] neg_lo:[0,1,0] neg_hi:[0,1,0]
    v_pk_mul_f32 v[92:93], v[92:93], v[158:159] op_sel:[0,1] op_sel_hi:[1,1]
    v_pk_fma_f32 v[94:95], v[142:143], v[158:159], v[94:95] op_sel_hi:[1,0,1] neg_lo:[0,1,0] neg_hi:[0,1,0]
    v_pk_mul_f32 v[94:95], v[94:95], v[158:159] op_sel:[0,1] op_sel_hi:[1,1]
    s_waitcnt lgkmcnt(0)
    v_cvt_pk_bf16_f32 v180, v92, v93
    v_cvt_pk_bf16_f32 v181, v94, v95
    ds_write_b64 v174, v[180:181] offset:6400
    v_pk_fma_f32 v[96:97], v[144:145], v[158:159], v[96:97] op_sel_hi:[1,0,1] neg_lo:[0,1,0] neg_hi:[0,1,0]
    v_pk_mul_f32 v[96:97], v[96:97], v[158:159] op_sel:[0,1] op_sel_hi:[1,1]
    v_pk_fma_f32 v[98:99], v[146:147], v[158:159], v[98:99] op_sel_hi:[1,0,1] neg_lo:[0,1,0] neg_hi:[0,1,0]
    v_pk_mul_f32 v[98:99], v[98:99], v[158:159] op_sel:[0,1] op_sel_hi:[1,1]
    s_waitcnt lgkmcnt(0)
    v_cvt_pk_bf16_f32 v182, v96, v97
    v_cvt_pk_bf16_f32 v183, v98, v99
    ds_write_b64 v175, v[182:183] offset:6400
    v_pk_fma_f32 v[100:101], v[136:137], v[160:161], v[100:101] op_sel_hi:[1,0,1] neg_lo:[0,1,0] neg_hi:[0,1,0]
    v_pk_mul_f32 v[100:101], v[100:101], v[160:161] op_sel:[0,1] op_sel_hi:[1,1]
    v_pk_fma_f32 v[102:103], v[138:139], v[160:161], v[102:103] op_sel_hi:[1,0,1] neg_lo:[0,1,0] neg_hi:[0,1,0]
    v_pk_mul_f32 v[102:103], v[102:103], v[160:161] op_sel:[0,1] op_sel_hi:[1,1]
    s_waitcnt lgkmcnt(0)
    v_cvt_pk_bf16_f32 v178, v100, v101
    v_cvt_pk_bf16_f32 v179, v102, v103
    ds_write_b64 v173, v[178:179] offset:12800
    v_pk_fma_f32 v[104:105], v[140:141], v[160:161], v[104:105] op_sel_hi:[1,0,1] neg_lo:[0,1,0] neg_hi:[0,1,0]
    v_pk_mul_f32 v[104:105], v[104:105], v[160:161] op_sel:[0,1] op_sel_hi:[1,1]
    v_pk_fma_f32 v[106:107], v[142:143], v[160:161], v[106:107] op_sel_hi:[1,0,1] neg_lo:[0,1,0] neg_hi:[0,1,0]
    v_pk_mul_f32 v[106:107], v[106:107], v[160:161] op_sel:[0,1] op_sel_hi:[1,1]
    s_waitcnt lgkmcnt(0)
    v_cvt_pk_bf16_f32 v180, v104, v105
    v_cvt_pk_bf16_f32 v181, v106, v107
    ds_write_b64 v174, v[180:181] offset:12800
    v_pk_fma_f32 v[108:109], v[144:145], v[160:161], v[108:109] op_sel_hi:[1,0,1] neg_lo:[0,1,0] neg_hi:[0,1,0]
    v_pk_mul_f32 v[108:109], v[108:109], v[160:161] op_sel:[0,1] op_sel_hi:[1,1]
    v_pk_fma_f32 v[110:111], v[146:147], v[160:161], v[110:111] op_sel_hi:[1,0,1] neg_lo:[0,1,0] neg_hi:[0,1,0]
    v_pk_mul_f32 v[110:111], v[110:111], v[160:161] op_sel:[0,1] op_sel_hi:[1,1]
    s_waitcnt lgkmcnt(0)
    v_cvt_pk_bf16_f32 v182, v108, v109
    v_cvt_pk_bf16_f32 v183, v110, v111
    ds_write_b64 v175, v[182:183] offset:12800
    v_pk_fma_f32 v[112:113], v[136:137], v[162:163], v[112:113] op_sel_hi:[1,0,1] neg_lo:[0,1,0] neg_hi:[0,1,0]
    v_pk_mul_f32 v[112:113], v[112:113], v[162:163] op_sel:[0,1] op_sel_hi:[1,1]
    v_pk_fma_f32 v[114:115], v[138:139], v[162:163], v[114:115] op_sel_hi:[1,0,1] neg_lo:[0,1,0] neg_hi:[0,1,0]
    v_pk_mul_f32 v[114:115], v[114:115], v[162:163] op_sel:[0,1] op_sel_hi:[1,1]
    s_waitcnt lgkmcnt(0)
    v_cvt_pk_bf16_f32 v178, v112, v113
    v_cvt_pk_bf16_f32 v179, v114, v115
    ds_write_b64 v173, v[178:179] offset:19200
    v_pk_fma_f32 v[116:117], v[140:141], v[162:163], v[116:117] op_sel_hi:[1,0,1] neg_lo:[0,1,0] neg_hi:[0,1,0]
    v_pk_mul_f32 v[116:117], v[116:117], v[162:163] op_sel:[0,1] op_sel_hi:[1,1]
    v_pk_fma_f32 v[118:119], v[142:143], v[162:163], v[118:119] op_sel_hi:[1,0,1] neg_lo:[0,1,0] neg_hi:[0,1,0]
    v_pk_mul_f32 v[118:119], v[118:119], v[162:163] op_sel:[0,1] op_sel_hi:[1,1]
    s_waitcnt lgkmcnt(0)
    v_cvt_pk_bf16_f32 v180, v116, v117
    v_cvt_pk_bf16_f32 v181, v118, v119
    ds_write_b64 v174, v[180:181] offset:19200
    v_pk_fma_f32 v[120:121], v[144:145], v[162:163], v[120:121] op_sel_hi:[1,0,1] neg_lo:[0,1,0] neg_hi:[0,1,0]
    v_pk_mul_f32 v[120:121], v[120:121], v[162:163] op_sel:[0,1] op_sel_hi:[1,1]
    v_pk_fma_f32 v[122:123], v[146:147], v[162:163], v[122:123] op_sel_hi:[1,0,1] neg_lo:[0,1,0] neg_hi:[0,1,0]
    v_pk_mul_f32 v[122:123], v[122:123], v[162:163] op_sel:[0,1] op_sel_hi:[1,1]
    s_waitcnt lgkmcnt(0)
    v_cvt_pk_bf16_f32 v182, v120, v121
    v_cvt_pk_bf16_f32 v183, v122, v123
    ds_write_b64 v175, v[182:183] offset:19200
    v_pk_fma_f32 v[124:125], v[136:137], v[164:165], v[124:125] op_sel_hi:[1,0,1] neg_lo:[0,1,0] neg_hi:[0,1,0]
    v_pk_mul_f32 v[124:125], v[124:125], v[164:165] op_sel:[0,1] op_sel_hi:[1,1]
    v_pk_fma_f32 v[126:127], v[138:139], v[164:165], v[126:127] op_sel_hi:[1,0,1] neg_lo:[0,1,0] neg_hi:[0,1,0]
    v_pk_mul_f32 v[126:127], v[126:127], v[164:165] op_sel:[0,1] op_sel_hi:[1,1]
    s_waitcnt lgkmcnt(0)
    v_cvt_pk_bf16_f32 v178, v124, v125
    v_cvt_pk_bf16_f32 v179, v126, v127
    ds_write_b64 v173, v[178:179] offset:25600
    v_pk_fma_f32 v[128:129], v[140:141], v[164:165], v[128:129] op_sel_hi:[1,0,1] neg_lo:[0,1,0] neg_hi:[0,1,0]
    v_pk_mul_f32 v[128:129], v[128:129], v[164:165] op_sel:[0,1] op_sel_hi:[1,1]
    v_pk_fma_f32 v[130:131], v[142:143], v[164:165], v[130:131] op_sel_hi:[1,0,1] neg_lo:[0,1,0] neg_hi:[0,1,0]
    v_pk_mul_f32 v[130:131], v[130:131], v[164:165] op_sel:[0,1] op_sel_hi:[1,1]
    s_waitcnt lgkmcnt(0)
    v_cvt_pk_bf16_f32 v180, v128, v129
    v_cvt_pk_bf16_f32 v181, v130, v131
    ds_write_b64 v174, v[180:181] offset:25600
    v_pk_fma_f32 v[132:133], v[144:145], v[164:165], v[132:133] op_sel_hi:[1,0,1] neg_lo:[0,1,0] neg_hi:[0,1,0]
    v_pk_mul_f32 v[132:133], v[132:133], v[164:165] op_sel:[0,1] op_sel_hi:[1,1]
    v_pk_fma_f32 v[134:135], v[146:147], v[164:165], v[134:135] op_sel_hi:[1,0,1] neg_lo:[0,1,0] neg_hi:[0,1,0]
    v_pk_mul_f32 v[134:135], v[134:135], v[164:165] op_sel:[0,1] op_sel_hi:[1,1]
    s_waitcnt lgkmcnt(0)
    v_cvt_pk_bf16_f32 v182, v132, v133
    v_cvt_pk_bf16_f32 v183, v134, v135
    ds_write_b64 v175, v[182:183] offset:25600
    s_waitcnt lgkmcnt(0)
    s_barrier
    s_lshl_b32 s37, s86, 4
    s_add_u32 s37, s37, 16
    v_add_u32 v5, s37, v2
    v_mul_u32_u24 v8, 400, v5
    v_lshl_add_u32 v8, v3, 4, v8
    v_subrev_u32 v9, 6400, v8
    v_lshrrev_b32 v5, 2, v2
    v_lshl_add_u32 v5, v3, 3, v5
    s_lshl_b32 s37, s86, 4
    v_add_u32 v5, s37, v5
    v_mul_u32_u24 v10, 400, v5
    v_and_b32 v5, 3, v2
    v_lshl_add_u32 v10, v5, 3, v10
    v_lshlrev_b32 v5, 2, v3
    v_sub_u32 v11, v2, v5
    v_add_u32 v11, 16, v11
    s_lshl_b32 s37, s87, 6
    s_lshl_b32 s38, s86, 4
    s_add_u32 s37, s37, s38
    s_sub_u32 s37, s37, 16
    v_lshl_add_u32 v12, v3, 2, s37
    v_and_b32 v5, 1, v3
    v_lshl_add_u32 v13, v5, 5, v2
    v_lshlrev_b32 v13, 2, v13
    v_add_u32 v14, 64, v13
    s_lshl_b32 s37, s86, 4
    v_add_u32 v5, s37, v2
    v_mul_u32_u24 v15, 112, v5
    v_lshl_add_u32 v15, v3, 3, v15
    v_add_u32 v15, 40960, v15
    v_mov_b32 v16, 3463342888
    s_mov_b32 s39, 1049335798
    ds_read_b128 v[20:23], v8 offset:0
    ds_read_b128 v[24:27], v9 offset:128
    ds_read_b128 v[28:31], v8 offset:128
    ds_read_b64_tr_b16 v[40:41], v10 offset:256
    ds_read_b64_tr_b16 v[42:43], v10 offset:1856
    ds_read_b64_tr_b16 v[44:45], v10 offset:288
    ds_read_b64_tr_b16 v[46:47], v10 offset:1888
    v_mov_b32 v32, 0
    v_mov_b32 v64, 0
    v_mov_b32 v33, 0
    v_mov_b32 v65, 0
    v_mov_b32 v34, 0
    v_mov_b32 v66, 0
    v_mov_b32 v35, 0
    v_mov_b32 v67, 0
    v_mov_b32 v36, 0
    v_mov_b32 v68, 0
    v_mov_b32 v37, 0
    v_mov_b32 v69, 0
    v_mov_b32 v38, 0
    v_mov_b32 v70, 0
    v_mov_b32 v39, 0
    v_mov_b32 v71, 0
    s_waitcnt lgkmcnt(4)
    v_mfma_f32_16x16x32_bf16 v[32:35], v[24:27], v[20:23], v[32:35]
    v_mfma_f32_16x16x32_bf16 v[36:39], v[28:31], v[20:23], v[36:39]
    s_nop 7
    s_nop 1
    v_mul_f32 v32, s39, v32
    v_subrev_u32 v5, 0, v11
    v_and_b32 v5, 0xfffffff1, v5
    v_add_u32 v6, 0, v12
    v_ashrrev_i32 v6, 31, v6
    v_or_b32 v5, v5, v6
    v_cmp_eq_u32 vcc, 0, v5
    s_nop 1
    v_cndmask_b32 v32, v16, v32, vcc
    v_mul_f32 v33, s39, v33
    v_subrev_u32 v5, 1, v11
    v_and_b32 v5, 0xfffffff1, v5
    v_add_u32 v6, 1, v12
    v_ashrrev_i32 v6, 31, v6
    v_or_b32 v5, v5, v6
    v_cmp_eq_u32 vcc, 0, v5
    s_nop 1
    v_cndmask_b32 v33, v16, v33, vcc
    v_mul_f32 v34, s39, v34
    v_subrev_u32 v5, 2, v11
    v_and_b32 v5, 0xfffffff1, v5
    v_add_u32 v6, 2, v12
    v_ashrrev_i32 v6, 31, v6
    v_or_b32 v5, v5, v6
    v_cmp_eq_u32 vcc, 0, v5
    s_nop 1
    v_cndmask_b32 v34, v16, v34, vcc
    v_mul_f32 v35, s39, v35
    v_subrev_u32 v5, 3, v11
    v_and_b32 v5, 0xfffffff1, v5
    v_add_u32 v6, 3, v12
    v_ashrrev_i32 v6, 31, v6
    v_or_b32 v5, v5, v6
    v_cmp_eq_u32 vcc, 0, v5
    s_nop 1
    v_cndmask_b32 v35, v16, v35, vcc
    v_mul_f32 v36, s39, v36
    v_subrev_u32 v5, 16, v11
    v_and_b32 v5, 0xfffffff1, v5
    v_add_u32 v6, 16, v12
    v_ashrrev_i32 v6, 31, v6
    v_or_b32 v5, v5, v6
    v_cmp_eq_u32 vcc, 0, v5
    s_nop 1
    v_cndmask_b32 v36, v16, v36, vcc
    v_mul_f32 v37, s39, v37
    v_subrev_u32 v5, 17, v11
    v_and_b32 v5, 0xfffffff1, v5
    v_add_u32 v6, 17, v12
    v_ashrrev_i32 v6, 31, v6
    v_or_b32 v5, v5, v6
    v_cmp_eq_u32 vcc, 0, v5
    s_nop 1
    v_cndmask_b32 v37, v16, v37, vcc
    v_mul_f32 v38, s39, v38
    v_subrev_u32 v5, 18, v11
    v_and_b32 v5, 0xfffffff1, v5
    v_add_u32 v6, 18, v12
    v_ashrrev_i32 v6, 31, v6
    v_or_b32 v5, v5, v6
    v_cmp_eq_u32 vcc, 0, v5
    s_nop 1
    v_cndmask_b32 v38, v16, v38, vcc
    v_mul_f32 v39, s39, v39
    v_subrev_u32 v5, 19, v11
    v_and_b32 v5, 0xfffffff1, v5
    v_add_u32 v6, 19, v12
    v_ashrrev_i32 v6, 31, v6
    v_or_b32 v5, v5, v6
    v_cmp_eq_u32 vcc, 0, v5
    s_nop 1
    v_cndmask_b32 v39, v16, v39, vcc
    v_max3_f32 v72, v32, v33, v34
    v_max3_f32 v72, v35, v36, v72
    v_max3_f32 v72, v37, v38, v72
    v_max_f32 v72, v39, v72
    v_mov_b32 v5, v72
    s_nop 1
    v_permlane16_swap_b32 v72, v5
    v_max_f32 v72, v72, v5
    v_mov_b32 v5, v72
    s_nop 1
    v_permlane32_swap_b32 v72, v5
    v_max_f32 v72, v72, v5
    v_sub_f32 v32, v32, v72
    v_exp_f32 v32, v32
    v_sub_f32 v33, v33, v72
    v_exp_f32 v33, v33
    v_sub_f32 v34, v34, v72
    v_exp_f32 v34, v34
    v_sub_f32 v35, v35, v72
    v_exp_f32 v35, v35
    v_sub_f32 v36, v36, v72
    v_exp_f32 v36, v36
    v_sub_f32 v37, v37, v72
    v_exp_f32 v37, v37
    v_sub_f32 v38, v38, v72
    v_exp_f32 v38, v38
    v_sub_f32 v39, v39, v72
    v_exp_f32 v39, v39
    s_nop 0
    v_add_f32 v73, v32, v33
    v_add_f32 v73, v73, v34
    v_add_f32 v73, v73, v35
    v_add_f32 v73, v73, v36
    v_add_f32 v73, v73, v37
    v_add_f32 v73, v73, v38
    v_add_f32 v73, v73, v39
    v_mov_b32 v5, v73
    s_nop 1
    v_permlane16_swap_b32 v73, v5
    v_add_f32 v73, v73, v5
    v_mov_b32 v5, v73
    s_nop 1
    v_permlane32_swap_b32 v73, v5
    v_add_f32 v73, v73, v5
    v_rcp_f32 v73, v73
    s_nop 0
    v_mul_f32 v32, v32, v73
    v_mul_f32 v33, v33, v73
    v_mul_f32 v34, v34, v73
    v_mul_f32 v35, v35, v73
    v_mul_f32 v36, v36, v73
    v_mul_f32 v37, v37, v73
    v_mul_f32 v38, v38, v73
    v_mul_f32 v39, v39, v73
    v_cvt_pk_bf16_f32 v48, v32, v33
    v_cvt_pk_bf16_f32 v49, v34, v35
    v_cvt_pk_bf16_f32 v50, v36, v37
    v_cvt_pk_bf16_f32 v51, v38, v39
    ds_bpermute_b32 v52, v13, v48
    ds_bpermute_b32 v56, v14, v48
    ds_bpermute_b32 v53, v13, v49
    ds_bpermute_b32 v57, v14, v49
    ds_bpermute_b32 v54, v13, v50
    ds_bpermute_b32 v58, v14, v50
    ds_bpermute_b32 v55, v13, v51
    ds_bpermute_b32 v59, v14, v51
    v_cmp_le_u32 vcc, 2, v3
    s_waitcnt lgkmcnt(0)
    v_cndmask_b32 v60, v52, v54, vcc
    v_cndmask_b32 v61, v53, v55, vcc
    v_cndmask_b32 v62, v56, v58, vcc
    v_cndmask_b32 v63, v57, v59, vcc
    s_nop 1
    v_mfma_f32_16x16x32_bf16 v[64:67], v[40:43], v[60:63], v[64:67]
    v_mfma_f32_16x16x32_bf16 v[68:71], v[44:47], v[60:63], v[68:71]
    s_nop 7
    s_nop 1
    v_cvt_pk_bf16_f32 v74, v64, v65
    v_cvt_pk_bf16_f32 v75, v66, v67
    ds_write_b64 v15, v[74:75] offset:0
    s_waitcnt lgkmcnt(0)
    v_cvt_pk_bf16_f32 v74, v68, v69
    v_cvt_pk_bf16_f32 v75, v70, v71
    s_mov_b32 exec_hi, 0x0000ffff
    ds_write_b64 v15, v[74:75] offset:32
    s_mov_b64 exec, -1
    s_waitcnt lgkmcnt(0)
    ds_read_b128 v[20:23], v8 offset:64
    ds_read_b128 v[24:27], v9 offset:192
    ds_read_b128 v[28:31], v8 offset:192
    ds_read_b64_tr_b16 v[40:41], v10 offset:320
    ds_read_b64_tr_b16 v[42:43], v10 offset:1920
    ds_read_b64_tr_b16 v[44:45], v10 offset:352
    ds_read_b64_tr_b16 v[46:47], v10 offset:1952
    v_mov_b32 v32, 0
    v_mov_b32 v64, 0
    v_mov_b32 v33, 0
    v_mov_b32 v65, 0
    v_mov_b32 v34, 0
    v_mov_b32 v66, 0
    v_mov_b32 v35, 0
    v_mov_b32 v67, 0
    v_mov_b32 v36, 0
    v_mov_b32 v68, 0
    v_mov_b32 v37, 0
    v_mov_b32 v69, 0
    v_mov_b32 v38, 0
    v_mov_b32 v70, 0
    v_mov_b32 v39, 0
    v_mov_b32 v71, 0
    s_waitcnt lgkmcnt(4)
    v_mfma_f32_16x16x32_bf16 v[32:35], v[24:27], v[20:23], v[32:35]
    v_mfma_f32_16x16x32_bf16 v[36:39], v[28:31], v[20:23], v[36:39]
    s_nop 7
    s_nop 1
    v_mul_f32 v32, s39, v32
    v_subrev_u32 v5, 0, v11
    v_and_b32 v5, 0xfffffff1, v5
    v_add_u32 v6, 0, v12
    v_ashrrev_i32 v6, 31, v6
    v_or_b32 v5, v5, v6
    v_cmp_eq_u32 vcc, 0, v5
    s_nop 1
    v_cndmask_b32 v32, v16, v32, vcc
    v_mul_f32 v33, s39, v33
    v_subrev_u32 v5, 1, v11
    v_and_b32 v5, 0xfffffff1, v5
    v_add_u32 v6, 1, v12
    v_ashrrev_i32 v6, 31, v6
    v_or_b32 v5, v5, v6
    v_cmp_eq_u32 vcc, 0, v5
    s_nop 1
    v_cndmask_b32 v33, v16, v33, vcc
    v_mul_f32 v34, s39, v34
    v_subrev_u32 v5, 2, v11
    v_and_b32 v5, 0xfffffff1, v5
    v_add_u32 v6, 2, v12
    v_ashrrev_i32 v6, 31, v6
    v_or_b32 v5, v5, v6
    v_cmp_eq_u32 vcc, 0, v5
    s_nop 1
    v_cndmask_b32 v34, v16, v34, vcc
    v_mul_f32 v35, s39, v35
    v_subrev_u32 v5, 3, v11
    v_and_b32 v5, 0xfffffff1, v5
    v_add_u32 v6, 3, v12
    v_ashrrev_i32 v6, 31, v6
    v_or_b32 v5, v5, v6
    v_cmp_eq_u32 vcc, 0, v5
    s_nop 1
    v_cndmask_b32 v35, v16, v35, vcc
    v_mul_f32 v36, s39, v36
    v_subrev_u32 v5, 16, v11
    v_and_b32 v5, 0xfffffff1, v5
    v_add_u32 v6, 16, v12
    v_ashrrev_i32 v6, 31, v6
    v_or_b32 v5, v5, v6
    v_cmp_eq_u32 vcc, 0, v5
    s_nop 1
    v_cndmask_b32 v36, v16, v36, vcc
    v_mul_f32 v37, s39, v37
    v_subrev_u32 v5, 17, v11
    v_and_b32 v5, 0xfffffff1, v5
    v_add_u32 v6, 17, v12
    v_ashrrev_i32 v6, 31, v6
    v_or_b32 v5, v5, v6
    v_cmp_eq_u32 vcc, 0, v5
    s_nop 1
    v_cndmask_b32 v37, v16, v37, vcc
    v_mul_f32 v38, s39, v38
    v_subrev_u32 v5, 18, v11
    v_and_b32 v5, 0xfffffff1, v5
    v_add_u32 v6, 18, v12
    v_ashrrev_i32 v6, 31, v6
    v_or_b32 v5, v5, v6
    v_cmp_eq_u32 vcc, 0, v5
    s_nop 1
    v_cndmask_b32 v38, v16, v38, vcc
    v_mul_f32 v39, s39, v39
    v_subrev_u32 v5, 19, v11
    v_and_b32 v5, 0xfffffff1, v5
    v_add_u32 v6, 19, v12
    v_ashrrev_i32 v6, 31, v6
    v_or_b32 v5, v5, v6
    v_cmp_eq_u32 vcc, 0, v5
    s_nop 1
    v_cndmask_b32 v39, v16, v39, vcc
    v_max3_f32 v72, v32, v33, v34
    v_max3_f32 v72, v35, v36, v72
    v_max3_f32 v72, v37, v38, v72
    v_max_f32 v72, v39, v72
    v_mov_b32 v5, v72
    s_nop 1
    v_permlane16_swap_b32 v72, v5
    v_max_f32 v72, v72, v5
    v_mov_b32 v5, v72
    s_nop 1
    v_permlane32_swap_b32 v72, v5
    v_max_f32 v72, v72, v5
    v_sub_f32 v32, v32, v72
    v_exp_f32 v32, v32
    v_sub_f32 v33, v33, v72
    v_exp_f32 v33, v33
    v_sub_f32 v34, v34, v72
    v_exp_f32 v34, v34
    v_sub_f32 v35, v35, v72
    v_exp_f32 v35, v35
    v_sub_f32 v36, v36, v72
    v_exp_f32 v36, v36
    v_sub_f32 v37, v37, v72
    v_exp_f32 v37, v37
    v_sub_f32 v38, v38, v72
    v_exp_f32 v38, v38
    v_sub_f32 v39, v39, v72
    v_exp_f32 v39, v39
    s_nop 0
    v_add_f32 v73, v32, v33
    v_add_f32 v73, v73, v34
    v_add_f32 v73, v73, v35
    v_add_f32 v73, v73, v36
    v_add_f32 v73, v73, v37
    v_add_f32 v73, v73, v38
    v_add_f32 v73, v73, v39
    v_mov_b32 v5, v73
    s_nop 1
    v_permlane16_swap_b32 v73, v5
    v_add_f32 v73, v73, v5
    v_mov_b32 v5, v73
    s_nop 1
    v_permlane32_swap_b32 v73, v5
    v_add_f32 v73, v73, v5
    v_rcp_f32 v73, v73
    s_nop 0
    v_mul_f32 v32, v32, v73
    v_mul_f32 v33, v33, v73
    v_mul_f32 v34, v34, v73
    v_mul_f32 v35, v35, v73
    v_mul_f32 v36, v36, v73
    v_mul_f32 v37, v37, v73
    v_mul_f32 v38, v38, v73
    v_mul_f32 v39, v39, v73
    v_cvt_pk_bf16_f32 v48, v32, v33
    v_cvt_pk_bf16_f32 v49, v34, v35
    v_cvt_pk_bf16_f32 v50, v36, v37
    v_cvt_pk_bf16_f32 v51, v38, v39
    ds_bpermute_b32 v52, v13, v48
    ds_bpermute_b32 v56, v14, v48
    ds_bpermute_b32 v53, v13, v49
    ds_bpermute_b32 v57, v14, v49
    ds_bpermute_b32 v54, v13, v50
    ds_bpermute_b32 v58, v14, v50
    ds_bpermute_b32 v55, v13, v51
    ds_bpermute_b32 v59, v14, v51
    v_cmp_le_u32 vcc, 2, v3
    s_waitcnt lgkmcnt(0)
    v_cndmask_b32 v60, v52, v54, vcc
    v_cndmask_b32 v61, v53, v55, vcc
    v_cndmask_b32 v62, v56, v58, vcc
    v_cndmask_b32 v63, v57, v59, vcc
    s_nop 1
    v_mfma_f32_16x16x32_bf16 v[64:67], v[40:43], v[60:63], v[64:67]
    v_mfma_f32_16x16x32_bf16 v[68:71], v[44:47], v[60:63], v[68:71]
    s_nop 7
    s_nop 1
    v_cvt_pk_bf16_f32 v74, v64, v65
    v_cvt_pk_bf16_f32 v75, v66, v67
    ds_write_b64 v15, v[74:75] offset:56
    s_waitcnt lgkmcnt(0)
    v_cvt_pk_bf16_f32 v74, v68, v69
    v_cvt_pk_bf16_f32 v75, v70, v71
    s_mov_b32 exec_hi, 0x0000ffff
    ds_write_b64 v15, v[74:75] offset:88
    s_mov_b64 exec, -1
    s_waitcnt lgkmcnt(0)
    s_barrier
    s_add_u32 s16, s84, 13631488
    s_addc_u32 s17, s85, 0
    s_mov_b32 s18, 1835008
    s_mov_b32 s19, 0x00020000
    v_mul_u32_u24 v76, 37, v1
    v_lshrrev_b32 v76, 8, v76
    v_mul_u32_u24 v5, 7, v76
    v_sub_u32 v77, v1, v5
    s_lshl_b32 s37, s86, 4
    v_add_u32 v76, s37, v76
    v_mul_u32_u24 v78, 112, v76
    v_lshl_add_u32 v78, v77, 4, v78
    v_add_u32 v78, 40960, v78
    s_lshl_b32 s37, s87, 6
    v_add_u32 v79, s37, v76
    v_mul_u32_u24 v79, 896, v79
    v_lshl_add_u32 v79, v77, 4, v79
    s_mul_i32 s37, s88, 112
    v_add_u32 v79, s37, v79
    s_mov_b32 exec_hi, 0x00ffffff
    ds_read_b128 v[80:83], v78 offset:0
    s_waitcnt lgkmcnt(0)
    s_mov_b32 s37, 0
    s_cmp_eq_u32 s91, 1
    s_cbranch_scc1 Ls39_p
    buffer_store_dwordx4 v[80:83], v79, s[16:19], s37 offen sc1
    s_branch Ls39_d
Ls39_p:
    buffer_store_dwordx4 v[80:83], v79, s[16:19], s37 offen
Ls39_d:
    s_nop 1
    ds_read_b128 v[80:83], v78 offset:896
    s_waitcnt lgkmcnt(0)
    s_mov_b32 s37, 7168
    s_cmp_eq_u32 s91, 1
    s_cbranch_scc1 Ls40_p
    buffer_store_dwordx4 v[80:83], v79, s[16:19], s37 offen sc1
    s_branch Ls40_d
Ls40_p:
    buffer_store_dwordx4 v[80:83], v79, s[16:19], s37 offen
Ls40_d:
    s_nop 1
    s_mov_b64 exec, -1
    s_waitcnt vmcnt(0)
    s_lshl_b32 s32, s89, 7
    s_lshl_b32 s33, s86, 2
    s_add_u32 s32, s32, s33
    v_mov_b32 v84, s32
    v_mov_b32 v85, 8
    s_mov_b64 exec, 1
    s_mov_b32 s57, s91
    s_cmp_eq_u32 s57, 1
    s_cbranch_scc1 Ls41_p
    buffer_store_dword v85, v84, s[24:27], 0 offen sc1
    s_branch Ls41_d
Ls41_p:
    buffer_store_dword v85, v84, s[24:27], 0 offen
Ls41_d:
    s_mov_b64 exec, -1
    s_barrier
    s_add_u32 s8, s84, 13631488
    s_addc_u32 s9, s85, 0
    s_mov_b32 s10, 1835008
    s_mov_b32 s11, 0x00020000
    s_mov_b32 s12, s68
    s_mov_b32 s13, s69
    s_mov_b32 s14, 401408
    s_mov_b32 s15, 0x00020000
    s_lshl_b32 s32, s86, 10
    s_and_b32 s40, s86, 1
    s_add_u32 s33, s40, 8
    s_mul_i32 s34, s86, 7168
    s_mul_i32 s35, s86, 7168
    s_mul_i32 s36, s88, 112
    v_lshrrev_b32 v5, 3, v1
    v_lshrrev_b32 v7, 4, v1
    s_lshl_b32 s37, s40, 2
    v_add_u32 v7, s37, v7
    v_and_b32 v6, 7, v1
    v_xor_b32 v6, v6, v7
    s_lshl_b32 s37, s87, 6
    s_lshl_b32 s38, s86, 3
    s_add_u32 s38, s38, 0
    s_add_u32 s38, s38, s37
    v_add_u32 v7, s38, v5
    s_mov_b32 s39, 896
    v_mul_lo_u32 v7, v7, s39
    v_lshl_add_u32 v9, v6, 4, v7
    s_lshl_b32 s38, s86, 3
    s_add_u32 s38, s38, 32
    s_add_u32 s38, s38, s37
    v_add_u32 v7, s38, v5
    s_mov_b32 s39, 896
    v_mul_lo_u32 v7, v7, s39
    v_lshl_add_u32 v10, v6, 4, v7
    v_bfe_u32 v7, v1, 4, 1
    v_lshlrev_b32 v7, 1, v7
    s_lshl_b32 s37, s40, 2
    v_add_u32 v7, s37, v7
    v_and_b32 v8, 7, v1
    v_xor_b32 v8, v8, v7
    s_mov_b32 s39, 896
    v_mul_lo_u32 v7, v5, s39
    v_lshl_add_u32 v11, v8, 4, v7
    s_add_u32 s42, s36, 0
    s_cmp_lg_u32 s86, 0
    s_cbranch_scc1 Lp42_skip
    v_lshrrev_b32 v13, 3, v1
    v_add_u32 v13, s87, v13
    v_add_u32 v13, 0, v13
    v_mov_b32 v14, s87
    v_cmp_gt_u32 vcc, 32, v13
    s_nop 1
    v_cndmask_b32 v13, v14, v13, vcc
    v_and_b32 v12, 7, v1
    v_lshlrev_b32 v12, 5, v12
    v_and_b32 v14, 3, v13
    v_lshl_add_u32 v12, v14, 3, v12
    v_lshrrev_b32 v14, 2, v13
    v_add_u32 v12, v12, v14
    v_lshlrev_b32 v12, 7, v12
    v_add_u32 v12, 0, v12
    v_mov_b32 v20, 0
    s_mov_b32 s52, 0
    s_mov_b32 s53, 8
    s_mov_b32 exec_lo, 255
    s_mov_b32 exec_hi, 0
Lp42_loop:
    buffer_load_dwordx4 v[16:19], v12, s[24:27], 0 offen sc1
    s_waitcnt vmcnt(0)
    v_min_u32 v16, v16, v17
    v_min_u32 v18, v18, v19
    v_min_u32 v16, v16, v18
    v_cmp_gt_u32 vcc, s53, v16
    s_cbranch_vccz Lp42_ok
Lp42_again:
    s_add_u32 s52, s52, 1
    s_cmp_lt_u32 s52, 20000
    s_cbranch_scc1 Lp42_loop
Lp42_ok:
    s_mov_b64 exec, -1
Lp42_skip:
    s_barrier
    s_add_u32 m0, s32, 0
    s_nop 0
    s_mov_b32 s37, 0
    buffer_load_dwordx4 v9, s[8:11], s37 offen lds
    s_add_u32 m0, s32, 4096
    s_nop 0
    s_mov_b32 s37, 0
    buffer_load_dwordx4 v10, s[8:11], s37 offen lds
    s_add_u32 m0, s32, 8192
    s_nop 0
    s_mov_b32 s37, 128
    buffer_load_dwordx4 v9, s[8:11], s37 offen lds
    s_add_u32 m0, s32, 12288
    s_nop 0
    s_mov_b32 s37, 128
    buffer_load_dwordx4 v10, s[8:11], s37 offen lds
    s_add_u32 m0, s32, 16384
    s_nop 0
    s_mov_b32 s37, 256
    buffer_load_dwordx4 v9, s[8:11], s37 offen lds
    s_add_u32 m0, s32, 20480
    s_nop 0
    s_mov_b32 s37, 256
    buffer_load_dwordx4 v10, s[8:11], s37 offen lds
    s_add_u32 m0, s32, 24576
    s_nop 0
    s_mov_b32 s37, 384
    buffer_load_dwordx4 v9, s[8:11], s37 offen lds
    s_add_u32 m0, s32, 28672
    s_nop 0
    s_mov_b32 s37, 384
    buffer_load_dwordx4 v10, s[8:11], s37 offen lds
    s_add_u32 m0, s32, 32768
    s_nop 0
    s_mov_b32 s37, 512
    buffer_load_dwordx4 v9, s[8:11], s37 offen lds
    s_add_u32 m0, s32, 36864
    s_nop 0
    s_mov_b32 s37, 512
    buffer_load_dwordx4 v10, s[8:11], s37 offen lds
    s_add_u32 m0, s32, 40960
    s_nop 0
    s_mov_b32 s37, 640
    buffer_load_dwordx4 v9, s[8:11], s37 offen lds
    s_add_u32 m0, s32, 45056
    s_nop 0
    s_mov_b32 s37, 640
    buffer_load_dwordx4 v10, s[8:11], s37 offen lds
    s_add_u32 m0, s32, 49152
    s_nop 0
    s_mov_b32 s37, 768
    buffer_load_dwordx4 v9, s[8:11], s37 offen lds
    s_add_u32 m0, s32, 53248
    s_nop 0
    s_mov_b32 s37, 768
    buffer_load_dwordx4 v10, s[8:11], s37 offen lds
    s_lshl_b32 s37, s87, 6
    s_lshr_b32 s38, s86, 1
    s_mul_i32 s38, s38, 32
    s_add_u32 s37, s37, s38
    v_add_u32 v13, s37, v2
    s_mov_b32 s38, 896
    v_mul_lo_u32 v13, v13, s38
    v_lshl_add_u32 v12, v3, 3, v13
    s_and_b32 s37, s86, 1
    s_lshl_b32 s37, s37, 6
    s_mul_i32 s38, s88, 112
    s_add_u32 s37, s37, s38
    v_add_u32 v12, s37, v12
    s_add_u32 s20, s84, 9437184
    s_addc_u32 s21, s85, 0
    s_mov_b32 s22, 1835008
    s_mov_b32 s23, 0x00020000
    s_mov_b32 s37, 0
    buffer_load_dwordx2 v[14:15], v12, s[20:23], s37 offen offset:0
    buffer_load_dwordx2 v[16:17], v12, s[20:23], s37 offen offset:32
    s_mov_b32 s37, 14336
    buffer_load_dwordx2 v[18:19], v12, s[20:23], s37 offen offset:0
    buffer_load_dwordx2 v[20:21], v12, s[20:23], s37 offen offset:32
    v_lshrrev_b32 v7, 1, v2
    v_and_b32 v7, 7, v7
    v_add_u32 v8, 0, v3
    v_xor_b32 v8, v8, v7
    v_lshlrev_b32 v8, 4, v8
    v_lshl_add_u32 v22, v2, 7, v8
    v_add_u32 v8, 4, v3
    v_xor_b32 v8, v8, v7
    v_lshlrev_b32 v8, 4, v8
    v_lshl_add_u32 v23, v2, 7, v8
    s_lshr_b32 s37, s86, 1
    s_mul_i32 s37, s37, 4096
    v_add_u32 v22, s37, v22
    v_add_u32 v23, s37, v23
    v_lshrrev_b32 v26, 2, v2
    v_lshl_add_u32 v26, v3, 3, v26
    v_lshlrev_b32 v26, 7, v26
    v_bfe_u32 v27, v2, 3, 1
    v_lshlrev_b32 v27, 2, v27
    v_and_b32 v7, 1, v3
    v_lshl_add_u32 v27, v7, 3, v27
    v_and_b32 v28, 3, v2
    s_and_b32 s37, s86, 1
    s_mul_i32 s37, s37, 2
    s_add_u32 s38, s37, 0
    s_and_b32 s39, s38, 3
    s_lshl_b32 s39, s39, 2
    v_add_u32 v7, s39, v28
    v_xor_b32 v7, v7, v27
    v_lshl_add_u32 v7, v7, 3, v26
    s_lshr_b32 s38, s38, 2
    s_lshl_b32 s38, s38, 13
    v_add_u32 v24, s38, v7
    s_add_u32 s38, s37, 1
    s_and_b32 s39, s38, 3
    s_lshl_b32 s39, s39, 2
    v_add_u32 v7, s39, v28
    v_xor_b32 v7, v7, v27
    v_lshl_add_u32 v7, v7, 3, v26
    s_lshr_b32 s38, s38, 2
    s_lshl_b32 s38, s38, 13
    v_add_u32 v25, s38, v7
    v_add_u32 v29, 65536, v22
    v_add_u32 v30, 65536, v23
    v_add_u32 v31, 65536, v24
    v_add_u32 v32, 65536, v25
    v_mov_b32 v36, 0
    v_mov_b32 v37, 0
    v_mov_b32 v38, 0
    v_mov_b32 v39, 0
    v_mov_b32 v40, 0
    v_mov_b32 v41, 0
    v_mov_b32 v42, 0
    v_mov_b32 v43, 0
    v_mov_b32 v44, 0
    v_mov_b32 v45, 0
    v_mov_b32 v46, 0
    v_mov_b32 v47, 0
    v_mov_b32 v48, 0
    v_mov_b32 v49, 0
    v_mov_b32 v50, 0
    v_mov_b32 v51, 0
    s_waitcnt vmcnt(14)
    s_barrier
    ds_read_b128 v[52:55], v22 offset:0
    ds_read_b128 v[56:59], v22 offset:2048
    ds_read_b64_tr_b16 v[68:69], v24 offset:57344
    ds_read_b64_tr_b16 v[70:71], v24 offset:57856
    ds_read_b64_tr_b16 v[72:73], v25 offset:57344
    ds_read_b64_tr_b16 v[74:75], v25 offset:57856
    s_waitcnt lgkmcnt(0)
    v_mfma_f32_16x16x32_bf16 v[36:39], v[68:71], v[52:55], v[36:39]
    ds_read_b128 v[60:63], v23 offset:0
    ds_read_b128 v[64:67], v23 offset:2048
    ds_read_b64_tr_b16 v[76:77], v24 offset:61440
    v_mfma_f32_16x16x32_bf16 v[44:47], v[68:71], v[56:59], v[44:47]
    ds_read_b64_tr_b16 v[78:79], v24 offset:61952
    ds_read_b64_tr_b16 v[80:81], v25 offset:61440
    ds_read_b64_tr_b16 v[82:83], v25 offset:61952
    v_mfma_f32_16x16x32_bf16 v[40:43], v[72:75], v[52:55], v[40:43]
    v_mfma_f32_16x16x32_bf16 v[48:51], v[72:75], v[56:59], v[48:51]
    s_waitcnt lgkmcnt(0)
    v_mfma_f32_16x16x32_bf16 v[36:39], v[76:79], v[60:63], v[36:39]
    ds_read_b128 v[52:55], v22 offset:8192
    ds_read_b128 v[56:59], v22 offset:10240
    ds_read_b64_tr_b16 v[68:69], v31 offset:0
    v_mfma_f32_16x16x32_bf16 v[44:47], v[76:79], v[64:67], v[44:47]
    ds_read_b64_tr_b16 v[70:71], v31 offset:512
    ds_read_b64_tr_b16 v[72:73], v32 offset:0
    ds_read_b64_tr_b16 v[74:75], v32 offset:512
    v_mfma_f32_16x16x32_bf16 v[40:43], v[80:83], v[60:63], v[40:43]
    v_mfma_f32_16x16x32_bf16 v[48:51], v[80:83], v[64:67], v[48:51]
    s_waitcnt lgkmcnt(0)
    v_mfma_f32_16x16x32_bf16 v[36:39], v[68:71], v[52:55], v[36:39]
    ds_read_b128 v[60:63], v23 offset:8192
    ds_read_b128 v[64:67], v23 offset:10240
    ds_read_b64_tr_b16 v[76:77], v31 offset:4096
    v_mfma_f32_16x16x32_bf16 v[44:47], v[68:71], v[56:59], v[44:47]
    ds_read_b64_tr_b16 v[78:79], v31 offset:4608
    ds_read_b64_tr_b16 v[80:81], v32 offset:4096
    ds_read_b64_tr_b16 v[82:83], v32 offset:4608
    v_mfma_f32_16x16x32_bf16 v[40:43], v[72:75], v[52:55], v[40:43]
    v_mfma_f32_16x16x32_bf16 v[48:51], v[72:75], v[56:59], v[48:51]
    s_waitcnt lgkmcnt(0)
    s_waitcnt vmcnt(8)
    s_barrier
    v_mfma_f32_16x16x32_bf16 v[36:39], v[76:79], v[60:63], v[36:39]
    ds_read_b128 v[52:55], v22 offset:16384
    ds_read_b128 v[56:59], v22 offset:18432
    ds_read_b64_tr_b16 v[68:69], v31 offset:8192
    v_mfma_f32_16x16x32_bf16 v[44:47], v[76:79], v[64:67], v[44:47]
    ds_read_b64_tr_b16 v[70:71], v31 offset:8704
    ds_read_b64_tr_b16 v[72:73], v32 offset:8192
    ds_read_b64_tr_b16 v[74:75], v32 offset:8704
    v_mfma_f32_16x16x32_bf16 v[40:43], v[80:83], v[60:63], v[40:43]
    v_mfma_f32_16x16x32_bf16 v[48:51], v[80:83], v[64:67], v[48:51]
    s_waitcnt lgkmcnt(0)
    v_mfma_f32_16x16x32_bf16 v[36:39], v[68:71], v[52:55], v[36:39]
    ds_read_b128 v[60:63], v23 offset:16384
    ds_read_b128 v[64:67], v23 offset:18432
    ds_read_b64_tr_b16 v[76:77], v31 offset:12288
    v_mfma_f32_16x16x32_bf16 v[44:47], v[68:71], v[56:59], v[44:47]
    ds_read_b64_tr_b16 v[78:79], v31 offset:12800
    ds_read_b64_tr_b16 v[80:81], v32 offset:12288
    ds_read_b64_tr_b16 v[82:83], v32 offset:12800
    v_mfma_f32_16x16x32_bf16 v[40:43], v[72:75], v[52:55], v[40:43]
    v_mfma_f32_16x16x32_bf16 v[48:51], v[72:75], v[56:59], v[48:51]
    s_waitcnt lgkmcnt(0)
    v_mfma_f32_16x16x32_bf16 v[36:39], v[76:79], v[60:63], v[36:39]
    ds_read_b128 v[52:55], v22 offset:24576
    ds_read_b128 v[56:59], v22 offset:26624
    ds_read_b64_tr_b16 v[68:69], v31 offset:16384
    v_mfma_f32_16x16x32_bf16 v[44:47], v[76:79], v[64:67], v[44:47]
    ds_read_b64_tr_b16 v[70:71], v31 offset:16896
    ds_read_b64_tr_b16 v[72:73], v32 offset:16384
    ds_read_b64_tr_b16 v[74:75], v32 offset:16896
    v_mfma_f32_16x16x32_bf16 v[40:43], v[80:83], v[60:63], v[40:43]
    v_mfma_f32_16x16x32_bf16 v[48:51], v[80:83], v[64:67], v[48:51]
    s_waitcnt lgkmcnt(0)
    v_mfma_f32_16x16x32_bf16 v[36:39], v[68:71], v[52:55], v[36:39]
    ds_read_b128 v[60:63], v23 offset:24576
    ds_read_b128 v[64:67], v23 offset:26624
    ds_read_b64_tr_b16 v[76:77], v31 offset:20480
    v_mfma_f32_16x16x32_bf16 v[44:47], v[68:71], v[56:59], v[44:47]
    ds_read_b64_tr_b16 v[78:79], v31 offset:20992
    ds_read_b64_tr_b16 v[80:81], v32 offset:20480
    ds_read_b64_tr_b16 v[82:83], v32 offset:20992
    v_mfma_f32_16x16x32_bf16 v[40:43], v[72:75], v[52:55], v[40:43]
    v_mfma_f32_16x16x32_bf16 v[48:51], v[72:75], v[56:59], v[48:51]
    s_waitcnt lgkmcnt(0)
    v_mfma_f32_16x16x32_bf16 v[36:39], v[76:79], v[60:63], v[36:39]
    ds_read_b128 v[52:55], v22 offset:32768
    ds_read_b128 v[56:59], v22 offset:34816
    ds_read_b64_tr_b16 v[68:69], v31 offset:24576
    v_mfma_f32_16x16x32_bf16 v[44:47], v[76:79], v[64:67], v[44:47]
    ds_read_b64_tr_b16 v[70:71], v31 offset:25088
    ds_read_b64_tr_b16 v[72:73], v32 offset:24576
    ds_read_b64_tr_b16 v[74:75], v32 offset:25088
    v_mfma_f32_16x16x32_bf16 v[40:43], v[80:83], v[60:63], v[40:43]
    v_mfma_f32_16x16x32_bf16 v[48:51], v[80:83], v[64:67], v[48:51]
    s_waitcnt lgkmcnt(0)
    v_mfma_f32_16x16x32_bf16 v[36:39], v[68:71], v[52:55], v[36:39]
    ds_read_b128 v[60:63], v23 offset:32768
    ds_read_b128 v[64:67], v23 offset:34816
    ds_read_b64_tr_b16 v[76:77], v31 offset:28672
    v_mfma_f32_16x16x32_bf16 v[44:47], v[68:71], v[56:59], v[44:47]
    ds_read_b64_tr_b16 v[78:79], v31 offset:29184
    ds_read_b64_tr_b16 v[80:81], v32 offset:28672
    ds_read_b64_tr_b16 v[82:83], v32 offset:29184
    v_mfma_f32_16x16x32_bf16 v[40:43], v[72:75], v[52:55], v[40:43]
    v_mfma_f32_16x16x32_bf16 v[48:51], v[72:75], v[56:59], v[48:51]
    s_waitcnt lgkmcnt(0)
    s_waitcnt vmcnt(4)
    s_barrier
    v_mfma_f32_16x16x32_bf16 v[36:39], v[76:79], v[60:63], v[36:39]
    ds_read_b128 v[52:55], v22 offset:40960
    ds_read_b128 v[56:59], v22 offset:43008
    ds_read_b64_tr_b16 v[68:69], v31 offset:32768
    v_mfma_f32_16x16x32_bf16 v[44:47], v[76:79], v[64:67], v[44:47]
    ds_read_b64_tr_b16 v[70:71], v31 offset:33280
    ds_read_b64_tr_b16 v[72:73], v32 offset:32768
    ds_read_b64_tr_b16 v[74:75], v32 offset:33280
    v_mfma_f32_16x16x32_bf16 v[40:43], v[80:83], v[60:63], v[40:43]
    v_mfma_f32_16x16x32_bf16 v[48:51], v[80:83], v[64:67], v[48:51]
    s_waitcnt lgkmcnt(0)
    v_mfma_f32_16x16x32_bf16 v[36:39], v[68:71], v[52:55], v[36:39]
    ds_read_b128 v[60:63], v23 offset:40960
    ds_read_b128 v[64:67], v23 offset:43008
    ds_read_b64_tr_b16 v[76:77], v31 offset:36864
    v_mfma_f32_16x16x32_bf16 v[44:47], v[68:71], v[56:59], v[44:47]
    ds_read_b64_tr_b16 v[78:79], v31 offset:37376
    ds_read_b64_tr_b16 v[80:81], v32 offset:36864
    ds_read_b64_tr_b16 v[82:83], v32 offset:37376
    v_mfma_f32_16x16x32_bf16 v[40:43], v[72:75], v[52:55], v[40:43]
    v_mfma_f32_16x16x32_bf16 v[48:51], v[72:75], v[56:59], v[48:51]
    s_waitcnt lgkmcnt(0)
    v_mfma_f32_16x16x32_bf16 v[36:39], v[76:79], v[60:63], v[36:39]
    ds_read_b128 v[52:55], v22 offset:49152
    ds_read_b128 v[56:59], v22 offset:51200
    ds_read_b64_tr_b16 v[68:69], v31 offset:40960
    v_mfma_f32_16x16x32_bf16 v[44:47], v[76:79], v[64:67], v[44:47]
    ds_read_b64_tr_b16 v[70:71], v31 offset:41472
    ds_read_b64_tr_b16 v[72:73], v32 offset:40960
    ds_read_b64_tr_b16 v[74:75], v32 offset:41472
    v_mfma_f32_16x16x32_bf16 v[40:43], v[80:83], v[60:63], v[40:43]
    v_mfma_f32_16x16x32_bf16 v[48:51], v[80:83], v[64:67], v[48:51]
    s_waitcnt lgkmcnt(0)
    v_mfma_f32_16x16x32_bf16 v[36:39], v[68:71], v[52:55], v[36:39]
    ds_read_b128 v[60:63], v23 offset:49152
    ds_read_b128 v[64:67], v23 offset:51200
    ds_read_b64_tr_b16 v[76:77], v31 offset:45056
    v_mfma_f32_16x16x32_bf16 v[44:47], v[68:71], v[56:59], v[44:47]
    ds_read_b64_tr_b16 v[78:79], v31 offset:45568
    ds_read_b64_tr_b16 v[80:81], v32 offset:45056
    ds_read_b64_tr_b16 v[82:83], v32 offset:45568
    v_mfma_f32_16x16x32_bf16 v[40:43], v[72:75], v[52:55], v[40:43]
    v_mfma_f32_16x16x32_bf16 v[48:51], v[72:75], v[56:59], v[48:51]
    s_waitcnt lgkmcnt(0)
    v_mfma_f32_16x16x32_bf16 v[36:39], v[76:79], v[60:63], v[36:39]
    v_mfma_f32_16x16x32_bf16 v[44:47], v[76:79], v[64:67], v[44:47]
    v_mfma_f32_16x16x32_bf16 v[40:43], v[80:83], v[60:63], v[40:43]
    v_mfma_f32_16x16x32_bf16 v[48:51], v[80:83], v[64:67], v[48:51]
    s_nop 7
    s_nop 7
    s_barrier
    s_mov_b32 s54, 1027024659
    s_mov_b32 s55, 3222493025
    s_waitcnt vmcnt(0)
    s_add_u32 s16, s84, 15728640
    s_addc_u32 s17, s85, 0
    s_mov_b32 s18, 1835008
    s_mov_b32 s19, 0x00020000
    s_lshl_b32 s37, s87, 6
    s_lshr_b32 s38, s86, 1
    s_mul_i32 s38, s38, 32
    s_add_u32 s37, s37, s38
    v_add_u32 v52, s37, v2
    s_mov_b32 s38, 896
    v_mul_lo_u32 v60, v52, s38
    v_and_b32 v52, 1, v3
    v_lshl_add_u32 v60, v52, 5, v60
    v_lshrrev_b32 v52, 1, v3
    v_lshl_add_u32 v60, v52, 4, v60
    v_lshlrev_b32 v52, 16, v14
    v_add_f32 v36, v36, v52
    v_and_b32 v52, 0xffff0000, v14
    v_add_f32 v37, v37, v52
    v_lshlrev_b32 v52, 16, v15
    v_add_f32 v38, v38, v52
    v_and_b32 v52, 0xffff0000, v15
    v_add_f32 v39, v39, v52
    v_lshlrev_b32 v52, 16, v16
    v_add_f32 v40, v40, v52
    v_and_b32 v52, 0xffff0000, v16
    v_add_f32 v41, v41, v52
    v_lshlrev_b32 v52, 16, v17
    v_add_f32 v42, v42, v52
    v_and_b32 v52, 0xffff0000, v17
    v_add_f32 v43, v43, v52
    v_cvt_pk_bf16_f32 v64, v36, v37
    v_cvt_pk_bf16_f32 v65, v38, v39
    v_cvt_pk_bf16_f32 v66, v40, v41
    v_cvt_pk_bf16_f32 v67, v42, v43
    s_nop 1
    v_permlane16_swap_b32 v64, v66
    v_permlane16_swap_b32 v65, v67
    s_and_b32 s37, s86, 1
    s_lshl_b32 s37, s37, 6
    s_mul_i32 s38, s88, 112
    s_add_u32 s37, s37, s38
    s_add_u32 s37, s37, 0
    s_and_b32 s38, s86, 1
    s_cmp_eq_u32 s38, 1
    s_cselect_b32 exec_hi, 0xffff, -1
    s_cmp_eq_u32 s91, 1
    s_cbranch_scc1 Ls43_p
    buffer_store_dwordx4 v[64:67], v60, s[16:19], s37 offen sc1
    s_branch Ls43_d
Ls43_p:
    buffer_store_dwordx4 v[64:67], v60, s[16:19], s37 offen
Ls43_d:
    s_mov_b64 exec, -1
    s_nop 1
    v_lshlrev_b32 v52, 16, v18
    v_add_f32 v44, v44, v52
    v_and_b32 v52, 0xffff0000, v18
    v_add_f32 v45, v45, v52
    v_lshlrev_b32 v52, 16, v19
    v_add_f32 v46, v46, v52
    v_and_b32 v52, 0xffff0000, v19
    v_add_f32 v47, v47, v52
    v_lshlrev_b32 v52, 16, v20
    v_add_f32 v48, v48, v52
    v_and_b32 v52, 0xffff0000, v20
    v_add_f32 v49, v49, v52
    v_lshlrev_b32 v52, 16, v21
    v_add_f32 v50, v50, v52
    v_and_b32 v52, 0xffff0000, v21
    v_add_f32 v51, v51, v52
    v_cvt_pk_bf16_f32 v64, v44, v45
    v_cvt_pk_bf16_f32 v65, v46, v47
    v_cvt_pk_bf16_f32 v66, v48, v49
    v_cvt_pk_bf16_f32 v67, v50, v51
    s_nop 1
    v_permlane16_swap_b32 v64, v66
    v_permlane16_swap_b32 v65, v67
    s_and_b32 s37, s86, 1
    s_lshl_b32 s37, s37, 6
    s_mul_i32 s38, s88, 112
    s_add_u32 s37, s37, s38
    s_add_u32 s37, s37, 14336
    s_and_b32 s38, s86, 1
    s_cmp_eq_u32 s38, 1
    s_cselect_b32 exec_hi, 0xffff, -1
    s_cmp_eq_u32 s91, 1
    s_cbranch_scc1 Ls44_p
    buffer_store_dwordx4 v[64:67], v60, s[16:19], s37 offen sc1
    s_branch Ls44_d
Ls44_p:
    buffer_store_dwordx4 v[64:67], v60, s[16:19], s37 offen
Ls44_d:
    s_mov_b64 exec, -1
    s_nop 1
    s_and_b32 s37, s86, 1
    s_cmp_eq_u32 s37, 1
    s_cselect_b32 s61, 0, -1
    s_mov_b32 s60, -1
    s_add_u32 s20, s84, 44302336
    s_addc_u32 s21, s85, 0
    s_mov_b32 s22, 262144
    s_mov_b32 s23, 0x00020000
    v_mov_b32 v64, 0
    s_lshl_b32 s37, s87, 6
    s_lshr_b32 s38, s86, 1
    s_mul_i32 s38, s38, 32
    s_add_u32 s37, s37, s38
    v_add_u32 v61, s37, v2
    v_lshlrev_b32 v61, 7, v61
    s_lshl_b32 s37, s88, 1
    s_and_b32 s38, s86, 1
    s_add_u32 s37, s37, s38
    s_lshl_b32 s37, s37, 3
    v_add_u32 v61, s37, v61
    v_mov_b32 v62, v36
    v_mul_f32 v63, v36, v36
    v_add_f32 v62, v62, v37
    v_fma_f32 v63, v37, v37, v63
    v_add_f32 v62, v62, v38
    v_fma_f32 v63, v38, v38, v63
    v_add_f32 v62, v62, v39
    v_fma_f32 v63, v39, v39, v63
    v_cndmask_b32 v52, v64, v40, s[60:61]
    v_add_f32 v62, v62, v52
    v_fma_f32 v63, v52, v52, v63
    v_cndmask_b32 v52, v64, v41, s[60:61]
    v_add_f32 v62, v62, v52
    v_fma_f32 v63, v52, v52, v63
    v_cndmask_b32 v52, v64, v42, s[60:61]
    v_add_f32 v62, v62, v52
    v_fma_f32 v63, v52, v52, v63
    v_cndmask_b32 v52, v64, v43, s[60:61]
    v_add_f32 v62, v62, v52
    v_fma_f32 v63, v52, v52, v63
    v_mov_b32 v52, v62
    s_nop 1
    v_permlane16_swap_b32 v62, v52
    v_add_f32 v62, v62, v52
    v_mov_b32 v52, v62
    s_nop 1
    v_permlane32_swap_b32 v62, v52
    v_add_f32 v62, v62, v52
    v_mov_b32 v52, v63
    s_nop 1
    v_permlane16_swap_b32 v63, v52
    v_add_f32 v63, v63, v52
    v_mov_b32 v52, v63
    s_nop 1
    v_permlane32_swap_b32 v63, v52
    v_add_f32 v63, v63, v52
    s_mov_b32 exec_lo, 0xffff
    s_mov_b32 exec_hi, 0
    s_cmp_eq_u32 s91, 1
    s_cbranch_scc1 Ls45_p
    buffer_store_dwordx2 v[62:63], v61, s[20:23], 0 offen offset:0 sc1
    s_branch Ls45_d
Ls45_p:
    buffer_store_dwordx2 v[62:63], v61, s[20:23], 0 offen offset:0
Ls45_d:
    s_mov_b64 exec, -1
    s_nop 1
    v_mov_b32 v62, v44
    v_mul_f32 v63, v44, v44
    v_add_f32 v62, v62, v45
    v_fma_f32 v63, v45, v45, v63
    v_add_f32 v62, v62, v46
    v_fma_f32 v63, v46, v46, v63
    v_add_f32 v62, v62, v47
    v_fma_f32 v63, v47, v47, v63
    v_cndmask_b32 v52, v64, v48, s[60:61]
    v_add_f32 v62, v62, v52
    v_fma_f32 v63, v52, v52, v63
    v_cndmask_b32 v52, v64, v49, s[60:61]
    v_add_f32 v62, v62, v52
    v_fma_f32 v63, v52, v52, v63
    v_cndmask_b32 v52, v64, v50, s[60:61]
    v_add_f32 v62, v62, v52
    v_fma_f32 v63, v52, v52, v63
    v_cndmask_b32 v52, v64, v51, s[60:61]
    v_add_f32 v62, v62, v52
    v_fma_f32 v63, v52, v52, v63
    v_mov_b32 v52, v62
    s_nop 1
    v_permlane16_swap_b32 v62, v52
    v_add_f32 v62, v62, v52
    v_mov_b32 v52, v62
    s_nop 1
    v_permlane32_swap_b32 v62, v52
    v_add_f32 v62, v62, v52
    v_mov_b32 v52, v63
    s_nop 1
    v_permlane16_swap_b32 v63, v52
    v_add_f32 v63, v63, v52
    v_mov_b32 v52, v63
    s_nop 1
    v_permlane32_swap_b32 v63, v52
    v_add_f32 v63, v63, v52
    s_mov_b32 exec_lo, 0xffff
    s_mov_b32 exec_hi, 0
    s_cmp_eq_u32 s91, 1
    s_cbranch_scc1 Ls46_p
    buffer_store_dwordx2 v[62:63], v61, s[20:23], 0 offen offset:2048 sc1
    s_branch Ls46_d
Ls46_p:
    buffer_store_dwordx2 v[62:63], v61, s[20:23], 0 offen offset:2048
Ls46_d:
    s_mov_b64 exec, -1
    s_nop 1
    s_mov_b32 s12, s72
    s_mov_b32 s13, s73
    s_mov_b32 s14, 401408
    s_mov_b32 s15, 0x00020000
    s_lshl_b32 s32, s86, 10
    s_and_b32 s40, s86, 1
    s_mul_i32 s35, s86, 7168
    v_lshrrev_b32 v67, 3, v1
    v_bfe_u32 v65, v1, 4, 1
    v_lshlrev_b32 v65, 1, v65
    s_lshl_b32 s37, s40, 2
    v_add_u32 v65, s37, v65
    v_and_b32 v66, 7, v1
    v_xor_b32 v66, v66, v65
    s_mov_b32 s39, 896
    v_mul_lo_u32 v65, v67, s39
    v_lshl_add_u32 v68, v66, 4, v65
    s_mul_i32 s42, s88, 112
    s_add_u32 s42, s42, 0
    s_add_u32 m0, s32, 57344
    s_add_u32 s37, s35, 0
    s_add_u32 s37, s37, s42
    buffer_load_dwordx4 v68, s[12:15], s37 offen lds
    s_add_u32 m0, s32, 61440
    s_add_u32 s37, s35, 28672
    s_add_u32 s37, s37, s42
    buffer_load_dwordx4 v68, s[12:15], s37 offen lds
    s_add_u32 m0, s32, 65536
    s_add_u32 s37, s35, 57344
    s_add_u32 s37, s37, s42
    buffer_load_dwordx4 v68, s[12:15], s37 offen lds
    s_add_u32 m0, s32, 69632
    s_add_u32 s37, s35, 86016
    s_add_u32 s37, s37, s42
    buffer_load_dwordx4 v68, s[12:15], s37 offen lds
    s_add_u32 m0, s32, 73728
    s_add_u32 s37, s35, 114688
    s_add_u32 s37, s37, s42
    buffer_load_dwordx4 v68, s[12:15], s37 offen lds
    s_add_u32 m0, s32, 77824
    s_add_u32 s37, s35, 143360
    s_add_u32 s37, s37, s42
    buffer_load_dwordx4 v68, s[12:15], s37 offen lds
    s_add_u32 m0, s32, 81920
    s_add_u32 s37, s35, 172032
    s_add_u32 s37, s37, s42
    buffer_load_dwordx4 v68, s[12:15], s37 offen lds
    s_add_u32 m0, s32, 86016
    s_add_u32 s37, s35, 200704
    s_add_u32 s37, s37, s42
    buffer_load_dwordx4 v68, s[12:15], s37 offen lds
    s_add_u32 m0, s32, 90112
    s_add_u32 s37, s35, 229376
    s_add_u32 s37, s37, s42
    buffer_load_dwordx4 v68, s[12:15], s37 offen lds
    s_add_u32 m0, s32, 94208
    s_add_u32 s37, s35, 258048
    s_add_u32 s37, s37, s42
    buffer_load_dwordx4 v68, s[12:15], s37 offen lds
    s_add_u32 m0, s32, 98304
    s_add_u32 s37, s35, 286720
    s_add_u32 s37, s37, s42
    buffer_load_dwordx4 v68, s[12:15], s37 offen lds
    s_add_u32 m0, s32, 102400
    s_add_u32 s37, s35, 315392
    s_add_u32 s37, s37, s42
    buffer_load_dwordx4 v68, s[12:15], s37 offen lds
    s_add_u32 m0, s32, 106496
    s_add_u32 s37, s35, 344064
    s_add_u32 s37, s37, s42
    buffer_load_dwordx4 v68, s[12:15], s37 offen lds
    s_add_u32 m0, s32, 110592
    s_add_u32 s37, s35, 372736
    s_add_u32 s37, s37, s42
    buffer_load_dwordx4 v68, s[12:15], s37 offen lds
    s_waitcnt vmcnt(14)
    s_lshl_b32 s32, s89, 7
    s_lshl_b32 s33, s86, 2
    s_add_u32 s32, s32, s33
    v_mov_b32 v65, s32
    v_mov_b32 v66, 9
    s_mov_b64 exec, 1
    s_mov_b32 s57, s91
    s_cmp_eq_u32 s57, 1
    s_cbranch_scc1 Ls47_p
    buffer_store_dword v66, v65, s[24:27], 0 offen sc1
    s_branch Ls47_d
Ls47_p:
    buffer_store_dword v66, v65, s[24:27], 0 offen
Ls47_d:
    s_mov_b64 exec, -1
    s_barrier
    s_add_u32 s8, s84, 15728640
    s_addc_u32 s9, s85, 0
    s_mov_b32 s10, 1835008
    s_mov_b32 s11, 0x00020000
    s_mov_b32 s12, s72
    s_mov_b32 s13, s73
    s_mov_b32 s14, 401408
    s_mov_b32 s15, 0x00020000
    s_lshl_b32 s32, s86, 10
    s_and_b32 s40, s86, 1
    s_add_u32 s33, s40, 8
    s_mul_i32 s34, s86, 7168
    s_mul_i32 s35, s86, 7168
    s_mul_i32 s36, s88, 112
    v_lshrrev_b32 v5, 3, v1
    v_lshrrev_b32 v7, 4, v1
    s_lshl_b32 s37, s40, 2
    v_add_u32 v7, s37, v7
    v_and_b32 v6, 7, v1
    v_xor_b32 v6, v6, v7
    s_lshl_b32 s37, s87, 6
    s_lshl_b32 s38, s86, 3
    s_add_u32 s38, s38, 0
    s_add_u32 s38, s38, s37
    v_add_u32 v7, s38, v5
    s_mov_b32 s39, 896
    v_mul_lo_u32 v7, v7, s39
    v_lshl_add_u32 v9, v6, 4, v7
    s_lshl_b32 s38, s86, 3
    s_add_u32 s38, s38, 32
    s_add_u32 s38, s38, s37
    v_add_u32 v7, s38, v5
    s_mov_b32 s39, 896
    v_mul_lo_u32 v7, v7, s39
    v_lshl_add_u32 v10, v6, 4, v7
    v_bfe_u32 v7, v1, 4, 1
    v_lshlrev_b32 v7, 1, v7
    s_lshl_b32 s37, s40, 2
    v_add_u32 v7, s37, v7
    v_and_b32 v8, 7, v1
    v_xor_b32 v8, v8, v7
    s_mov_b32 s39, 896
    v_mul_lo_u32 v7, v5, s39
    v_lshl_add_u32 v11, v8, 4, v7
    s_add_u32 s42, s36, 0
    s_cmp_lg_u32 s86, 0
    s_cbranch_scc1 Lp48_skip
    v_lshrrev_b32 v13, 3, v1
    v_add_u32 v13, s87, v13
    v_add_u32 v13, 0, v13
    v_mov_b32 v14, s87
    v_cmp_gt_u32 vcc, 32, v13
    s_nop 1
    v_cndmask_b32 v13, v14, v13, vcc
    v_and_b32 v12, 7, v1
    v_lshlrev_b32 v12, 5, v12
    v_and_b32 v14, 3, v13
    v_lshl_add_u32 v12, v14, 3, v12
    v_lshrrev_b32 v14, 2, v13
    v_add_u32 v12, v12, v14
    v_lshlrev_b32 v12, 7, v12
    v_add_u32 v12, 0, v12
    v_mov_b32 v20, 0
    s_mov_b32 s52, 0
    s_mov_b32 s53, 9
    s_mov_b32 exec_lo, 255
    s_mov_b32 exec_hi, 0
Lp48_loop:
    buffer_load_dwordx4 v[16:19], v12, s[24:27], 0 offen sc1
    s_waitcnt vmcnt(0)
    v_min_u32 v16, v16, v17
    v_min_u32 v18, v18, v19
    v_min_u32 v16, v16, v18
    v_cmp_gt_u32 vcc, s53, v16
    s_cbranch_vccz Lp48_ok
Lp48_again:
    s_add_u32 s52, s52, 1
    s_cmp_lt_u32 s52, 20000
    s_cbranch_scc1 Lp48_loop
Lp48_ok:
    s_mov_b64 exec, -1
Lp48_skip:
    s_barrier
    s_add_u32 m0, s32, 0
    s_nop 0
    s_mov_b32 s37, 0
    buffer_load_dwordx4 v9, s[8:11], s37 offen lds
    s_add_u32 m0, s32, 4096
    s_nop 0
    s_mov_b32 s37, 0
    buffer_load_dwordx4 v10, s[8:11], s37 offen lds
    s_add_u32 m0, s32, 8192
    s_nop 0
    s_mov_b32 s37, 128
    buffer_load_dwordx4 v9, s[8:11], s37 offen lds
    s_add_u32 m0, s32, 12288
    s_nop 0
    s_mov_b32 s37, 128
    buffer_load_dwordx4 v10, s[8:11], s37 offen lds
    s_add_u32 m0, s32, 16384
    s_nop 0
    s_mov_b32 s37, 256
    buffer_load_dwordx4 v9, s[8:11], s37 offen lds
    s_add_u32 m0, s32, 20480
    s_nop 0
    s_mov_b32 s37, 256
    buffer_load_dwordx4 v10, s[8:11], s37 offen lds
    s_add_u32 m0, s32, 24576
    s_nop 0
    s_mov_b32 s37, 384
    buffer_load_dwordx4 v9, s[8:11], s37 offen lds
    s_add_u32 m0, s32, 28672
    s_nop 0
    s_mov_b32 s37, 384
    buffer_load_dwordx4 v10, s[8:11], s37 offen lds
    s_add_u32 m0, s32, 32768
    s_nop 0
    s_mov_b32 s37, 512
    buffer_load_dwordx4 v9, s[8:11], s37 offen lds
    s_add_u32 m0, s32, 36864
    s_nop 0
    s_mov_b32 s37, 512
    buffer_load_dwordx4 v10, s[8:11], s37 offen lds
    s_add_u32 m0, s32, 40960
    s_nop 0
    s_mov_b32 s37, 640
    buffer_load_dwordx4 v9, s[8:11], s37 offen lds
    s_add_u32 m0, s32, 45056
    s_nop 0
    s_mov_b32 s37, 640
    buffer_load_dwordx4 v10, s[8:11], s37 offen lds
    s_add_u32 m0, s32, 49152
    s_nop 0
    s_mov_b32 s37, 768
    buffer_load_dwordx4 v9, s[8:11], s37 offen lds
    s_add_u32 m0, s32, 53248
    s_nop 0
    s_mov_b32 s37, 768
    buffer_load_dwordx4 v10, s[8:11], s37 offen lds
    s_add_u32 s20, s84, 44302336
    s_addc_u32 s21, s85, 0
    s_mov_b32 s22, 262144
    s_mov_b32 s23, 0x00020000
    s_lshl_b32 s37, s87, 6
    s_lshr_b32 s38, s86, 1
    s_mul_i32 s38, s38, 32
    s_add_u32 s37, s37, s38
    v_add_u32 v12, s37, v2
    v_lshlrev_b32 v12, 7, v12
    v_lshl_add_u32 v12, v3, 5, v12
    buffer_load_dwordx4 v[16:19], v12, s[20:23], 0 offen
    buffer_load_dwordx4 v[20:23], v12, s[20:23], 0 offen offset:16
    v_add_u32 v12, 2048, v12
    buffer_load_dwordx4 v[24:27], v12, s[20:23], 0 offen
    buffer_load_dwordx4 v[28:31], v12, s[20:23], 0 offen offset:16
    v_lshrrev_b32 v7, 1, v2
    v_and_b32 v7, 7, v7
    v_add_u32 v8, 0, v3
    v_xor_b32 v8, v8, v7
    v_lshlrev_b32 v8, 4, v8
    v_lshl_add_u32 v32, v2, 7, v8
    v_add_u32 v8, 4, v3
    v_xor_b32 v8, v8, v7
    v_lshlrev_b32 v8, 4, v8
    v_lshl_add_u32 v33, v2, 7, v8
    s_lshl_b32 s37, s86, 11
    v_add_u32 v34, s37, v32
    v_add_u32 v35, s37, v33
    s_lshr_b32 s37, s86, 1
    s_mul_i32 s37, s37, 4096
    v_add_u32 v32, s37, v32
    v_add_u32 v33, s37, v33
    v_lshrrev_b32 v38, 2, v2
    v_lshl_add_u32 v38, v3, 3, v38
    v_lshlrev_b32 v38, 7, v38
    v_bfe_u32 v39, v2, 3, 1
    v_lshlrev_b32 v39, 2, v39
    v_and_b32 v7, 1, v3
    v_lshl_add_u32 v39, v7, 3, v39
    v_and_b32 v40, 3, v2
    s_and_b32 s37, s86, 1
    s_mul_i32 s37, s37, 2
    s_add_u32 s38, s37, 0
    s_and_b32 s39, s38, 3
    s_lshl_b32 s39, s39, 2
    v_add_u32 v7, s39, v40
    v_xor_b32 v7, v7, v39
    v_lshl_add_u32 v7, v7, 3, v38
    s_lshr_b32 s38, s38, 2
    s_lshl_b32 s38, s38, 13
    v_add_u32 v36, s38, v7
    s_add_u32 s38, s37, 1
    s_and_b32 s39, s38, 3
    s_lshl_b32 s39, s39, 2
    v_add_u32 v7, s39, v40
    v_xor_b32 v7, v7, v39
    v_lshl_add_u32 v7, v7, 3, v38
    s_lshr_b32 s38, s38, 2
    s_lshl_b32 s38, s38, 13
    v_add_u32 v37, s38, v7
    v_add_u32 v41, 65536, v32
    v_add_u32 v42, 65536, v33
    v_add_u32 v43, 65536, v34
    v_add_u32 v44, 65536, v35
    v_add_u32 v45, 65536, v36
    v_add_u32 v46, 65536, v37
    v_mov_b32 v48, 0
    v_mov_b32 v49, 0
    v_mov_b32 v50, 0
    v_mov_b32 v51, 0
    v_mov_b32 v52, 0
    v_mov_b32 v53, 0
    v_mov_b32 v54, 0
    v_mov_b32 v55, 0
    v_mov_b32 v56, 0
    v_mov_b32 v57, 0
    v_mov_b32 v58, 0
    v_mov_b32 v59, 0
    v_mov_b32 v60, 0
    v_mov_b32 v61, 0
    v_mov_b32 v62, 0
    v_mov_b32 v63, 0
    v_mov_b32 v64, 0
    v_mov_b32 v65, 0
    v_mov_b32 v66, 0
    v_mov_b32 v67, 0
    v_mov_b32 v68, 0
    v_mov_b32 v69, 0
    v_mov_b32 v70, 0
    v_mov_b32 v71, 0
    v_mov_b32 v72, 0x3f803f80
    v_mov_b32 v73, 0x3f803f80
    v_mov_b32 v74, 0x3f803f80
    v_mov_b32 v75, 0x3f803f80
    s_waitcnt vmcnt(29)
    s_waitcnt vmcnt(14)
    s_barrier
    ds_read_b128 v[76:79], v32 offset:0
    ds_read_b128 v[80:83], v32 offset:2048
    ds_read_b64_tr_b16 v[92:93], v36 offset:57344
    ds_read_b64_tr_b16 v[94:95], v36 offset:57856
    ds_read_b64_tr_b16 v[96:97], v37 offset:57344
    ds_read_b64_tr_b16 v[98:99], v37 offset:57856
    s_waitcnt lgkmcnt(0)
    v_mfma_f32_16x16x32_bf16 v[48:51], v[92:95], v[76:79], v[48:51]
    ds_read_b128 v[84:87], v33 offset:0
    ds_read_b128 v[88:91], v33 offset:2048
    v_mfma_f32_16x16x32_bf16 v[56:59], v[92:95], v[80:83], v[56:59]
    ds_read_b64_tr_b16 v[100:101], v36 offset:61440
    ds_read_b64_tr_b16 v[102:103], v36 offset:61952
    v_mfma_f32_16x16x32_bf16 v[64:67], v[92:95], v[72:75], v[64:67]
    ds_read_b64_tr_b16 v[104:105], v37 offset:61440
    ds_read_b64_tr_b16 v[106:107], v37 offset:61952
    v_mfma_f32_16x16x32_bf16 v[52:55], v[96:99], v[76:79], v[52:55]
    v_mfma_f32_16x16x32_bf16 v[60:63], v[96:99], v[80:83], v[60:63]
    v_mfma_f32_16x16x32_bf16 v[68:71], v[96:99], v[72:75], v[68:71]
    s_waitcnt lgkmcnt(0)
    v_mfma_f32_16x16x32_bf16 v[48:51], v[100:103], v[84:87], v[48:51]
    ds_read_b128 v[76:79], v32 offset:8192
    ds_read_b128 v[80:83], v32 offset:10240
    v_mfma_f32_16x16x32_bf16 v[56:59], v[100:103], v[88:91], v[56:59]
    ds_read_b64_tr_b16 v[92:93], v45 offset:0
    ds_read_b64_tr_b16 v[94:95], v45 offset:512
    v_mfma_f32_16x16x32_bf16 v[64:67], v[100:103], v[72:75], v[64:67]
    ds_read_b64_tr_b16 v[96:97], v46 offset:0
    ds_read_b64_tr_b16 v[98:99], v46 offset:512
    v_mfma_f32_16x16x32_bf16 v[52:55], v[104:107], v[84:87], v[52:55]
    v_mfma_f32_16x16x32_bf16 v[60:63], v[104:107], v[88:91], v[60:63]
    v_mfma_f32_16x16x32_bf16 v[68:71], v[104:107], v[72:75], v[68:71]
    s_waitcnt lgkmcnt(0)
    v_mfma_f32_16x16x32_bf16 v[48:51], v[92:95], v[76:79], v[48:51]
    ds_read_b128 v[84:87], v33 offset:8192
    ds_read_b128 v[88:91], v33 offset:10240
    v_mfma_f32_16x16x32_bf16 v[56:59], v[92:95], v[80:83], v[56:59]
    ds_read_b64_tr_b16 v[100:101], v45 offset:4096
    ds_read_b64_tr_b16 v[102:103], v45 offset:4608
    v_mfma_f32_16x16x32_bf16 v[64:67], v[92:95], v[72:75], v[64:67]
    ds_read_b64_tr_b16 v[104:105], v46 offset:4096
    ds_read_b64_tr_b16 v[106:107], v46 offset:4608
    v_mfma_f32_16x16x32_bf16 v[52:55], v[96:99], v[76:79], v[52:55]
    v_mfma_f32_16x16x32_bf16 v[60:63], v[96:99], v[80:83], v[60:63]
    v_mfma_f32_16x16x32_bf16 v[68:71], v[96:99], v[72:75], v[68:71]
    s_waitcnt lgkmcnt(0)
    s_waitcnt vmcnt(8)
    s_barrier
    v_mfma_f32_16x16x32_bf16 v[48:51], v[100:103], v[84:87], v[48:51]
    ds_read_b128 v[76:79], v32 offset:16384
    ds_read_b128 v[80:83], v32 offset:18432
    v_mfma_f32_16x16x32_bf16 v[56:59], v[100:103], v[88:91], v[56:59]
    ds_read_b64_tr_b16 v[92:93], v45 offset:8192
    ds_read_b64_tr_b16 v[94:95], v45 offset:8704
    v_mfma_f32_16x16x32_bf16 v[64:67], v[100:103], v[72:75], v[64:67]
    ds_read_b64_tr_b16 v[96:97], v46 offset:8192
    ds_read_b64_tr_b16 v[98:99], v46 offset:8704
    v_mfma_f32_16x16x32_bf16 v[52:55], v[104:107], v[84:87], v[52:55]
    v_mfma_f32_16x16x32_bf16 v[60:63], v[104:107], v[88:91], v[60:63]
    v_mfma_f32_16x16x32_bf16 v[68:71], v[104:107], v[72:75], v[68:71]
    s_waitcnt lgkmcnt(0)
    v_mfma_f32_16x16x32_bf16 v[48:51], v[92:95], v[76:79], v[48:51]
    ds_read_b128 v[84:87], v33 offset:16384
    ds_read_b128 v[88:91], v33 offset:18432
    v_mfma_f32_16x16x32_bf16 v[56:59], v[92:95], v[80:83], v[56:59]
    ds_read_b64_tr_b16 v[100:101], v45 offset:12288
    ds_read_b64_tr_b16 v[102:103], v45 offset:12800
    v_mfma_f32_16x16x32_bf16 v[64:67], v[92:95], v[72:75], v[64:67]
    ds_read_b64_tr_b16 v[104:105], v46 offset:12288
    ds_read_b64_tr_b16 v[106:107], v46 offset:12800
    v_mfma_f32_16x16x32_bf16 v[52:55], v[96:99], v[76:79], v[52:55]
    v_mfma_f32_16x16x32_bf16 v[60:63], v[96:99], v[80:83], v[60:63]
    v_mfma_f32_16x16x32_bf16 v[68:71], v[96:99], v[72:75], v[68:71]
    s_waitcnt lgkmcnt(0)
    v_mfma_f32_16x16x32_bf16 v[48:51], v[100:103], v[84:87], v[48:51]
    ds_read_b128 v[76:79], v32 offset:24576
    ds_read_b128 v[80:83], v32 offset:26624
    v_mfma_f32_16x16x32_bf16 v[56:59], v[100:103], v[88:91], v[56:59]
    ds_read_b64_tr_b16 v[92:93], v45 offset:16384
    ds_read_b64_tr_b16 v[94:95], v45 offset:16896
    v_mfma_f32_16x16x32_bf16 v[64:67], v[100:103], v[72:75], v[64:67]
    ds_read_b64_tr_b16 v[96:97], v46 offset:16384
    ds_read_b64_tr_b16 v[98:99], v46 offset:16896
    v_mfma_f32_16x16x32_bf16 v[52:55], v[104:107], v[84:87], v[52:55]
    v_mfma_f32_16x16x32_bf16 v[60:63], v[104:107], v[88:91], v[60:63]
    v_mfma_f32_16x16x32_bf16 v[68:71], v[104:107], v[72:75], v[68:71]
    s_waitcnt lgkmcnt(0)
    v_mfma_f32_16x16x32_bf16 v[48:51], v[92:95], v[76:79], v[48:51]
    ds_read_b128 v[84:87], v33 offset:24576
    ds_read_b128 v[88:91], v33 offset:26624
    v_mfma_f32_16x16x32_bf16 v[56:59], v[92:95], v[80:83], v[56:59]
    ds_read_b64_tr_b16 v[100:101], v45 offset:20480
    ds_read_b64_tr_b16 v[102:103], v45 offset:20992
    v_mfma_f32_16x16x32_bf16 v[64:67], v[92:95], v[72:75], v[64:67]
    ds_read_b64_tr_b16 v[104:105], v46 offset:20480
    ds_read_b64_tr_b16 v[106:107], v46 offset:20992
    v_mfma_f32_16x16x32_bf16 v[52:55], v[96:99], v[76:79], v[52:55]
    v_mfma_f32_16x16x32_bf16 v[60:63], v[96:99], v[80:83], v[60:63]
    v_mfma_f32_16x16x32_bf16 v[68:71], v[96:99], v[72:75], v[68:71]
    s_waitcnt lgkmcnt(0)
    v_mfma_f32_16x16x32_bf16 v[48:51], v[100:103], v[84:87], v[48:51]
    ds_read_b128 v[76:79], v32 offset:32768
    ds_read_b128 v[80:83], v32 offset:34816
    v_mfma_f32_16x16x32_bf16 v[56:59], v[100:103], v[88:91], v[56:59]
    ds_read_b64_tr_b16 v[92:93], v45 offset:24576
    ds_read_b64_tr_b16 v[94:95], v45 offset:25088
    v_mfma_f32_16x16x32_bf16 v[64:67], v[100:103], v[72:75], v[64:67]
    ds_read_b64_tr_b16 v[96:97], v46 offset:24576
    ds_read_b64_tr_b16 v[98:99], v46 offset:25088
    v_mfma_f32_16x16x32_bf16 v[52:55], v[104:107], v[84:87], v[52:55]
    v_mfma_f32_16x16x32_bf16 v[60:63], v[104:107], v[88:91], v[60:63]
    v_mfma_f32_16x16x32_bf16 v[68:71], v[104:107], v[72:75], v[68:71]
    s_waitcnt lgkmcnt(0)
    v_mfma_f32_16x16x32_bf16 v[48:51], v[92:95], v[76:79], v[48:51]
    ds_read_b128 v[84:87], v33 offset:32768
    ds_read_b128 v[88:91], v33 offset:34816
    v_mfma_f32_16x16x32_bf16 v[56:59], v[92:95], v[80:83], v[56:59]
    ds_read_b64_tr_b16 v[100:101], v45 offset:28672
    ds_read_b64_tr_b16 v[102:103], v45 offset:29184
    v_mfma_f32_16x16x32_bf16 v[64:67], v[92:95], v[72:75], v[64:67]
    ds_read_b64_tr_b16 v[104:105], v46 offset:28672
    ds_read_b64_tr_b16 v[106:107], v46 offset:29184
    v_mfma_f32_16x16x32_bf16 v[52:55], v[96:99], v[76:79], v[52:55]
    v_mfma_f32_16x16x32_bf16 v[60:63], v[96:99], v[80:83], v[60:63]
    v_mfma_f32_16x16x32_bf16 v[68:71], v[96:99], v[72:75], v[68:71]
    s_waitcnt lgkmcnt(0)
    s_waitcnt vmcnt(4)
    s_barrier
    v_mfma_f32_16x16x32_bf16 v[48:51], v[100:103], v[84:87], v[48:51]
    ds_read_b128 v[76:79], v32 offset:40960
    ds_read_b128 v[80:83], v32 offset:43008
    v_mfma_f32_16x16x32_bf16 v[56:59], v[100:103], v[88:91], v[56:59]
    ds_read_b64_tr_b16 v[92:93], v45 offset:32768
    ds_read_b64_tr_b16 v[94:95], v45 offset:33280
    v_mfma_f32_16x16x32_bf16 v[64:67], v[100:103], v[72:75], v[64:67]
    ds_read_b64_tr_b16 v[96:97], v46 offset:32768
    ds_read_b64_tr_b16 v[98:99], v46 offset:33280
    v_mfma_f32_16x16x32_bf16 v[52:55], v[104:107], v[84:87], v[52:55]
    v_mfma_f32_16x16x32_bf16 v[60:63], v[104:107], v[88:91], v[60:63]
    v_mfma_f32_16x16x32_bf16 v[68:71], v[104:107], v[72:75], v[68:71]
    s_waitcnt lgkmcnt(0)
    v_mfma_f32_16x16x32_bf16 v[48:51], v[92:95], v[76:79], v[48:51]
    ds_read_b128 v[84:87], v33 offset:40960
    ds_read_b128 v[88:91], v33 offset:43008
    v_mfma_f32_16x16x32_bf16 v[56:59], v[92:95], v[80:83], v[56:59]
    ds_read_b64_tr_b16 v[100:101], v45 offset:36864
    ds_read_b64_tr_b16 v[102:103], v45 offset:37376
    v_mfma_f32_16x16x32_bf16 v[64:67], v[92:95], v[72:75], v[64:67]
    ds_read_b64_tr_b16 v[104:105], v46 offset:36864
    ds_read_b64_tr_b16 v[106:107], v46 offset:37376
    v_mfma_f32_16x16x32_bf16 v[52:55], v[96:99], v[76:79], v[52:55]
    v_mfma_f32_16x16x32_bf16 v[60:63], v[96:99], v[80:83], v[60:63]
    v_mfma_f32_16x16x32_bf16 v[68:71], v[96:99], v[72:75], v[68:71]
    s_waitcnt lgkmcnt(0)
    v_mfma_f32_16x16x32_bf16 v[48:51], v[100:103], v[84:87], v[48:51]
    ds_read_b128 v[76:79], v32 offset:49152
    ds_read_b128 v[80:83], v32 offset:51200
    v_mfma_f32_16x16x32_bf16 v[56:59], v[100:103], v[88:91], v[56:59]
    ds_read_b64_tr_b16 v[92:93], v45 offset:40960
    ds_read_b64_tr_b16 v[94:95], v45 offset:41472
    v_mfma_f32_16x16x32_bf16 v[64:67], v[100:103], v[72:75], v[64:67]
    ds_read_b64_tr_b16 v[96:97], v46 offset:40960
    ds_read_b64_tr_b16 v[98:99], v46 offset:41472
    v_mfma_f32_16x16x32_bf16 v[52:55], v[104:107], v[84:87], v[52:55]
    v_mfma_f32_16x16x32_bf16 v[60:63], v[104:107], v[88:91], v[60:63]
    v_mfma_f32_16x16x32_bf16 v[68:71], v[104:107], v[72:75], v[68:71]
    s_waitcnt lgkmcnt(0)
    v_mfma_f32_16x16x32_bf16 v[48:51], v[92:95], v[76:79], v[48:51]
    ds_read_b128 v[84:87], v33 offset:49152
    ds_read_b128 v[88:91], v33 offset:51200
    v_mfma_f32_16x16x32_bf16 v[56:59], v[92:95], v[80:83], v[56:59]
    ds_read_b64_tr_b16 v[100:101], v45 offset:45056
    ds_read_b64_tr_b16 v[102:103], v45 offset:45568
    v_mfma_f32_16x16x32_bf16 v[64:67], v[92:95], v[72:75], v[64:67]
    ds_read_b64_tr_b16 v[104:105], v46 offset:45056
    ds_read_b64_tr_b16 v[106:107], v46 offset:45568
    v_mfma_f32_16x16x32_bf16 v[52:55], v[96:99], v[76:79], v[52:55]
    v_mfma_f32_16x16x32_bf16 v[60:63], v[96:99], v[80:83], v[60:63]
    v_mfma_f32_16x16x32_bf16 v[68:71], v[96:99], v[72:75], v[68:71]
    s_waitcnt lgkmcnt(0)
    v_mfma_f32_16x16x32_bf16 v[48:51], v[100:103], v[84:87], v[48:51]
    v_mfma_f32_16x16x32_bf16 v[56:59], v[100:103], v[88:91], v[56:59]
    v_mfma_f32_16x16x32_bf16 v[64:67], v[100:103], v[72:75], v[64:67]
    v_mfma_f32_16x16x32_bf16 v[52:55], v[104:107], v[84:87], v[52:55]
    v_mfma_f32_16x16x32_bf16 v[60:63], v[104:107], v[88:91], v[60:63]
    v_mfma_f32_16x16x32_bf16 v[68:71], v[104:107], v[72:75], v[68:71]
    s_nop 7
    s_nop 7
    s_barrier
    s_waitcnt vmcnt(0)
    v_add_f32 v80, v16, v18
    v_add_f32 v81, v17, v19
    v_add_f32 v76, v20, v22
    v_add_f32 v77, v21, v23
    v_add_f32 v80, v80, v76
    v_add_f32 v81, v81, v77
    v_mov_b32 v76, v80
    s_nop 1
    v_permlane16_swap_b32 v80, v76
    v_add_f32 v80, v80, v76
    v_mov_b32 v76, v80
    s_nop 1
    v_permlane32_swap_b32 v80, v76
    v_add_f32 v80, v80, v76
    v_mov_b32 v76, v81
    s_nop 1
    v_permlane16_swap_b32 v81, v76
    v_add_f32 v81, v81, v76
    v_mov_b32 v76, v81
    s_nop 1
    v_permlane32_swap_b32 v81, v76
    v_add_f32 v81, v81, v76
    v_mul_f32 v80, 991054117, v80
    v_mul_f32 v81, 991054117, v81
    v_fma_f32 v81, -v80, v80, v81
    v_max_f32 v81, 0, v81
    v_add_f32 v76, 925353388, v81
    v_rsq_f32 v77, v76
    s_nop 0
    v_mul_f32 v78, v77, v77
    s_mov_b32 s39, 925353388
    v_fma_f32 v78, v78, v81, s39
    v_rsq_f32 v78, v78
    s_nop 0
    v_mul_f32 v81, v77, v78
    v_mov_b32 v84, v80
    v_mov_b32 v85, v77
    s_add_u32 s20, s84, 24117248
    s_addc_u32 s21, s85, 0
    s_mov_b32 s22, 16384
    s_mov_b32 s23, 0x00020000
    s_lshl_b32 s37, s87, 6
    s_lshr_b32 s38, s86, 1
    s_mul_i32 s38, s38, 32
    s_add_u32 s37, s37, s38
    v_add_u32 v76, s37, v2
    v_lshlrev_b32 v76, 3, v76
    s_mov_b32 exec_lo, 0xffff
    s_mov_b32 exec_hi, 0
    buffer_store_dwordx2 v[84:85], v76, s[20:23], 0 offen offset:0
    s_mov_b64 exec, -1
    v_add_f32 v82, v24, v26
    v_add_f32 v83, v25, v27
    v_add_f32 v76, v28, v30
    v_add_f32 v77, v29, v31
    v_add_f32 v82, v82, v76
    v_add_f32 v83, v83, v77
    v_mov_b32 v76, v82
    s_nop 1
    v_permlane16_swap_b32 v82, v76
    v_add_f32 v82, v82, v76
    v_mov_b32 v76, v82
    s_nop 1
    v_permlane32_swap_b32 v82, v76
    v_add_f32 v82, v82, v76
    v_mov_b32 v76, v83
    s_nop 1
    v_permlane16_swap_b32 v83, v76
    v_add_f32 v83, v83, v76
    v_mov_b32 v76, v83
    s_nop 1
    v_permlane32_swap_b32 v83, v76
    v_add_f32 v83, v83, v76
    v_mul_f32 v82, 991054117, v82
    v_mul_f32 v83, 991054117, v83
    v_fma_f32 v83, -v82, v82, v83
    v_max_f32 v83, 0, v83
    v_add_f32 v76, 925353388, v83
    v_rsq_f32 v77, v76
    s_nop 0
    v_mul_f32 v78, v77, v77
    s_mov_b32 s39, 925353388
    v_fma_f32 v78, v78, v83, s39
    v_rsq_f32 v78, v78
    s_nop 0
    v_mul_f32 v83, v77, v78
    v_mov_b32 v86, v82
    v_mov_b32 v87, v77
    s_add_u32 s20, s84, 24117248
    s_addc_u32 s21, s85, 0
    s_mov_b32 s22, 16384
    s_mov_b32 s23, 0x00020000
    s_lshl_b32 s37, s87, 6
    s_lshr_b32 s38, s86, 1
    s_mul_i32 s38, s38, 32
    s_add_u32 s37, s37, s38
    v_add_u32 v76, s37, v2
    v_lshlrev_b32 v76, 3, v76
    s_mov_b32 exec_lo, 0xffff
    s_mov_b32 exec_hi, 0
    buffer_store_dwordx2 v[86:87], v76, s[20:23], 0 offen offset:128
    s_mov_b64 exec, -1
    s_mov_b32 s54, 1027024659
    s_mov_b32 s55, 3222493025
    s_add_u32 s16, s84, 17825792
    s_addc_u32 s17, s85, 0
    s_mov_b32 s18, 1835008
    s_mov_b32 s19, 0x00020000
    s_lshl_b32 s37, s87, 6
    s_lshr_b32 s38, s86, 1
    s_mul_i32 s38, s38, 32
    s_add_u32 s37, s37, s38
    v_add_u32 v76, s37, v2
    s_mov_b32 s38, 896
    v_mul_lo_u32 v92, v76, s38
    v_and_b32 v76, 1, v3
    v_lshl_add_u32 v92, v76, 5, v92
    v_lshrrev_b32 v76, 1, v3
    v_lshl_add_u32 v92, v76, 4, v92
    v_pk_fma_f32 v[48:49], v[64:65], v[80:81], v[48:49] op_sel_hi:[1,0,1] neg_lo:[0,1,0] neg_hi:[0,1,0]
    v_pk_mul_f32 v[48:49], v[48:49], v[80:81] op_sel:[0,1] op_sel_hi:[1,1]
    v_pk_mul_f32 v[88:89], v[48:49], v[48:49]
    v_pk_mul_f32 v[90:91], v[48:49], s[54:55] op_sel:[0,1] op_sel_hi:[1,1]
    v_pk_fma_f32 v[88:89], v[88:89], s[54:55], 1.0 op_sel_hi:[1,0,0]
    v_pk_mul_f32 v[88:89], v[88:89], v[90:91]
    v_exp_f32 v88, v88
    v_exp_f32 v89, v89
    s_nop 0
    v_pk_add_f32 v[88:89], v[88:89], 1.0 op_sel_hi:[1,0]
    v_rcp_f32 v88, v88
    v_rcp_f32 v89, v89
    s_nop 0
    v_pk_mul_f32 v[48:49], v[48:49], v[88:89]
    v_pk_fma_f32 v[50:51], v[66:67], v[80:81], v[50:51] op_sel_hi:[1,0,1] neg_lo:[0,1,0] neg_hi:[0,1,0]
    v_pk_mul_f32 v[50:51], v[50:51], v[80:81] op_sel:[0,1] op_sel_hi:[1,1]
    v_pk_mul_f32 v[88:89], v[50:51], v[50:51]
    v_pk_mul_f32 v[90:91], v[50:51], s[54:55] op_sel:[0,1] op_sel_hi:[1,1]
    v_pk_fma_f32 v[88:89], v[88:89], s[54:55], 1.0 op_sel_hi:[1,0,0]
    v_pk_mul_f32 v[88:89], v[88:89], v[90:91]
    v_exp_f32 v88, v88
    v_exp_f32 v89, v89
    s_nop 0
    v_pk_add_f32 v[88:89], v[88:89], 1.0 op_sel_hi:[1,0]
    v_rcp_f32 v88, v88
    v_rcp_f32 v89, v89
    s_nop 0
    v_pk_mul_f32 v[50:51], v[50:51], v[88:89]
    v_pk_fma_f32 v[52:53], v[68:69], v[80:81], v[52:53] op_sel_hi:[1,0,1] neg_lo:[0,1,0] neg_hi:[0,1,0]
    v_pk_mul_f32 v[52:53], v[52:53], v[80:81] op_sel:[0,1] op_sel_hi:[1,1]
    v_pk_mul_f32 v[88:89], v[52:53], v[52:53]
    v_pk_mul_f32 v[90:91], v[52:53], s[54:55] op_sel:[0,1] op_sel_hi:[1,1]
    v_pk_fma_f32 v[88:89], v[88:89], s[54:55], 1.0 op_sel_hi:[1,0,0]
    v_pk_mul_f32 v[88:89], v[88:89], v[90:91]
    v_exp_f32 v88, v88
    v_exp_f32 v89, v89
    s_nop 0
    v_pk_add_f32 v[88:89], v[88:89], 1.0 op_sel_hi:[1,0]
    v_rcp_f32 v88, v88
    v_rcp_f32 v89, v89
    s_nop 0
    v_pk_mul_f32 v[52:53], v[52:53], v[88:89]
    v_pk_fma_f32 v[54:55], v[70:71], v[80:81], v[54:55] op_sel_hi:[1,0,1] neg_lo:[0,1,0] neg_hi:[0,1,0]
    v_pk_mul_f32 v[54:55], v[54:55], v[80:81] op_sel:[0,1] op_sel_hi:[1,1]
    v_pk_mul_f32 v[88:89], v[54:55], v[54:55]
    v_pk_mul_f32 v[90:91], v[54:55], s[54:55] op_sel:[0,1] op_sel_hi:[1,1]
    v_pk_fma_f32 v[88:89], v[88:89], s[54:55], 1.0 op_sel_hi:[1,0,0]
    v_pk_mul_f32 v[88:89], v[88:89], v[90:91]
    v_exp_f32 v88, v88
    v_exp_f32 v89, v89
    s_nop 0
    v_pk_add_f32 v[88:89], v[88:89], 1.0 op_sel_hi:[1,0]
    v_rcp_f32 v88, v88
    v_rcp_f32 v89, v89
    s_nop 0
    v_pk_mul_f32 v[54:55], v[54:55], v[88:89]
    v_cvt_pk_bf16_f32 v96, v48, v49
    v_cvt_pk_bf16_f32 v97, v50, v51
    v_cvt_pk_bf16_f32 v98, v52, v53
    v_cvt_pk_bf16_f32 v99, v54, v55
    s_nop 1
    v_permlane16_swap_b32 v96, v98
    v_permlane16_swap_b32 v97, v99
    s_and_b32 s37, s86, 1
    s_lshl_b32 s37, s37, 6
    s_mul_i32 s38, s88, 112
    s_add_u32 s37, s37, s38
    s_add_u32 s37, s37, 0
    s_and_b32 s38, s86, 1
    s_cmp_eq_u32 s38, 1
    s_cselect_b32 exec_hi, 0xffff, -1
    s_lshr_b32 s57, s86, 1
    s_cmp_eq_u32 s57, 0
    s_cselect_b32 s57, s92, s91
    s_cmp_eq_u32 s57, 1
    s_cbranch_scc1 Ls49_p
    buffer_store_dwordx4 v[96:99], v92, s[16:19], s37 offen sc1
    s_branch Ls49_d
Ls49_p:
    buffer_store_dwordx4 v[96:99], v92, s[16:19], s37 offen
Ls49_d:
    s_mov_b64 exec, -1
    s_nop 1
    v_pk_fma_f32 v[56:57], v[64:65], v[82:83], v[56:57] op_sel_hi:[1,0,1] neg_lo:[0,1,0] neg_hi:[0,1,0]
    v_pk_mul_f32 v[56:57], v[56:57], v[82:83] op_sel:[0,1] op_sel_hi:[1,1]
    v_pk_mul_f32 v[88:89], v[56:57], v[56:57]
    v_pk_mul_f32 v[90:91], v[56:57], s[54:55] op_sel:[0,1] op_sel_hi:[1,1]
    v_pk_fma_f32 v[88:89], v[88:89], s[54:55], 1.0 op_sel_hi:[1,0,0]
    v_pk_mul_f32 v[88:89], v[88:89], v[90:91]
    v_exp_f32 v88, v88
    v_exp_f32 v89, v89
    s_nop 0
    v_pk_add_f32 v[88:89], v[88:89], 1.0 op_sel_hi:[1,0]
    v_rcp_f32 v88, v88
    v_rcp_f32 v89, v89
    s_nop 0
    v_pk_mul_f32 v[56:57], v[56:57], v[88:89]
    v_pk_fma_f32 v[58:59], v[66:67], v[82:83], v[58:59] op_sel_hi:[1,0,1] neg_lo:[0,1,0] neg_hi:[0,1,0]
    v_pk_mul_f32 v[58:59], v[58:59], v[82:83] op_sel:[0,1] op_sel_hi:[1,1]
    v_pk_mul_f32 v[88:89], v[58:59], v[58:59]
    v_pk_mul_f32 v[90:91], v[58:59], s[54:55] op_sel:[0,1] op_sel_hi:[1,1]
    v_pk_fma_f32 v[88:89], v[88:89], s[54:55], 1.0 op_sel_hi:[1,0,0]
    v_pk_mul_f32 v[88:89], v[88:89], v[90:91]
    v_exp_f32 v88, v88
    v_exp_f32 v89, v89
    s_nop 0
    v_pk_add_f32 v[88:89], v[88:89], 1.0 op_sel_hi:[1,0]
    v_rcp_f32 v88, v88
    v_rcp_f32 v89, v89
    s_nop 0
    v_pk_mul_f32 v[58:59], v[58:59], v[88:89]
    v_pk_fma_f32 v[60:61], v[68:69], v[82:83], v[60:61] op_sel_hi:[1,0,1] neg_lo:[0,1,0] neg_hi:[0,1,0]
    v_pk_mul_f32 v[60:61], v[60:61], v[82:83] op_sel:[0,1] op_sel_hi:[1,1]
    v_pk_mul_f32 v[88:89], v[60:61], v[60:61]
    v_pk_mul_f32 v[90:91], v[60:61], s[54:55] op_sel:[0,1] op_sel_hi:[1,1]
    v_pk_fma_f32 v[88:89], v[88:89], s[54:55], 1.0 op_sel_hi:[1,0,0]
    v_pk_mul_f32 v[88:89], v[88:89], v[90:91]
    v_exp_f32 v88, v88
    v_exp_f32 v89, v89
    s_nop 0
    v_pk_add_f32 v[88:89], v[88:89], 1.0 op_sel_hi:[1,0]
    v_rcp_f32 v88, v88
    v_rcp_f32 v89, v89
    s_nop 0
    v_pk_mul_f32 v[60:61], v[60:61], v[88:89]
    v_pk_fma_f32 v[62:63], v[70:71], v[82:83], v[62:63] op_sel_hi:[1,0,1] neg_lo:[0,1,0] neg_hi:[0,1,0]
    v_pk_mul_f32 v[62:63], v[62:63], v[82:83] op_sel:[0,1] op_sel_hi:[1,1]
    v_pk_mul_f32 v[88:89], v[62:63], v[62:63]
    v_pk_mul_f32 v[90:91], v[62:63], s[54:55] op_sel:[0,1] op_sel_hi:[1,1]
    v_pk_fma_f32 v[88:89], v[88:89], s[54:55], 1.0 op_sel_hi:[1,0,0]
    v_pk_mul_f32 v[88:89], v[88:89], v[90:91]
    v_exp_f32 v88, v88
    v_exp_f32 v89, v89
    s_nop 0
    v_pk_add_f32 v[88:89], v[88:89], 1.0 op_sel_hi:[1,0]
    v_rcp_f32 v88, v88
    v_rcp_f32 v89, v89
    s_nop 0
    v_pk_mul_f32 v[62:63], v[62:63], v[88:89]
    v_cvt_pk_bf16_f32 v96, v56, v57
    v_cvt_pk_bf16_f32 v97, v58, v59
    v_cvt_pk_bf16_f32 v98, v60, v61
    v_cvt_pk_bf16_f32 v99, v62, v63
    s_nop 1
    v_permlane16_swap_b32 v96, v98
    v_permlane16_swap_b32 v97, v99
    s_and_b32 s37, s86, 1
    s_lshl_b32 s37, s37, 6
    s_mul_i32 s38, s88, 112
    s_add_u32 s37, s37, s38
    s_add_u32 s37, s37, 14336
    s_and_b32 s38, s86, 1
    s_cmp_eq_u32 s38, 1
    s_cselect_b32 exec_hi, 0xffff, -1
    s_lshr_b32 s57, s86, 1
    s_cmp_eq_u32 s57, 1
    s_cselect_b32 s57, s93, s91
    s_cmp_eq_u32 s57, 1
    s_cbranch_scc1 Ls50_p
    buffer_store_dwordx4 v[96:99], v92, s[16:19], s37 offen sc1
    s_branch Ls50_d
Ls50_p:
    buffer_store_dwordx4 v[96:99], v92, s[16:19], s37 offen
Ls50_d:
    s_mov_b64 exec, -1
    s_nop 1
    s_mov_b32 s12, s74
    s_mov_b32 s13, s75
    s_mov_b32 s14, 401408
    s_mov_b32 s15, 0x00020000
    s_lshl_b32 s32, s86, 10
    s_and_b32 s40, s86, 1
    s_mul_i32 s35, s86, 7168
    v_lshrrev_b32 v95, 3, v1
    v_bfe_u32 v93, v1, 4, 1
    v_lshlrev_b32 v93, 1, v93
    s_lshl_b32 s37, s40, 2
    v_add_u32 v93, s37, v93
    v_and_b32 v94, 7, v1
    v_xor_b32 v94, v94, v93
    s_mov_b32 s39, 896
    v_mul_lo_u32 v93, v95, s39
    v_lshl_add_u32 v96, v94, 4, v93
    s_mul_i32 s42, s88, 112
    s_add_u32 s42, s42, 0
    s_add_u32 m0, s32, 57344
    s_add_u32 s37, s35, 0
    s_add_u32 s37, s37, s42
    buffer_load_dwordx4 v96, s[12:15], s37 offen lds
    s_add_u32 m0, s32, 61440
    s_add_u32 s37, s35, 28672
    s_add_u32 s37, s37, s42
    buffer_load_dwordx4 v96, s[12:15], s37 offen lds
    s_add_u32 m0, s32, 65536
    s_add_u32 s37, s35, 57344
    s_add_u32 s37, s37, s42
    buffer_load_dwordx4 v96, s[12:15], s37 offen lds
    s_add_u32 m0, s32, 69632
    s_add_u32 s37, s35, 86016
    s_add_u32 s37, s37, s42
    buffer_load_dwordx4 v96, s[12:15], s37 offen lds
    s_add_u32 m0, s32, 73728
    s_add_u32 s37, s35, 114688
    s_add_u32 s37, s37, s42
    buffer_load_dwordx4 v96, s[12:15], s37 offen lds
    s_add_u32 m0, s32, 77824
    s_add_u32 s37, s35, 143360
    s_add_u32 s37, s37, s42
    buffer_load_dwordx4 v96, s[12:15], s37 offen lds
    s_add_u32 m0, s32, 81920
    s_add_u32 s37, s35, 172032
    s_add_u32 s37, s37, s42
    buffer_load_dwordx4 v96, s[12:15], s37 offen lds
    s_add_u32 m0, s32, 86016
    s_add_u32 s37, s35, 200704
    s_add_u32 s37, s37, s42
    buffer_load_dwordx4 v96, s[12:15], s37 offen lds
    s_add_u32 m0, s32, 90112
    s_add_u32 s37, s35, 229376
    s_add_u32 s37, s37, s42
    buffer_load_dwordx4 v96, s[12:15], s37 offen lds
    s_add_u32 m0, s32, 94208
    s_add_u32 s37, s35, 258048
    s_add_u32 s37, s37, s42
    buffer_load_dwordx4 v96, s[12:15], s37 offen lds
    s_add_u32 m0, s32, 98304
    s_add_u32 s37, s35, 286720
    s_add_u32 s37, s37, s42
    buffer_load_dwordx4 v96, s[12:15], s37 offen lds
    s_add_u32 m0, s32, 102400
    s_add_u32 s37, s35, 315392
    s_add_u32 s37, s37, s42
    buffer_load_dwordx4 v96, s[12:15], s37 offen lds
    s_add_u32 m0, s32, 106496
    s_add_u32 s37, s35, 344064
    s_add_u32 s37, s37, s42
    buffer_load_dwordx4 v96, s[12:15], s37 offen lds
    s_add_u32 m0, s32, 110592
    s_add_u32 s37, s35, 372736
    s_add_u32 s37, s37, s42
    buffer_load_dwordx4 v96, s[12:15], s37 offen lds
    s_waitcnt vmcnt(14)
    s_lshl_b32 s32, s89, 7
    s_lshl_b32 s33, s86, 2
    s_add_u32 s32, s32, s33
    v_mov_b32 v93, s32
    v_mov_b32 v94, 10
    s_mov_b64 exec, 1
    s_and_b32 s57, s92, s93
    s_cmp_eq_u32 s57, 1
    s_cbranch_scc1 Ls51_p
    buffer_store_dword v94, v93, s[24:27], 0 offen sc1
    s_branch Ls51_d
Ls51_p:
    buffer_store_dword v94, v93, s[24:27], 0 offen
Ls51_d:
    s_mov_b64 exec, -1
    s_barrier
    s_add_u32 s8, s84, 17825792
    s_addc_u32 s9, s85, 0
    s_mov_b32 s10, 1835008
    s_mov_b32 s11, 0x00020000
    s_mov_b32 s12, s74
    s_mov_b32 s13, s75
    s_mov_b32 s14, 401408
    s_mov_b32 s15, 0x00020000
    s_lshl_b32 s32, s86, 10
    s_and_b32 s40, s86, 1
    s_add_u32 s33, s40, 8
    s_mul_i32 s34, s86, 7168
    s_mul_i32 s35, s86, 7168
    s_mul_i32 s36, s88, 112
    v_lshrrev_b32 v5, 3, v1
    v_lshrrev_b32 v7, 4, v1
    s_lshl_b32 s37, s40, 2
    v_add_u32 v7, s37, v7
    v_and_b32 v6, 7, v1
    v_xor_b32 v6, v6, v7
    s_lshl_b32 s37, s87, 6
    s_lshl_b32 s38, s86, 3
    s_add_u32 s38, s38, 0
    s_add_u32 s38, s38, s37
    v_add_u32 v7, s38, v5
    s_mov_b32 s39, 896
    v_mul_lo_u32 v7, v7, s39
    v_lshl_add_u32 v9, v6, 4, v7
    s_lshl_b32 s38, s86, 3
    s_add_u32 s38, s38, 32
    s_add_u32 s38, s38, s37
    v_add_u32 v7, s38, v5
    s_mov_b32 s39, 896
    v_mul_lo_u32 v7, v7, s39
    v_lshl_add_u32 v10, v6, 4, v7
    v_bfe_u32 v7, v1, 4, 1
    v_lshlrev_b32 v7, 1, v7
    s_lshl_b32 s37, s40, 2
    v_add_u32 v7, s37, v7
    v_and_b32 v8, 7, v1
    v_xor_b32 v8, v8, v7
    s_mov_b32 s39, 896
    v_mul_lo_u32 v7, v5, s39
    v_lshl_add_u32 v11, v8, 4, v7
    s_add_u32 s42, s36, 0
    s_cmp_lg_u32 s86, 0
    s_cbranch_scc1 Lp52_skip
    v_lshrrev_b32 v15, 3, v1
    v_add_u32 v15, s87, v15
    v_add_u32 v15, -1, v15
    v_mov_b32 v16, s87
    v_cmp_gt_u32 vcc, 32, v15
    s_nop 1
    v_cndmask_b32 v15, v16, v15, vcc
    v_and_b32 v14, 7, v1
    v_lshlrev_b32 v14, 5, v14
    v_and_b32 v16, 3, v15
    v_lshl_add_u32 v14, v16, 3, v14
    v_lshrrev_b32 v16, 2, v15
    v_add_u32 v14, v14, v16
    v_lshlrev_b32 v14, 7, v14
    v_add_u32 v14, 0, v14
    v_mov_b32 v24, 0
    s_mov_b32 s52, 0
    s_mov_b32 s53, 10
    s_mov_b32 exec_lo, 16777215
    s_mov_b32 exec_hi, 0
Lp52_loop:
    buffer_load_dwordx4 v[20:23], v14, s[24:27], 0 offen sc1
    s_waitcnt vmcnt(0)
    v_min_u32 v20, v20, v21
    v_min_u32 v22, v22, v23
    v_min_u32 v20, v20, v22
    v_cmp_gt_u32 vcc, s53, v20
    s_cbranch_vccz Lp52_ok
Lp52_again:
    s_add_u32 s52, s52, 1
    s_cmp_lt_u32 s52, 20000
    s_cbranch_scc1 Lp52_loop
Lp52_ok:
    s_mov_b64 exec, -1
Lp52_skip:
    s_barrier
    v_mov_b32 v12, -896
    s_add_u32 m0, s32, 0
    v_add_u32 v7, v12, v9
    s_mov_b32 s37, 0
    buffer_load_dwordx4 v7, s[8:11], s37 offen lds
    s_add_u32 m0, s32, 4096
    v_add_u32 v7, v12, v10
    s_mov_b32 s37, 0
    buffer_load_dwordx4 v7, s[8:11], s37 offen lds
    v_mov_b32 v13, 896
    v_mov_b32 v12, -896
    v_cmp_le_u32 vcc, 6, v6
    s_nop 1
    v_cndmask_b32 v12, v12, v13, vcc
    s_add_u32 m0, s32, 8192
    v_add_u32 v7, v12, v9
    s_mov_b32 s37, 128
    buffer_load_dwordx4 v7, s[8:11], s37 offen lds
    s_add_u32 m0, s32, 12288
    v_add_u32 v7, v12, v10
    s_mov_b32 s37, 128
    buffer_load_dwordx4 v7, s[8:11], s37 offen lds
    v_mov_b32 v12, 896
    s_add_u32 m0, s32, 16384
    v_add_u32 v7, v12, v9
    s_mov_b32 s37, 256
    buffer_load_dwordx4 v7, s[8:11], s37 offen lds
    s_add_u32 m0, s32, 20480
    v_add_u32 v7, v12, v10
    s_mov_b32 s37, 256
    buffer_load_dwordx4 v7, s[8:11], s37 offen lds
    v_mov_b32 v13, -1792
    v_mov_b32 v12, 896
    v_cmp_le_u32 vcc, 4, v6
    s_nop 1
    v_cndmask_b32 v12, v12, v13, vcc
    s_add_u32 m0, s32, 24576
    v_add_u32 v7, v12, v9
    s_mov_b32 s37, 384
    buffer_load_dwordx4 v7, s[8:11], s37 offen lds
    s_add_u32 m0, s32, 28672
    v_add_u32 v7, v12, v10
    s_mov_b32 s37, 384
    buffer_load_dwordx4 v7, s[8:11], s37 offen lds
    v_mov_b32 v12, -1792
    s_add_u32 m0, s32, 32768
    v_add_u32 v7, v12, v9
    s_mov_b32 s37, 512
    buffer_load_dwordx4 v7, s[8:11], s37 offen lds
    s_add_u32 m0, s32, 36864
    v_add_u32 v7, v12, v10
    s_mov_b32 s37, 512
    buffer_load_dwordx4 v7, s[8:11], s37 offen lds
    v_mov_b32 v13, 1792
    v_mov_b32 v12, -1792
    v_cmp_le_u32 vcc, 2, v6
    s_nop 1
    v_cndmask_b32 v12, v12, v13, vcc
    s_add_u32 m0, s32, 40960
    v_add_u32 v7, v12, v9
    s_mov_b32 s37, 640
    buffer_load_dwordx4 v7, s[8:11], s37 offen lds
    s_add_u32 m0, s32, 45056
    v_add_u32 v7, v12, v10
    s_mov_b32 s37, 640
    buffer_load_dwordx4 v7, s[8:11], s37 offen lds
    v_mov_b32 v12, 1792
    s_add_u32 m0, s32, 49152
    v_add_u32 v7, v12, v9
    s_mov_b32 s37, 768
    buffer_load_dwordx4 v7, s[8:11], s37 offen lds
    s_add_u32 m0, s32, 53248
    v_add_u32 v7, v12, v10
    s_mov_b32 s37, 768
    buffer_load_dwordx4 v7, s[8:11], s37 offen lds
    s_lshl_b32 s37, s87, 6
    s_lshr_b32 s38, s86, 1
    s_mul_i32 s38, s38, 32
    s_add_u32 s37, s37, s38
    v_add_u32 v15, s37, v2
    s_mov_b32 s38, 896
    v_mul_lo_u32 v15, v15, s38
    v_lshl_add_u32 v14, v3, 3, v15
    s_and_b32 s37, s86, 1
    s_lshl_b32 s37, s37, 6
    s_mul_i32 s38, s88, 112
    s_add_u32 s37, s37, s38
    v_add_u32 v14, s37, v14
    s_add_u32 s20, s84, 15728640
    s_addc_u32 s21, s85, 0
    s_mov_b32 s22, 1835008
    s_mov_b32 s23, 0x00020000
    s_mov_b32 s37, 0
    buffer_load_dwordx2 v[16:17], v14, s[20:23], s37 offen offset:0
    buffer_load_dwordx2 v[18:19], v14, s[20:23], s37 offen offset:32
    s_mov_b32 s37, 14336
    buffer_load_dwordx2 v[20:21], v14, s[20:23], s37 offen offset:0
    buffer_load_dwordx2 v[22:23], v14, s[20:23], s37 offen offset:32
    s_add_u32 s20, s84, 24117248
    s_addc_u32 s21, s85, 0
    s_mov_b32 s22, 16384
    s_mov_b32 s23, 0x00020000
    s_lshl_b32 s37, s87, 6
    s_lshr_b32 s38, s86, 1
    s_mul_i32 s38, s38, 32
    s_add_u32 s37, s37, s38
    v_add_u32 v24, s37, v2
    v_lshlrev_b32 v24, 3, v24
    buffer_load_dwordx2 v[26:27], v24, s[20:23], 0 offen offset:0
    buffer_load_dwordx2 v[28:29], v24, s[20:23], 0 offen offset:128
    v_lshrrev_b32 v7, 1, v2
    v_and_b32 v7, 7, v7
    v_add_u32 v8, 0, v3
    v_xor_b32 v8, v8, v7
    v_lshlrev_b32 v8, 4, v8
    v_lshl_add_u32 v30, v2, 7, v8
    v_add_u32 v8, 4, v3
    v_xor_b32 v8, v8, v7
    v_lshlrev_b32 v8, 4, v8
    v_lshl_add_u32 v31, v2, 7, v8
    s_lshr_b32 s37, s86, 1
    s_mul_i32 s37, s37, 4096
    v_add_u32 v30, s37, v30
    v_add_u32 v31, s37, v31
    v_lshrrev_b32 v34, 2, v2
    v_lshl_add_u32 v34, v3, 3, v34
    v_lshlrev_b32 v34, 7, v34
    v_bfe_u32 v35, v2, 3, 1
    v_lshlrev_b32 v35, 2, v35
    v_and_b32 v7, 1, v3
    v_lshl_add_u32 v35, v7, 3, v35
    v_and_b32 v36, 3, v2
    s_and_b32 s37, s86, 1
    s_mul_i32 s37, s37, 2
    s_add_u32 s38, s37, 0
    s_and_b32 s39, s38, 3
    s_lshl_b32 s39, s39, 2
    v_add_u32 v7, s39, v36
    v_xor_b32 v7, v7, v35
    v_lshl_add_u32 v7, v7, 3, v34
    s_lshr_b32 s38, s38, 2
    s_lshl_b32 s38, s38, 13
    v_add_u32 v32, s38, v7
    s_add_u32 s38, s37, 1
    s_and_b32 s39, s38, 3
    s_lshl_b32 s39, s39, 2
    v_add_u32 v7, s39, v36
    v_xor_b32 v7, v7, v35
    v_lshl_add_u32 v7, v7, 3, v34
    s_lshr_b32 s38, s38, 2
    s_lshl_b32 s38, s38, 13
    v_add_u32 v33, s38, v7
    v_add_u32 v37, 65536, v30
    v_add_u32 v38, 65536, v31
    v_add_u32 v39, 65536, v32
    v_add_u32 v40, 65536, v33
    v_mov_b32 v44, 0
    v_mov_b32 v45, 0
    v_mov_b32 v46, 0
    v_mov_b32 v47, 0
    v_mov_b32 v48, 0
    v_mov_b32 v49, 0
    v_mov_b32 v50, 0
    v_mov_b32 v51, 0
    v_mov_b32 v52, 0
    v_mov_b32 v53, 0
    v_mov_b32 v54, 0
    v_mov_b32 v55, 0
    v_mov_b32 v56, 0
    v_mov_b32 v57, 0
    v_mov_b32 v58, 0
    v_mov_b32 v59, 0
    s_waitcnt vmcnt(31)
    s_waitcnt vmcnt(16)
    s_barrier
    ds_read_b128 v[60:63], v30 offset:0
    ds_read_b128 v[64:67], v30 offset:2048
    ds_read_b64_tr_b16 v[76:77], v32 offset:57344
    ds_read_b64_tr_b16 v[78:79], v32 offset:57856
    ds_read_b64_tr_b16 v[80:81], v33 offset:57344
    ds_read_b64_tr_b16 v[82:83], v33 offset:57856
    s_waitcnt lgkmcnt(0)
    v_mfma_f32_16x16x32_bf16 v[44:47], v[76:79], v[60:63], v[44:47]
    ds_read_b128 v[68:71], v31 offset:0
    ds_read_b128 v[72:75], v31 offset:2048
    ds_read_b64_tr_b16 v[84:85], v32 offset:61440
    v_mfma_f32_16x16x32_bf16 v[52:55], v[76:79], v[64:67], v[52:55]
    ds_read_b64_tr_b16 v[86:87], v32 offset:61952
    ds_read_b64_tr_b16 v[88:89], v33 offset:61440
    ds_read_b64_tr_b16 v[90:91], v33 offset:61952
    v_mfma_f32_16x16x32_bf16 v[48:51], v[80:83], v[60:63], v[48:51]
    v_mfma_f32_16x16x32_bf16 v[56:59], v[80:83], v[64:67], v[56:59]
    s_waitcnt lgkmcnt(0)
    v_mfma_f32_16x16x32_bf16 v[44:47], v[84:87], v[68:71], v[44:47]
    ds_read_b128 v[60:63], v30 offset:8192
    ds_read_b128 v[64:67], v30 offset:10240
    ds_read_b64_tr_b16 v[76:77], v39 offset:0
    v_mfma_f32_16x16x32_bf16 v[52:55], v[84:87], v[72:75], v[52:55]
    ds_read_b64_tr_b16 v[78:79], v39 offset:512
    ds_read_b64_tr_b16 v[80:81], v40 offset:0
    ds_read_b64_tr_b16 v[82:83], v40 offset:512
    v_mfma_f32_16x16x32_bf16 v[48:51], v[88:91], v[68:71], v[48:51]
    v_mfma_f32_16x16x32_bf16 v[56:59], v[88:91], v[72:75], v[56:59]
    s_waitcnt lgkmcnt(0)
    v_mfma_f32_16x16x32_bf16 v[44:47], v[76:79], v[60:63], v[44:47]
    ds_read_b128 v[68:71], v31 offset:8192
    ds_read_b128 v[72:75], v31 offset:10240
    ds_read_b64_tr_b16 v[84:85], v39 offset:4096
    v_mfma_f32_16x16x32_bf16 v[52:55], v[76:79], v[64:67], v[52:55]
    ds_read_b64_tr_b16 v[86:87], v39 offset:4608
    ds_read_b64_tr_b16 v[88:89], v40 offset:4096
    ds_read_b64_tr_b16 v[90:91], v40 offset:4608
    v_mfma_f32_16x16x32_bf16 v[48:51], v[80:83], v[60:63], v[48:51]
    v_mfma_f32_16x16x32_bf16 v[56:59], v[80:83], v[64:67], v[56:59]
    s_waitcnt lgkmcnt(0)
    s_waitcnt vmcnt(10)
    s_barrier
    v_mfma_f32_16x16x32_bf16 v[44:47], v[84:87], v[68:71], v[44:47]
    ds_read_b128 v[60:63], v30 offset:16384
    ds_read_b128 v[64:67], v30 offset:18432
    ds_read_b64_tr_b16 v[76:77], v39 offset:8192
    v_mfma_f32_16x16x32_bf16 v[52:55], v[84:87], v[72:75], v[52:55]
    ds_read_b64_tr_b16 v[78:79], v39 offset:8704
    ds_read_b64_tr_b16 v[80:81], v40 offset:8192
    ds_read_b64_tr_b16 v[82:83], v40 offset:8704
    v_mfma_f32_16x16x32_bf16 v[48:51], v[88:91], v[68:71], v[48:51]
    v_mfma_f32_16x16x32_bf16 v[56:59], v[88:91], v[72:75], v[56:59]
    s_waitcnt lgkmcnt(0)
    v_mfma_f32_16x16x32_bf16 v[44:47], v[76:79], v[60:63], v[44:47]
    ds_read_b128 v[68:71], v31 offset:16384
    ds_read_b128 v[72:75], v31 offset:18432
    ds_read_b64_tr_b16 v[84:85], v39 offset:12288
    v_mfma_f32_16x16x32_bf16 v[52:55], v[76:79], v[64:67], v[52:55]
    ds_read_b64_tr_b16 v[86:87], v39 offset:12800
    ds_read_b64_tr_b16 v[88:89], v40 offset:12288
    ds_read_b64_tr_b16 v[90:91], v40 offset:12800
    v_mfma_f32_16x16x32_bf16 v[48:51], v[80:83], v[60:63], v[48:51]
    v_mfma_f32_16x16x32_bf16 v[56:59], v[80:83], v[64:67], v[56:59]
    s_waitcnt lgkmcnt(0)
    v_mfma_f32_16x16x32_bf16 v[44:47], v[84:87], v[68:71], v[44:47]
    ds_read_b128 v[60:63], v30 offset:24576
    ds_read_b128 v[64:67], v30 offset:26624
    ds_read_b64_tr_b16 v[76:77], v39 offset:16384
    v_mfma_f32_16x16x32_bf16 v[52:55], v[84:87], v[72:75], v[52:55]
    ds_read_b64_tr_b16 v[78:79], v39 offset:16896
    ds_read_b64_tr_b16 v[80:81], v40 offset:16384
    ds_read_b64_tr_b16 v[82:83], v40 offset:16896
    v_mfma_f32_16x16x32_bf16 v[48:51], v[88:91], v[68:71], v[48:51]
    v_mfma_f32_16x16x32_bf16 v[56:59], v[88:91], v[72:75], v[56:59]
    s_waitcnt lgkmcnt(0)
    v_mfma_f32_16x16x32_bf16 v[44:47], v[76:79], v[60:63], v[44:47]
    ds_read_b128 v[68:71], v31 offset:24576
    ds_read_b128 v[72:75], v31 offset:26624
    ds_read_b64_tr_b16 v[84:85], v39 offset:20480
    v_mfma_f32_16x16x32_bf16 v[52:55], v[76:79], v[64:67], v[52:55]
    ds_read_b64_tr_b16 v[86:87], v39 offset:20992
    ds_read_b64_tr_b16 v[88:89], v40 offset:20480
    ds_read_b64_tr_b16 v[90:91], v40 offset:20992
    v_mfma_f32_16x16x32_bf16 v[48:51], v[80:83], v[60:63], v[48:51]
    v_mfma_f32_16x16x32_bf16 v[56:59], v[80:83], v[64:67], v[56:59]
    s_waitcnt lgkmcnt(0)
    v_mfma_f32_16x16x32_bf16 v[44:47], v[84:87], v[68:71], v[44:47]
    ds_read_b128 v[60:63], v30 offset:32768
    ds_read_b128 v[64:67], v30 offset:34816
    ds_read_b64_tr_b16 v[76:77], v39 offset:24576
    v_mfma_f32_16x16x32_bf16 v[52:55], v[84:87], v[72:75], v[52:55]
    ds_read_b64_tr_b16 v[78:79], v39 offset:25088
    ds_read_b64_tr_b16 v[80:81], v40 offset:24576
    ds_read_b64_tr_b16 v[82:83], v40 offset:25088
    v_mfma_f32_16x16x32_bf16 v[48:51], v[88:91], v[68:71], v[48:51]
    v_mfma_f32_16x16x32_bf16 v[56:59], v[88:91], v[72:75], v[56:59]
    s_waitcnt lgkmcnt(0)
    v_mfma_f32_16x16x32_bf16 v[44:47], v[76:79], v[60:63], v[44:47]
    ds_read_b128 v[68:71], v31 offset:32768
    ds_read_b128 v[72:75], v31 offset:34816
    ds_read_b64_tr_b16 v[84:85], v39 offset:28672
    v_mfma_f32_16x16x32_bf16 v[52:55], v[76:79], v[64:67], v[52:55]
    ds_read_b64_tr_b16 v[86:87], v39 offset:29184
    ds_read_b64_tr_b16 v[88:89], v40 offset:28672
    ds_read_b64_tr_b16 v[90:91], v40 offset:29184
    v_mfma_f32_16x16x32_bf16 v[48:51], v[80:83], v[60:63], v[48:51]
    v_mfma_f32_16x16x32_bf16 v[56:59], v[80:83], v[64:67], v[56:59]
    s_waitcnt lgkmcnt(0)
    s_waitcnt vmcnt(6)
    s_barrier
    v_mfma_f32_16x16x32_bf16 v[44:47], v[84:87], v[68:71], v[44:47]
    ds_read_b128 v[60:63], v30 offset:40960
    ds_read_b128 v[64:67], v30 offset:43008
    ds_read_b64_tr_b16 v[76:77], v39 offset:32768
    v_mfma_f32_16x16x32_bf16 v[52:55], v[84:87], v[72:75], v[52:55]
    ds_read_b64_tr_b16 v[78:79], v39 offset:33280
    ds_read_b64_tr_b16 v[80:81], v40 offset:32768
    ds_read_b64_tr_b16 v[82:83], v40 offset:33280
    v_mfma_f32_16x16x32_bf16 v[48:51], v[88:91], v[68:71], v[48:51]
    v_mfma_f32_16x16x32_bf16 v[56:59], v[88:91], v[72:75], v[56:59]
    s_waitcnt lgkmcnt(0)
    v_mfma_f32_16x16x32_bf16 v[44:47], v[76:79], v[60:63], v[44:47]
    ds_read_b128 v[68:71], v31 offset:40960
    ds_read_b128 v[72:75], v31 offset:43008
    ds_read_b64_tr_b16 v[84:85], v39 offset:36864
    v_mfma_f32_16x16x32_bf16 v[52:55], v[76:79], v[64:67], v[52:55]
    ds_read_b64_tr_b16 v[86:87], v39 offset:37376
    ds_read_b64_tr_b16 v[88:89], v40 offset:36864
    ds_read_b64_tr_b16 v[90:91], v40 offset:37376
    v_mfma_f32_16x16x32_bf16 v[48:51], v[80:83], v[60:63], v[48:51]
    v_mfma_f32_16x16x32_bf16 v[56:59], v[80:83], v[64:67], v[56:59]
    s_waitcnt lgkmcnt(0)
    v_mfma_f32_16x16x32_bf16 v[44:47], v[84:87], v[68:71], v[44:47]
    ds_read_b128 v[60:63], v30 offset:49152
    ds_read_b128 v[64:67], v30 offset:51200
    ds_read_b64_tr_b16 v[76:77], v39 offset:40960
    v_mfma_f32_16x16x32_bf16 v[52:55], v[84:87], v[72:75], v[52:55]
    ds_read_b64_tr_b16 v[78:79], v39 offset:41472
    ds_read_b64_tr_b16 v[80:81], v40 offset:40960
    ds_read_b64_tr_b16 v[82:83], v40 offset:41472
    v_mfma_f32_16x16x32_bf16 v[48:51], v[88:91], v[68:71], v[48:51]
    v_mfma_f32_16x16x32_bf16 v[56:59], v[88:91], v[72:75], v[56:59]
    s_waitcnt lgkmcnt(0)
    v_mfma_f32_16x16x32_bf16 v[44:47], v[76:79], v[60:63], v[44:47]
    ds_read_b128 v[68:71], v31 offset:49152
    ds_read_b128 v[72:75], v31 offset:51200
    ds_read_b64_tr_b16 v[84:85], v39 offset:45056
    v_mfma_f32_16x16x32_bf16 v[52:55], v[76:79], v[64:67], v[52:55]
    ds_read_b64_tr_b16 v[86:87], v39 offset:45568
    ds_read_b64_tr_b16 v[88:89], v40 offset:45056
    ds_read_b64_tr_b16 v[90:91], v40 offset:45568
    v_mfma_f32_16x16x32_bf16 v[48:51], v[80:83], v[60:63], v[48:51]
    v_mfma_f32_16x16x32_bf16 v[56:59], v[80:83], v[64:67], v[56:59]
    s_waitcnt lgkmcnt(0)
    v_mfma_f32_16x16x32_bf16 v[44:47], v[84:87], v[68:71], v[44:47]
    v_mfma_f32_16x16x32_bf16 v[52:55], v[84:87], v[72:75], v[52:55]
    v_mfma_f32_16x16x32_bf16 v[48:51], v[88:91], v[68:71], v[48:51]
    v_mfma_f32_16x16x32_bf16 v[56:59], v[88:91], v[72:75], v[56:59]
    s_nop 7
    s_nop 7
    s_barrier
    s_mov_b32 s54, 1027024659
    s_mov_b32 s55, 3222493025
    s_waitcnt vmcnt(0)
    s_add_u32 s16, s84, 19922944
    s_addc_u32 s17, s85, 0
    s_mov_b32 s18, 1835008
    s_mov_b32 s19, 0x00020000
    s_lshl_b32 s37, s87, 6
    s_lshr_b32 s38, s86, 1
    s_mul_i32 s38, s38, 32
    s_add_u32 s37, s37, s38
    v_add_u32 v60, s37, v2
    s_mov_b32 s38, 896
    v_mul_lo_u32 v68, v60, s38
    v_and_b32 v60, 1, v3
    v_lshl_add_u32 v68, v60, 5, v68
    v_lshrrev_b32 v60, 1, v3
    v_lshl_add_u32 v68, v60, 4, v68
    v_lshlrev_b32 v60, 16, v16
    v_sub_f32 v60, v60, v26
    v_mul_f32 v60, v60, v27
    v_add_f32 v44, v44, v60
    v_and_b32 v60, 0xffff0000, v16
    v_sub_f32 v60, v60, v26
    v_mul_f32 v60, v60, v27
    v_add_f32 v45, v45, v60
    v_lshlrev_b32 v60, 16, v17
    v_sub_f32 v60, v60, v26
    v_mul_f32 v60, v60, v27
    v_add_f32 v46, v46, v60
    v_and_b32 v60, 0xffff0000, v17
    v_sub_f32 v60, v60, v26
    v_mul_f32 v60, v60, v27
    v_add_f32 v47, v47, v60
    v_lshlrev_b32 v60, 16, v18
    v_sub_f32 v60, v60, v26
    v_mul_f32 v60, v60, v27
    v_add_f32 v48, v48, v60
    v_and_b32 v60, 0xffff0000, v18
    v_sub_f32 v60, v60, v26
    v_mul_f32 v60, v60, v27
    v_add_f32 v49, v49, v60
    v_lshlrev_b32 v60, 16, v19
    v_sub_f32 v60, v60, v26
    v_mul_f32 v60, v60, v27
    v_add_f32 v50, v50, v60
    v_and_b32 v60, 0xffff0000, v19
    v_sub_f32 v60, v60, v26
    v_mul_f32 v60, v60, v27
    v_add_f32 v51, v51, v60
    v_cvt_pk_bf16_f32 v72, v44, v45
    v_cvt_pk_bf16_f32 v73, v46, v47
    v_cvt_pk_bf16_f32 v74, v48, v49
    v_cvt_pk_bf16_f32 v75, v50, v51
    s_nop 1
    v_permlane16_swap_b32 v72, v74
    v_permlane16_swap_b32 v73, v75
    s_and_b32 s37, s86, 1
    s_lshl_b32 s37, s37, 6
    s_mul_i32 s38, s88, 112
    s_add_u32 s37, s37, s38
    s_add_u32 s37, s37, 0
    s_and_b32 s38, s86, 1
    s_cmp_eq_u32 s38, 1
    s_cselect_b32 exec_hi, 0xffff, -1
    s_cmp_eq_u32 s91, 1
    s_cbranch_scc1 Ls53_p
    buffer_store_dwordx4 v[72:75], v68, s[16:19], s37 offen sc1
    s_branch Ls53_d
Ls53_p:
    buffer_store_dwordx4 v[72:75], v68, s[16:19], s37 offen
Ls53_d:
    s_mov_b64 exec, -1
    s_nop 1
    v_lshlrev_b32 v60, 16, v20
    v_sub_f32 v60, v60, v28
    v_mul_f32 v60, v60, v29
    v_add_f32 v52, v52, v60
    v_and_b32 v60, 0xffff0000, v20
    v_sub_f32 v60, v60, v28
    v_mul_f32 v60, v60, v29
    v_add_f32 v53, v53, v60
    v_lshlrev_b32 v60, 16, v21
    v_sub_f32 v60, v60, v28
    v_mul_f32 v60, v60, v29
    v_add_f32 v54, v54, v60
    v_and_b32 v60, 0xffff0000, v21
    v_sub_f32 v60, v60, v28
    v_mul_f32 v60, v60, v29
    v_add_f32 v55, v55, v60
    v_lshlrev_b32 v60, 16, v22
    v_sub_f32 v60, v60, v28
    v_mul_f32 v60, v60, v29
    v_add_f32 v56, v56, v60
    v_and_b32 v60, 0xffff0000, v22
    v_sub_f32 v60, v60, v28
    v_mul_f32 v60, v60, v29
    v_add_f32 v57, v57, v60
    v_lshlrev_b32 v60, 16, v23
    v_sub_f32 v60, v60, v28
    v_mul_f32 v60, v60, v29
    v_add_f32 v58, v58, v60
    v_and_b32 v60, 0xffff0000, v23
    v_sub_f32 v60, v60, v28
    v_mul_f32 v60, v60, v29
    v_add_f32 v59, v59, v60
    v_cvt_pk_bf16_f32 v72, v52, v53
    v_cvt_pk_bf16_f32 v73, v54, v55
    v_cvt_pk_bf16_f32 v74, v56, v57
    v_cvt_pk_bf16_f32 v75, v58, v59
    s_nop 1
    v_permlane16_swap_b32 v72, v74
    v_permlane16_swap_b32 v73, v75
    s_and_b32 s37, s86, 1
    s_lshl_b32 s37, s37, 6
    s_mul_i32 s38, s88, 112
    s_add_u32 s37, s37, s38
    s_add_u32 s37, s37, 14336
    s_and_b32 s38, s86, 1
    s_cmp_eq_u32 s38, 1
    s_cselect_b32 exec_hi, 0xffff, -1
    s_cmp_eq_u32 s91, 1
    s_cbranch_scc1 Ls54_p
    buffer_store_dwordx4 v[72:75], v68, s[16:19], s37 offen sc1
    s_branch Ls54_d
Ls54_p:
    buffer_store_dwordx4 v[72:75], v68, s[16:19], s37 offen
Ls54_d:
    s_mov_b64 exec, -1
    s_nop 1
    s_and_b32 s37, s86, 1
    s_cmp_eq_u32 s37, 1
    s_cselect_b32 s61, 0, -1
    s_mov_b32 s60, -1
    s_add_u32 s20, s84, 44564480
    s_addc_u32 s21, s85, 0
    s_mov_b32 s22, 262144
    s_mov_b32 s23, 0x00020000
    v_mov_b32 v72, 0
    s_lshl_b32 s37, s87, 6
    s_lshr_b32 s38, s86, 1
    s_mul_i32 s38, s38, 32
    s_add_u32 s37, s37, s38
    v_add_u32 v69, s37, v2
    v_lshlrev_b32 v69, 7, v69
    s_lshl_b32 s37, s88, 1
    s_and_b32 s38, s86, 1
    s_add_u32 s37, s37, s38
    s_lshl_b32 s37, s37, 3
    v_add_u32 v69, s37, v69
    v_mov_b32 v70, v44
    v_mul_f32 v71, v44, v44
    v_add_f32 v70, v70, v45
    v_fma_f32 v71, v45, v45, v71
    v_add_f32 v70, v70, v46
    v_fma_f32 v71, v46, v46, v71
    v_add_f32 v70, v70, v47
    v_fma_f32 v71, v47, v47, v71
    v_cndmask_b32 v60, v72, v48, s[60:61]
    v_add_f32 v70, v70, v60
    v_fma_f32 v71, v60, v60, v71
    v_cndmask_b32 v60, v72, v49, s[60:61]
    v_add_f32 v70, v70, v60
    v_fma_f32 v71, v60, v60, v71
    v_cndmask_b32 v60, v72, v50, s[60:61]
    v_add_f32 v70, v70, v60
    v_fma_f32 v71, v60, v60, v71
    v_cndmask_b32 v60, v72, v51, s[60:61]
    v_add_f32 v70, v70, v60
    v_fma_f32 v71, v60, v60, v71
    v_mov_b32 v60, v70
    s_nop 1
    v_permlane16_swap_b32 v70, v60
    v_add_f32 v70, v70, v60
    v_mov_b32 v60, v70
    s_nop 1
    v_permlane32_swap_b32 v70, v60
    v_add_f32 v70, v70, v60
    v_mov_b32 v60, v71
    s_nop 1
    v_permlane16_swap_b32 v71, v60
    v_add_f32 v71, v71, v60
    v_mov_b32 v60, v71
    s_nop 1
    v_permlane32_swap_b32 v71, v60
    v_add_f32 v71, v71, v60
    s_mov_b32 exec_lo, 0xffff
    s_mov_b32 exec_hi, 0
    s_cmp_eq_u32 s91, 1
    s_cbranch_scc1 Ls55_p
    buffer_store_dwordx2 v[70:71], v69, s[20:23], 0 offen offset:0 sc1
    s_branch Ls55_d
Ls55_p:
    buffer_store_dwordx2 v[70:71], v69, s[20:23], 0 offen offset:0
Ls55_d:
    s_mov_b64 exec, -1
    s_nop 1
    v_mov_b32 v70, v52
    v_mul_f32 v71, v52, v52
    v_add_f32 v70, v70, v53
    v_fma_f32 v71, v53, v53, v71
    v_add_f32 v70, v70, v54
    v_fma_f32 v71, v54, v54, v71
    v_add_f32 v70, v70, v55
    v_fma_f32 v71, v55, v55, v71
    v_cndmask_b32 v60, v72, v56, s[60:61]
    v_add_f32 v70, v70, v60
    v_fma_f32 v71, v60, v60, v71
    v_cndmask_b32 v60, v72, v57, s[60:61]
    v_add_f32 v70, v70, v60
    v_fma_f32 v71, v60, v60, v71
    v_cndmask_b32 v60, v72, v58, s[60:61]
    v_add_f32 v70, v70, v60
    v_fma_f32 v71, v60, v60, v71
    v_cndmask_b32 v60, v72, v59, s[60:61]
    v_add_f32 v70, v70, v60
    v_fma_f32 v71, v60, v60, v71
    v_mov_b32 v60, v70
    s_nop 1
    v_permlane16_swap_b32 v70, v60
    v_add_f32 v70, v70, v60
    v_mov_b32 v60, v70
    s_nop 1
    v_permlane32_swap_b32 v70, v60
    v_add_f32 v70, v70, v60
    v_mov_b32 v60, v71
    s_nop 1
    v_permlane16_swap_b32 v71, v60
    v_add_f32 v71, v71, v60
    v_mov_b32 v60, v71
    s_nop 1
    v_permlane32_swap_b32 v71, v60
    v_add_f32 v71, v71, v60
    s_mov_b32 exec_lo, 0xffff
    s_mov_b32 exec_hi, 0
    s_cmp_eq_u32 s91, 1
    s_cbranch_scc1 Ls56_p
    buffer_store_dwordx2 v[70:71], v69, s[20:23], 0 offen offset:2048 sc1
    s_branch Ls56_d
Ls56_p:
    buffer_store_dwordx2 v[70:71], v69, s[20:23], 0 offen offset:2048
Ls56_d:
    s_mov_b64 exec, -1
    s_nop 1
    s_mov_b32 s12, s76
    s_mov_b32 s13, s77
    s_mov_b32 s14, 1605632
    s_mov_b32 s15, 0x00020000
    s_lshl_b32 s32, s86, 10
    s_and_b32 s40, s86, 1
    s_mul_i32 s35, s86, 28672
    v_lshrrev_b32 v75, 3, v1
    v_bfe_u32 v73, v1, 4, 1
    v_lshlrev_b32 v73, 1, v73
    s_lshl_b32 s37, s40, 2
    v_add_u32 v73, s37, v73
    v_and_b32 v74, 7, v1
    v_xor_b32 v74, v74, v73
    s_mov_b32 s39, 3584
    v_mul_lo_u32 v73, v75, s39
    v_lshl_add_u32 v76, v74, 4, v73
    s_mul_i32 s42, s88, 448
    s_add_u32 s42, s42, 0
    s_mul_i32 s43, s88, 448
    s_add_u32 s43, s43, 112
    s_mul_i32 s44, s88, 448
    s_add_u32 s44, s44, 224
    s_mul_i32 s45, s88, 448
    s_add_u32 s45, s45, 336
    s_add_u32 m0, s32, 57344
    s_add_u32 s37, s35, 0
    s_add_u32 s37, s37, s42
    buffer_load_dwordx4 v76, s[12:15], s37 offen lds
    s_add_u32 m0, s32, 61440
    s_add_u32 s37, s35, 114688
    s_add_u32 s37, s37, s42
    buffer_load_dwordx4 v76, s[12:15], s37 offen lds
    s_add_u32 m0, s32, 65536
    s_add_u32 s37, s35, 0
    s_add_u32 s37, s37, s43
    buffer_load_dwordx4 v76, s[12:15], s37 offen lds
    s_add_u32 m0, s32, 69632
    s_add_u32 s37, s35, 114688
    s_add_u32 s37, s37, s43
    buffer_load_dwordx4 v76, s[12:15], s37 offen lds
    s_add_u32 m0, s32, 73728
    s_add_u32 s37, s35, 0
    s_add_u32 s37, s37, s44
    buffer_load_dwordx4 v76, s[12:15], s37 offen lds
    s_add_u32 m0, s32, 77824
    s_add_u32 s37, s35, 114688
    s_add_u32 s37, s37, s44
    buffer_load_dwordx4 v76, s[12:15], s37 offen lds
    s_add_u32 m0, s32, 81920
    s_add_u32 s37, s35, 0
    s_add_u32 s37, s37, s45
    buffer_load_dwordx4 v76, s[12:15], s37 offen lds
    s_add_u32 m0, s32, 86016
    s_add_u32 s37, s35, 114688
    s_add_u32 s37, s37, s45
    buffer_load_dwordx4 v76, s[12:15], s37 offen lds
    s_add_u32 m0, s32, 90112
    s_add_u32 s37, s35, 229376
    s_add_u32 s37, s37, s42
    buffer_load_dwordx4 v76, s[12:15], s37 offen lds
    s_add_u32 m0, s32, 94208
    s_add_u32 s37, s35, 344064
    s_add_u32 s37, s37, s42
    buffer_load_dwordx4 v76, s[12:15], s37 offen lds
    s_add_u32 m0, s32, 98304
    s_add_u32 s37, s35, 229376
    s_add_u32 s37, s37, s43
    buffer_load_dwordx4 v76, s[12:15], s37 offen lds
    s_add_u32 m0, s32, 102400
    s_add_u32 s37, s35, 344064
    s_add_u32 s37, s37, s43
    buffer_load_dwordx4 v76, s[12:15], s37 offen lds
    s_add_u32 m0, s32, 106496
    s_add_u32 s37, s35, 229376
    s_add_u32 s37, s37, s44
    buffer_load_dwordx4 v76, s[12:15], s37 offen lds
    s_add_u32 m0, s32, 110592
    s_add_u32 s37, s35, 344064
    s_add_u32 s37, s37, s44
    buffer_load_dwordx4 v76, s[12:15], s37 offen lds
    s_add_u32 m0, s32, 114688
    s_add_u32 s37, s35, 229376
    s_add_u32 s37, s37, s45
    buffer_load_dwordx4 v76, s[12:15], s37 offen lds
    s_add_u32 m0, s32, 118784
    s_add_u32 s37, s35, 344064
    s_add_u32 s37, s37, s45
    buffer_load_dwordx4 v76, s[12:15], s37 offen lds
    s_add_u32 m0, s32, 122880
    s_add_u32 s37, s35, 458752
    s_add_u32 s37, s37, s42
    buffer_load_dwordx4 v76, s[12:15], s37 offen lds
    s_add_u32 m0, s32, 126976
    s_add_u32 s37, s35, 573440
    s_add_u32 s37, s37, s42
    buffer_load_dwordx4 v76, s[12:15], s37 offen lds
    s_add_u32 m0, s32, 131072
    s_add_u32 s37, s35, 458752
    s_add_u32 s37, s37, s43
    buffer_load_dwordx4 v76, s[12:15], s37 offen lds
    s_add_u32 m0, s32, 135168
    s_add_u32 s37, s35, 573440
    s_add_u32 s37, s37, s43
    buffer_load_dwordx4 v76, s[12:15], s37 offen lds
    s_add_u32 m0, s32, 139264
    s_add_u32 s37, s35, 458752
    s_add_u32 s37, s37, s44
    buffer_load_dwordx4 v76, s[12:15], s37 offen lds
    s_add_u32 m0, s32, 143360
    s_add_u32 s37, s35, 573440
    s_add_u32 s37, s37, s44
    buffer_load_dwordx4 v76, s[12:15], s37 offen lds
    s_add_u32 m0, s32, 147456
    s_add_u32 s37, s35, 458752
    s_add_u32 s37, s37, s45
    buffer_load_dwordx4 v76, s[12:15], s37 offen lds
    s_add_u32 m0, s32, 151552
    s_add_u32 s37, s35, 573440
    s_add_u32 s37, s37, s45
    buffer_load_dwordx4 v76, s[12:15], s37 offen lds
    s_waitcnt vmcnt(24)
    s_lshl_b32 s32, s89, 7
    s_lshl_b32 s33, s86, 2
    s_add_u32 s32, s32, s33
    v_mov_b32 v73, s32
    v_mov_b32 v74, 11
    s_mov_b64 exec, 1
    s_mov_b32 s57, s91
    s_cmp_eq_u32 s57, 1
    s_cbranch_scc1 Ls57_p
    buffer_store_dword v74, v73, s[24:27], 0 offen sc1
    s_branch Ls57_d
Ls57_p:
    buffer_store_dword v74, v73, s[24:27], 0 offen
Ls57_d:
    s_mov_b64 exec, -1
    s_barrier
    s_add_u32 s8, s84, 19922944
    s_addc_u32 s9, s85, 0
    s_mov_b32 s10, 1835008
    s_mov_b32 s11, 0x00020000
    s_mov_b32 s12, s76
    s_mov_b32 s13, s77
    s_mov_b32 s14, 1605632
    s_mov_b32 s15, 0x00020000
    s_lshl_b32 s32, s86, 10
    s_and_b32 s40, s86, 1
    s_add_u32 s33, s40, 8
    s_mul_i32 s34, s86, 7168
    s_mul_i32 s35, s86, 28672
    s_mul_i32 s36, s88, 112
    v_lshrrev_b32 v5, 3, v1
    v_lshrrev_b32 v7, 4, v1
    s_lshl_b32 s37, s40, 2
    v_add_u32 v7, s37, v7
    v_and_b32 v6, 7, v1
    v_xor_b32 v6, v6, v7
    s_lshl_b32 s37, s87, 6
    s_lshl_b32 s38, s86, 3
    s_add_u32 s38, s38, 0
    s_add_u32 s38, s38, s37
    v_add_u32 v7, s38, v5
    s_mov_b32 s39, 896
    v_mul_lo_u32 v7, v7, s39
    v_lshl_add_u32 v9, v6, 4, v7
    s_lshl_b32 s38, s86, 3
    s_add_u32 s38, s38, 32
    s_add_u32 s38, s38, s37
    v_add_u32 v7, s38, v5
    s_mov_b32 s39, 896
    v_mul_lo_u32 v7, v7, s39
    v_lshl_add_u32 v10, v6, 4, v7
    v_bfe_u32 v7, v1, 4, 1
    v_lshlrev_b32 v7, 1, v7
    s_lshl_b32 s37, s40, 2
    v_add_u32 v7, s37, v7
    v_and_b32 v8, 7, v1
    v_xor_b32 v8, v8, v7
    s_mov_b32 s39, 3584
    v_mul_lo_u32 v7, v5, s39
    v_lshl_add_u32 v11, v8, 4, v7
    s_mul_i32 s42, s88, 448
    s_add_u32 s42, s42, 0
    s_mul_i32 s43, s88, 448
    s_add_u32 s43, s43, 112
    s_mul_i32 s44, s88, 448
    s_add_u32 s44, s44, 224
    s_mul_i32 s45, s88, 448
    s_add_u32 s45, s45, 336
    s_cmp_lg_u32 s86, 0
    s_cbranch_scc1 Lp58_skip
    v_lshrrev_b32 v13, 3, v1
    v_add_u32 v13, s87, v13
    v_add_u32 v13, 0, v13
    v_mov_b32 v14, s87
    v_cmp_gt_u32 vcc, 32, v13
    s_nop 1
    v_cndmask_b32 v13, v14, v13, vcc
    v_and_b32 v12, 7, v1
    v_lshlrev_b32 v12, 5, v12
    v_and_b32 v14, 3, v13
    v_lshl_add_u32 v12, v14, 3, v12
    v_lshrrev_b32 v14, 2, v13
    v_add_u32 v12, v12, v14
    v_lshlrev_b32 v12, 7, v12
    v_add_u32 v12, 0, v12
    v_mov_b32 v20, 0
    s_mov_b32 s52, 0
    s_mov_b32 s53, 11
    s_mov_b32 exec_lo, 255
    s_mov_b32 exec_hi, 0
Lp58_loop:
    buffer_load_dwordx4 v[16:19], v12, s[24:27], 0 offen sc1
    s_waitcnt vmcnt(0)
    v_min_u32 v16, v16, v17
    v_min_u32 v18, v18, v19
    v_min_u32 v16, v16, v18
    v_cmp_gt_u32 vcc, s53, v16
    s_cbranch_vccz Lp58_ok
Lp58_again:
    s_add_u32 s52, s52, 1
    s_cmp_lt_u32 s52, 20000
    s_cbranch_scc1 Lp58_loop
Lp58_ok:
    s_mov_b64 exec, -1
Lp58_skip:
    s_barrier
    s_add_u32 m0, s32, 0
    s_nop 0
    s_mov_b32 s37, 0
    buffer_load_dwordx4 v9, s[8:11], s37 offen lds
    s_add_u32 m0, s32, 4096
    s_nop 0
    s_mov_b32 s37, 0
    buffer_load_dwordx4 v10, s[8:11], s37 offen lds
    s_add_u32 m0, s32, 8192
    s_nop 0
    s_mov_b32 s37, 128
    buffer_load_dwordx4 v9, s[8:11], s37 offen lds
    s_add_u32 m0, s32, 12288
    s_nop 0
    s_mov_b32 s37, 128
    buffer_load_dwordx4 v10, s[8:11], s37 offen lds
    s_add_u32 m0, s32, 16384
    s_nop 0
    s_mov_b32 s37, 256
    buffer_load_dwordx4 v9, s[8:11], s37 offen lds
    s_add_u32 m0, s32, 20480
    s_nop 0
    s_mov_b32 s37, 256
    buffer_load_dwordx4 v10, s[8:11], s37 offen lds
    s_add_u32 m0, s32, 24576
    s_nop 0
    s_mov_b32 s37, 384
    buffer_load_dwordx4 v9, s[8:11], s37 offen lds
    s_add_u32 m0, s32, 28672
    s_nop 0
    s_mov_b32 s37, 384
    buffer_load_dwordx4 v10, s[8:11], s37 offen lds
    s_add_u32 m0, s32, 32768
    s_nop 0
    s_mov_b32 s37, 512
    buffer_load_dwordx4 v9, s[8:11], s37 offen lds
    s_add_u32 m0, s32, 36864
    s_nop 0
    s_mov_b32 s37, 512
    buffer_load_dwordx4 v10, s[8:11], s37 offen lds
    s_add_u32 m0, s32, 40960
    s_nop 0
    s_mov_b32 s37, 640
    buffer_load_dwordx4 v9, s[8:11], s37 offen lds
    s_add_u32 m0, s32, 45056
    s_nop 0
    s_mov_b32 s37, 640
    buffer_load_dwordx4 v10, s[8:11], s37 offen lds
    s_add_u32 m0, s32, 49152
    s_nop 0
    s_mov_b32 s37, 768
    buffer_load_dwordx4 v9, s[8:11], s37 offen lds
    s_add_u32 m0, s32, 53248
    s_nop 0
    s_mov_b32 s37, 768
    buffer_load_dwordx4 v10, s[8:11], s37 offen lds
    s_add_u32 s20, s84, 44564480
    s_addc_u32 s21, s85, 0
    s_mov_b32 s22, 262144
    s_mov_b32 s23, 0x00020000
    s_lshl_b32 s37, s87, 6
    s_lshr_b32 s38, s86, 1
    s_mul_i32 s38, s38, 32
    s_add_u32 s37, s37, s38
    v_add_u32 v12, s37, v2
    v_lshlrev_b32 v12, 7, v12
    v_lshl_add_u32 v12, v3, 5, v12
    buffer_load_dwordx4 v[16:19], v12, s[20:23], 0 offen
    buffer_load_dwordx4 v[20:23], v12, s[20:23], 0 offen offset:16
    v_add_u32 v12, 2048, v12
    buffer_load_dwordx4 v[24:27], v12, s[20:23], 0 offen
    buffer_load_dwordx4 v[28:31], v12, s[20:23], 0 offen offset:16
    v_lshrrev_b32 v7, 1, v2
    v_and_b32 v7, 7, v7
    v_add_u32 v8, 0, v3
    v_xor_b32 v8, v8, v7
    v_lshlrev_b32 v8, 4, v8
    v_lshl_add_u32 v32, v2, 7, v8
    v_add_u32 v8, 4, v3
    v_xor_b32 v8, v8, v7
    v_lshlrev_b32 v8, 4, v8
    v_lshl_add_u32 v33, v2, 7, v8
    s_lshl_b32 s37, s86, 11
    v_add_u32 v34, s37, v32
    v_add_u32 v35, s37, v33
    s_lshr_b32 s37, s86, 1
    s_mul_i32 s37, s37, 4096
    v_add_u32 v32, s37, v32
    v_add_u32 v33, s37, v33
    v_lshrrev_b32 v44, 2, v2
    v_lshl_add_u32 v44, v3, 3, v44
    v_lshlrev_b32 v44, 7, v44
    v_bfe_u32 v45, v2, 3, 1
    v_lshlrev_b32 v45, 2, v45
    v_and_b32 v7, 1, v3
    v_lshl_add_u32 v45, v7, 3, v45
    v_and_b32 v46, 3, v2
    s_and_b32 s37, s86, 1
    s_mul_i32 s37, s37, 8
    s_add_u32 s38, s37, 0
    s_and_b32 s39, s38, 3
    s_lshl_b32 s39, s39, 2
    v_add_u32 v7, s39, v46
    v_xor_b32 v7, v7, v45
    v_lshl_add_u32 v7, v7, 3, v44
    s_lshr_b32 s38, s38, 2
    s_lshl_b32 s38, s38, 13
    v_add_u32 v36, s38, v7
    s_add_u32 s38, s37, 1
    s_and_b32 s39, s38, 3
    s_lshl_b32 s39, s39, 2
    v_add_u32 v7, s39, v46
    v_xor_b32 v7, v7, v45
    v_lshl_add_u32 v7, v7, 3, v44
    s_lshr_b32 s38, s38, 2
    s_lshl_b32 s38, s38, 13
    v_add_u32 v37, s38, v7
    s_add_u32 s38, s37, 2
    s_and_b32 s39, s38, 3
    s_lshl_b32 s39, s39, 2
    v_add_u32 v7, s39, v46
    v_xor_b32 v7, v7, v45
    v_lshl_add_u32 v7, v7, 3, v44
    s_lshr_b32 s38, s38, 2
    s_lshl_b32 s38, s38, 13
    v_add_u32 v38, s38, v7
    s_add_u32 s38, s37, 3
    s_and_b32 s39, s38, 3
    s_lshl_b32 s39, s39, 2
    v_add_u32 v7, s39, v46
    v_xor_b32 v7, v7, v45
    v_lshl_add_u32 v7, v7, 3, v44
    s_lshr_b32 s38, s38, 2
    s_lshl_b32 s38, s38, 13
    v_add_u32 v39, s38, v7
    s_add_u32 s38, s37, 4
    s_and_b32 s39, s38, 3
    s_lshl_b32 s39, s39, 2
    v_add_u32 v7, s39, v46
    v_xor_b32 v7, v7, v45
    v_lshl_add_u32 v7, v7, 3, v44
    s_lshr_b32 s38, s38, 2
    s_lshl_b32 s38, s38, 13
    v_add_u32 v40, s38, v7
    s_add_u32 s38, s37, 5
    s_and_b32 s39, s38, 3
    s_lshl_b32 s39, s39, 2
    v_add_u32 v7, s39, v46
    v_xor_b32 v7, v7, v45
    v_lshl_add_u32 v7, v7, 3, v44
    s_lshr_b32 s38, s38, 2
    s_lshl_b32 s38, s38, 13
    v_add_u32 v41, s38, v7
    s_add_u32 s38, s37, 6
    s_and_b32 s39, s38, 3
    s_lshl_b32 s39, s39, 2
    v_add_u32 v7, s39, v46
    v_xor_b32 v7, v7, v45
    v_lshl_add_u32 v7, v7, 3, v44
    s_lshr_b32 s38, s38, 2
    s_lshl_b32 s38, s38, 13
    v_add_u32 v42, s38, v7
    s_add_u32 s38, s37, 7
    s_and_b32 s39, s38, 3
    s_lshl_b32 s39, s39, 2
    v_add_u32 v7, s39, v46
    v_xor_b32 v7, v7, v45
    v_lshl_add_u32 v7, v7, 3, v44
    s_lshr_b32 s38, s38, 2
    s_lshl_b32 s38, s38, 13
    v_add_u32 v43, s38, v7
    v_add_u32 v47, 65536, v32
    v_add_u32 v48, 65536, v33
    v_add_u32 v49, 65536, v34
    v_add_u32 v50, 65536, v35
    v_add_u32 v51, 65536, v36
    v_add_u32 v52, 131072, v36
    v_add_u32 v53, 65536, v37
    v_add_u32 v54, 131072, v37
    v_add_u32 v55, 65536, v38
    v_add_u32 v56, 131072, v38
    v_add_u32 v57, 65536, v39
    v_add_u32 v58, 131072, v39
    v_add_u32 v59, 65536, v40
    v_add_u32 v60, 131072, v40
    v_add_u32 v61, 65536, v41
    v_add_u32 v62, 131072, v41
    v_add_u32 v63, 65536, v42
    v_add_u32 v64, 131072, v42
    v_add_u32 v65, 65536, v43
    v_add_u32 v66, 131072, v43
    v_mov_b32 v68, 0
    v_mov_b32 v69, 0
    v_mov_b32 v70, 0
    v_mov_b32 v71, 0
    v_mov_b32 v72, 0
    v_mov_b32 v73, 0
    v_mov_b32 v74, 0
    v_mov_b32 v75, 0
    v_mov_b32 v76, 0
    v_mov_b32 v77, 0
    v_mov_b32 v78, 0
    v_mov_b32 v79, 0
    v_mov_b32 v80, 0
    v_mov_b32 v81, 0
    v_mov_b32 v82, 0
    v_mov_b32 v83, 0
    v_mov_b32 v84, 0
    v_mov_b32 v85, 0
    v_mov_b32 v86, 0
    v_mov_b32 v87, 0
    v_mov_b32 v88, 0
    v_mov_b32 v89, 0
    v_mov_b32 v90, 0
    v_mov_b32 v91, 0
    v_mov_b32 v92, 0
    v_mov_b32 v93, 0
    v_mov_b32 v94, 0
    v_mov_b32 v95, 0
    v_mov_b32 v96, 0
    v_mov_b32 v97, 0
    v_mov_b32 v98, 0
    v_mov_b32 v99, 0
    v_mov_b32 v100, 0
    v_mov_b32 v101, 0
    v_mov_b32 v102, 0
    v_mov_b32 v103, 0
    v_mov_b32 v104, 0
    v_mov_b32 v105, 0
    v_mov_b32 v106, 0
    v_mov_b32 v107, 0
    v_mov_b32 v108, 0
    v_mov_b32 v109, 0
    v_mov_b32 v110, 0
    v_mov_b32 v111, 0
    v_mov_b32 v112, 0
    v_mov_b32 v113, 0
    v_mov_b32 v114, 0
    v_mov_b32 v115, 0
    v_mov_b32 v116, 0
    v_mov_b32 v117, 0
    v_mov_b32 v118, 0
    v_mov_b32 v119, 0
    v_mov_b32 v120, 0
    v_mov_b32 v121, 0
    v_mov_b32 v122, 0
    v_mov_b32 v123, 0
    v_mov_b32 v124, 0
    v_mov_b32 v125, 0
    v_mov_b32 v126, 0
    v_mov_b32 v127, 0
    v_mov_b32 v128, 0
    v_mov_b32 v129, 0
    v_mov_b32 v130, 0
    v_mov_b32 v131, 0
    v_mov_b32 v132, 0
    v_mov_b32 v133, 0
    v_mov_b32 v134, 0
    v_mov_b32 v135, 0
    v_mov_b32 v136, 0
    v_mov_b32 v137, 0
    v_mov_b32 v138, 0
    v_mov_b32 v139, 0
    v_mov_b32 v140, 0
    v_mov_b32 v141, 0
    v_mov_b32 v142, 0
    v_mov_b32 v143, 0
    v_mov_b32 v144, 0
    v_mov_b32 v145, 0
    v_mov_b32 v146, 0
    v_mov_b32 v147, 0
    v_mov_b32 v148, 0
    v_mov_b32 v149, 0
    v_mov_b32 v150, 0
    v_mov_b32 v151, 0
    v_mov_b32 v152, 0
    v_mov_b32 v153, 0
    v_mov_b32 v154, 0
    v_mov_b32 v155, 0
    v_mov_b32 v156, 0
    v_mov_b32 v157, 0
    v_mov_b32 v158, 0
    v_mov_b32 v159, 0
    v_mov_b32 v160, 0
    v_mov_b32 v161, 0
    v_mov_b32 v162, 0
    v_mov_b32 v163, 0
    v_mov_b32 v164, 0x3f803f80
    v_mov_b32 v165, 0x3f803f80
    v_mov_b32 v166, 0x3f803f80
    v_mov_b32 v167, 0x3f803f80
    s_waitcnt vmcnt(35)
    s_waitcnt vmcnt(16)
    s_barrier
    ds_read_b128 v[168:171], v32 offset:0
    ds_read_b128 v[172:175], v32 offset:2048
    ds_read_b64_tr_b16 v[184:185], v36 offset:57344
    ds_read_b64_tr_b16 v[186:187], v36 offset:57856
    ds_read_b64_tr_b16 v[188:189], v37 offset:57344
    ds_read_b64_tr_b16 v[190:191], v37 offset:57856
    ds_read_b64_tr_b16 v[192:193], v38 offset:57344
    ds_read_b64_tr_b16 v[194:195], v38 offset:57856
    ds_read_b64_tr_b16 v[196:197], v39 offset:57344
    ds_read_b64_tr_b16 v[198:199], v39 offset:57856
    ds_read_b64_tr_b16 v[200:201], v40 offset:57344
    ds_read_b64_tr_b16 v[202:203], v40 offset:57856
    ds_read_b64_tr_b16 v[204:205], v41 offset:57344
    ds_read_b64_tr_b16 v[206:207], v41 offset:57856
    ds_read_b64_tr_b16 v[208:209], v42 offset:57344
    ds_read_b64_tr_b16 v[210:211], v42 offset:57856
    ds_read_b64_tr_b16 v[212:213], v43 offset:57344
    ds_read_b64_tr_b16 v[214:215], v43 offset:57856
    s_waitcnt lgkmcnt(0)
    v_mfma_f32_16x16x32_bf16 v[68:71], v[184:187], v[168:171], v[68:71]
    ds_read_b128 v[176:179], v33 offset:0
    ds_read_b128 v[180:183], v33 offset:2048
    v_mfma_f32_16x16x32_bf16 v[100:103], v[184:187], v[172:175], v[100:103]
    ds_read_b64_tr_b16 v[216:217], v36 offset:61440
    ds_read_b64_tr_b16 v[218:219], v36 offset:61952
    v_mfma_f32_16x16x32_bf16 v[132:135], v[184:187], v[164:167], v[132:135]
    ds_read_b64_tr_b16 v[220:221], v37 offset:61440
    ds_read_b64_tr_b16 v[222:223], v37 offset:61952
    v_mfma_f32_16x16x32_bf16 v[72:75], v[188:191], v[168:171], v[72:75]
    ds_read_b64_tr_b16 v[224:225], v38 offset:61440
    ds_read_b64_tr_b16 v[226:227], v38 offset:61952
    v_mfma_f32_16x16x32_bf16 v[104:107], v[188:191], v[172:175], v[104:107]
    ds_read_b64_tr_b16 v[228:229], v39 offset:61440
    ds_read_b64_tr_b16 v[230:231], v39 offset:61952
    v_mfma_f32_16x16x32_bf16 v[136:139], v[188:191], v[164:167], v[136:139]
    ds_read_b64_tr_b16 v[232:233], v40 offset:61440
    ds_read_b64_tr_b16 v[234:235], v40 offset:61952
    v_mfma_f32_16x16x32_bf16 v[76:79], v[192:195], v[168:171], v[76:79]
    ds_read_b64_tr_b16 v[236:237], v41 offset:61440
    ds_read_b64_tr_b16 v[238:239], v41 offset:61952
    v_mfma_f32_16x16x32_bf16 v[108:111], v[192:195], v[172:175], v[108:111]
    ds_read_b64_tr_b16 v[240:241], v42 offset:61440
    ds_read_b64_tr_b16 v[242:243], v42 offset:61952
    v_mfma_f32_16x16x32_bf16 v[140:143], v[192:195], v[164:167], v[140:143]
    ds_read_b64_tr_b16 v[244:245], v43 offset:61440
    ds_read_b64_tr_b16 v[246:247], v43 offset:61952
    v_mfma_f32_16x16x32_bf16 v[80:83], v[196:199], v[168:171], v[80:83]
    v_mfma_f32_16x16x32_bf16 v[112:115], v[196:199], v[172:175], v[112:115]
    v_mfma_f32_16x16x32_bf16 v[144:147], v[196:199], v[164:167], v[144:147]
    v_mfma_f32_16x16x32_bf16 v[84:87], v[200:203], v[168:171], v[84:87]
    v_mfma_f32_16x16x32_bf16 v[116:119], v[200:203], v[172:175], v[116:119]
    v_mfma_f32_16x16x32_bf16 v[148:151], v[200:203], v[164:167], v[148:151]
    v_mfma_f32_16x16x32_bf16 v[88:91], v[204:207], v[168:171], v[88:91]
    v_mfma_f32_16x16x32_bf16 v[120:123], v[204:207], v[172:175], v[120:123]
    v_mfma_f32_16x16x32_bf16 v[152:155], v[204:207], v[164:167], v[152:155]
    v_mfma_f32_16x16x32_bf16 v[92:95], v[208:211], v[168:171], v[92:95]
    v_mfma_f32_16x16x32_bf16 v[124:127], v[208:211], v[172:175], v[124:127]
    v_mfma_f32_16x16x32_bf16 v[156:159], v[208:211], v[164:167], v[156:159]
    v_mfma_f32_16x16x32_bf16 v[96:99], v[212:215], v[168:171], v[96:99]
    v_mfma_f32_16x16x32_bf16 v[128:131], v[212:215], v[172:175], v[128:131]
    v_mfma_f32_16x16x32_bf16 v[160:163], v[212:215], v[164:167], v[160:163]
    s_waitcnt lgkmcnt(0)
    s_waitcnt vmcnt(14)
    s_barrier
    s_add_u32 m0, s32, 57344
    s_add_u32 s37, s35, 688128
    s_add_u32 s37, s37, s42
    buffer_load_dwordx4 v11, s[12:15], s37 offen lds
    s_add_u32 m0, s32, 61440
    s_add_u32 s37, s35, 802816
    s_add_u32 s37, s37, s42
    buffer_load_dwordx4 v11, s[12:15], s37 offen lds
    s_add_u32 m0, s32, 65536
    s_add_u32 s37, s35, 688128
    s_add_u32 s37, s37, s43
    buffer_load_dwordx4 v11, s[12:15], s37 offen lds
    s_add_u32 m0, s32, 69632
    s_add_u32 s37, s35, 802816
    s_add_u32 s37, s37, s43
    buffer_load_dwordx4 v11, s[12:15], s37 offen lds
    s_add_u32 m0, s32, 73728
    s_add_u32 s37, s35, 688128
    s_add_u32 s37, s37, s44
    buffer_load_dwordx4 v11, s[12:15], s37 offen lds
    s_add_u32 m0, s32, 77824
    s_add_u32 s37, s35, 802816
    s_add_u32 s37, s37, s44
    buffer_load_dwordx4 v11, s[12:15], s37 offen lds
    s_add_u32 m0, s32, 81920
    s_add_u32 s37, s35, 688128
    s_add_u32 s37, s37, s45
    buffer_load_dwordx4 v11, s[12:15], s37 offen lds
    s_add_u32 m0, s32, 86016
    s_add_u32 s37, s35, 802816
    s_add_u32 s37, s37, s45
    buffer_load_dwordx4 v11, s[12:15], s37 offen lds
    v_mfma_f32_16x16x32_bf16 v[68:71], v[216:219], v[176:179], v[68:71]
    ds_read_b128 v[168:171], v32 offset:8192
    ds_read_b128 v[172:175], v32 offset:10240
    v_mfma_f32_16x16x32_bf16 v[100:103], v[216:219], v[180:183], v[100:103]
    ds_read_b64_tr_b16 v[184:185], v51 offset:24576
    ds_read_b64_tr_b16 v[186:187], v51 offset:25088
    v_mfma_f32_16x16x32_bf16 v[132:135], v[216:219], v[164:167], v[132:135]
    ds_read_b64_tr_b16 v[188:189], v53 offset:24576
    ds_read_b64_tr_b16 v[190:191], v53 offset:25088
    v_mfma_f32_16x16x32_bf16 v[72:75], v[220:223], v[176:179], v[72:75]
    ds_read_b64_tr_b16 v[192:193], v55 offset:24576
    ds_read_b64_tr_b16 v[194:195], v55 offset:25088
    v_mfma_f32_16x16x32_bf16 v[104:107], v[220:223], v[180:183], v[104:107]
    ds_read_b64_tr_b16 v[196:197], v57 offset:24576
    ds_read_b64_tr_b16 v[198:199], v57 offset:25088
    v_mfma_f32_16x16x32_bf16 v[136:139], v[220:223], v[164:167], v[136:139]
    ds_read_b64_tr_b16 v[200:201], v59 offset:24576
    ds_read_b64_tr_b16 v[202:203], v59 offset:25088
    v_mfma_f32_16x16x32_bf16 v[76:79], v[224:227], v[176:179], v[76:79]
    ds_read_b64_tr_b16 v[204:205], v61 offset:24576
    ds_read_b64_tr_b16 v[206:207], v61 offset:25088
    v_mfma_f32_16x16x32_bf16 v[108:111], v[224:227], v[180:183], v[108:111]
    ds_read_b64_tr_b16 v[208:209], v63 offset:24576
    ds_read_b64_tr_b16 v[210:211], v63 offset:25088
    v_mfma_f32_16x16x32_bf16 v[140:143], v[224:227], v[164:167], v[140:143]
    ds_read_b64_tr_b16 v[212:213], v65 offset:24576
    ds_read_b64_tr_b16 v[214:215], v65 offset:25088
    v_mfma_f32_16x16x32_bf16 v[80:83], v[228:231], v[176:179], v[80:83]
    v_mfma_f32_16x16x32_bf16 v[112:115], v[228:231], v[180:183], v[112:115]
    v_mfma_f32_16x16x32_bf16 v[144:147], v[228:231], v[164:167], v[144:147]
    v_mfma_f32_16x16x32_bf16 v[84:87], v[232:235], v[176:179], v[84:87]
    v_mfma_f32_16x16x32_bf16 v[116:119], v[232:235], v[180:183], v[116:119]
    v_mfma_f32_16x16x32_bf16 v[148:151], v[232:235], v[164:167], v[148:151]
    v_mfma_f32_16x16x32_bf16 v[88:91], v[236:239], v[176:179], v[88:91]
    v_mfma_f32_16x16x32_bf16 v[120:123], v[236:239], v[180:183], v[120:123]
    v_mfma_f32_16x16x32_bf16 v[152:155], v[236:239], v[164:167], v[152:155]
    v_mfma_f32_16x16x32_bf16 v[92:95], v[240:243], v[176:179], v[92:95]
    v_mfma_f32_16x16x32_bf16 v[124:127], v[240:243], v[180:183], v[124:127]
    v_mfma_f32_16x16x32_bf16 v[156:159], v[240:243], v[164:167], v[156:159]
    v_mfma_f32_16x16x32_bf16 v[96:99], v[244:247], v[176:179], v[96:99]
    v_mfma_f32_16x16x32_bf16 v[128:131], v[244:247], v[180:183], v[128:131]
    v_mfma_f32_16x16x32_bf16 v[160:163], v[244:247], v[164:167], v[160:163]
    s_waitcnt lgkmcnt(0)
    v_mfma_f32_16x16x32_bf16 v[68:71], v[184:187], v[168:171], v[68:71]
    ds_read_b128 v[176:179], v33 offset:8192
    ds_read_b128 v[180:183], v33 offset:10240
    v_mfma_f32_16x16x32_bf16 v[100:103], v[184:187], v[172:175], v[100:103]
    ds_read_b64_tr_b16 v[216:217], v51 offset:28672
    ds_read_b64_tr_b16 v[218:219], v51 offset:29184
    v_mfma_f32_16x16x32_bf16 v[132:135], v[184:187], v[164:167], v[132:135]
    ds_read_b64_tr_b16 v[220:221], v53 offset:28672
    ds_read_b64_tr_b16 v[222:223], v53 offset:29184
    v_mfma_f32_16x16x32_bf16 v[72:75], v[188:191], v[168:171], v[72:75]
    ds_read_b64_tr_b16 v[224:225], v55 offset:28672
    ds_read_b64_tr_b16 v[226:227], v55 offset:29184
    v_mfma_f32_16x16x32_bf16 v[104:107], v[188:191], v[172:175], v[104:107]
    ds_read_b64_tr_b16 v[228:229], v57 offset:28672
    ds_read_b64_tr_b16 v[230:231], v57 offset:29184
    v_mfma_f32_16x16x32_bf16 v[136:139], v[188:191], v[164:167], v[136:139]
    ds_read_b64_tr_b16 v[232:233], v59 offset:28672
    ds_read_b64_tr_b16 v[234:235], v59 offset:29184
    v_mfma_f32_16x16x32_bf16 v[76:79], v[192:195], v[168:171], v[76:79]
    ds_read_b64_tr_b16 v[236:237], v61 offset:28672
    ds_read_b64_tr_b16 v[238:239], v61 offset:29184
    v_mfma_f32_16x16x32_bf16 v[108:111], v[192:195], v[172:175], v[108:111]
    ds_read_b64_tr_b16 v[240:241], v63 offset:28672
    ds_read_b64_tr_b16 v[242:243], v63 offset:29184
    v_mfma_f32_16x16x32_bf16 v[140:143], v[192:195], v[164:167], v[140:143]
    ds_read_b64_tr_b16 v[244:245], v65 offset:28672
    ds_read_b64_tr_b16 v[246:247], v65 offset:29184
    v_mfma_f32_16x16x32_bf16 v[80:83], v[196:199], v[168:171], v[80:83]
    v_mfma_f32_16x16x32_bf16 v[112:115], v[196:199], v[172:175], v[112:115]
    v_mfma_f32_16x16x32_bf16 v[144:147], v[196:199], v[164:167], v[144:147]
    v_mfma_f32_16x16x32_bf16 v[84:87], v[200:203], v[168:171], v[84:87]
    v_mfma_f32_16x16x32_bf16 v[116:119], v[200:203], v[172:175], v[116:119]
    v_mfma_f32_16x16x32_bf16 v[148:151], v[200:203], v[164:167], v[148:151]
    v_mfma_f32_16x16x32_bf16 v[88:91], v[204:207], v[168:171], v[88:91]
    v_mfma_f32_16x16x32_bf16 v[120:123], v[204:207], v[172:175], v[120:123]
    v_mfma_f32_16x16x32_bf16 v[152:155], v[204:207], v[164:167], v[152:155]
    v_mfma_f32_16x16x32_bf16 v[92:95], v[208:211], v[168:171], v[92:95]
    v_mfma_f32_16x16x32_bf16 v[124:127], v[208:211], v[172:175], v[124:127]
    v_mfma_f32_16x16x32_bf16 v[156:159], v[208:211], v[164:167], v[156:159]
    v_mfma_f32_16x16x32_bf16 v[96:99], v[212:215], v[168:171], v[96:99]
    v_mfma_f32_16x16x32_bf16 v[128:131], v[212:215], v[172:175], v[128:131]
    v_mfma_f32_16x16x32_bf16 v[160:163], v[212:215], v[164:167], v[160:163]
    s_waitcnt lgkmcnt(0)
    s_waitcnt vmcnt(20)
    s_barrier
    s_add_u32 m0, s32, 90112
    s_add_u32 s37, s35, 917504
    s_add_u32 s37, s37, s42
    buffer_load_dwordx4 v11, s[12:15], s37 offen lds
    s_add_u32 m0, s32, 94208
    s_add_u32 s37, s35, 1032192
    s_add_u32 s37, s37, s42
    buffer_load_dwordx4 v11, s[12:15], s37 offen lds
    s_add_u32 m0, s32, 98304
    s_add_u32 s37, s35, 917504
    s_add_u32 s37, s37, s43
    buffer_load_dwordx4 v11, s[12:15], s37 offen lds
    s_add_u32 m0, s32, 102400
    s_add_u32 s37, s35, 1032192
    s_add_u32 s37, s37, s43
    buffer_load_dwordx4 v11, s[12:15], s37 offen lds
    s_add_u32 m0, s32, 106496
    s_add_u32 s37, s35, 917504
    s_add_u32 s37, s37, s44
    buffer_load_dwordx4 v11, s[12:15], s37 offen lds
    s_add_u32 m0, s32, 110592
    s_add_u32 s37, s35, 1032192
    s_add_u32 s37, s37, s44
    buffer_load_dwordx4 v11, s[12:15], s37 offen lds
    s_add_u32 m0, s32, 114688
    s_add_u32 s37, s35, 917504
    s_add_u32 s37, s37, s45
    buffer_load_dwordx4 v11, s[12:15], s37 offen lds
    s_add_u32 m0, s32, 118784
    s_add_u32 s37, s35, 1032192
    s_add_u32 s37, s37, s45
    buffer_load_dwordx4 v11, s[12:15], s37 offen lds
    v_mfma_f32_16x16x32_bf16 v[68:71], v[216:219], v[176:179], v[68:71]
    ds_read_b128 v[168:171], v32 offset:16384
    ds_read_b128 v[172:175], v32 offset:18432
    v_mfma_f32_16x16x32_bf16 v[100:103], v[216:219], v[180:183], v[100:103]
    ds_read_b64_tr_b16 v[184:185], v51 offset:57344
    ds_read_b64_tr_b16 v[186:187], v51 offset:57856
    v_mfma_f32_16x16x32_bf16 v[132:135], v[216:219], v[164:167], v[132:135]
    ds_read_b64_tr_b16 v[188:189], v53 offset:57344
    ds_read_b64_tr_b16 v[190:191], v53 offset:57856
    v_mfma_f32_16x16x32_bf16 v[72:75], v[220:223], v[176:179], v[72:75]
    ds_read_b64_tr_b16 v[192:193], v55 offset:57344
    ds_read_b64_tr_b16 v[194:195], v55 offset:57856
    v_mfma_f32_16x16x32_bf16 v[104:107], v[220:223], v[180:183], v[104:107]
    ds_read_b64_tr_b16 v[196:197], v57 offset:57344
    ds_read_b64_tr_b16 v[198:199], v57 offset:57856
    v_mfma_f32_16x16x32_bf16 v[136:139], v[220:223], v[164:167], v[136:139]
    ds_read_b64_tr_b16 v[200:201], v59 offset:57344
    ds_read_b64_tr_b16 v[202:203], v59 offset:57856
    v_mfma_f32_16x16x32_bf16 v[76:79], v[224:227], v[176:179], v[76:79]
    ds_read_b64_tr_b16 v[204:205], v61 offset:57344
    ds_read_b64_tr_b16 v[206:207], v61 offset:57856
    v_mfma_f32_16x16x32_bf16 v[108:111], v[224:227], v[180:183], v[108:111]
    ds_read_b64_tr_b16 v[208:209], v63 offset:57344
    ds_read_b64_tr_b16 v[210:211], v63 offset:57856
    v_mfma_f32_16x16x32_bf16 v[140:143], v[224:227], v[164:167], v[140:143]
    ds_read_b64_tr_b16 v[212:213], v65 offset:57344
    ds_read_b64_tr_b16 v[214:215], v65 offset:57856
    v_mfma_f32_16x16x32_bf16 v[80:83], v[228:231], v[176:179], v[80:83]
    v_mfma_f32_16x16x32_bf16 v[112:115], v[228:231], v[180:183], v[112:115]
    v_mfma_f32_16x16x32_bf16 v[144:147], v[228:231], v[164:167], v[144:147]
    v_mfma_f32_16x16x32_bf16 v[84:87], v[232:235], v[176:179], v[84:87]
    v_mfma_f32_16x16x32_bf16 v[116:119], v[232:235], v[180:183], v[116:119]
    v_mfma_f32_16x16x32_bf16 v[148:151], v[232:235], v[164:167], v[148:151]
    v_mfma_f32_16x16x32_bf16 v[88:91], v[236:239], v[176:179], v[88:91]
    v_mfma_f32_16x16x32_bf16 v[120:123], v[236:239], v[180:183], v[120:123]
    v_mfma_f32_16x16x32_bf16 v[152:155], v[236:239], v[164:167], v[152:155]
    v_mfma_f32_16x16x32_bf16 v[92:95], v[240:243], v[176:179], v[92:95]
    v_mfma_f32_16x16x32_bf16 v[124:127], v[240:243], v[180:183], v[124:127]
    v_mfma_f32_16x16x32_bf16 v[156:159], v[240:243], v[164:167], v[156:159]
    v_mfma_f32_16x16x32_bf16 v[96:99], v[244:247], v[176:179], v[96:99]
    v_mfma_f32_16x16x32_bf16 v[128:131], v[244:247], v[180:183], v[128:131]
    v_mfma_f32_16x16x32_bf16 v[160:163], v[244:247], v[164:167], v[160:163]
    s_waitcnt lgkmcnt(0)
    v_mfma_f32_16x16x32_bf16 v[68:71], v[184:187], v[168:171], v[68:71]
    ds_read_b128 v[176:179], v33 offset:16384
    ds_read_b128 v[180:183], v33 offset:18432
    v_mfma_f32_16x16x32_bf16 v[100:103], v[184:187], v[172:175], v[100:103]
    ds_read_b64_tr_b16 v[216:217], v51 offset:61440
    ds_read_b64_tr_b16 v[218:219], v51 offset:61952
    v_mfma_f32_16x16x32_bf16 v[132:135], v[184:187], v[164:167], v[132:135]
    ds_read_b64_tr_b16 v[220:221], v53 offset:61440
    ds_read_b64_tr_b16 v[222:223], v53 offset:61952
    v_mfma_f32_16x16x32_bf16 v[72:75], v[188:191], v[168:171], v[72:75]
    ds_read_b64_tr_b16 v[224:225], v55 offset:61440
    ds_read_b64_tr_b16 v[226:227], v55 offset:61952
    v_mfma_f32_16x16x32_bf16 v[104:107], v[188:191], v[172:175], v[104:107]
    ds_read_b64_tr_b16 v[228:229], v57 offset:61440
    ds_read_b64_tr_b16 v[230:231], v57 offset:61952
    v_mfma_f32_16x16x32_bf16 v[136:139], v[188:191], v[164:167], v[136:139]
    ds_read_b64_tr_b16 v[232:233], v59 offset:61440
    ds_read_b64_tr_b16 v[234:235], v59 offset:61952
    v_mfma_f32_16x16x32_bf16 v[76:79], v[192:195], v[168:171], v[76:79]
    ds_read_b64_tr_b16 v[236:237], v61 offset:61440
    ds_read_b64_tr_b16 v[238:239], v61 offset:61952
    v_mfma_f32_16x16x32_bf16 v[108:111], v[192:195], v[172:175], v[108:111]
    ds_read_b64_tr_b16 v[240:241], v63 offset:61440
    ds_read_b64_tr_b16 v[242:243], v63 offset:61952
    v_mfma_f32_16x16x32_bf16 v[140:143], v[192:195], v[164:167], v[140:143]
    ds_read_b64_tr_b16 v[244:245], v65 offset:61440
    ds_read_b64_tr_b16 v[246:247], v65 offset:61952
    v_mfma_f32_16x16x32_bf16 v[80:83], v[196:199], v[168:171], v[80:83]
    v_mfma_f32_16x16x32_bf16 v[112:115], v[196:199], v[172:175], v[112:115]
    v_mfma_f32_16x16x32_bf16 v[144:147], v[196:199], v[164:167], v[144:147]
    v_mfma_f32_16x16x32_bf16 v[84:87], v[200:203], v[168:171], v[84:87]
    v_mfma_f32_16x16x32_bf16 v[116:119], v[200:203], v[172:175], v[116:119]
    v_mfma_f32_16x16x32_bf16 v[148:151], v[200:203], v[164:167], v[148:151]
    v_mfma_f32_16x16x32_bf16 v[88:91], v[204:207], v[168:171], v[88:91]
    v_mfma_f32_16x16x32_bf16 v[120:123], v[204:207], v[172:175], v[120:123]
    v_mfma_f32_16x16x32_bf16 v[152:155], v[204:207], v[164:167], v[152:155]
    v_mfma_f32_16x16x32_bf16 v[92:95], v[208:211], v[168:171], v[92:95]
    v_mfma_f32_16x16x32_bf16 v[124:127], v[208:211], v[172:175], v[124:127]
    v_mfma_f32_16x16x32_bf16 v[156:159], v[208:211], v[164:167], v[156:159]
    v_mfma_f32_16x16x32_bf16 v[96:99], v[212:215], v[168:171], v[96:99]
    v_mfma_f32_16x16x32_bf16 v[128:131], v[212:215], v[172:175], v[128:131]
    v_mfma_f32_16x16x32_bf16 v[160:163], v[212:215], v[164:167], v[160:163]
    s_waitcnt lgkmcnt(0)
    s_waitcnt vmcnt(8)
    s_barrier
    s_add_u32 m0, s32, 122880
    s_add_u32 s37, s35, 1146880
    s_add_u32 s37, s37, s42
    buffer_load_dwordx4 v11, s[12:15], s37 offen lds
    s_add_u32 m0, s32, 126976
    s_add_u32 s37, s35, 1261568
    s_add_u32 s37, s37, s42
    buffer_load_dwordx4 v11, s[12:15], s37 offen lds
    s_add_u32 m0, s32, 131072
    s_add_u32 s37, s35, 1146880
    s_add_u32 s37, s37, s43
    buffer_load_dwordx4 v11, s[12:15], s37 offen lds
    s_add_u32 m0, s32, 135168
    s_add_u32 s37, s35, 1261568
    s_add_u32 s37, s37, s43
    buffer_load_dwordx4 v11, s[12:15], s37 offen lds
    s_add_u32 m0, s32, 139264
    s_add_u32 s37, s35, 1146880
    s_add_u32 s37, s37, s44
    buffer_load_dwordx4 v11, s[12:15], s37 offen lds
    s_add_u32 m0, s32, 143360
    s_add_u32 s37, s35, 1261568
    s_add_u32 s37, s37, s44
    buffer_load_dwordx4 v11, s[12:15], s37 offen lds
    s_add_u32 m0, s32, 147456
    s_add_u32 s37, s35, 1146880
    s_add_u32 s37, s37, s45
    buffer_load_dwordx4 v11, s[12:15], s37 offen lds
    s_add_u32 m0, s32, 151552
    s_add_u32 s37, s35, 1261568
    s_add_u32 s37, s37, s45
    buffer_load_dwordx4 v11, s[12:15], s37 offen lds
    v_mfma_f32_16x16x32_bf16 v[68:71], v[216:219], v[176:179], v[68:71]
    ds_read_b128 v[168:171], v32 offset:24576
    ds_read_b128 v[172:175], v32 offset:26624
    v_mfma_f32_16x16x32_bf16 v[100:103], v[216:219], v[180:183], v[100:103]
    ds_read_b64_tr_b16 v[184:185], v36 offset:57344
    ds_read_b64_tr_b16 v[186:187], v36 offset:57856
    v_mfma_f32_16x16x32_bf16 v[132:135], v[216:219], v[164:167], v[132:135]
    ds_read_b64_tr_b16 v[188:189], v37 offset:57344
    ds_read_b64_tr_b16 v[190:191], v37 offset:57856
    v_mfma_f32_16x16x32_bf16 v[72:75], v[220:223], v[176:179], v[72:75]
    ds_read_b64_tr_b16 v[192:193], v38 offset:57344
    ds_read_b64_tr_b16 v[194:195], v38 offset:57856
    v_mfma_f32_16x16x32_bf16 v[104:107], v[220:223], v[180:183], v[104:107]
    ds_read_b64_tr_b16 v[196:197], v39 offset:57344
    ds_read_b64_tr_b16 v[198:199], v39 offset:57856
    v_mfma_f32_16x16x32_bf16 v[136:139], v[220:223], v[164:167], v[136:139]
    ds_read_b64_tr_b16 v[200:201], v40 offset:57344
    ds_read_b64_tr_b16 v[202:203], v40 offset:57856
    v_mfma_f32_16x16x32_bf16 v[76:79], v[224:227], v[176:179], v[76:79]
    ds_read_b64_tr_b16 v[204:205], v41 offset:57344
    ds_read_b64_tr_b16 v[206:207], v41 offset:57856
    v_mfma_f32_16x16x32_bf16 v[108:111], v[224:227], v[180:183], v[108:111]
    ds_read_b64_tr_b16 v[208:209], v42 offset:57344
    ds_read_b64_tr_b16 v[210:211], v42 offset:57856
    v_mfma_f32_16x16x32_bf16 v[140:143], v[224:227], v[164:167], v[140:143]
    ds_read_b64_tr_b16 v[212:213], v43 offset:57344
    ds_read_b64_tr_b16 v[214:215], v43 offset:57856
    v_mfma_f32_16x16x32_bf16 v[80:83], v[228:231], v[176:179], v[80:83]
    v_mfma_f32_16x16x32_bf16 v[112:115], v[228:231], v[180:183], v[112:115]
    v_mfma_f32_16x16x32_bf16 v[144:147], v[228:231], v[164:167], v[144:147]
    v_mfma_f32_16x16x32_bf16 v[84:87], v[232:235], v[176:179], v[84:87]
    v_mfma_f32_16x16x32_bf16 v[116:119], v[232:235], v[180:183], v[116:119]
    v_mfma_f32_16x16x32_bf16 v[148:151], v[232:235], v[164:167], v[148:151]
    v_mfma_f32_16x16x32_bf16 v[88:91], v[236:239], v[176:179], v[88:91]
    v_mfma_f32_16x16x32_bf16 v[120:123], v[236:239], v[180:183], v[120:123]
    v_mfma_f32_16x16x32_bf16 v[152:155], v[236:239], v[164:167], v[152:155]
    v_mfma_f32_16x16x32_bf16 v[92:95], v[240:243], v[176:179], v[92:95]
    v_mfma_f32_16x16x32_bf16 v[124:127], v[240:243], v[180:183], v[124:127]
    v_mfma_f32_16x16x32_bf16 v[156:159], v[240:243], v[164:167], v[156:159]
    v_mfma_f32_16x16x32_bf16 v[96:99], v[244:247], v[176:179], v[96:99]
    v_mfma_f32_16x16x32_bf16 v[128:131], v[244:247], v[180:183], v[128:131]
    v_mfma_f32_16x16x32_bf16 v[160:163], v[244:247], v[164:167], v[160:163]
    s_waitcnt lgkmcnt(0)
    v_mfma_f32_16x16x32_bf16 v[68:71], v[184:187], v[168:171], v[68:71]
    ds_read_b128 v[176:179], v33 offset:24576
    ds_read_b128 v[180:183], v33 offset:26624
    v_mfma_f32_16x16x32_bf16 v[100:103], v[184:187], v[172:175], v[100:103]
    ds_read_b64_tr_b16 v[216:217], v36 offset:61440
    ds_read_b64_tr_b16 v[218:219], v36 offset:61952
    v_mfma_f32_16x16x32_bf16 v[132:135], v[184:187], v[164:167], v[132:135]
    ds_read_b64_tr_b16 v[220:221], v37 offset:61440
    ds_read_b64_tr_b16 v[222:223], v37 offset:61952
    v_mfma_f32_16x16x32_bf16 v[72:75], v[188:191], v[168:171], v[72:75]
    ds_read_b64_tr_b16 v[224:225], v38 offset:61440
    ds_read_b64_tr_b16 v[226:227], v38 offset:61952
    v_mfma_f32_16x16x32_bf16 v[104:107], v[188:191], v[172:175], v[104:107]
    ds_read_b64_tr_b16 v[228:229], v39 offset:61440
    ds_read_b64_tr_b16 v[230:231], v39 offset:61952
    v_mfma_f32_16x16x32_bf16 v[136:139], v[188:191], v[164:167], v[136:139]
    ds_read_b64_tr_b16 v[232:233], v40 offset:61440
    ds_read_b64_tr_b16 v[234:235], v40 offset:61952
    v_mfma_f32_16x16x32_bf16 v[76:79], v[192:195], v[168:171], v[76:79]
    ds_read_b64_tr_b16 v[236:237], v41 offset:61440
    ds_read_b64_tr_b16 v[238:239], v41 offset:61952
    v_mfma_f32_16x16x32_bf16 v[108:111], v[192:195], v[172:175], v[108:111]
    ds_read_b64_tr_b16 v[240:241], v42 offset:61440
    ds_read_b64_tr_b16 v[242:243], v42 offset:61952
    v_mfma_f32_16x16x32_bf16 v[140:143], v[192:195], v[164:167], v[140:143]
    ds_read_b64_tr_b16 v[244:245], v43 offset:61440
    ds_read_b64_tr_b16 v[246:247], v43 offset:61952
    v_mfma_f32_16x16x32_bf16 v[80:83], v[196:199], v[168:171], v[80:83]
    v_mfma_f32_16x16x32_bf16 v[112:115], v[196:199], v[172:175], v[112:115]
    v_mfma_f32_16x16x32_bf16 v[144:147], v[196:199], v[164:167], v[144:147]
    v_mfma_f32_16x16x32_bf16 v[84:87], v[200:203], v[168:171], v[84:87]
    v_mfma_f32_16x16x32_bf16 v[116:119], v[200:203], v[172:175], v[116:119]
    v_mfma_f32_16x16x32_bf16 v[148:151], v[200:203], v[164:167], v[148:151]
    v_mfma_f32_16x16x32_bf16 v[88:91], v[204:207], v[168:171], v[88:91]
    v_mfma_f32_16x16x32_bf16 v[120:123], v[204:207], v[172:175], v[120:123]
    v_mfma_f32_16x16x32_bf16 v[152:155], v[204:207], v[164:167], v[152:155]
    v_mfma_f32_16x16x32_bf16 v[92:95], v[208:211], v[168:171], v[92:95]
    v_mfma_f32_16x16x32_bf16 v[124:127], v[208:211], v[172:175], v[124:127]
    v_mfma_f32_16x16x32_bf16 v[156:159], v[208:211], v[164:167], v[156:159]
    v_mfma_f32_16x16x32_bf16 v[96:99], v[212:215], v[168:171], v[96:99]
    v_mfma_f32_16x16x32_bf16 v[128:131], v[212:215], v[172:175], v[128:131]
    v_mfma_f32_16x16x32_bf16 v[160:163], v[212:215], v[164:167], v[160:163]
    s_waitcnt lgkmcnt(0)
    s_waitcnt vmcnt(8)
    s_barrier
    s_add_u32 m0, s32, 57344
    s_add_u32 s37, s35, 1376256
    s_add_u32 s37, s37, s42
    buffer_load_dwordx4 v11, s[12:15], s37 offen lds
    s_add_u32 m0, s32, 61440
    s_add_u32 s37, s35, 1490944
    s_add_u32 s37, s37, s42
    buffer_load_dwordx4 v11, s[12:15], s37 offen lds
    s_add_u32 m0, s32, 65536
    s_add_u32 s37, s35, 1376256
    s_add_u32 s37, s37, s43
    buffer_load_dwordx4 v11, s[12:15], s37 offen lds
    s_add_u32 m0, s32, 69632
    s_add_u32 s37, s35, 1490944
    s_add_u32 s37, s37, s43
    buffer_load_dwordx4 v11, s[12:15], s37 offen lds
    s_add_u32 m0, s32, 73728
    s_add_u32 s37, s35, 1376256
    s_add_u32 s37, s37, s44
    buffer_load_dwordx4 v11, s[12:15], s37 offen lds
    s_add_u32 m0, s32, 77824
    s_add_u32 s37, s35, 1490944
    s_add_u32 s37, s37, s44
    buffer_load_dwordx4 v11, s[12:15], s37 offen lds
    s_add_u32 m0, s32, 81920
    s_add_u32 s37, s35, 1376256
    s_add_u32 s37, s37, s45
    buffer_load_dwordx4 v11, s[12:15], s37 offen lds
    s_add_u32 m0, s32, 86016
    s_add_u32 s37, s35, 1490944
    s_add_u32 s37, s37, s45
    buffer_load_dwordx4 v11, s[12:15], s37 offen lds
    v_mfma_f32_16x16x32_bf16 v[68:71], v[216:219], v[176:179], v[68:71]
    ds_read_b128 v[168:171], v32 offset:32768
    ds_read_b128 v[172:175], v32 offset:34816
    v_mfma_f32_16x16x32_bf16 v[100:103], v[216:219], v[180:183], v[100:103]
    ds_read_b64_tr_b16 v[184:185], v51 offset:24576
    ds_read_b64_tr_b16 v[186:187], v51 offset:25088
    v_mfma_f32_16x16x32_bf16 v[132:135], v[216:219], v[164:167], v[132:135]
    ds_read_b64_tr_b16 v[188:189], v53 offset:24576
    ds_read_b64_tr_b16 v[190:191], v53 offset:25088
    v_mfma_f32_16x16x32_bf16 v[72:75], v[220:223], v[176:179], v[72:75]
    ds_read_b64_tr_b16 v[192:193], v55 offset:24576
    ds_read_b64_tr_b16 v[194:195], v55 offset:25088
    v_mfma_f32_16x16x32_bf16 v[104:107], v[220:223], v[180:183], v[104:107]
    ds_read_b64_tr_b16 v[196:197], v57 offset:24576
    ds_read_b64_tr_b16 v[198:199], v57 offset:25088
    v_mfma_f32_16x16x32_bf16 v[136:139], v[220:223], v[164:167], v[136:139]
    ds_read_b64_tr_b16 v[200:201], v59 offset:24576
    ds_read_b64_tr_b16 v[202:203], v59 offset:25088
    v_mfma_f32_16x16x32_bf16 v[76:79], v[224:227], v[176:179], v[76:79]
    ds_read_b64_tr_b16 v[204:205], v61 offset:24576
    ds_read_b64_tr_b16 v[206:207], v61 offset:25088
    v_mfma_f32_16x16x32_bf16 v[108:111], v[224:227], v[180:183], v[108:111]
    ds_read_b64_tr_b16 v[208:209], v63 offset:24576
    ds_read_b64_tr_b16 v[210:211], v63 offset:25088
    v_mfma_f32_16x16x32_bf16 v[140:143], v[224:227], v[164:167], v[140:143]
    ds_read_b64_tr_b16 v[212:213], v65 offset:24576
    ds_read_b64_tr_b16 v[214:215], v65 offset:25088
    v_mfma_f32_16x16x32_bf16 v[80:83], v[228:231], v[176:179], v[80:83]
    v_mfma_f32_16x16x32_bf16 v[112:115], v[228:231], v[180:183], v[112:115]
    v_mfma_f32_16x16x32_bf16 v[144:147], v[228:231], v[164:167], v[144:147]
    v_mfma_f32_16x16x32_bf16 v[84:87], v[232:235], v[176:179], v[84:87]
    v_mfma_f32_16x16x32_bf16 v[116:119], v[232:235], v[180:183], v[116:119]
    v_mfma_f32_16x16x32_bf16 v[148:151], v[232:235], v[164:167], v[148:151]
    v_mfma_f32_16x16x32_bf16 v[88:91], v[236:239], v[176:179], v[88:91]
    v_mfma_f32_16x16x32_bf16 v[120:123], v[236:239], v[180:183], v[120:123]
    v_mfma_f32_16x16x32_bf16 v[152:155], v[236:239], v[164:167], v[152:155]
    v_mfma_f32_16x16x32_bf16 v[92:95], v[240:243], v[176:179], v[92:95]
    v_mfma_f32_16x16x32_bf16 v[124:127], v[240:243], v[180:183], v[124:127]
    v_mfma_f32_16x16x32_bf16 v[156:159], v[240:243], v[164:167], v[156:159]
    v_mfma_f32_16x16x32_bf16 v[96:99], v[244:247], v[176:179], v[96:99]
    v_mfma_f32_16x16x32_bf16 v[128:131], v[244:247], v[180:183], v[128:131]
    v_mfma_f32_16x16x32_bf16 v[160:163], v[244:247], v[164:167], v[160:163]
    s_waitcnt lgkmcnt(0)
    v_mfma_f32_16x16x32_bf16 v[68:71], v[184:187], v[168:171], v[68:71]
    ds_read_b128 v[176:179], v33 offset:32768
    ds_read_b128 v[180:183], v33 offset:34816
    v_mfma_f32_16x16x32_bf16 v[100:103], v[184:187], v[172:175], v[100:103]
    ds_read_b64_tr_b16 v[216:217], v51 offset:28672
    ds_read_b64_tr_b16 v[218:219], v51 offset:29184
    v_mfma_f32_16x16x32_bf16 v[132:135], v[184:187], v[164:167], v[132:135]
    ds_read_b64_tr_b16 v[220:221], v53 offset:28672
    ds_read_b64_tr_b16 v[222:223], v53 offset:29184
    v_mfma_f32_16x16x32_bf16 v[72:75], v[188:191], v[168:171], v[72:75]
    ds_read_b64_tr_b16 v[224:225], v55 offset:28672
    ds_read_b64_tr_b16 v[226:227], v55 offset:29184
    v_mfma_f32_16x16x32_bf16 v[104:107], v[188:191], v[172:175], v[104:107]
    ds_read_b64_tr_b16 v[228:229], v57 offset:28672
    ds_read_b64_tr_b16 v[230:231], v57 offset:29184
    v_mfma_f32_16x16x32_bf16 v[136:139], v[188:191], v[164:167], v[136:139]
    ds_read_b64_tr_b16 v[232:233], v59 offset:28672
    ds_read_b64_tr_b16 v[234:235], v59 offset:29184
    v_mfma_f32_16x16x32_bf16 v[76:79], v[192:195], v[168:171], v[76:79]
    ds_read_b64_tr_b16 v[236:237], v61 offset:28672
    ds_read_b64_tr_b16 v[238:239], v61 offset:29184
    v_mfma_f32_16x16x32_bf16 v[108:111], v[192:195], v[172:175], v[108:111]
    ds_read_b64_tr_b16 v[240:241], v63 offset:28672
    ds_read_b64_tr_b16 v[242:243], v63 offset:29184
    v_mfma_f32_16x16x32_bf16 v[140:143], v[192:195], v[164:167], v[140:143]
    ds_read_b64_tr_b16 v[244:245], v65 offset:28672
    ds_read_b64_tr_b16 v[246:247], v65 offset:29184
    v_mfma_f32_16x16x32_bf16 v[80:83], v[196:199], v[168:171], v[80:83]
    v_mfma_f32_16x16x32_bf16 v[112:115], v[196:199], v[172:175], v[112:115]
    v_mfma_f32_16x16x32_bf16 v[144:147], v[196:199], v[164:167], v[144:147]
    v_mfma_f32_16x16x32_bf16 v[84:87], v[200:203], v[168:171], v[84:87]
    v_mfma_f32_16x16x32_bf16 v[116:119], v[200:203], v[172:175], v[116:119]
    v_mfma_f32_16x16x32_bf16 v[148:151], v[200:203], v[164:167], v[148:151]
    v_mfma_f32_16x16x32_bf16 v[88:91], v[204:207], v[168:171], v[88:91]
    v_mfma_f32_16x16x32_bf16 v[120:123], v[204:207], v[172:175], v[120:123]
    v_mfma_f32_16x16x32_bf16 v[152:155], v[204:207], v[164:167], v[152:155]
    v_mfma_f32_16x16x32_bf16 v[92:95], v[208:211], v[168:171], v[92:95]
    v_mfma_f32_16x16x32_bf16 v[124:127], v[208:211], v[172:175], v[124:127]
    v_mfma_f32_16x16x32_bf16 v[156:159], v[208:211], v[164:167], v[156:159]
    v_mfma_f32_16x16x32_bf16 v[96:99], v[212:215], v[168:171], v[96:99]
    v_mfma_f32_16x16x32_bf16 v[128:131], v[212:215], v[172:175], v[128:131]
    v_mfma_f32_16x16x32_bf16 v[160:163], v[212:215], v[164:167], v[160:163]
    s_waitcnt lgkmcnt(0)
    s_waitcnt vmcnt(8)
    s_barrier
    v_mfma_f32_16x16x32_bf16 v[68:71], v[216:219], v[176:179], v[68:71]
    ds_read_b128 v[168:171], v32 offset:40960
    ds_read_b128 v[172:175], v32 offset:43008
    v_mfma_f32_16x16x32_bf16 v[100:103], v[216:219], v[180:183], v[100:103]
    ds_read_b64_tr_b16 v[184:185], v51 offset:57344
    ds_read_b64_tr_b16 v[186:187], v51 offset:57856
    v_mfma_f32_16x16x32_bf16 v[132:135], v[216:219], v[164:167], v[132:135]
    ds_read_b64_tr_b16 v[188:189], v53 offset:57344
    ds_read_b64_tr_b16 v[190:191], v53 offset:57856
    v_mfma_f32_16x16x32_bf16 v[72:75], v[220:223], v[176:179], v[72:75]
    ds_read_b64_tr_b16 v[192:193], v55 offset:57344
    ds_read_b64_tr_b16 v[194:195], v55 offset:57856
    v_mfma_f32_16x16x32_bf16 v[104:107], v[220:223], v[180:183], v[104:107]
    ds_read_b64_tr_b16 v[196:197], v57 offset:57344
    ds_read_b64_tr_b16 v[198:199], v57 offset:57856
    v_mfma_f32_16x16x32_bf16 v[136:139], v[220:223], v[164:167], v[136:139]
    ds_read_b64_tr_b16 v[200:201], v59 offset:57344
    ds_read_b64_tr_b16 v[202:203], v59 offset:57856
    v_mfma_f32_16x16x32_bf16 v[76:79], v[224:227], v[176:179], v[76:79]
    ds_read_b64_tr_b16 v[204:205], v61 offset:57344
    ds_read_b64_tr_b16 v[206:207], v61 offset:57856
    v_mfma_f32_16x16x32_bf16 v[108:111], v[224:227], v[180:183], v[108:111]
    ds_read_b64_tr_b16 v[208:209], v63 offset:57344
    ds_read_b64_tr_b16 v[210:211], v63 offset:57856
    v_mfma_f32_16x16x32_bf16 v[140:143], v[224:227], v[164:167], v[140:143]
    ds_read_b64_tr_b16 v[212:213], v65 offset:57344
    ds_read_b64_tr_b16 v[214:215], v65 offset:57856
    v_mfma_f32_16x16x32_bf16 v[80:83], v[228:231], v[176:179], v[80:83]
    v_mfma_f32_16x16x32_bf16 v[112:115], v[228:231], v[180:183], v[112:115]
    v_mfma_f32_16x16x32_bf16 v[144:147], v[228:231], v[164:167], v[144:147]
    v_mfma_f32_16x16x32_bf16 v[84:87], v[232:235], v[176:179], v[84:87]
    v_mfma_f32_16x16x32_bf16 v[116:119], v[232:235], v[180:183], v[116:119]
    v_mfma_f32_16x16x32_bf16 v[148:151], v[232:235], v[164:167], v[148:151]
    v_mfma_f32_16x16x32_bf16 v[88:91], v[236:239], v[176:179], v[88:91]
    v_mfma_f32_16x16x32_bf16 v[120:123], v[236:239], v[180:183], v[120:123]
    v_mfma_f32_16x16x32_bf16 v[152:155], v[236:239], v[164:167], v[152:155]
    v_mfma_f32_16x16x32_bf16 v[92:95], v[240:243], v[176:179], v[92:95]
    v_mfma_f32_16x16x32_bf16 v[124:127], v[240:243], v[180:183], v[124:127]
    v_mfma_f32_16x16x32_bf16 v[156:159], v[240:243], v[164:167], v[156:159]
    v_mfma_f32_16x16x32_bf16 v[96:99], v[244:247], v[176:179], v[96:99]
    v_mfma_f32_16x16x32_bf16 v[128:131], v[244:247], v[180:183], v[128:131]
    v_mfma_f32_16x16x32_bf16 v[160:163], v[244:247], v[164:167], v[160:163]
    s_waitcnt lgkmcnt(0)
    v_mfma_f32_16x16x32_bf16 v[68:71], v[184:187], v[168:171], v[68:71]
    ds_read_b128 v[176:179], v33 offset:40960
    ds_read_b128 v[180:183], v33 offset:43008
    v_mfma_f32_16x16x32_bf16 v[100:103], v[184:187], v[172:175], v[100:103]
    ds_read_b64_tr_b16 v[216:217], v51 offset:61440
    ds_read_b64_tr_b16 v[218:219], v51 offset:61952
    v_mfma_f32_16x16x32_bf16 v[132:135], v[184:187], v[164:167], v[132:135]
    ds_read_b64_tr_b16 v[220:221], v53 offset:61440
    ds_read_b64_tr_b16 v[222:223], v53 offset:61952
    v_mfma_f32_16x16x32_bf16 v[72:75], v[188:191], v[168:171], v[72:75]
    ds_read_b64_tr_b16 v[224:225], v55 offset:61440
    ds_read_b64_tr_b16 v[226:227], v55 offset:61952
    v_mfma_f32_16x16x32_bf16 v[104:107], v[188:191], v[172:175], v[104:107]
    ds_read_b64_tr_b16 v[228:229], v57 offset:61440
    ds_read_b64_tr_b16 v[230:231], v57 offset:61952
    v_mfma_f32_16x16x32_bf16 v[136:139], v[188:191], v[164:167], v[136:139]
    ds_read_b64_tr_b16 v[232:233], v59 offset:61440
    ds_read_b64_tr_b16 v[234:235], v59 offset:61952
    v_mfma_f32_16x16x32_bf16 v[76:79], v[192:195], v[168:171], v[76:79]
    ds_read_b64_tr_b16 v[236:237], v61 offset:61440
    ds_read_b64_tr_b16 v[238:239], v61 offset:61952
    v_mfma_f32_16x16x32_bf16 v[108:111], v[192:195], v[172:175], v[108:111]
    ds_read_b64_tr_b16 v[240:241], v63 offset:61440
    ds_read_b64_tr_b16 v[242:243], v63 offset:61952
    v_mfma_f32_16x16x32_bf16 v[140:143], v[192:195], v[164:167], v[140:143]
    ds_read_b64_tr_b16 v[244:245], v65 offset:61440
    ds_read_b64_tr_b16 v[246:247], v65 offset:61952
    v_mfma_f32_16x16x32_bf16 v[80:83], v[196:199], v[168:171], v[80:83]
    v_mfma_f32_16x16x32_bf16 v[112:115], v[196:199], v[172:175], v[112:115]
    v_mfma_f32_16x16x32_bf16 v[144:147], v[196:199], v[164:167], v[144:147]
    v_mfma_f32_16x16x32_bf16 v[84:87], v[200:203], v[168:171], v[84:87]
    v_mfma_f32_16x16x32_bf16 v[116:119], v[200:203], v[172:175], v[116:119]
    v_mfma_f32_16x16x32_bf16 v[148:151], v[200:203], v[164:167], v[148:151]
    v_mfma_f32_16x16x32_bf16 v[88:91], v[204:207], v[168:171], v[88:91]
    v_mfma_f32_16x16x32_bf16 v[120:123], v[204:207], v[172:175], v[120:123]
    v_mfma_f32_16x16x32_bf16 v[152:155], v[204:207], v[164:167], v[152:155]
    v_mfma_f32_16x16x32_bf16 v[92:95], v[208:211], v[168:171], v[92:95]
    v_mfma_f32_16x16x32_bf16 v[124:127], v[208:211], v[172:175], v[124:127]
    v_mfma_f32_16x16x32_bf16 v[156:159], v[208:211], v[164:167], v[156:159]
    v_mfma_f32_16x16x32_bf16 v[96:99], v[212:215], v[168:171], v[96:99]
    v_mfma_f32_16x16x32_bf16 v[128:131], v[212:215], v[172:175], v[128:131]
    v_mfma_f32_16x16x32_bf16 v[160:163], v[212:215], v[164:167], v[160:163]
    s_waitcnt lgkmcnt(0)
    s_waitcnt vmcnt(0)
    s_barrier
    v_mfma_f32_16x16x32_bf16 v[68:71], v[216:219], v[176:179], v[68:71]
    ds_read_b128 v[168:171], v32 offset:49152
    ds_read_b128 v[172:175], v32 offset:51200
    v_mfma_f32_16x16x32_bf16 v[100:103], v[216:219], v[180:183], v[100:103]
    ds_read_b64_tr_b16 v[184:185], v36 offset:57344
    ds_read_b64_tr_b16 v[186:187], v36 offset:57856
    v_mfma_f32_16x16x32_bf16 v[132:135], v[216:219], v[164:167], v[132:135]
    ds_read_b64_tr_b16 v[188:189], v37 offset:57344
    ds_read_b64_tr_b16 v[190:191], v37 offset:57856
    v_mfma_f32_16x16x32_bf16 v[72:75], v[220:223], v[176:179], v[72:75]
    ds_read_b64_tr_b16 v[192:193], v38 offset:57344
    ds_read_b64_tr_b16 v[194:195], v38 offset:57856
    v_mfma_f32_16x16x32_bf16 v[104:107], v[220:223], v[180:183], v[104:107]
    ds_read_b64_tr_b16 v[196:197], v39 offset:57344
    ds_read_b64_tr_b16 v[198:199], v39 offset:57856
    v_mfma_f32_16x16x32_bf16 v[136:139], v[220:223], v[164:167], v[136:139]
    ds_read_b64_tr_b16 v[200:201], v40 offset:57344
    ds_read_b64_tr_b16 v[202:203], v40 offset:57856
    v_mfma_f32_16x16x32_bf16 v[76:79], v[224:227], v[176:179], v[76:79]
    ds_read_b64_tr_b16 v[204:205], v41 offset:57344
    ds_read_b64_tr_b16 v[206:207], v41 offset:57856
    v_mfma_f32_16x16x32_bf16 v[108:111], v[224:227], v[180:183], v[108:111]
    ds_read_b64_tr_b16 v[208:209], v42 offset:57344
    ds_read_b64_tr_b16 v[210:211], v42 offset:57856
    v_mfma_f32_16x16x32_bf16 v[140:143], v[224:227], v[164:167], v[140:143]
    ds_read_b64_tr_b16 v[212:213], v43 offset:57344
    ds_read_b64_tr_b16 v[214:215], v43 offset:57856
    v_mfma_f32_16x16x32_bf16 v[80:83], v[228:231], v[176:179], v[80:83]
    v_mfma_f32_16x16x32_bf16 v[112:115], v[228:231], v[180:183], v[112:115]
    v_mfma_f32_16x16x32_bf16 v[144:147], v[228:231], v[164:167], v[144:147]
    v_mfma_f32_16x16x32_bf16 v[84:87], v[232:235], v[176:179], v[84:87]
    v_mfma_f32_16x16x32_bf16 v[116:119], v[232:235], v[180:183], v[116:119]
    v_mfma_f32_16x16x32_bf16 v[148:151], v[232:235], v[164:167], v[148:151]
    v_mfma_f32_16x16x32_bf16 v[88:91], v[236:239], v[176:179], v[88:91]
    v_mfma_f32_16x16x32_bf16 v[120:123], v[236:239], v[180:183], v[120:123]
    v_mfma_f32_16x16x32_bf16 v[152:155], v[236:239], v[164:167], v[152:155]
    v_mfma_f32_16x16x32_bf16 v[92:95], v[240:243], v[176:179], v[92:95]
    v_mfma_f32_16x16x32_bf16 v[124:127], v[240:243], v[180:183], v[124:127]
    v_mfma_f32_16x16x32_bf16 v[156:159], v[240:243], v[164:167], v[156:159]
    v_mfma_f32_16x16x32_bf16 v[96:99], v[244:247], v[176:179], v[96:99]
    v_mfma_f32_16x16x32_bf16 v[128:131], v[244:247], v[180:183], v[128:131]
    v_mfma_f32_16x16x32_bf16 v[160:163], v[244:247], v[164:167], v[160:163]
    s_waitcnt lgkmcnt(0)
    v_mfma_f32_16x16x32_bf16 v[68:71], v[184:187], v[168:171], v[68:71]
    ds_read_b128 v[176:179], v33 offset:49152
    ds_read_b128 v[180:183], v33 offset:51200
    v_mfma_f32_16x16x32_bf16 v[100:103], v[184:187], v[172:175], v[100:103]
    ds_read_b64_tr_b16 v[216:217], v36 offset:61440
    ds_read_b64_tr_b16 v[218:219], v36 offset:61952
    v_mfma_f32_16x16x32_bf16 v[132:135], v[184:187], v[164:167], v[132:135]
    ds_read_b64_tr_b16 v[220:221], v37 offset:61440
    ds_read_b64_tr_b16 v[222:223], v37 offset:61952
    v_mfma_f32_16x16x32_bf16 v[72:75], v[188:191], v[168:171], v[72:75]
    ds_read_b64_tr_b16 v[224:225], v38 offset:61440
    ds_read_b64_tr_b16 v[226:227], v38 offset:61952
    v_mfma_f32_16x16x32_bf16 v[104:107], v[188:191], v[172:175], v[104:107]
    ds_read_b64_tr_b16 v[228:229], v39 offset:61440
    ds_read_b64_tr_b16 v[230:231], v39 offset:61952
    v_mfma_f32_16x16x32_bf16 v[136:139], v[188:191], v[164:167], v[136:139]
    ds_read_b64_tr_b16 v[232:233], v40 offset:61440
    ds_read_b64_tr_b16 v[234:235], v40 offset:61952
    v_mfma_f32_16x16x32_bf16 v[76:79], v[192:195], v[168:171], v[76:79]
    ds_read_b64_tr_b16 v[236:237], v41 offset:61440
    ds_read_b64_tr_b16 v[238:239], v41 offset:61952
    v_mfma_f32_16x16x32_bf16 v[108:111], v[192:195], v[172:175], v[108:111]
    ds_read_b64_tr_b16 v[240:241], v42 offset:61440
    ds_read_b64_tr_b16 v[242:243], v42 offset:61952
    v_mfma_f32_16x16x32_bf16 v[140:143], v[192:195], v[164:167], v[140:143]
    ds_read_b64_tr_b16 v[244:245], v43 offset:61440
    ds_read_b64_tr_b16 v[246:247], v43 offset:61952
    v_mfma_f32_16x16x32_bf16 v[80:83], v[196:199], v[168:171], v[80:83]
    v_mfma_f32_16x16x32_bf16 v[112:115], v[196:199], v[172:175], v[112:115]
    v_mfma_f32_16x16x32_bf16 v[144:147], v[196:199], v[164:167], v[144:147]
    v_mfma_f32_16x16x32_bf16 v[84:87], v[200:203], v[168:171], v[84:87]
    v_mfma_f32_16x16x32_bf16 v[116:119], v[200:203], v[172:175], v[116:119]
    v_mfma_f32_16x16x32_bf16 v[148:151], v[200:203], v[164:167], v[148:151]
    v_mfma_f32_16x16x32_bf16 v[88:91], v[204:207], v[168:171], v[88:91]
    v_mfma_f32_16x16x32_bf16 v[120:123], v[204:207], v[172:175], v[120:123]
    v_mfma_f32_16x16x32_bf16 v[152:155], v[204:207], v[164:167], v[152:155]
    v_mfma_f32_16x16x32_bf16 v[92:95], v[208:211], v[168:171], v[92:95]
    v_mfma_f32_16x16x32_bf16 v[124:127], v[208:211], v[172:175], v[124:127]
    v_mfma_f32_16x16x32_bf16 v[156:159], v[208:211], v[164:167], v[156:159]
    v_mfma_f32_16x16x32_bf16 v[96:99], v[212:215], v[168:171], v[96:99]
    v_mfma_f32_16x16x32_bf16 v[128:131], v[212:215], v[172:175], v[128:131]
    v_mfma_f32_16x16x32_bf16 v[160:163], v[212:215], v[164:167], v[160:163]
    s_waitcnt lgkmcnt(0)
    v_mfma_f32_16x16x32_bf16 v[68:71], v[216:219], v[176:179], v[68:71]
    v_mfma_f32_16x16x32_bf16 v[100:103], v[216:219], v[180:183], v[100:103]
    v_mfma_f32_16x16x32_bf16 v[132:135], v[216:219], v[164:167], v[132:135]
    v_mfma_f32_16x16x32_bf16 v[72:75], v[220:223], v[176:179], v[72:75]
    v_mfma_f32_16x16x32_bf16 v[104:107], v[220:223], v[180:183], v[104:107]
    v_mfma_f32_16x16x32_bf16 v[136:139], v[220:223], v[164:167], v[136:139]
    v_mfma_f32_16x16x32_bf16 v[76:79], v[224:227], v[176:179], v[76:79]
    v_mfma_f32_16x16x32_bf16 v[108:111], v[224:227], v[180:183], v[108:111]
    v_mfma_f32_16x16x32_bf16 v[140:143], v[224:227], v[164:167], v[140:143]
    v_mfma_f32_16x16x32_bf16 v[80:83], v[228:231], v[176:179], v[80:83]
    v_mfma_f32_16x16x32_bf16 v[112:115], v[228:231], v[180:183], v[112:115]
    v_mfma_f32_16x16x32_bf16 v[144:147], v[228:231], v[164:167], v[144:147]
    v_mfma_f32_16x16x32_bf16 v[84:87], v[232:235], v[176:179], v[84:87]
    v_mfma_f32_16x16x32_bf16 v[116:119], v[232:235], v[180:183], v[116:119]
    v_mfma_f32_16x16x32_bf16 v[148:151], v[232:235], v[164:167], v[148:151]
    v_mfma_f32_16x16x32_bf16 v[88:91], v[236:239], v[176:179], v[88:91]
    v_mfma_f32_16x16x32_bf16 v[120:123], v[236:239], v[180:183], v[120:123]
    v_mfma_f32_16x16x32_bf16 v[152:155], v[236:239], v[164:167], v[152:155]
    v_mfma_f32_16x16x32_bf16 v[92:95], v[240:243], v[176:179], v[92:95]
    v_mfma_f32_16x16x32_bf16 v[124:127], v[240:243], v[180:183], v[124:127]
    v_mfma_f32_16x16x32_bf16 v[156:159], v[240:243], v[164:167], v[156:159]
    v_mfma_f32_16x16x32_bf16 v[96:99], v[244:247], v[176:179], v[96:99]
    v_mfma_f32_16x16x32_bf16 v[128:131], v[244:247], v[180:183], v[128:131]
    v_mfma_f32_16x16x32_bf16 v[160:163], v[244:247], v[164:167], v[160:163]
    s_nop 7
    s_nop 7
    s_barrier
    s_mov_b32 s12, s78
    s_mov_b32 s13, s79
    s_mov_b32 s14, 1605632
    s_mov_b32 s15, 0x00020000
    s_lshl_b32 s32, s86, 10
    s_and_b32 s40, s86, 1
    s_mul_i32 s35, s86, 7168
    v_lshrrev_b32 v170, 3, v1
    v_bfe_u32 v168, v1, 4, 1
    v_lshlrev_b32 v168, 1, v168
    s_lshl_b32 s37, s40, 2
    v_add_u32 v168, s37, v168
    v_and_b32 v169, 7, v1
    v_xor_b32 v169, v169, v168
    s_mov_b32 s39, 896
    v_mul_lo_u32 v168, v170, s39
    v_lshl_add_u32 v171, v169, 4, v168
    s_mul_i32 s42, s88, 112
    s_add_u32 s42, s42, 0
    s_add_u32 m0, s32, 73728
    s_add_u32 s37, s35, 0
    s_add_u32 s37, s37, s42
    buffer_load_dwordx4 v171, s[12:15], s37 offen lds
    s_add_u32 m0, s32, 77824
    s_add_u32 s37, s35, 28672
    s_add_u32 s37, s37, s42
    buffer_load_dwordx4 v171, s[12:15], s37 offen lds
    s_add_u32 m0, s32, 81920
    s_add_u32 s37, s35, 57344
    s_add_u32 s37, s37, s42
    buffer_load_dwordx4 v171, s[12:15], s37 offen lds
    s_add_u32 m0, s32, 86016
    s_add_u32 s37, s35, 86016
    s_add_u32 s37, s37, s42
    buffer_load_dwordx4 v171, s[12:15], s37 offen lds
    s_add_u32 m0, s32, 90112
    s_add_u32 s37, s35, 114688
    s_add_u32 s37, s37, s42
    buffer_load_dwordx4 v171, s[12:15], s37 offen lds
    s_add_u32 m0, s32, 94208
    s_add_u32 s37, s35, 143360
    s_add_u32 s37, s37, s42
    buffer_load_dwordx4 v171, s[12:15], s37 offen lds
    s_add_u32 m0, s32, 98304
    s_add_u32 s37, s35, 172032
    s_add_u32 s37, s37, s42
    buffer_load_dwordx4 v171, s[12:15], s37 offen lds
    s_add_u32 m0, s32, 102400
    s_add_u32 s37, s35, 200704
    s_add_u32 s37, s37, s42
    buffer_load_dwordx4 v171, s[12:15], s37 offen lds
    s_add_u32 m0, s32, 106496
    s_add_u32 s37, s35, 229376
    s_add_u32 s37, s37, s42
    buffer_load_dwordx4 v171, s[12:15], s37 offen lds
    s_add_u32 m0, s32, 110592
    s_add_u32 s37, s35, 258048
    s_add_u32 s37, s37, s42
    buffer_load_dwordx4 v171, s[12:15], s37 offen lds
    s_add_u32 m0, s32, 114688
    s_add_u32 s37, s35, 286720
    s_add_u32 s37, s37, s42
    buffer_load_dwordx4 v171, s[12:15], s37 offen lds
    s_add_u32 m0, s32, 118784
    s_add_u32 s37, s35, 315392
    s_add_u32 s37, s37, s42
    buffer_load_dwordx4 v171, s[12:15], s37 offen lds
    s_add_u32 m0, s32, 122880
    s_add_u32 s37, s35, 344064
    s_add_u32 s37, s37, s42
    buffer_load_dwordx4 v171, s[12:15], s37 offen lds
    s_add_u32 m0, s32, 126976
    s_add_u32 s37, s35, 372736
    s_add_u32 s37, s37, s42
    buffer_load_dwordx4 v171, s[12:15], s37 offen lds
    s_add_u32 m0, s32, 131072
    s_add_u32 s37, s35, 401408
    s_add_u32 s37, s37, s42
    buffer_load_dwordx4 v171, s[12:15], s37 offen lds
    s_add_u32 m0, s32, 135168
    s_add_u32 s37, s35, 430080
    s_add_u32 s37, s37, s42
    buffer_load_dwordx4 v171, s[12:15], s37 offen lds
    s_add_u32 m0, s32, 139264
    s_add_u32 s37, s35, 458752
    s_add_u32 s37, s37, s42
    buffer_load_dwordx4 v171, s[12:15], s37 offen lds
    s_add_u32 m0, s32, 143360
    s_add_u32 s37, s35, 487424
    s_add_u32 s37, s37, s42
    buffer_load_dwordx4 v171, s[12:15], s37 offen lds
    v_add_f32 v172, v16, v18
    v_add_f32 v173, v17, v19
    v_add_f32 v168, v20, v22
    v_add_f32 v169, v21, v23
    v_add_f32 v172, v172, v168
    v_add_f32 v173, v173, v169
    v_mov_b32 v168, v172
    s_nop 1
    v_permlane16_swap_b32 v172, v168
    v_add_f32 v172, v172, v168
    v_mov_b32 v168, v172
    s_nop 1
    v_permlane32_swap_b32 v172, v168
    v_add_f32 v172, v172, v168
    v_mov_b32 v168, v173
    s_nop 1
    v_permlane16_swap_b32 v173, v168
    v_add_f32 v173, v173, v168
    v_mov_b32 v168, v173
    s_nop 1
    v_permlane32_swap_b32 v173, v168
    v_add_f32 v173, v173, v168
    v_mul_f32 v172, 991054117, v172
    v_mul_f32 v173, 991054117, v173
    v_fma_f32 v173, -v172, v172, v173
    v_max_f32 v173, 0, v173
    v_add_f32 v168, 925353388, v173
    v_rsq_f32 v169, v168
    s_nop 0
    v_mov_b32 v173, v169
    v_add_f32 v174, v24, v26
    v_add_f32 v175, v25, v27
    v_add_f32 v168, v28, v30
    v_add_f32 v169, v29, v31
    v_add_f32 v174, v174, v168
    v_add_f32 v175, v175, v169
    v_mov_b32 v168, v174
    s_nop 1
    v_permlane16_swap_b32 v174, v168
    v_add_f32 v174, v174, v168
    v_mov_b32 v168, v174
    s_nop 1
    v_permlane32_swap_b32 v174, v168
    v_add_f32 v174, v174, v168
    v_mov_b32 v168, v175
    s_nop 1
    v_permlane16_swap_b32 v175, v168
    v_add_f32 v175, v175, v168
    v_mov_b32 v168, v175
    s_nop 1
    v_permlane32_swap_b32 v175, v168
    v_add_f32 v175, v175, v168
    v_mul_f32 v174, 991054117, v174
    v_mul_f32 v175, 991054117, v175
    v_fma_f32 v175, -v174, v174, v175
    v_max_f32 v175, 0, v175
    v_add_f32 v168, 925353388, v175
    v_rsq_f32 v169, v168
    s_nop 0
    v_mov_b32 v175, v169
    s_mov_b32 s54, 1027024659
    s_mov_b32 s55, 3222493025
    s_add_u32 s16, s84, 34603008
    s_addc_u32 s17, s85, 0
    s_mov_b32 s18, 7340032
    s_mov_b32 s19, 0x00020000
    s_lshl_b32 s37, s87, 6
    s_lshr_b32 s38, s86, 1
    s_mul_i32 s38, s38, 32
    s_add_u32 s37, s37, s38
    v_add_u32 v168, s37, v2
    s_mov_b32 s38, 3584
    v_mul_lo_u32 v180, v168, s38
    v_and_b32 v168, 1, v3
    v_lshl_add_u32 v180, v168, 5, v180
    v_lshrrev_b32 v168, 1, v3
    v_lshl_add_u32 v180, v168, 4, v180
    v_pk_fma_f32 v[68:69], v[132:133], v[172:173], v[68:69] op_sel_hi:[1,0,1] neg_lo:[0,1,0] neg_hi:[0,1,0]
    v_pk_mul_f32 v[68:69], v[68:69], v[172:173] op_sel:[0,1] op_sel_hi:[1,1]
    v_pk_mul_f32 v[176:177], v[68:69], v[68:69]
    v_pk_mul_f32 v[178:179], v[68:69], s[54:55] op_sel:[0,1] op_sel_hi:[1,1]
    v_pk_fma_f32 v[176:177], v[176:177], s[54:55], 1.0 op_sel_hi:[1,0,0]
    v_pk_mul_f32 v[176:177], v[176:177], v[178:179]
    v_exp_f32 v176, v176
    v_exp_f32 v177, v177
    s_nop 0
    v_pk_add_f32 v[176:177], v[176:177], 1.0 op_sel_hi:[1,0]
    v_rcp_f32 v176, v176
    v_rcp_f32 v177, v177
    s_nop 0
    v_pk_mul_f32 v[68:69], v[68:69], v[176:177]
    v_pk_fma_f32 v[70:71], v[134:135], v[172:173], v[70:71] op_sel_hi:[1,0,1] neg_lo:[0,1,0] neg_hi:[0,1,0]
    v_pk_mul_f32 v[70:71], v[70:71], v[172:173] op_sel:[0,1] op_sel_hi:[1,1]
    v_pk_mul_f32 v[176:177], v[70:71], v[70:71]
    v_pk_mul_f32 v[178:179], v[70:71], s[54:55] op_sel:[0,1] op_sel_hi:[1,1]
    v_pk_fma_f32 v[176:177], v[176:177], s[54:55], 1.0 op_sel_hi:[1,0,0]
    v_pk_mul_f32 v[176:177], v[176:177], v[178:179]
    v_exp_f32 v176, v176
    v_exp_f32 v177, v177
    s_nop 0
    v_pk_add_f32 v[176:177], v[176:177], 1.0 op_sel_hi:[1,0]
    v_rcp_f32 v176, v176
    v_rcp_f32 v177, v177
    s_nop 0
    v_pk_mul_f32 v[70:71], v[70:71], v[176:177]
    v_pk_fma_f32 v[72:73], v[136:137], v[172:173], v[72:73] op_sel_hi:[1,0,1] neg_lo:[0,1,0] neg_hi:[0,1,0]
    v_pk_mul_f32 v[72:73], v[72:73], v[172:173] op_sel:[0,1] op_sel_hi:[1,1]
    v_pk_mul_f32 v[176:177], v[72:73], v[72:73]
    v_pk_mul_f32 v[178:179], v[72:73], s[54:55] op_sel:[0,1] op_sel_hi:[1,1]
    v_pk_fma_f32 v[176:177], v[176:177], s[54:55], 1.0 op_sel_hi:[1,0,0]
    v_pk_mul_f32 v[176:177], v[176:177], v[178:179]
    v_exp_f32 v176, v176
    v_exp_f32 v177, v177
    s_nop 0
    v_pk_add_f32 v[176:177], v[176:177], 1.0 op_sel_hi:[1,0]
    v_rcp_f32 v176, v176
    v_rcp_f32 v177, v177
    s_nop 0
    v_pk_mul_f32 v[72:73], v[72:73], v[176:177]
    v_pk_fma_f32 v[74:75], v[138:139], v[172:173], v[74:75] op_sel_hi:[1,0,1] neg_lo:[0,1,0] neg_hi:[0,1,0]
    v_pk_mul_f32 v[74:75], v[74:75], v[172:173] op_sel:[0,1] op_sel_hi:[1,1]
    v_pk_mul_f32 v[176:177], v[74:75], v[74:75]
    v_pk_mul_f32 v[178:179], v[74:75], s[54:55] op_sel:[0,1] op_sel_hi:[1,1]
    v_pk_fma_f32 v[176:177], v[176:177], s[54:55], 1.0 op_sel_hi:[1,0,0]
    v_pk_mul_f32 v[176:177], v[176:177], v[178:179]
    v_exp_f32 v176, v176
    v_exp_f32 v177, v177
    s_nop 0
    v_pk_add_f32 v[176:177], v[176:177], 1.0 op_sel_hi:[1,0]
    v_rcp_f32 v176, v176
    v_rcp_f32 v177, v177
    s_nop 0
    v_pk_mul_f32 v[74:75], v[74:75], v[176:177]
    v_pk_fma_f32 v[76:77], v[140:141], v[172:173], v[76:77] op_sel_hi:[1,0,1] neg_lo:[0,1,0] neg_hi:[0,1,0]
    v_pk_mul_f32 v[76:77], v[76:77], v[172:173] op_sel:[0,1] op_sel_hi:[1,1]
    v_pk_mul_f32 v[176:177], v[76:77], v[76:77]
    v_pk_mul_f32 v[178:179], v[76:77], s[54:55] op_sel:[0,1] op_sel_hi:[1,1]
    v_pk_fma_f32 v[176:177], v[176:177], s[54:55], 1.0 op_sel_hi:[1,0,0]
    v_pk_mul_f32 v[176:177], v[176:177], v[178:179]
    v_exp_f32 v176, v176
    v_exp_f32 v177, v177
    s_nop 0
    v_pk_add_f32 v[176:177], v[176:177], 1.0 op_sel_hi:[1,0]
    v_rcp_f32 v176, v176
    v_rcp_f32 v177, v177
    s_nop 0
    v_pk_mul_f32 v[76:77], v[76:77], v[176:177]
    v_pk_fma_f32 v[78:79], v[142:143], v[172:173], v[78:79] op_sel_hi:[1,0,1] neg_lo:[0,1,0] neg_hi:[0,1,0]
    v_pk_mul_f32 v[78:79], v[78:79], v[172:173] op_sel:[0,1] op_sel_hi:[1,1]
    v_pk_mul_f32 v[176:177], v[78:79], v[78:79]
    v_pk_mul_f32 v[178:179], v[78:79], s[54:55] op_sel:[0,1] op_sel_hi:[1,1]
    v_pk_fma_f32 v[176:177], v[176:177], s[54:55], 1.0 op_sel_hi:[1,0,0]
    v_pk_mul_f32 v[176:177], v[176:177], v[178:179]
    v_exp_f32 v176, v176
    v_exp_f32 v177, v177
    s_nop 0
    v_pk_add_f32 v[176:177], v[176:177], 1.0 op_sel_hi:[1,0]
    v_rcp_f32 v176, v176
    v_rcp_f32 v177, v177
    s_nop 0
    v_pk_mul_f32 v[78:79], v[78:79], v[176:177]
    v_pk_fma_f32 v[80:81], v[144:145], v[172:173], v[80:81] op_sel_hi:[1,0,1] neg_lo:[0,1,0] neg_hi:[0,1,0]
    v_pk_mul_f32 v[80:81], v[80:81], v[172:173] op_sel:[0,1] op_sel_hi:[1,1]
    v_pk_mul_f32 v[176:177], v[80:81], v[80:81]
    v_pk_mul_f32 v[178:179], v[80:81], s[54:55] op_sel:[0,1] op_sel_hi:[1,1]
    v_pk_fma_f32 v[176:177], v[176:177], s[54:55], 1.0 op_sel_hi:[1,0,0]
    v_pk_mul_f32 v[176:177], v[176:177], v[178:179]
    v_exp_f32 v176, v176
    v_exp_f32 v177, v177
    s_nop 0
    v_pk_add_f32 v[176:177], v[176:177], 1.0 op_sel_hi:[1,0]
    v_rcp_f32 v176, v176
    v_rcp_f32 v177, v177
    s_nop 0
    v_pk_mul_f32 v[80:81], v[80:81], v[176:177]
    v_pk_fma_f32 v[82:83], v[146:147], v[172:173], v[82:83] op_sel_hi:[1,0,1] neg_lo:[0,1,0] neg_hi:[0,1,0]
    v_pk_mul_f32 v[82:83], v[82:83], v[172:173] op_sel:[0,1] op_sel_hi:[1,1]
    v_pk_mul_f32 v[176:177], v[82:83], v[82:83]
    v_pk_mul_f32 v[178:179], v[82:83], s[54:55] op_sel:[0,1] op_sel_hi:[1,1]
    v_pk_fma_f32 v[176:177], v[176:177], s[54:55], 1.0 op_sel_hi:[1,0,0]
    v_pk_mul_f32 v[176:177], v[176:177], v[178:179]
    v_exp_f32 v176, v176
    v_exp_f32 v177, v177
    s_nop 0
    v_pk_add_f32 v[176:177], v[176:177], 1.0 op_sel_hi:[1,0]
    v_rcp_f32 v176, v176
    v_rcp_f32 v177, v177
    s_nop 0
    v_pk_mul_f32 v[82:83], v[82:83], v[176:177]
    v_pk_fma_f32 v[84:85], v[148:149], v[172:173], v[84:85] op_sel_hi:[1,0,1] neg_lo:[0,1,0] neg_hi:[0,1,0]
    v_pk_mul_f32 v[84:85], v[84:85], v[172:173] op_sel:[0,1] op_sel_hi:[1,1]
    v_pk_mul_f32 v[176:177], v[84:85], v[84:85]
    v_pk_mul_f32 v[178:179], v[84:85], s[54:55] op_sel:[0,1] op_sel_hi:[1,1]
    v_pk_fma_f32 v[176:177], v[176:177], s[54:55], 1.0 op_sel_hi:[1,0,0]
    v_pk_mul_f32 v[176:177], v[176:177], v[178:179]
    v_exp_f32 v176, v176
    v_exp_f32 v177, v177
    s_nop 0
    v_pk_add_f32 v[176:177], v[176:177], 1.0 op_sel_hi:[1,0]
    v_rcp_f32 v176, v176
    v_rcp_f32 v177, v177
    s_nop 0
    v_pk_mul_f32 v[84:85], v[84:85], v[176:177]
    v_pk_fma_f32 v[86:87], v[150:151], v[172:173], v[86:87] op_sel_hi:[1,0,1] neg_lo:[0,1,0] neg_hi:[0,1,0]
    v_pk_mul_f32 v[86:87], v[86:87], v[172:173] op_sel:[0,1] op_sel_hi:[1,1]
    v_pk_mul_f32 v[176:177], v[86:87], v[86:87]
    v_pk_mul_f32 v[178:179], v[86:87], s[54:55] op_sel:[0,1] op_sel_hi:[1,1]
    v_pk_fma_f32 v[176:177], v[176:177], s[54:55], 1.0 op_sel_hi:[1,0,0]
    v_pk_mul_f32 v[176:177], v[176:177], v[178:179]
    v_exp_f32 v176, v176
    v_exp_f32 v177, v177
    s_nop 0
    v_pk_add_f32 v[176:177], v[176:177], 1.0 op_sel_hi:[1,0]
    v_rcp_f32 v176, v176
    v_rcp_f32 v177, v177
    s_nop 0
    v_pk_mul_f32 v[86:87], v[86:87], v[176:177]
    v_pk_fma_f32 v[88:89], v[152:153], v[172:173], v[88:89] op_sel_hi:[1,0,1] neg_lo:[0,1,0] neg_hi:[0,1,0]
    v_pk_mul_f32 v[88:89], v[88:89], v[172:173] op_sel:[0,1] op_sel_hi:[1,1]
    v_pk_mul_f32 v[176:177], v[88:89], v[88:89]
    v_pk_mul_f32 v[178:179], v[88:89], s[54:55] op_sel:[0,1] op_sel_hi:[1,1]
    v_pk_fma_f32 v[176:177], v[176:177], s[54:55], 1.0 op_sel_hi:[1,0,0]
    v_pk_mul_f32 v[176:177], v[176:177], v[178:179]
    v_exp_f32 v176, v176
    v_exp_f32 v177, v177
    s_nop 0
    v_pk_add_f32 v[176:177], v[176:177], 1.0 op_sel_hi:[1,0]
    v_rcp_f32 v176, v176
    v_rcp_f32 v177, v177
    s_nop 0
    v_pk_mul_f32 v[88:89], v[88:89], v[176:177]
    v_pk_fma_f32 v[90:91], v[154:155], v[172:173], v[90:91] op_sel_hi:[1,0,1] neg_lo:[0,1,0] neg_hi:[0,1,0]
    v_pk_mul_f32 v[90:91], v[90:91], v[172:173] op_sel:[0,1] op_sel_hi:[1,1]
    v_pk_mul_f32 v[176:177], v[90:91], v[90:91]
    v_pk_mul_f32 v[178:179], v[90:91], s[54:55] op_sel:[0,1] op_sel_hi:[1,1]
    v_pk_fma_f32 v[176:177], v[176:177], s[54:55], 1.0 op_sel_hi:[1,0,0]
    v_pk_mul_f32 v[176:177], v[176:177], v[178:179]
    v_exp_f32 v176, v176
    v_exp_f32 v177, v177
    s_nop 0
    v_pk_add_f32 v[176:177], v[176:177], 1.0 op_sel_hi:[1,0]
    v_rcp_f32 v176, v176
    v_rcp_f32 v177, v177
    s_nop 0
    v_pk_mul_f32 v[90:91], v[90:91], v[176:177]
    v_pk_fma_f32 v[92:93], v[156:157], v[172:173], v[92:93] op_sel_hi:[1,0,1] neg_lo:[0,1,0] neg_hi:[0,1,0]
    v_pk_mul_f32 v[92:93], v[92:93], v[172:173] op_sel:[0,1] op_sel_hi:[1,1]
    v_pk_mul_f32 v[176:177], v[92:93], v[92:93]
    v_pk_mul_f32 v[178:179], v[92:93], s[54:55] op_sel:[0,1] op_sel_hi:[1,1]
    v_pk_fma_f32 v[176:177], v[176:177], s[54:55], 1.0 op_sel_hi:[1,0,0]
    v_pk_mul_f32 v[176:177], v[176:177], v[178:179]
    v_exp_f32 v176, v176
    v_exp_f32 v177, v177
    s_nop 0
    v_pk_add_f32 v[176:177], v[176:177], 1.0 op_sel_hi:[1,0]
    v_rcp_f32 v176, v176
    v_rcp_f32 v177, v177
    s_nop 0
    v_pk_mul_f32 v[92:93], v[92:93], v[176:177]
    v_pk_fma_f32 v[94:95], v[158:159], v[172:173], v[94:95] op_sel_hi:[1,0,1] neg_lo:[0,1,0] neg_hi:[0,1,0]
    v_pk_mul_f32 v[94:95], v[94:95], v[172:173] op_sel:[0,1] op_sel_hi:[1,1]
    v_pk_mul_f32 v[176:177], v[94:95], v[94:95]
    v_pk_mul_f32 v[178:179], v[94:95], s[54:55] op_sel:[0,1] op_sel_hi:[1,1]
    v_pk_fma_f32 v[176:177], v[176:177], s[54:55], 1.0 op_sel_hi:[1,0,0]
    v_pk_mul_f32 v[176:177], v[176:177], v[178:179]
    v_exp_f32 v176, v176
    v_exp_f32 v177, v177
    s_nop 0
    v_pk_add_f32 v[176:177], v[176:177], 1.0 op_sel_hi:[1,0]
    v_rcp_f32 v176, v176
    v_rcp_f32 v177, v177
    s_nop 0
    v_pk_mul_f32 v[94:95], v[94:95], v[176:177]
    v_pk_fma_f32 v[96:97], v[160:161], v[172:173], v[96:97] op_sel_hi:[1,0,1] neg_lo:[0,1,0] neg_hi:[0,1,0]
    v_pk_mul_f32 v[96:97], v[96:97], v[172:173] op_sel:[0,1] op_sel_hi:[1,1]
    v_pk_mul_f32 v[176:177], v[96:97], v[96:97]
    v_pk_mul_f32 v[178:179], v[96:97], s[54:55] op_sel:[0,1] op_sel_hi:[1,1]
    v_pk_fma_f32 v[176:177], v[176:177], s[54:55], 1.0 op_sel_hi:[1,0,0]
    v_pk_mul_f32 v[176:177], v[176:177], v[178:179]
    v_exp_f32 v176, v176
    v_exp_f32 v177, v177
    s_nop 0
    v_pk_add_f32 v[176:177], v[176:177], 1.0 op_sel_hi:[1,0]
    v_rcp_f32 v176, v176
    v_rcp_f32 v177, v177
    s_nop 0
    v_pk_mul_f32 v[96:97], v[96:97], v[176:177]
    v_pk_fma_f32 v[98:99], v[162:163], v[172:173], v[98:99] op_sel_hi:[1,0,1] neg_lo:[0,1,0] neg_hi:[0,1,0]
    v_pk_mul_f32 v[98:99], v[98:99], v[172:173] op_sel:[0,1] op_sel_hi:[1,1]
    v_pk_mul_f32 v[176:177], v[98:99], v[98:99]
    v_pk_mul_f32 v[178:179], v[98:99], s[54:55] op_sel:[0,1] op_sel_hi:[1,1]
    v_pk_fma_f32 v[176:177], v[176:177], s[54:55], 1.0 op_sel_hi:[1,0,0]
    v_pk_mul_f32 v[176:177], v[176:177], v[178:179]
    v_exp_f32 v176, v176
    v_exp_f32 v177, v177
    s_nop 0
    v_pk_add_f32 v[176:177], v[176:177], 1.0 op_sel_hi:[1,0]
    v_rcp_f32 v176, v176
    v_rcp_f32 v177, v177
    s_nop 0
    v_pk_mul_f32 v[98:99], v[98:99], v[176:177]
    v_cvt_pk_bf16_f32 v184, v68, v69
    v_cvt_pk_bf16_f32 v185, v70, v71
    v_cvt_pk_bf16_f32 v186, v72, v73
    v_cvt_pk_bf16_f32 v187, v74, v75
    s_nop 1
    v_permlane16_swap_b32 v184, v186
    v_permlane16_swap_b32 v185, v187
    s_and_b32 s37, s86, 1
    s_mul_i32 s37, s37, 224
    s_mul_i32 s38, s88, 448
    s_add_u32 s37, s37, s38
    s_add_u32 s37, s37, 0
    s_cmp_eq_u32 s91, 1
    s_cbranch_scc1 Ls59_p
    buffer_store_dwordx4 v[184:187], v180, s[16:19], s37 offen sc1
    s_branch Ls59_d
Ls59_p:
    buffer_store_dwordx4 v[184:187], v180, s[16:19], s37 offen
Ls59_d:
    s_nop 1
    v_cvt_pk_bf16_f32 v184, v76, v77
    v_cvt_pk_bf16_f32 v185, v78, v79
    v_cvt_pk_bf16_f32 v186, v80, v81
    v_cvt_pk_bf16_f32 v187, v82, v83
    s_nop 1
    v_permlane16_swap_b32 v184, v186
    v_permlane16_swap_b32 v185, v187
    s_and_b32 s37, s86, 1
    s_mul_i32 s37, s37, 224
    s_mul_i32 s38, s88, 448
    s_add_u32 s37, s37, s38
    s_add_u32 s37, s37, 64
    s_mov_b32 exec_hi, 0xffff
    s_cmp_eq_u32 s91, 1
    s_cbranch_scc1 Ls60_p
    buffer_store_dwordx4 v[184:187], v180, s[16:19], s37 offen sc1
    s_branch Ls60_d
Ls60_p:
    buffer_store_dwordx4 v[184:187], v180, s[16:19], s37 offen
Ls60_d:
    s_mov_b64 exec, -1
    s_nop 1
    v_cvt_pk_bf16_f32 v184, v84, v85
    v_cvt_pk_bf16_f32 v185, v86, v87
    v_cvt_pk_bf16_f32 v186, v88, v89
    v_cvt_pk_bf16_f32 v187, v90, v91
    s_nop 1
    v_permlane16_swap_b32 v184, v186
    v_permlane16_swap_b32 v185, v187
    s_and_b32 s37, s86, 1
    s_mul_i32 s37, s37, 224
    s_mul_i32 s38, s88, 448
    s_add_u32 s37, s37, s38
    s_add_u32 s37, s37, 112
    s_cmp_eq_u32 s91, 1
    s_cbranch_scc1 Ls61_p
    buffer_store_dwordx4 v[184:187], v180, s[16:19], s37 offen sc1
    s_branch Ls61_d
Ls61_p:
    buffer_store_dwordx4 v[184:187], v180, s[16:19], s37 offen
Ls61_d:
    s_nop 1
    v_cvt_pk_bf16_f32 v184, v92, v93
    v_cvt_pk_bf16_f32 v185, v94, v95
    v_cvt_pk_bf16_f32 v186, v96, v97
    v_cvt_pk_bf16_f32 v187, v98, v99
    s_nop 1
    v_permlane16_swap_b32 v184, v186
    v_permlane16_swap_b32 v185, v187
    s_and_b32 s37, s86, 1
    s_mul_i32 s37, s37, 224
    s_mul_i32 s38, s88, 448
    s_add_u32 s37, s37, s38
    s_add_u32 s37, s37, 176
    s_mov_b32 exec_hi, 0xffff
    s_cmp_eq_u32 s91, 1
    s_cbranch_scc1 Ls62_p
    buffer_store_dwordx4 v[184:187], v180, s[16:19], s37 offen sc1
    s_branch Ls62_d
Ls62_p:
    buffer_store_dwordx4 v[184:187], v180, s[16:19], s37 offen
Ls62_d:
    s_mov_b64 exec, -1
    s_nop 1
    v_pk_fma_f32 v[100:101], v[132:133], v[174:175], v[100:101] op_sel_hi:[1,0,1] neg_lo:[0,1,0] neg_hi:[0,1,0]
    v_pk_mul_f32 v[100:101], v[100:101], v[174:175] op_sel:[0,1] op_sel_hi:[1,1]
    v_pk_mul_f32 v[176:177], v[100:101], v[100:101]
    v_pk_mul_f32 v[178:179], v[100:101], s[54:55] op_sel:[0,1] op_sel_hi:[1,1]
    v_pk_fma_f32 v[176:177], v[176:177], s[54:55], 1.0 op_sel_hi:[1,0,0]
    v_pk_mul_f32 v[176:177], v[176:177], v[178:179]
    v_exp_f32 v176, v176
    v_exp_f32 v177, v177
    s_nop 0
    v_pk_add_f32 v[176:177], v[176:177], 1.0 op_sel_hi:[1,0]
    v_rcp_f32 v176, v176
    v_rcp_f32 v177, v177
    s_nop 0
    v_pk_mul_f32 v[100:101], v[100:101], v[176:177]
    v_pk_fma_f32 v[102:103], v[134:135], v[174:175], v[102:103] op_sel_hi:[1,0,1] neg_lo:[0,1,0] neg_hi:[0,1,0]
    v_pk_mul_f32 v[102:103], v[102:103], v[174:175] op_sel:[0,1] op_sel_hi:[1,1]
    v_pk_mul_f32 v[176:177], v[102:103], v[102:103]
    v_pk_mul_f32 v[178:179], v[102:103], s[54:55] op_sel:[0,1] op_sel_hi:[1,1]
    v_pk_fma_f32 v[176:177], v[176:177], s[54:55], 1.0 op_sel_hi:[1,0,0]
    v_pk_mul_f32 v[176:177], v[176:177], v[178:179]
    v_exp_f32 v176, v176
    v_exp_f32 v177, v177
    s_nop 0
    v_pk_add_f32 v[176:177], v[176:177], 1.0 op_sel_hi:[1,0]
    v_rcp_f32 v176, v176
    v_rcp_f32 v177, v177
    s_nop 0
    v_pk_mul_f32 v[102:103], v[102:103], v[176:177]
    v_pk_fma_f32 v[104:105], v[136:137], v[174:175], v[104:105] op_sel_hi:[1,0,1] neg_lo:[0,1,0] neg_hi:[0,1,0]
    v_pk_mul_f32 v[104:105], v[104:105], v[174:175] op_sel:[0,1] op_sel_hi:[1,1]
    v_pk_mul_f32 v[176:177], v[104:105], v[104:105]
    v_pk_mul_f32 v[178:179], v[104:105], s[54:55] op_sel:[0,1] op_sel_hi:[1,1]
    v_pk_fma_f32 v[176:177], v[176:177], s[54:55], 1.0 op_sel_hi:[1,0,0]
    v_pk_mul_f32 v[176:177], v[176:177], v[178:179]
    v_exp_f32 v176, v176
    v_exp_f32 v177, v177
    s_nop 0
    v_pk_add_f32 v[176:177], v[176:177], 1.0 op_sel_hi:[1,0]
    v_rcp_f32 v176, v176
    v_rcp_f32 v177, v177
    s_nop 0
    v_pk_mul_f32 v[104:105], v[104:105], v[176:177]
    v_pk_fma_f32 v[106:107], v[138:139], v[174:175], v[106:107] op_sel_hi:[1,0,1] neg_lo:[0,1,0] neg_hi:[0,1,0]
    v_pk_mul_f32 v[106:107], v[106:107], v[174:175] op_sel:[0,1] op_sel_hi:[1,1]
    v_pk_mul_f32 v[176:177], v[106:107], v[106:107]
    v_pk_mul_f32 v[178:179], v[106:107], s[54:55] op_sel:[0,1] op_sel_hi:[1,1]
    v_pk_fma_f32 v[176:177], v[176:177], s[54:55], 1.0 op_sel_hi:[1,0,0]
    v_pk_mul_f32 v[176:177], v[176:177], v[178:179]
    v_exp_f32 v176, v176
    v_exp_f32 v177, v177
    s_nop 0
    v_pk_add_f32 v[176:177], v[176:177], 1.0 op_sel_hi:[1,0]
    v_rcp_f32 v176, v176
    v_rcp_f32 v177, v177
    s_nop 0
    v_pk_mul_f32 v[106:107], v[106:107], v[176:177]
    v_pk_fma_f32 v[108:109], v[140:141], v[174:175], v[108:109] op_sel_hi:[1,0,1] neg_lo:[0,1,0] neg_hi:[0,1,0]
    v_pk_mul_f32 v[108:109], v[108:109], v[174:175] op_sel:[0,1] op_sel_hi:[1,1]
    v_pk_mul_f32 v[176:177], v[108:109], v[108:109]
    v_pk_mul_f32 v[178:179], v[108:109], s[54:55] op_sel:[0,1] op_sel_hi:[1,1]
    v_pk_fma_f32 v[176:177], v[176:177], s[54:55], 1.0 op_sel_hi:[1,0,0]
    v_pk_mul_f32 v[176:177], v[176:177], v[178:179]
    v_exp_f32 v176, v176
    v_exp_f32 v177, v177
    s_nop 0
    v_pk_add_f32 v[176:177], v[176:177], 1.0 op_sel_hi:[1,0]
    v_rcp_f32 v176, v176
    v_rcp_f32 v177, v177
    s_nop 0
    v_pk_mul_f32 v[108:109], v[108:109], v[176:177]
    v_pk_fma_f32 v[110:111], v[142:143], v[174:175], v[110:111] op_sel_hi:[1,0,1] neg_lo:[0,1,0] neg_hi:[0,1,0]
    v_pk_mul_f32 v[110:111], v[110:111], v[174:175] op_sel:[0,1] op_sel_hi:[1,1]
    v_pk_mul_f32 v[176:177], v[110:111], v[110:111]
    v_pk_mul_f32 v[178:179], v[110:111], s[54:55] op_sel:[0,1] op_sel_hi:[1,1]
    v_pk_fma_f32 v[176:177], v[176:177], s[54:55], 1.0 op_sel_hi:[1,0,0]
    v_pk_mul_f32 v[176:177], v[176:177], v[178:179]
    v_exp_f32 v176, v176
    v_exp_f32 v177, v177
    s_nop 0
    v_pk_add_f32 v[176:177], v[176:177], 1.0 op_sel_hi:[1,0]
    v_rcp_f32 v176, v176
    v_rcp_f32 v177, v177
    s_nop 0
    v_pk_mul_f32 v[110:111], v[110:111], v[176:177]
    v_pk_fma_f32 v[112:113], v[144:145], v[174:175], v[112:113] op_sel_hi:[1,0,1] neg_lo:[0,1,0] neg_hi:[0,1,0]
    v_pk_mul_f32 v[112:113], v[112:113], v[174:175] op_sel:[0,1] op_sel_hi:[1,1]
    v_pk_mul_f32 v[176:177], v[112:113], v[112:113]
    v_pk_mul_f32 v[178:179], v[112:113], s[54:55] op_sel:[0,1] op_sel_hi:[1,1]
    v_pk_fma_f32 v[176:177], v[176:177], s[54:55], 1.0 op_sel_hi:[1,0,0]
    v_pk_mul_f32 v[176:177], v[176:177], v[178:179]
    v_exp_f32 v176, v176
    v_exp_f32 v177, v177
    s_nop 0
    v_pk_add_f32 v[176:177], v[176:177], 1.0 op_sel_hi:[1,0]
    v_rcp_f32 v176, v176
    v_rcp_f32 v177, v177
    s_nop 0
    v_pk_mul_f32 v[112:113], v[112:113], v[176:177]
    v_pk_fma_f32 v[114:115], v[146:147], v[174:175], v[114:115] op_sel_hi:[1,0,1] neg_lo:[0,1,0] neg_hi:[0,1,0]
    v_pk_mul_f32 v[114:115], v[114:115], v[174:175] op_sel:[0,1] op_sel_hi:[1,1]
    v_pk_mul_f32 v[176:177], v[114:115], v[114:115]
    v_pk_mul_f32 v[178:179], v[114:115], s[54:55] op_sel:[0,1] op_sel_hi:[1,1]
    v_pk_fma_f32 v[176:177], v[176:177], s[54:55], 1.0 op_sel_hi:[1,0,0]
    v_pk_mul_f32 v[176:177], v[176:177], v[178:179]
    v_exp_f32 v176, v176
    v_exp_f32 v177, v177
    s_nop 0
    v_pk_add_f32 v[176:177], v[176:177], 1.0 op_sel_hi:[1,0]
    v_rcp_f32 v176, v176
    v_rcp_f32 v177, v177
    s_nop 0
    v_pk_mul_f32 v[114:115], v[114:115], v[176:177]
    v_pk_fma_f32 v[116:117], v[148:149], v[174:175], v[116:117] op_sel_hi:[1,0,1] neg_lo:[0,1,0] neg_hi:[0,1,0]
    v_pk_mul_f32 v[116:117], v[116:117], v[174:175] op_sel:[0,1] op_sel_hi:[1,1]
    v_pk_mul_f32 v[176:177], v[116:117], v[116:117]
    v_pk_mul_f32 v[178:179], v[116:117], s[54:55] op_sel:[0,1] op_sel_hi:[1,1]
    v_pk_fma_f32 v[176:177], v[176:177], s[54:55], 1.0 op_sel_hi:[1,0,0]
    v_pk_mul_f32 v[176:177], v[176:177], v[178:179]
    v_exp_f32 v176, v176
    v_exp_f32 v177, v177
    s_nop 0
    v_pk_add_f32 v[176:177], v[176:177], 1.0 op_sel_hi:[1,0]
    v_rcp_f32 v176, v176
    v_rcp_f32 v177, v177
    s_nop 0
    v_pk_mul_f32 v[116:117], v[116:117], v[176:177]
    v_pk_fma_f32 v[118:119], v[150:151], v[174:175], v[118:119] op_sel_hi:[1,0,1] neg_lo:[0,1,0] neg_hi:[0,1,0]
    v_pk_mul_f32 v[118:119], v[118:119], v[174:175] op_sel:[0,1] op_sel_hi:[1,1]
    v_pk_mul_f32 v[176:177], v[118:119], v[118:119]
    v_pk_mul_f32 v[178:179], v[118:119], s[54:55] op_sel:[0,1] op_sel_hi:[1,1]
    v_pk_fma_f32 v[176:177], v[176:177], s[54:55], 1.0 op_sel_hi:[1,0,0]
    v_pk_mul_f32 v[176:177], v[176:177], v[178:179]
    v_exp_f32 v176, v176
    v_exp_f32 v177, v177
    s_nop 0
    v_pk_add_f32 v[176:177], v[176:177], 1.0 op_sel_hi:[1,0]
    v_rcp_f32 v176, v176
    v_rcp_f32 v177, v177
    s_nop 0
    v_pk_mul_f32 v[118:119], v[118:119], v[176:177]
    v_pk_fma_f32 v[120:121], v[152:153], v[174:175], v[120:121] op_sel_hi:[1,0,1] neg_lo:[0,1,0] neg_hi:[0,1,0]
    v_pk_mul_f32 v[120:121], v[120:121], v[174:175] op_sel:[0,1] op_sel_hi:[1,1]
    v_pk_mul_f32 v[176:177], v[120:121], v[120:121]
    v_pk_mul_f32 v[178:179], v[120:121], s[54:55] op_sel:[0,1] op_sel_hi:[1,1]
    v_pk_fma_f32 v[176:177], v[176:177], s[54:55], 1.0 op_sel_hi:[1,0,0]
    v_pk_mul_f32 v[176:177], v[176:177], v[178:179]
    v_exp_f32 v176, v176
    v_exp_f32 v177, v177
    s_nop 0
    v_pk_add_f32 v[176:177], v[176:177], 1.0 op_sel_hi:[1,0]
    v_rcp_f32 v176, v176
    v_rcp_f32 v177, v177
    s_nop 0
    v_pk_mul_f32 v[120:121], v[120:121], v[176:177]
    v_pk_fma_f32 v[122:123], v[154:155], v[174:175], v[122:123] op_sel_hi:[1,0,1] neg_lo:[0,1,0] neg_hi:[0,1,0]
    v_pk_mul_f32 v[122:123], v[122:123], v[174:175] op_sel:[0,1] op_sel_hi:[1,1]
    v_pk_mul_f32 v[176:177], v[122:123], v[122:123]
    v_pk_mul_f32 v[178:179], v[122:123], s[54:55] op_sel:[0,1] op_sel_hi:[1,1]
    v_pk_fma_f32 v[176:177], v[176:177], s[54:55], 1.0 op_sel_hi:[1,0,0]
    v_pk_mul_f32 v[176:177], v[176:177], v[178:179]
    v_exp_f32 v176, v176
    v_exp_f32 v177, v177
    s_nop 0
    v_pk_add_f32 v[176:177], v[176:177], 1.0 op_sel_hi:[1,0]
    v_rcp_f32 v176, v176
    v_rcp_f32 v177, v177
    s_nop 0
    v_pk_mul_f32 v[122:123], v[122:123], v[176:177]
    v_pk_fma_f32 v[124:125], v[156:157], v[174:175], v[124:125] op_sel_hi:[1,0,1] neg_lo:[0,1,0] neg_hi:[0,1,0]
    v_pk_mul_f32 v[124:125], v[124:125], v[174:175] op_sel:[0,1] op_sel_hi:[1,1]
    v_pk_mul_f32 v[176:177], v[124:125], v[124:125]
    v_pk_mul_f32 v[178:179], v[124:125], s[54:55] op_sel:[0,1] op_sel_hi:[1,1]
    v_pk_fma_f32 v[176:177], v[176:177], s[54:55], 1.0 op_sel_hi:[1,0,0]
    v_pk_mul_f32 v[176:177], v[176:177], v[178:179]
    v_exp_f32 v176, v176
    v_exp_f32 v177, v177
    s_nop 0
    v_pk_add_f32 v[176:177], v[176:177], 1.0 op_sel_hi:[1,0]
    v_rcp_f32 v176, v176
    v_rcp_f32 v177, v177
    s_nop 0
    v_pk_mul_f32 v[124:125], v[124:125], v[176:177]
    v_pk_fma_f32 v[126:127], v[158:159], v[174:175], v[126:127] op_sel_hi:[1,0,1] neg_lo:[0,1,0] neg_hi:[0,1,0]
    v_pk_mul_f32 v[126:127], v[126:127], v[174:175] op_sel:[0,1] op_sel_hi:[1,1]
    v_pk_mul_f32 v[176:177], v[126:127], v[126:127]
    v_pk_mul_f32 v[178:179], v[126:127], s[54:55] op_sel:[0,1] op_sel_hi:[1,1]
    v_pk_fma_f32 v[176:177], v[176:177], s[54:55], 1.0 op_sel_hi:[1,0,0]
    v_pk_mul_f32 v[176:177], v[176:177], v[178:179]
    v_exp_f32 v176, v176
    v_exp_f32 v177, v177
    s_nop 0
    v_pk_add_f32 v[176:177], v[176:177], 1.0 op_sel_hi:[1,0]
    v_rcp_f32 v176, v176
    v_rcp_f32 v177, v177
    s_nop 0
    v_pk_mul_f32 v[126:127], v[126:127], v[176:177]
    v_pk_fma_f32 v[128:129], v[160:161], v[174:175], v[128:129] op_sel_hi:[1,0,1] neg_lo:[0,1,0] neg_hi:[0,1,0]
    v_pk_mul_f32 v[128:129], v[128:129], v[174:175] op_sel:[0,1] op_sel_hi:[1,1]
    v_pk_mul_f32 v[176:177], v[128:129], v[128:129]
    v_pk_mul_f32 v[178:179], v[128:129], s[54:55] op_sel:[0,1] op_sel_hi:[1,1]
    v_pk_fma_f32 v[176:177], v[176:177], s[54:55], 1.0 op_sel_hi:[1,0,0]
    v_pk_mul_f32 v[176:177], v[176:177], v[178:179]
    v_exp_f32 v176, v176
    v_exp_f32 v177, v177
    s_nop 0
    v_pk_add_f32 v[176:177], v[176:177], 1.0 op_sel_hi:[1,0]
    v_rcp_f32 v176, v176
    v_rcp_f32 v177, v177
    s_nop 0
    v_pk_mul_f32 v[128:129], v[128:129], v[176:177]
    v_pk_fma_f32 v[130:131], v[162:163], v[174:175], v[130:131] op_sel_hi:[1,0,1] neg_lo:[0,1,0] neg_hi:[0,1,0]
    v_pk_mul_f32 v[130:131], v[130:131], v[174:175] op_sel:[0,1] op_sel_hi:[1,1]
    v_pk_mul_f32 v[176:177], v[130:131], v[130:131]
    v_pk_mul_f32 v[178:179], v[130:131], s[54:55] op_sel:[0,1] op_sel_hi:[1,1]
    v_pk_fma_f32 v[176:177], v[176:177], s[54:55], 1.0 op_sel_hi:[1,0,0]
    v_pk_mul_f32 v[176:177], v[176:177], v[178:179]
    v_exp_f32 v176, v176
    v_exp_f32 v177, v177
    s_nop 0
    v_pk_add_f32 v[176:177], v[176:177], 1.0 op_sel_hi:[1,0]
    v_rcp_f32 v176, v176
    v_rcp_f32 v177, v177
    s_nop 0
    v_pk_mul_f32 v[130:131], v[130:131], v[176:177]
    v_cvt_pk_bf16_f32 v184, v100, v101
    v_cvt_pk_bf16_f32 v185, v102, v103
    v_cvt_pk_bf16_f32 v186, v104, v105
    v_cvt_pk_bf16_f32 v187, v106, v107
    s_nop 1
    v_permlane16_swap_b32 v184, v186
    v_permlane16_swap_b32 v185, v187
    s_and_b32 s37, s86, 1
    s_mul_i32 s37, s37, 224
    s_mul_i32 s38, s88, 448
    s_add_u32 s37, s37, s38
    s_add_u32 s37, s37, 57344
    s_cmp_eq_u32 s91, 1
    s_cbranch_scc1 Ls63_p
    buffer_store_dwordx4 v[184:187], v180, s[16:19], s37 offen sc1
    s_branch Ls63_d
Ls63_p:
    buffer_store_dwordx4 v[184:187], v180, s[16:19], s37 offen
Ls63_d:
    s_nop 1
    v_cvt_pk_bf16_f32 v184, v108, v109
    v_cvt_pk_bf16_f32 v185, v110, v111
    v_cvt_pk_bf16_f32 v186, v112, v113
    v_cvt_pk_bf16_f32 v187, v114, v115
    s_nop 1
    v_permlane16_swap_b32 v184, v186
    v_permlane16_swap_b32 v185, v187
    s_and_b32 s37, s86, 1
    s_mul_i32 s37, s37, 224
    s_mul_i32 s38, s88, 448
    s_add_u32 s37, s37, s38
    s_add_u32 s37, s37, 57408
    s_mov_b32 exec_hi, 0xffff
    s_cmp_eq_u32 s91, 1
    s_cbranch_scc1 Ls64_p
    buffer_store_dwordx4 v[184:187], v180, s[16:19], s37 offen sc1
    s_branch Ls64_d
Ls64_p:
    buffer_store_dwordx4 v[184:187], v180, s[16:19], s37 offen
Ls64_d:
    s_mov_b64 exec, -1
    s_nop 1
    v_cvt_pk_bf16_f32 v184, v116, v117
    v_cvt_pk_bf16_f32 v185, v118, v119
    v_cvt_pk_bf16_f32 v186, v120, v121
    v_cvt_pk_bf16_f32 v187, v122, v123
    s_nop 1
    v_permlane16_swap_b32 v184, v186
    v_permlane16_swap_b32 v185, v187
    s_and_b32 s37, s86, 1
    s_mul_i32 s37, s37, 224
    s_mul_i32 s38, s88, 448
    s_add_u32 s37, s37, s38
    s_add_u32 s37, s37, 57456
    s_cmp_eq_u32 s91, 1
    s_cbranch_scc1 Ls65_p
    buffer_store_dwordx4 v[184:187], v180, s[16:19], s37 offen sc1
    s_branch Ls65_d
Ls65_p:
    buffer_store_dwordx4 v[184:187], v180, s[16:19], s37 offen
Ls65_d:
    s_nop 1
    v_cvt_pk_bf16_f32 v184, v124, v125
    v_cvt_pk_bf16_f32 v185, v126, v127
    v_cvt_pk_bf16_f32 v186, v128, v129
    v_cvt_pk_bf16_f32 v187, v130, v131
    s_nop 1
    v_permlane16_swap_b32 v184, v186
    v_permlane16_swap_b32 v185, v187
    s_and_b32 s37, s86, 1
    s_mul_i32 s37, s37, 224
    s_mul_i32 s38, s88, 448
    s_add_u32 s37, s37, s38
    s_add_u32 s37, s37, 57520
    s_mov_b32 exec_hi, 0xffff
    s_cmp_eq_u32 s91, 1
    s_cbranch_scc1 Ls66_p
    buffer_store_dwordx4 v[184:187], v180, s[16:19], s37 offen sc1
    s_branch Ls66_d
Ls66_p:
    buffer_store_dwordx4 v[184:187], v180, s[16:19], s37 offen
Ls66_d:
    s_mov_b64 exec, -1
    s_nop 1
    s_waitcnt vmcnt(0)
    s_lshl_b32 s32, s89, 7
    s_lshl_b32 s33, s86, 2
    s_add_u32 s32, s32, s33
    v_mov_b32 v181, s32
    v_mov_b32 v182, 12
    s_mov_b64 exec, 1
    s_mov_b32 s57, s91
    s_cmp_eq_u32 s57, 1
    s_cbranch_scc1 Ls67_p
    buffer_store_dword v182, v181, s[24:27], 0 offen sc1
    s_branch Ls67_d
Ls67_p:
    buffer_store_dword v182, v181, s[24:27], 0 offen
Ls67_d:
    s_mov_b64 exec, -1
    s_barrier
    s_add_u32 s8, s84, 34603008
    s_addc_u32 s9, s85, 0
    s_mov_b32 s10, 7340032
    s_mov_b32 s11, 0x00020000
    s_mov_b32 s12, s78
    s_mov_b32 s13, s79
    s_mov_b32 s14, 1605632
    s_mov_b32 s15, 0x00020000
    s_lshl_b32 s32, s86, 10
    s_and_b32 s40, s86, 1
    s_add_u32 s33, s40, 8
    s_mul_i32 s34, s86, 28672
    s_mul_i32 s35, s86, 7168
    s_mul_i32 s36, s88, 112
    v_lshrrev_b32 v5, 3, v1
    v_lshrrev_b32 v7, 4, v1
    s_lshl_b32 s37, s40, 2
    v_add_u32 v7, s37, v7
    v_and_b32 v6, 7, v1
    v_xor_b32 v6, v6, v7
    s_lshl_b32 s37, s87, 6
    s_lshl_b32 s38, s86, 3
    s_add_u32 s38, s38, 0
    s_add_u32 s38, s38, s37
    v_add_u32 v7, s38, v5
    s_mov_b32 s39, 3584
    v_mul_lo_u32 v7, v7, s39
    v_lshl_add_u32 v9, v6, 4, v7
    s_lshl_b32 s38, s86, 3
    s_add_u32 s38, s38, 32
    s_add_u32 s38, s38, s37
    v_add_u32 v7, s38, v5
    s_mov_b32 s39, 3584
    v_mul_lo_u32 v7, v7, s39
    v_lshl_add_u32 v10, v6, 4, v7
    v_bfe_u32 v7, v1, 4, 1
    v_lshlrev_b32 v7, 1, v7
    s_lshl_b32 s37, s40, 2
    v_add_u32 v7, s37, v7
    v_and_b32 v8, 7, v1
    v_xor_b32 v8, v8, v7
    s_mov_b32 s39, 896
    v_mul_lo_u32 v7, v5, s39
    v_lshl_add_u32 v11, v8, 4, v7
    s_add_u32 s42, s36, 0
    s_cmp_lg_u32 s86, 0
    s_cbranch_scc1 Lp68_skip
    v_lshrrev_b32 v13, 3, v1
    v_add_u32 v13, s87, v13
    v_add_u32 v13, 0, v13
    v_mov_b32 v14, s87
    v_cmp_gt_u32 vcc, 32, v13
    s_nop 1
    v_cndmask_b32 v13, v14, v13, vcc
    v_and_b32 v12, 7, v1
    v_lshlrev_b32 v12, 5, v12
    v_and_b32 v14, 3, v13
    v_lshl_add_u32 v12, v14, 3, v12
    v_lshrrev_b32 v14, 2, v13
    v_add_u32 v12, v12, v14
    v_lshlrev_b32 v12, 7, v12
    v_add_u32 v12, 0, v12
    v_mov_b32 v20, 0
    s_mov_b32 s52, 0
    s_mov_b32 s53, 12
    s_mov_b32 exec_lo, 255
    s_mov_b32 exec_hi, 0
Lp68_loop:
    buffer_load_dwordx4 v[16:19], v12, s[24:27], 0 offen sc1
    s_waitcnt vmcnt(0)
    v_min_u32 v16, v16, v17
    v_min_u32 v18, v18, v19
    v_min_u32 v16, v16, v18
    v_cmp_gt_u32 vcc, s53, v16
    s_cbranch_vccz Lp68_ok
Lp68_again:
    s_add_u32 s52, s52, 1
    s_cmp_lt_u32 s52, 20000
    s_cbranch_scc1 Lp68_loop
Lp68_ok:
    s_mov_b64 exec, -1
Lp68_skip:
    s_barrier
    s_add_u32 m0, s32, 0
    s_nop 0
    s_mov_b32 s37, 0
    buffer_load_dwordx4 v9, s[8:11], s37 offen lds
    s_add_u32 m0, s32, 4096
    s_nop 0
    s_mov_b32 s37, 0
    buffer_load_dwordx4 v10, s[8:11], s37 offen lds
    s_add_u32 m0, s32, 8192
    s_nop 0
    s_mov_b32 s37, 128
    buffer_load_dwordx4 v9, s[8:11], s37 offen lds
    s_add_u32 m0, s32, 12288
    s_nop 0
    s_mov_b32 s37, 128
    buffer_load_dwordx4 v10, s[8:11], s37 offen lds
    s_add_u32 m0, s32, 16384
    s_nop 0
    s_mov_b32 s37, 256
    buffer_load_dwordx4 v9, s[8:11], s37 offen lds
    s_add_u32 m0, s32, 20480
    s_nop 0
    s_mov_b32 s37, 256
    buffer_load_dwordx4 v10, s[8:11], s37 offen lds
    s_add_u32 m0, s32, 24576
    s_nop 0
    s_mov_b32 s37, 384
    buffer_load_dwordx4 v9, s[8:11], s37 offen lds
    s_add_u32 m0, s32, 28672
    s_nop 0
    s_mov_b32 s37, 384
    buffer_load_dwordx4 v10, s[8:11], s37 offen lds
    s_add_u32 m0, s32, 32768
    s_nop 0
    s_mov_b32 s37, 512
    buffer_load_dwordx4 v9, s[8:11], s37 offen lds
    s_add_u32 m0, s32, 36864
    s_nop 0
    s_mov_b32 s37, 512
    buffer_load_dwordx4 v10, s[8:11], s37 offen lds
    s_add_u32 m0, s32, 40960
    s_nop 0
    s_mov_b32 s37, 640
    buffer_load_dwordx4 v9, s[8:11], s37 offen lds
    s_add_u32 m0, s32, 45056
    s_nop 0
    s_mov_b32 s37, 640
    buffer_load_dwordx4 v10, s[8:11], s37 offen lds
    s_add_u32 m0, s32, 49152
    s_nop 0
    s_mov_b32 s37, 768
    buffer_load_dwordx4 v9, s[8:11], s37 offen lds
    s_add_u32 m0, s32, 53248
    s_nop 0
    s_mov_b32 s37, 768
    buffer_load_dwordx4 v10, s[8:11], s37 offen lds
    s_add_u32 m0, s32, 57344
    s_nop 0
    s_mov_b32 s37, 896
    buffer_load_dwordx4 v9, s[8:11], s37 offen lds
    s_add_u32 m0, s32, 61440
    s_nop 0
    s_mov_b32 s37, 896
    buffer_load_dwordx4 v10, s[8:11], s37 offen lds
    s_add_u32 m0, s32, 65536
    s_nop 0
    s_mov_b32 s37, 1024
    buffer_load_dwordx4 v9, s[8:11], s37 offen lds
    s_add_u32 m0, s32, 69632
    s_nop 0
    s_mov_b32 s37, 1024
    buffer_load_dwordx4 v10, s[8:11], s37 offen lds
    s_lshl_b32 s37, s87, 6
    s_lshr_b32 s38, s86, 1
    s_mul_i32 s38, s38, 32
    s_add_u32 s37, s37, s38
    v_add_u32 v13, s37, v2
    s_mov_b32 s38, 896
    v_mul_lo_u32 v13, v13, s38
    v_lshl_add_u32 v12, v3, 3, v13
    s_and_b32 s37, s86, 1
    s_lshl_b32 s37, s37, 6
    s_mul_i32 s38, s88, 112
    s_add_u32 s37, s37, s38
    v_add_u32 v12, s37, v12
    s_add_u32 s20, s84, 15728640
    s_addc_u32 s21, s85, 0
    s_mov_b32 s22, 1835008
    s_mov_b32 s23, 0x00020000
    s_mov_b32 s37, 0
    buffer_load_dwordx2 v[14:15], v12, s[20:23], s37 offen offset:0
    buffer_load_dwordx2 v[16:17], v12, s[20:23], s37 offen offset:32
    s_mov_b32 s37, 14336
    buffer_load_dwordx2 v[18:19], v12, s[20:23], s37 offen offset:0
    buffer_load_dwordx2 v[20:21], v12, s[20:23], s37 offen offset:32
    s_add_u32 s20, s84, 19922944
    s_addc_u32 s21, s85, 0
    s_mov_b32 s22, 1835008
    s_mov_b32 s23, 0x00020000
    s_mov_b32 s37, 0
    buffer_load_dwordx2 v[22:23], v12, s[20:23], s37 offen offset:0
    buffer_load_dwordx2 v[24:25], v12, s[20:23], s37 offen offset:32
    s_mov_b32 s37, 14336
    buffer_load_dwordx2 v[26:27], v12, s[20:23], s37 offen offset:0
    buffer_load_dwordx2 v[28:29], v12, s[20:23], s37 offen offset:32
    v_lshrrev_b32 v7, 1, v2
    v_and_b32 v7, 7, v7
    v_add_u32 v8, 0, v3
    v_xor_b32 v8, v8, v7
    v_lshlrev_b32 v8, 4, v8
    v_lshl_add_u32 v30, v2, 7, v8
    v_add_u32 v8, 4, v3
    v_xor_b32 v8, v8, v7
    v_lshlrev_b32 v8, 4, v8
    v_lshl_add_u32 v31, v2, 7, v8
    s_lshr_b32 s37, s86, 1
    s_mul_i32 s37, s37, 4096
    v_add_u32 v30, s37, v30
    v_add_u32 v31, s37, v31
    v_lshrrev_b32 v34, 2, v2
    v_lshl_add_u32 v34, v3, 3, v34
    v_lshlrev_b32 v34, 7, v34
    v_bfe_u32 v35, v2, 3, 1
    v_lshlrev_b32 v35, 2, v35
    v_and_b32 v7, 1, v3
    v_lshl_add_u32 v35, v7, 3, v35
    v_and_b32 v36, 3, v2
    s_and_b32 s37, s86, 1
    s_mul_i32 s37, s37, 2
    s_add_u32 s38, s37, 0
    s_and_b32 s39, s38, 3
    s_lshl_b32 s39, s39, 2
    v_add_u32 v7, s39, v36
    v_xor_b32 v7, v7, v35
    v_lshl_add_u32 v7, v7, 3, v34
    s_lshr_b32 s38, s38, 2
    s_lshl_b32 s38, s38, 13
    v_add_u32 v32, s38, v7
    s_add_u32 s38, s37, 1
    s_and_b32 s39, s38, 3
    s_lshl_b32 s39, s39, 2
    v_add_u32 v7, s39, v36
    v_xor_b32 v7, v7, v35
    v_lshl_add_u32 v7, v7, 3, v34
    s_lshr_b32 s38, s38, 2
    s_lshl_b32 s38, s38, 13
    v_add_u32 v33, s38, v7
    v_add_u32 v37, 65536, v30
    v_add_u32 v38, 65536, v31
    v_add_u32 v39, 65536, v32
    v_add_u32 v40, 131072, v32
    v_add_u32 v41, 65536, v33
    v_add_u32 v42, 131072, v33
    v_mov_b32 v44, 0
    v_mov_b32 v45, 0
    v_mov_b32 v46, 0
    v_mov_b32 v47, 0
    v_mov_b32 v48, 0
    v_mov_b32 v49, 0
    v_mov_b32 v50, 0
    v_mov_b32 v51, 0
    v_mov_b32 v52, 0
    v_mov_b32 v53, 0
    v_mov_b32 v54, 0
    v_mov_b32 v55, 0
    v_mov_b32 v56, 0
    v_mov_b32 v57, 0
    v_mov_b32 v58, 0
    v_mov_b32 v59, 0
    s_waitcnt vmcnt(24)
    s_barrier
    ds_read_b128 v[60:63], v30 offset:0
    ds_read_b128 v[64:67], v30 offset:2048
    ds_read_b64_tr_b16 v[76:77], v39 offset:8192
    ds_read_b64_tr_b16 v[78:79], v39 offset:8704
    ds_read_b64_tr_b16 v[80:81], v41 offset:8192
    ds_read_b64_tr_b16 v[82:83], v41 offset:8704
    s_waitcnt lgkmcnt(0)
    v_mfma_f32_16x16x32_bf16 v[44:47], v[76:79], v[60:63], v[44:47]
    ds_read_b128 v[68:71], v31 offset:0
    ds_read_b128 v[72:75], v31 offset:2048
    ds_read_b64_tr_b16 v[84:85], v39 offset:12288
    v_mfma_f32_16x16x32_bf16 v[52:55], v[76:79], v[64:67], v[52:55]
    ds_read_b64_tr_b16 v[86:87], v39 offset:12800
    ds_read_b64_tr_b16 v[88:89], v41 offset:12288
    ds_read_b64_tr_b16 v[90:91], v41 offset:12800
    v_mfma_f32_16x16x32_bf16 v[48:51], v[80:83], v[60:63], v[48:51]
    v_mfma_f32_16x16x32_bf16 v[56:59], v[80:83], v[64:67], v[56:59]
    s_waitcnt lgkmcnt(0)
    s_waitcnt vmcnt(22)
    s_barrier
    s_add_u32 m0, s32, 73728
    s_add_u32 s37, s35, 516096
    s_add_u32 s37, s37, s42
    buffer_load_dwordx4 v11, s[12:15], s37 offen lds
    s_add_u32 m0, s32, 77824
    s_add_u32 s37, s35, 544768
    s_add_u32 s37, s37, s42
    buffer_load_dwordx4 v11, s[12:15], s37 offen lds
    s_add_u32 m0, s32, 0
    s_nop 0
    s_mov_b32 s37, 1152
    buffer_load_dwordx4 v9, s[8:11], s37 offen lds
    s_add_u32 m0, s32, 4096
    s_nop 0
    s_mov_b32 s37, 1152
    buffer_load_dwordx4 v10, s[8:11], s37 offen lds
    v_mfma_f32_16x16x32_bf16 v[44:47], v[84:87], v[68:71], v[44:47]
    ds_read_b128 v[60:63], v30 offset:8192
    ds_read_b128 v[64:67], v30 offset:10240
    ds_read_b64_tr_b16 v[76:77], v39 offset:16384
    v_mfma_f32_16x16x32_bf16 v[52:55], v[84:87], v[72:75], v[52:55]
    ds_read_b64_tr_b16 v[78:79], v39 offset:16896
    ds_read_b64_tr_b16 v[80:81], v41 offset:16384
    ds_read_b64_tr_b16 v[82:83], v41 offset:16896
    v_mfma_f32_16x16x32_bf16 v[48:51], v[88:91], v[68:71], v[48:51]
    v_mfma_f32_16x16x32_bf16 v[56:59], v[88:91], v[72:75], v[56:59]
    s_waitcnt lgkmcnt(0)
    v_mfma_f32_16x16x32_bf16 v[44:47], v[76:79], v[60:63], v[44:47]
    ds_read_b128 v[68:71], v31 offset:8192
    ds_read_b128 v[72:75], v31 offset:10240
    ds_read_b64_tr_b16 v[84:85], v39 offset:20480
    v_mfma_f32_16x16x32_bf16 v[52:55], v[76:79], v[64:67], v[52:55]
    ds_read_b64_tr_b16 v[86:87], v39 offset:20992
    ds_read_b64_tr_b16 v[88:89], v41 offset:20480
    ds_read_b64_tr_b16 v[90:91], v41 offset:20992
    v_mfma_f32_16x16x32_bf16 v[48:51], v[80:83], v[60:63], v[48:51]
    v_mfma_f32_16x16x32_bf16 v[56:59], v[80:83], v[64:67], v[56:59]
    s_waitcnt lgkmcnt(0)
    s_waitcnt vmcnt(24)
    s_barrier
    s_add_u32 m0, s32, 81920
    s_add_u32 s37, s35, 573440
    s_add_u32 s37, s37, s42
    buffer_load_dwordx4 v11, s[12:15], s37 offen lds
    s_add_u32 m0, s32, 86016
    s_add_u32 s37, s35, 602112
    s_add_u32 s37, s37, s42
    buffer_load_dwordx4 v11, s[12:15], s37 offen lds
    s_add_u32 m0, s32, 8192
    s_nop 0
    s_mov_b32 s37, 1280
    buffer_load_dwordx4 v9, s[8:11], s37 offen lds
    s_add_u32 m0, s32, 12288
    s_nop 0
    s_mov_b32 s37, 1280
    buffer_load_dwordx4 v10, s[8:11], s37 offen lds
    v_mfma_f32_16x16x32_bf16 v[44:47], v[84:87], v[68:71], v[44:47]
    ds_read_b128 v[60:63], v30 offset:16384
    ds_read_b128 v[64:67], v30 offset:18432
    ds_read_b64_tr_b16 v[76:77], v39 offset:24576
    v_mfma_f32_16x16x32_bf16 v[52:55], v[84:87], v[72:75], v[52:55]
    ds_read_b64_tr_b16 v[78:79], v39 offset:25088
    ds_read_b64_tr_b16 v[80:81], v41 offset:24576
    ds_read_b64_tr_b16 v[82:83], v41 offset:25088
    v_mfma_f32_16x16x32_bf16 v[48:51], v[88:91], v[68:71], v[48:51]
    v_mfma_f32_16x16x32_bf16 v[56:59], v[88:91], v[72:75], v[56:59]
    s_waitcnt lgkmcnt(0)
    v_mfma_f32_16x16x32_bf16 v[44:47], v[76:79], v[60:63], v[44:47]
    ds_read_b128 v[68:71], v31 offset:16384
    ds_read_b128 v[72:75], v31 offset:18432
    ds_read_b64_tr_b16 v[84:85], v39 offset:28672
    v_mfma_f32_16x16x32_bf16 v[52:55], v[76:79], v[64:67], v[52:55]
    ds_read_b64_tr_b16 v[86:87], v39 offset:29184
    ds_read_b64_tr_b16 v[88:89], v41 offset:28672
    ds_read_b64_tr_b16 v[90:91], v41 offset:29184
    v_mfma_f32_16x16x32_bf16 v[48:51], v[80:83], v[60:63], v[48:51]
    v_mfma_f32_16x16x32_bf16 v[56:59], v[80:83], v[64:67], v[56:59]
    s_waitcnt lgkmcnt(0)
    s_waitcnt vmcnt(26)
    s_barrier
    s_add_u32 m0, s32, 90112
    s_add_u32 s37, s35, 630784
    s_add_u32 s37, s37, s42
    buffer_load_dwordx4 v11, s[12:15], s37 offen lds
    s_add_u32 m0, s32, 94208
    s_add_u32 s37, s35, 659456
    s_add_u32 s37, s37, s42
    buffer_load_dwordx4 v11, s[12:15], s37 offen lds
    s_add_u32 m0, s32, 16384
    s_nop 0
    s_mov_b32 s37, 1408
    buffer_load_dwordx4 v9, s[8:11], s37 offen lds
    s_add_u32 m0, s32, 20480
    s_nop 0
    s_mov_b32 s37, 1408
    buffer_load_dwordx4 v10, s[8:11], s37 offen lds
    v_mfma_f32_16x16x32_bf16 v[44:47], v[84:87], v[68:71], v[44:47]
    ds_read_b128 v[60:63], v30 offset:24576
    ds_read_b128 v[64:67], v30 offset:26624
    ds_read_b64_tr_b16 v[76:77], v39 offset:32768
    v_mfma_f32_16x16x32_bf16 v[52:55], v[84:87], v[72:75], v[52:55]
    ds_read_b64_tr_b16 v[78:79], v39 offset:33280
    ds_read_b64_tr_b16 v[80:81], v41 offset:32768
    ds_read_b64_tr_b16 v[82:83], v41 offset:33280
    v_mfma_f32_16x16x32_bf16 v[48:51], v[88:91], v[68:71], v[48:51]
    v_mfma_f32_16x16x32_bf16 v[56:59], v[88:91], v[72:75], v[56:59]
    s_waitcnt lgkmcnt(0)
    v_mfma_f32_16x16x32_bf16 v[44:47], v[76:79], v[60:63], v[44:47]
    ds_read_b128 v[68:71], v31 offset:24576
    ds_read_b128 v[72:75], v31 offset:26624
    ds_read_b64_tr_b16 v[84:85], v39 offset:36864
    v_mfma_f32_16x16x32_bf16 v[52:55], v[76:79], v[64:67], v[52:55]
    ds_read_b64_tr_b16 v[86:87], v39 offset:37376
    ds_read_b64_tr_b16 v[88:89], v41 offset:36864
    ds_read_b64_tr_b16 v[90:91], v41 offset:37376
    v_mfma_f32_16x16x32_bf16 v[48:51], v[80:83], v[60:63], v[48:51]
    v_mfma_f32_16x16x32_bf16 v[56:59], v[80:83], v[64:67], v[56:59]
    s_waitcnt lgkmcnt(0)
    s_waitcnt vmcnt(28)
    s_barrier
    s_add_u32 m0, s32, 98304
    s_add_u32 s37, s35, 688128
    s_add_u32 s37, s37, s42
    buffer_load_dwordx4 v11, s[12:15], s37 offen lds
    s_add_u32 m0, s32, 102400
    s_add_u32 s37, s35, 716800
    s_add_u32 s37, s37, s42
    buffer_load_dwordx4 v11, s[12:15], s37 offen lds
    s_add_u32 m0, s32, 24576
    s_nop 0
    s_mov_b32 s37, 1536
    buffer_load_dwordx4 v9, s[8:11], s37 offen lds
    s_add_u32 m0, s32, 28672
    s_nop 0
    s_mov_b32 s37, 1536
    buffer_load_dwordx4 v10, s[8:11], s37 offen lds
    v_mfma_f32_16x16x32_bf16 v[44:47], v[84:87], v[68:71], v[44:47]
    ds_read_b128 v[60:63], v30 offset:32768
    ds_read_b128 v[64:67], v30 offset:34816
    ds_read_b64_tr_b16 v[76:77], v39 offset:40960
    v_mfma_f32_16x16x32_bf16 v[52:55], v[84:87], v[72:75], v[52:55]
    ds_read_b64_tr_b16 v[78:79], v39 offset:41472
    ds_read_b64_tr_b16 v[80:81], v41 offset:40960
    ds_read_b64_tr_b16 v[82:83], v41 offset:41472
    v_mfma_f32_16x16x32_bf16 v[48:51], v[88:91], v[68:71], v[48:51]
    v_mfma_f32_16x16x32_bf16 v[56:59], v[88:91], v[72:75], v[56:59]
    s_waitcnt lgkmcnt(0)
    v_mfma_f32_16x16x32_bf16 v[44:47], v[76:79], v[60:63], v[44:47]
    ds_read_b128 v[68:71], v31 offset:32768
    ds_read_b128 v[72:75], v31 offset:34816
    ds_read_b64_tr_b16 v[84:85], v39 offset:45056
    v_mfma_f32_16x16x32_bf16 v[52:55], v[76:79], v[64:67], v[52:55]
    ds_read_b64_tr_b16 v[86:87], v39 offset:45568
    ds_read_b64_tr_b16 v[88:89], v41 offset:45056
    ds_read_b64_tr_b16 v[90:91], v41 offset:45568
    v_mfma_f32_16x16x32_bf16 v[48:51], v[80:83], v[60:63], v[48:51]
    v_mfma_f32_16x16x32_bf16 v[56:59], v[80:83], v[64:67], v[56:59]
    s_waitcnt lgkmcnt(0)
    s_waitcnt vmcnt(30)
    s_barrier
    s_add_u32 m0, s32, 106496
    s_add_u32 s37, s35, 745472
    s_add_u32 s37, s37, s42
    buffer_load_dwordx4 v11, s[12:15], s37 offen lds
    s_add_u32 m0, s32, 110592
    s_add_u32 s37, s35, 774144
    s_add_u32 s37, s37, s42
    buffer_load_dwordx4 v11, s[12:15], s37 offen lds
    s_add_u32 m0, s32, 32768
    s_nop 0
    s_mov_b32 s37, 1664
    buffer_load_dwordx4 v9, s[8:11], s37 offen lds
    s_add_u32 m0, s32, 36864
    s_nop 0
    s_mov_b32 s37, 1664
    buffer_load_dwordx4 v10, s[8:11], s37 offen lds
    v_mfma_f32_16x16x32_bf16 v[44:47], v[84:87], v[68:71], v[44:47]
    ds_read_b128 v[60:63], v30 offset:40960
    ds_read_b128 v[64:67], v30 offset:43008
    ds_read_b64_tr_b16 v[76:77], v39 offset:49152
    v_mfma_f32_16x16x32_bf16 v[52:55], v[84:87], v[72:75], v[52:55]
    ds_read_b64_tr_b16 v[78:79], v39 offset:49664
    ds_read_b64_tr_b16 v[80:81], v41 offset:49152
    ds_read_b64_tr_b16 v[82:83], v41 offset:49664
    v_mfma_f32_16x16x32_bf16 v[48:51], v[88:91], v[68:71], v[48:51]
    v_mfma_f32_16x16x32_bf16 v[56:59], v[88:91], v[72:75], v[56:59]
    s_waitcnt lgkmcnt(0)
    v_mfma_f32_16x16x32_bf16 v[44:47], v[76:79], v[60:63], v[44:47]
    ds_read_b128 v[68:71], v31 offset:40960
    ds_read_b128 v[72:75], v31 offset:43008
    ds_read_b64_tr_b16 v[84:85], v39 offset:53248
    v_mfma_f32_16x16x32_bf16 v[52:55], v[76:79], v[64:67], v[52:55]
    ds_read_b64_tr_b16 v[86:87], v39 offset:53760
    ds_read_b64_tr_b16 v[88:89], v41 offset:53248
    ds_read_b64_tr_b16 v[90:91], v41 offset:53760
    v_mfma_f32_16x16x32_bf16 v[48:51], v[80:83], v[60:63], v[48:51]
    v_mfma_f32_16x16x32_bf16 v[56:59], v[80:83], v[64:67], v[56:59]
    s_waitcnt lgkmcnt(0)
    s_waitcnt vmcnt(32)
    s_barrier
    s_add_u32 m0, s32, 114688
    s_add_u32 s37, s35, 802816
    s_add_u32 s37, s37, s42
    buffer_load_dwordx4 v11, s[12:15], s37 offen lds
    s_add_u32 m0, s32, 118784
    s_add_u32 s37, s35, 831488
    s_add_u32 s37, s37, s42
    buffer_load_dwordx4 v11, s[12:15], s37 offen lds
    s_add_u32 m0, s32, 40960
    s_nop 0
    s_mov_b32 s37, 1792
    buffer_load_dwordx4 v9, s[8:11], s37 offen lds
    s_add_u32 m0, s32, 45056
    s_nop 0
    s_mov_b32 s37, 1792
    buffer_load_dwordx4 v10, s[8:11], s37 offen lds
    v_mfma_f32_16x16x32_bf16 v[44:47], v[84:87], v[68:71], v[44:47]
    ds_read_b128 v[60:63], v30 offset:49152
    ds_read_b128 v[64:67], v30 offset:51200
    ds_read_b64_tr_b16 v[76:77], v39 offset:57344
    v_mfma_f32_16x16x32_bf16 v[52:55], v[84:87], v[72:75], v[52:55]
    ds_read_b64_tr_b16 v[78:79], v39 offset:57856
    ds_read_b64_tr_b16 v[80:81], v41 offset:57344
    ds_read_b64_tr_b16 v[82:83], v41 offset:57856
    v_mfma_f32_16x16x32_bf16 v[48:51], v[88:91], v[68:71], v[48:51]
    v_mfma_f32_16x16x32_bf16 v[56:59], v[88:91], v[72:75], v[56:59]
    s_waitcnt lgkmcnt(0)
    v_mfma_f32_16x16x32_bf16 v[44:47], v[76:79], v[60:63], v[44:47]
    ds_read_b128 v[68:71], v31 offset:49152
    ds_read_b128 v[72:75], v31 offset:51200
    ds_read_b64_tr_b16 v[84:85], v39 offset:61440
    v_mfma_f32_16x16x32_bf16 v[52:55], v[76:79], v[64:67], v[52:55]
    ds_read_b64_tr_b16 v[86:87], v39 offset:61952
    ds_read_b64_tr_b16 v[88:89], v41 offset:61440
    ds_read_b64_tr_b16 v[90:91], v41 offset:61952
    v_mfma_f32_16x16x32_bf16 v[48:51], v[80:83], v[60:63], v[48:51]
    v_mfma_f32_16x16x32_bf16 v[56:59], v[80:83], v[64:67], v[56:59]
    s_waitcnt lgkmcnt(0)
    s_waitcnt vmcnt(34)
    s_barrier
    s_add_u32 m0, s32, 122880
    s_add_u32 s37, s35, 860160
    s_add_u32 s37, s37, s42
    buffer_load_dwordx4 v11, s[12:15], s37 offen lds
    s_add_u32 m0, s32, 126976
    s_add_u32 s37, s35, 888832
    s_add_u32 s37, s37, s42
    buffer_load_dwordx4 v11, s[12:15], s37 offen lds
    s_add_u32 m0, s32, 49152
    s_nop 0
    s_mov_b32 s37, 1920
    buffer_load_dwordx4 v9, s[8:11], s37 offen lds
    s_add_u32 m0, s32, 53248
    s_nop 0
    s_mov_b32 s37, 1920
    buffer_load_dwordx4 v10, s[8:11], s37 offen lds
    v_mfma_f32_16x16x32_bf16 v[44:47], v[84:87], v[68:71], v[44:47]
    ds_read_b128 v[60:63], v30 offset:57344
    ds_read_b128 v[64:67], v30 offset:59392
    ds_read_b64_tr_b16 v[76:77], v40 offset:0
    v_mfma_f32_16x16x32_bf16 v[52:55], v[84:87], v[72:75], v[52:55]
    ds_read_b64_tr_b16 v[78:79], v40 offset:512
    ds_read_b64_tr_b16 v[80:81], v42 offset:0
    ds_read_b64_tr_b16 v[82:83], v42 offset:512
    v_mfma_f32_16x16x32_bf16 v[48:51], v[88:91], v[68:71], v[48:51]
    v_mfma_f32_16x16x32_bf16 v[56:59], v[88:91], v[72:75], v[56:59]
    s_waitcnt lgkmcnt(0)
    v_mfma_f32_16x16x32_bf16 v[44:47], v[76:79], v[60:63], v[44:47]
    ds_read_b128 v[68:71], v31 offset:57344
    ds_read_b128 v[72:75], v31 offset:59392
    ds_read_b64_tr_b16 v[84:85], v40 offset:4096
    v_mfma_f32_16x16x32_bf16 v[52:55], v[76:79], v[64:67], v[52:55]
    ds_read_b64_tr_b16 v[86:87], v40 offset:4608
    ds_read_b64_tr_b16 v[88:89], v42 offset:4096
    ds_read_b64_tr_b16 v[90:91], v42 offset:4608
    v_mfma_f32_16x16x32_bf16 v[48:51], v[80:83], v[60:63], v[48:51]
    v_mfma_f32_16x16x32_bf16 v[56:59], v[80:83], v[64:67], v[56:59]
    s_waitcnt lgkmcnt(0)
    s_waitcnt vmcnt(36)
    s_barrier
    s_add_u32 m0, s32, 131072
    s_add_u32 s37, s35, 917504
    s_add_u32 s37, s37, s42
    buffer_load_dwordx4 v11, s[12:15], s37 offen lds
    s_add_u32 m0, s32, 135168
    s_add_u32 s37, s35, 946176
    s_add_u32 s37, s37, s42
    buffer_load_dwordx4 v11, s[12:15], s37 offen lds
    s_add_u32 m0, s32, 57344
    s_nop 0
    s_mov_b32 s37, 2048
    buffer_load_dwordx4 v9, s[8:11], s37 offen lds
    s_add_u32 m0, s32, 61440
    s_nop 0
    s_mov_b32 s37, 2048
    buffer_load_dwordx4 v10, s[8:11], s37 offen lds
    v_mfma_f32_16x16x32_bf16 v[44:47], v[84:87], v[68:71], v[44:47]
    ds_read_b128 v[60:63], v37 offset:0
    ds_read_b128 v[64:67], v37 offset:2048
    ds_read_b64_tr_b16 v[76:77], v40 offset:8192
    v_mfma_f32_16x16x32_bf16 v[52:55], v[84:87], v[72:75], v[52:55]
    ds_read_b64_tr_b16 v[78:79], v40 offset:8704
    ds_read_b64_tr_b16 v[80:81], v42 offset:8192
    ds_read_b64_tr_b16 v[82:83], v42 offset:8704
    v_mfma_f32_16x16x32_bf16 v[48:51], v[88:91], v[68:71], v[48:51]
    v_mfma_f32_16x16x32_bf16 v[56:59], v[88:91], v[72:75], v[56:59]
    s_waitcnt lgkmcnt(0)
    v_mfma_f32_16x16x32_bf16 v[44:47], v[76:79], v[60:63], v[44:47]
    ds_read_b128 v[68:71], v38 offset:0
    ds_read_b128 v[72:75], v38 offset:2048
    ds_read_b64_tr_b16 v[84:85], v40 offset:12288
    v_mfma_f32_16x16x32_bf16 v[52:55], v[76:79], v[64:67], v[52:55]
    ds_read_b64_tr_b16 v[86:87], v40 offset:12800
    ds_read_b64_tr_b16 v[88:89], v42 offset:12288
    ds_read_b64_tr_b16 v[90:91], v42 offset:12800
    v_mfma_f32_16x16x32_bf16 v[48:51], v[80:83], v[60:63], v[48:51]
    v_mfma_f32_16x16x32_bf16 v[56:59], v[80:83], v[64:67], v[56:59]
    s_waitcnt lgkmcnt(0)
    s_waitcnt vmcnt(30)
    s_waitcnt vmcnt(28)
    s_barrier
    s_add_u32 m0, s32, 139264
    s_add_u32 s37, s35, 974848
    s_add_u32 s37, s37, s42
    buffer_load_dwordx4 v11, s[12:15], s37 offen lds
    s_add_u32 m0, s32, 143360
    s_add_u32 s37, s35, 1003520
    s_add_u32 s37, s37, s42
    buffer_load_dwordx4 v11, s[12:15], s37 offen lds
    s_add_u32 m0, s32, 65536
    s_nop 0
    s_mov_b32 s37, 2176
    buffer_load_dwordx4 v9, s[8:11], s37 offen lds
    s_add_u32 m0, s32, 69632
    s_nop 0
    s_mov_b32 s37, 2176
    buffer_load_dwordx4 v10, s[8:11], s37 offen lds
    v_mfma_f32_16x16x32_bf16 v[44:47], v[84:87], v[68:71], v[44:47]
    ds_read_b128 v[60:63], v30 offset:0
    ds_read_b128 v[64:67], v30 offset:2048
    ds_read_b64_tr_b16 v[76:77], v39 offset:8192
    v_mfma_f32_16x16x32_bf16 v[52:55], v[84:87], v[72:75], v[52:55]
    ds_read_b64_tr_b16 v[78:79], v39 offset:8704
    ds_read_b64_tr_b16 v[80:81], v41 offset:8192
    ds_read_b64_tr_b16 v[82:83], v41 offset:8704
    v_mfma_f32_16x16x32_bf16 v[48:51], v[88:91], v[68:71], v[48:51]
    v_mfma_f32_16x16x32_bf16 v[56:59], v[88:91], v[72:75], v[56:59]
    s_waitcnt lgkmcnt(0)
    v_mfma_f32_16x16x32_bf16 v[44:47], v[76:79], v[60:63], v[44:47]
    ds_read_b128 v[68:71], v31 offset:0
    ds_read_b128 v[72:75], v31 offset:2048
    ds_read_b64_tr_b16 v[84:85], v39 offset:12288
    v_mfma_f32_16x16x32_bf16 v[52:55], v[76:79], v[64:67], v[52:55]
    ds_read_b64_tr_b16 v[86:87], v39 offset:12800
    ds_read_b64_tr_b16 v[88:89], v41 offset:12288
    ds_read_b64_tr_b16 v[90:91], v41 offset:12800
    v_mfma_f32_16x16x32_bf16 v[48:51], v[80:83], v[60:63], v[48:51]
    v_mfma_f32_16x16x32_bf16 v[56:59], v[80:83], v[64:67], v[56:59]
    s_waitcnt lgkmcnt(0)
    s_waitcnt vmcnt(30)
    s_waitcnt vmcnt(28)
    s_barrier
    s_add_u32 m0, s32, 73728
    s_add_u32 s37, s35, 1032192
    s_add_u32 s37, s37, s42
    buffer_load_dwordx4 v11, s[12:15], s37 offen lds
    s_add_u32 m0, s32, 77824
    s_add_u32 s37, s35, 1060864
    s_add_u32 s37, s37, s42
    buffer_load_dwordx4 v11, s[12:15], s37 offen lds
    s_add_u32 m0, s32, 0
    s_nop 0
    s_mov_b32 s37, 2304
    buffer_load_dwordx4 v9, s[8:11], s37 offen lds
    s_add_u32 m0, s32, 4096
    s_nop 0
    s_mov_b32 s37, 2304
    buffer_load_dwordx4 v10, s[8:11], s37 offen lds
    v_mfma_f32_16x16x32_bf16 v[44:47], v[84:87], v[68:71], v[44:47]
    ds_read_b128 v[60:63], v30 offset:8192
    ds_read_b128 v[64:67], v30 offset:10240
    ds_read_b64_tr_b16 v[76:77], v39 offset:16384
    v_mfma_f32_16x16x32_bf16 v[52:55], v[84:87], v[72:75], v[52:55]
    ds_read_b64_tr_b16 v[78:79], v39 offset:16896
    ds_read_b64_tr_b16 v[80:81], v41 offset:16384
    ds_read_b64_tr_b16 v[82:83], v41 offset:16896
    v_mfma_f32_16x16x32_bf16 v[48:51], v[88:91], v[68:71], v[48:51]
    v_mfma_f32_16x16x32_bf16 v[56:59], v[88:91], v[72:75], v[56:59]
    s_waitcnt lgkmcnt(0)
    v_mfma_f32_16x16x32_bf16 v[44:47], v[76:79], v[60:63], v[44:47]
    ds_read_b128 v[68:71], v31 offset:8192
    ds_read_b128 v[72:75], v31 offset:10240
    ds_read_b64_tr_b16 v[84:85], v39 offset:20480
    v_mfma_f32_16x16x32_bf16 v[52:55], v[76:79], v[64:67], v[52:55]
    ds_read_b64_tr_b16 v[86:87], v39 offset:20992
    ds_read_b64_tr_b16 v[88:89], v41 offset:20480
    ds_read_b64_tr_b16 v[90:91], v41 offset:20992
    v_mfma_f32_16x16x32_bf16 v[48:51], v[80:83], v[60:63], v[48:51]
    v_mfma_f32_16x16x32_bf16 v[56:59], v[80:83], v[64:67], v[56:59]
    s_waitcnt lgkmcnt(0)
    s_waitcnt vmcnt(30)
    s_waitcnt vmcnt(28)
    s_barrier
    s_add_u32 m0, s32, 81920
    s_add_u32 s37, s35, 1089536
    s_add_u32 s37, s37, s42
    buffer_load_dwordx4 v11, s[12:15], s37 offen lds
    s_add_u32 m0, s32, 86016
    s_add_u32 s37, s35, 1118208
    s_add_u32 s37, s37, s42
    buffer_load_dwordx4 v11, s[12:15], s37 offen lds
    s_add_u32 m0, s32, 8192
    s_nop 0
    s_mov_b32 s37, 2432
    buffer_load_dwordx4 v9, s[8:11], s37 offen lds
    s_add_u32 m0, s32, 12288
    s_nop 0
    s_mov_b32 s37, 2432
    buffer_load_dwordx4 v10, s[8:11], s37 offen lds
    v_mfma_f32_16x16x32_bf16 v[44:47], v[84:87], v[68:71], v[44:47]
    ds_read_b128 v[60:63], v30 offset:16384
    ds_read_b128 v[64:67], v30 offset:18432
    ds_read_b64_tr_b16 v[76:77], v39 offset:24576
    v_mfma_f32_16x16x32_bf16 v[52:55], v[84:87], v[72:75], v[52:55]
    ds_read_b64_tr_b16 v[78:79], v39 offset:25088
    ds_read_b64_tr_b16 v[80:81], v41 offset:24576
    ds_read_b64_tr_b16 v[82:83], v41 offset:25088
    v_mfma_f32_16x16x32_bf16 v[48:51], v[88:91], v[68:71], v[48:51]
    v_mfma_f32_16x16x32_bf16 v[56:59], v[88:91], v[72:75], v[56:59]
    s_waitcnt lgkmcnt(0)
    v_mfma_f32_16x16x32_bf16 v[44:47], v[76:79], v[60:63], v[44:47]
    ds_read_b128 v[68:71], v31 offset:16384
    ds_read_b128 v[72:75], v31 offset:18432
    ds_read_b64_tr_b16 v[84:85], v39 offset:28672
    v_mfma_f32_16x16x32_bf16 v[52:55], v[76:79], v[64:67], v[52:55]
    ds_read_b64_tr_b16 v[86:87], v39 offset:29184
    ds_read_b64_tr_b16 v[88:89], v41 offset:28672
    ds_read_b64_tr_b16 v[90:91], v41 offset:29184
    v_mfma_f32_16x16x32_bf16 v[48:51], v[80:83], v[60:63], v[48:51]
    v_mfma_f32_16x16x32_bf16 v[56:59], v[80:83], v[64:67], v[56:59]
    s_waitcnt lgkmcnt(0)
    s_waitcnt vmcnt(30)
    s_waitcnt vmcnt(28)
    s_barrier
    s_add_u32 m0, s32, 90112
    s_add_u32 s37, s35, 1146880
    s_add_u32 s37, s37, s42
    buffer_load_dwordx4 v11, s[12:15], s37 offen lds
    s_add_u32 m0, s32, 94208
    s_add_u32 s37, s35, 1175552
    s_add_u32 s37, s37, s42
    buffer_load_dwordx4 v11, s[12:15], s37 offen lds
    s_add_u32 m0, s32, 16384
    s_nop 0
    s_mov_b32 s37, 2560
    buffer_load_dwordx4 v9, s[8:11], s37 offen lds
    s_add_u32 m0, s32, 20480
    s_nop 0
    s_mov_b32 s37, 2560
    buffer_load_dwordx4 v10, s[8:11], s37 offen lds
    v_mfma_f32_16x16x32_bf16 v[44:47], v[84:87], v[68:71], v[44:47]
    ds_read_b128 v[60:63], v30 offset:24576
    ds_read_b128 v[64:67], v30 offset:26624
    ds_read_b64_tr_b16 v[76:77], v39 offset:32768
    v_mfma_f32_16x16x32_bf16 v[52:55], v[84:87], v[72:75], v[52:55]
    ds_read_b64_tr_b16 v[78:79], v39 offset:33280
    ds_read_b64_tr_b16 v[80:81], v41 offset:32768
    ds_read_b64_tr_b16 v[82:83], v41 offset:33280
    v_mfma_f32_16x16x32_bf16 v[48:51], v[88:91], v[68:71], v[48:51]
    v_mfma_f32_16x16x32_bf16 v[56:59], v[88:91], v[72:75], v[56:59]
    s_waitcnt lgkmcnt(0)
    v_mfma_f32_16x16x32_bf16 v[44:47], v[76:79], v[60:63], v[44:47]
    ds_read_b128 v[68:71], v31 offset:24576
    ds_read_b128 v[72:75], v31 offset:26624
    ds_read_b64_tr_b16 v[84:85], v39 offset:36864
    v_mfma_f32_16x16x32_bf16 v[52:55], v[76:79], v[64:67], v[52:55]
    ds_read_b64_tr_b16 v[86:87], v39 offset:37376
    ds_read_b64_tr_b16 v[88:89], v41 offset:36864
    ds_read_b64_tr_b16 v[90:91], v41 offset:37376
    v_mfma_f32_16x16x32_bf16 v[48:51], v[80:83], v[60:63], v[48:51]
    v_mfma_f32_16x16x32_bf16 v[56:59], v[80:83], v[64:67], v[56:59]
    s_waitcnt lgkmcnt(0)
    s_waitcnt vmcnt(30)
    s_waitcnt vmcnt(28)
    s_barrier
    s_add_u32 m0, s32, 98304
    s_add_u32 s37, s35, 1204224
    s_add_u32 s37, s37, s42
    buffer_load_dwordx4 v11, s[12:15], s37 offen lds
    s_add_u32 m0, s32, 102400
    s_add_u32 s37, s35, 1232896
    s_add_u32 s37, s37, s42
    buffer_load_dwordx4 v11, s[12:15], s37 offen lds
    s_add_u32 m0, s32, 24576
    s_nop 0
    s_mov_b32 s37, 2688
    buffer_load_dwordx4 v9, s[8:11], s37 offen lds
    s_add_u32 m0, s32, 28672
    s_nop 0
    s_mov_b32 s37, 2688
    buffer_load_dwordx4 v10, s[8:11], s37 offen lds
    v_mfma_f32_16x16x32_bf16 v[44:47], v[84:87], v[68:71], v[44:47]
    ds_read_b128 v[60:63], v30 offset:32768
    ds_read_b128 v[64:67], v30 offset:34816
    ds_read_b64_tr_b16 v[76:77], v39 offset:40960
    v_mfma_f32_16x16x32_bf16 v[52:55], v[84:87], v[72:75], v[52:55]
    ds_read_b64_tr_b16 v[78:79], v39 offset:41472
    ds_read_b64_tr_b16 v[80:81], v41 offset:40960
    ds_read_b64_tr_b16 v[82:83], v41 offset:41472
    v_mfma_f32_16x16x32_bf16 v[48:51], v[88:91], v[68:71], v[48:51]
    v_mfma_f32_16x16x32_bf16 v[56:59], v[88:91], v[72:75], v[56:59]
    s_waitcnt lgkmcnt(0)
    v_mfma_f32_16x16x32_bf16 v[44:47], v[76:79], v[60:63], v[44:47]
    ds_read_b128 v[68:71], v31 offset:32768
    ds_read_b128 v[72:75], v31 offset:34816
    ds_read_b64_tr_b16 v[84:85], v39 offset:45056
    v_mfma_f32_16x16x32_bf16 v[52:55], v[76:79], v[64:67], v[52:55]
    ds_read_b64_tr_b16 v[86:87], v39 offset:45568
    ds_read_b64_tr_b16 v[88:89], v41 offset:45056
    ds_read_b64_tr_b16 v[90:91], v41 offset:45568
    v_mfma_f32_16x16x32_bf16 v[48:51], v[80:83], v[60:63], v[48:51]
    v_mfma_f32_16x16x32_bf16 v[56:59], v[80:83], v[64:67], v[56:59]
    s_waitcnt lgkmcnt(0)
    s_waitcnt vmcnt(30)
    s_waitcnt vmcnt(28)
    s_barrier
    s_add_u32 m0, s32, 106496
    s_add_u32 s37, s35, 1261568
    s_add_u32 s37, s37, s42
    buffer_load_dwordx4 v11, s[12:15], s37 offen lds
    s_add_u32 m0, s32, 110592
    s_add_u32 s37, s35, 1290240
    s_add_u32 s37, s37, s42
    buffer_load_dwordx4 v11, s[12:15], s37 offen lds
    s_add_u32 m0, s32, 32768
    s_nop 0
    s_mov_b32 s37, 2816
    buffer_load_dwordx4 v9, s[8:11], s37 offen lds
    s_add_u32 m0, s32, 36864
    s_nop 0
    s_mov_b32 s37, 2816
    buffer_load_dwordx4 v10, s[8:11], s37 offen lds
    v_mfma_f32_16x16x32_bf16 v[44:47], v[84:87], v[68:71], v[44:47]
    ds_read_b128 v[60:63], v30 offset:40960
    ds_read_b128 v[64:67], v30 offset:43008
    ds_read_b64_tr_b16 v[76:77], v39 offset:49152
    v_mfma_f32_16x16x32_bf16 v[52:55], v[84:87], v[72:75], v[52:55]
    ds_read_b64_tr_b16 v[78:79], v39 offset:49664
    ds_read_b64_tr_b16 v[80:81], v41 offset:49152
    ds_read_b64_tr_b16 v[82:83], v41 offset:49664
    v_mfma_f32_16x16x32_bf16 v[48:51], v[88:91], v[68:71], v[48:51]
    v_mfma_f32_16x16x32_bf16 v[56:59], v[88:91], v[72:75], v[56:59]
    s_waitcnt lgkmcnt(0)
    v_mfma_f32_16x16x32_bf16 v[44:47], v[76:79], v[60:63], v[44:47]
    ds_read_b128 v[68:71], v31 offset:40960
    ds_read_b128 v[72:75], v31 offset:43008
    ds_read_b64_tr_b16 v[84:85], v39 offset:53248
    v_mfma_f32_16x16x32_bf16 v[52:55], v[76:79], v[64:67], v[52:55]
    ds_read_b64_tr_b16 v[86:87], v39 offset:53760
    ds_read_b64_tr_b16 v[88:89], v41 offset:53248
    ds_read_b64_tr_b16 v[90:91], v41 offset:53760
    v_mfma_f32_16x16x32_bf16 v[48:51], v[80:83], v[60:63], v[48:51]
    v_mfma_f32_16x16x32_bf16 v[56:59], v[80:83], v[64:67], v[56:59]
    s_waitcnt lgkmcnt(0)
    s_waitcnt vmcnt(30)
    s_waitcnt vmcnt(28)
    s_barrier
    s_add_u32 m0, s32, 114688
    s_add_u32 s37, s35, 1318912
    s_add_u32 s37, s37, s42
    buffer_load_dwordx4 v11, s[12:15], s37 offen lds
    s_add_u32 m0, s32, 118784
    s_add_u32 s37, s35, 1347584
    s_add_u32 s37, s37, s42
    buffer_load_dwordx4 v11, s[12:15], s37 offen lds
    s_add_u32 m0, s32, 40960
    s_nop 0
    s_mov_b32 s37, 2944
    buffer_load_dwordx4 v9, s[8:11], s37 offen lds
    s_add_u32 m0, s32, 45056
    s_nop 0
    s_mov_b32 s37, 2944
    buffer_load_dwordx4 v10, s[8:11], s37 offen lds
    v_mfma_f32_16x16x32_bf16 v[44:47], v[84:87], v[68:71], v[44:47]
    ds_read_b128 v[60:63], v30 offset:49152
    ds_read_b128 v[64:67], v30 offset:51200
    ds_read_b64_tr_b16 v[76:77], v39 offset:57344
    v_mfma_f32_16x16x32_bf16 v[52:55], v[84:87], v[72:75], v[52:55]
    ds_read_b64_tr_b16 v[78:79], v39 offset:57856
    ds_read_b64_tr_b16 v[80:81], v41 offset:57344
    ds_read_b64_tr_b16 v[82:83], v41 offset:57856
    v_mfma_f32_16x16x32_bf16 v[48:51], v[88:91], v[68:71], v[48:51]
    v_mfma_f32_16x16x32_bf16 v[56:59], v[88:91], v[72:75], v[56:59]
    s_waitcnt lgkmcnt(0)
    v_mfma_f32_16x16x32_bf16 v[44:47], v[76:79], v[60:63], v[44:47]
    ds_read_b128 v[68:71], v31 offset:49152
    ds_read_b128 v[72:75], v31 offset:51200
    ds_read_b64_tr_b16 v[84:85], v39 offset:61440
    v_mfma_f32_16x16x32_bf16 v[52:55], v[76:79], v[64:67], v[52:55]
    ds_read_b64_tr_b16 v[86:87], v39 offset:61952
    ds_read_b64_tr_b16 v[88:89], v41 offset:61440
    ds_read_b64_tr_b16 v[90:91], v41 offset:61952
    v_mfma_f32_16x16x32_bf16 v[48:51], v[80:83], v[60:63], v[48:51]
    v_mfma_f32_16x16x32_bf16 v[56:59], v[80:83], v[64:67], v[56:59]
    s_waitcnt lgkmcnt(0)
    s_waitcnt vmcnt(30)
    s_waitcnt vmcnt(28)
    s_barrier
    s_add_u32 m0, s32, 122880
    s_add_u32 s37, s35, 1376256
    s_add_u32 s37, s37, s42
    buffer_load_dwordx4 v11, s[12:15], s37 offen lds
    s_add_u32 m0, s32, 126976
    s_add_u32 s37, s35, 1404928
    s_add_u32 s37, s37, s42
    buffer_load_dwordx4 v11, s[12:15], s37 offen lds
    s_add_u32 m0, s32, 49152
    s_nop 0
    s_mov_b32 s37, 3072
    buffer_load_dwordx4 v9, s[8:11], s37 offen lds
    s_add_u32 m0, s32, 53248
    s_nop 0
    s_mov_b32 s37, 3072
    buffer_load_dwordx4 v10, s[8:11], s37 offen lds
    v_mfma_f32_16x16x32_bf16 v[44:47], v[84:87], v[68:71], v[44:47]
    ds_read_b128 v[60:63], v30 offset:57344
    ds_read_b128 v[64:67], v30 offset:59392
    ds_read_b64_tr_b16 v[76:77], v40 offset:0
    v_mfma_f32_16x16x32_bf16 v[52:55], v[84:87], v[72:75], v[52:55]
    ds_read_b64_tr_b16 v[78:79], v40 offset:512
    ds_read_b64_tr_b16 v[80:81], v42 offset:0
    ds_read_b64_tr_b16 v[82:83], v42 offset:512
    v_mfma_f32_16x16x32_bf16 v[48:51], v[88:91], v[68:71], v[48:51]
    v_mfma_f32_16x16x32_bf16 v[56:59], v[88:91], v[72:75], v[56:59]
    s_waitcnt lgkmcnt(0)
    v_mfma_f32_16x16x32_bf16 v[44:47], v[76:79], v[60:63], v[44:47]
    ds_read_b128 v[68:71], v31 offset:57344
    ds_read_b128 v[72:75], v31 offset:59392
    ds_read_b64_tr_b16 v[84:85], v40 offset:4096
    v_mfma_f32_16x16x32_bf16 v[52:55], v[76:79], v[64:67], v[52:55]
    ds_read_b64_tr_b16 v[86:87], v40 offset:4608
    ds_read_b64_tr_b16 v[88:89], v42 offset:4096
    ds_read_b64_tr_b16 v[90:91], v42 offset:4608
    v_mfma_f32_16x16x32_bf16 v[48:51], v[80:83], v[60:63], v[48:51]
    v_mfma_f32_16x16x32_bf16 v[56:59], v[80:83], v[64:67], v[56:59]
    s_waitcnt lgkmcnt(0)
    s_waitcnt vmcnt(30)
    s_waitcnt vmcnt(28)
    s_barrier
    s_add_u32 m0, s32, 131072
    s_add_u32 s37, s35, 1433600
    s_add_u32 s37, s37, s42
    buffer_load_dwordx4 v11, s[12:15], s37 offen lds
    s_add_u32 m0, s32, 135168
    s_add_u32 s37, s35, 1462272
    s_add_u32 s37, s37, s42
    buffer_load_dwordx4 v11, s[12:15], s37 offen lds
    s_add_u32 m0, s32, 57344
    s_nop 0
    s_mov_b32 s37, 3200
    buffer_load_dwordx4 v9, s[8:11], s37 offen lds
    s_add_u32 m0, s32, 61440
    s_nop 0
    s_mov_b32 s37, 3200
    buffer_load_dwordx4 v10, s[8:11], s37 offen lds
    v_mfma_f32_16x16x32_bf16 v[44:47], v[84:87], v[68:71], v[44:47]
    ds_read_b128 v[60:63], v37 offset:0
    ds_read_b128 v[64:67], v37 offset:2048
    ds_read_b64_tr_b16 v[76:77], v40 offset:8192
    v_mfma_f32_16x16x32_bf16 v[52:55], v[84:87], v[72:75], v[52:55]
    ds_read_b64_tr_b16 v[78:79], v40 offset:8704
    ds_read_b64_tr_b16 v[80:81], v42 offset:8192
    ds_read_b64_tr_b16 v[82:83], v42 offset:8704
    v_mfma_f32_16x16x32_bf16 v[48:51], v[88:91], v[68:71], v[48:51]
    v_mfma_f32_16x16x32_bf16 v[56:59], v[88:91], v[72:75], v[56:59]
    s_waitcnt lgkmcnt(0)
    v_mfma_f32_16x16x32_bf16 v[44:47], v[76:79], v[60:63], v[44:47]
    ds_read_b128 v[68:71], v38 offset:0
    ds_read_b128 v[72:75], v38 offset:2048
    ds_read_b64_tr_b16 v[84:85], v40 offset:12288
    v_mfma_f32_16x16x32_bf16 v[52:55], v[76:79], v[64:67], v[52:55]
    ds_read_b64_tr_b16 v[86:87], v40 offset:12800
    ds_read_b64_tr_b16 v[88:89], v42 offset:12288
    ds_read_b64_tr_b16 v[90:91], v42 offset:12800
    v_mfma_f32_16x16x32_bf16 v[48:51], v[80:83], v[60:63], v[48:51]
    v_mfma_f32_16x16x32_bf16 v[56:59], v[80:83], v[64:67], v[56:59]
    s_waitcnt lgkmcnt(0)
    s_waitcnt vmcnt(30)
    s_waitcnt vmcnt(28)
    s_barrier
    s_add_u32 m0, s32, 139264
    s_add_u32 s37, s35, 1490944
    s_add_u32 s37, s37, s42
    buffer_load_dwordx4 v11, s[12:15], s37 offen lds
    s_add_u32 m0, s32, 143360
    s_add_u32 s37, s35, 1519616
    s_add_u32 s37, s37, s42
    buffer_load_dwordx4 v11, s[12:15], s37 offen lds
    s_add_u32 m0, s32, 65536
    s_nop 0
    s_mov_b32 s37, 3328
    buffer_load_dwordx4 v9, s[8:11], s37 offen lds
    s_add_u32 m0, s32, 69632
    s_nop 0
    s_mov_b32 s37, 3328
    buffer_load_dwordx4 v10, s[8:11], s37 offen lds
    v_mfma_f32_16x16x32_bf16 v[44:47], v[84:87], v[68:71], v[44:47]
    ds_read_b128 v[60:63], v30 offset:0
    ds_read_b128 v[64:67], v30 offset:2048
    ds_read_b64_tr_b16 v[76:77], v39 offset:8192
    v_mfma_f32_16x16x32_bf16 v[52:55], v[84:87], v[72:75], v[52:55]
    ds_read_b64_tr_b16 v[78:79], v39 offset:8704
    ds_read_b64_tr_b16 v[80:81], v41 offset:8192
    ds_read_b64_tr_b16 v[82:83], v41 offset:8704
    v_mfma_f32_16x16x32_bf16 v[48:51], v[88:91], v[68:71], v[48:51]
    v_mfma_f32_16x16x32_bf16 v[56:59], v[88:91], v[72:75], v[56:59]
    s_waitcnt lgkmcnt(0)
    v_mfma_f32_16x16x32_bf16 v[44:47], v[76:79], v[60:63], v[44:47]
    ds_read_b128 v[68:71], v31 offset:0
    ds_read_b128 v[72:75], v31 offset:2048
    ds_read_b64_tr_b16 v[84:85], v39 offset:12288
    v_mfma_f32_16x16x32_bf16 v[52:55], v[76:79], v[64:67], v[52:55]
    ds_read_b64_tr_b16 v[86:87], v39 offset:12800
    ds_read_b64_tr_b16 v[88:89], v41 offset:12288
    ds_read_b64_tr_b16 v[90:91], v41 offset:12800
    v_mfma_f32_16x16x32_bf16 v[48:51], v[80:83], v[60:63], v[48:51]
    v_mfma_f32_16x16x32_bf16 v[56:59], v[80:83], v[64:67], v[56:59]
    s_waitcnt lgkmcnt(0)
    s_waitcnt vmcnt(30)
    s_waitcnt vmcnt(28)
    s_barrier
    s_add_u32 m0, s32, 73728
    s_add_u32 s37, s35, 1548288
    s_add_u32 s37, s37, s42
    buffer_load_dwordx4 v11, s[12:15], s37 offen lds
    s_add_u32 m0, s32, 77824
    s_add_u32 s37, s35, 1576960
    s_add_u32 s37, s37, s42
    buffer_load_dwordx4 v11, s[12:15], s37 offen lds
    s_add_u32 m0, s32, 0
    s_nop 0
    s_mov_b32 s37, 3456
    buffer_load_dwordx4 v9, s[8:11], s37 offen lds
    s_add_u32 m0, s32, 4096
    s_nop 0
    s_mov_b32 s37, 3456
    buffer_load_dwordx4 v10, s[8:11], s37 offen lds
    v_mfma_f32_16x16x32_bf16 v[44:47], v[84:87], v[68:71], v[44:47]
    ds_read_b128 v[60:63], v30 offset:8192
    ds_read_b128 v[64:67], v30 offset:10240
    ds_read_b64_tr_b16 v[76:77], v39 offset:16384
    v_mfma_f32_16x16x32_bf16 v[52:55], v[84:87], v[72:75], v[52:55]
    ds_read_b64_tr_b16 v[78:79], v39 offset:16896
    ds_read_b64_tr_b16 v[80:81], v41 offset:16384
    ds_read_b64_tr_b16 v[82:83], v41 offset:16896
    v_mfma_f32_16x16x32_bf16 v[48:51], v[88:91], v[68:71], v[48:51]
    v_mfma_f32_16x16x32_bf16 v[56:59], v[88:91], v[72:75], v[56:59]
    s_waitcnt lgkmcnt(0)
    v_mfma_f32_16x16x32_bf16 v[44:47], v[76:79], v[60:63], v[44:47]
    ds_read_b128 v[68:71], v31 offset:8192
    ds_read_b128 v[72:75], v31 offset:10240
    ds_read_b64_tr_b16 v[84:85], v39 offset:20480
    v_mfma_f32_16x16x32_bf16 v[52:55], v[76:79], v[64:67], v[52:55]
    ds_read_b64_tr_b16 v[86:87], v39 offset:20992
    ds_read_b64_tr_b16 v[88:89], v41 offset:20480
    ds_read_b64_tr_b16 v[90:91], v41 offset:20992
    v_mfma_f32_16x16x32_bf16 v[48:51], v[80:83], v[60:63], v[48:51]
    v_mfma_f32_16x16x32_bf16 v[56:59], v[80:83], v[64:67], v[56:59]
    s_waitcnt lgkmcnt(0)
    s_waitcnt vmcnt(30)
    s_waitcnt vmcnt(28)
    s_barrier
    v_mfma_f32_16x16x32_bf16 v[44:47], v[84:87], v[68:71], v[44:47]
    ds_read_b128 v[60:63], v30 offset:16384
    ds_read_b128 v[64:67], v30 offset:18432
    ds_read_b64_tr_b16 v[76:77], v39 offset:24576
    v_mfma_f32_16x16x32_bf16 v[52:55], v[84:87], v[72:75], v[52:55]
    ds_read_b64_tr_b16 v[78:79], v39 offset:25088
    ds_read_b64_tr_b16 v[80:81], v41 offset:24576
    ds_read_b64_tr_b16 v[82:83], v41 offset:25088
    v_mfma_f32_16x16x32_bf16 v[48:51], v[88:91], v[68:71], v[48:51]
    v_mfma_f32_16x16x32_bf16 v[56:59], v[88:91], v[72:75], v[56:59]
    s_waitcnt lgkmcnt(0)
    v_mfma_f32_16x16x32_bf16 v[44:47], v[76:79], v[60:63], v[44:47]
    ds_read_b128 v[68:71], v31 offset:16384
    ds_read_b128 v[72:75], v31 offset:18432
    ds_read_b64_tr_b16 v[84:85], v39 offset:28672
    v_mfma_f32_16x16x32_bf16 v[52:55], v[76:79], v[64:67], v[52:55]
    ds_read_b64_tr_b16 v[86:87], v39 offset:29184
    ds_read_b64_tr_b16 v[88:89], v41 offset:28672
    ds_read_b64_tr_b16 v[90:91], v41 offset:29184
    v_mfma_f32_16x16x32_bf16 v[48:51], v[80:83], v[60:63], v[48:51]
    v_mfma_f32_16x16x32_bf16 v[56:59], v[80:83], v[64:67], v[56:59]
    s_waitcnt lgkmcnt(0)
    s_waitcnt vmcnt(26)
    s_waitcnt vmcnt(24)
    s_barrier
    v_mfma_f32_16x16x32_bf16 v[44:47], v[84:87], v[68:71], v[44:47]
    ds_read_b128 v[60:63], v30 offset:24576
    ds_read_b128 v[64:67], v30 offset:26624
    ds_read_b64_tr_b16 v[76:77], v39 offset:32768
    v_mfma_f32_16x16x32_bf16 v[52:55], v[84:87], v[72:75], v[52:55]
    ds_read_b64_tr_b16 v[78:79], v39 offset:33280
    ds_read_b64_tr_b16 v[80:81], v41 offset:32768
    ds_read_b64_tr_b16 v[82:83], v41 offset:33280
    v_mfma_f32_16x16x32_bf16 v[48:51], v[88:91], v[68:71], v[48:51]
    v_mfma_f32_16x16x32_bf16 v[56:59], v[88:91], v[72:75], v[56:59]
    s_waitcnt lgkmcnt(0)
    v_mfma_f32_16x16x32_bf16 v[44:47], v[76:79], v[60:63], v[44:47]
    ds_read_b128 v[68:71], v31 offset:24576
    ds_read_b128 v[72:75], v31 offset:26624
    ds_read_b64_tr_b16 v[84:85], v39 offset:36864
    v_mfma_f32_16x16x32_bf16 v[52:55], v[76:79], v[64:67], v[52:55]
    ds_read_b64_tr_b16 v[86:87], v39 offset:37376
    ds_read_b64_tr_b16 v[88:89], v41 offset:36864
    ds_read_b64_tr_b16 v[90:91], v41 offset:37376
    v_mfma_f32_16x16x32_bf16 v[48:51], v[80:83], v[60:63], v[48:51]
    v_mfma_f32_16x16x32_bf16 v[56:59], v[80:83], v[64:67], v[56:59]
    s_waitcnt lgkmcnt(0)
    s_waitcnt vmcnt(22)
    s_waitcnt vmcnt(20)
    s_barrier
    v_mfma_f32_16x16x32_bf16 v[44:47], v[84:87], v[68:71], v[44:47]
    ds_read_b128 v[60:63], v30 offset:32768
    ds_read_b128 v[64:67], v30 offset:34816
    ds_read_b64_tr_b16 v[76:77], v39 offset:40960
    v_mfma_f32_16x16x32_bf16 v[52:55], v[84:87], v[72:75], v[52:55]
    ds_read_b64_tr_b16 v[78:79], v39 offset:41472
    ds_read_b64_tr_b16 v[80:81], v41 offset:40960
    ds_read_b64_tr_b16 v[82:83], v41 offset:41472
    v_mfma_f32_16x16x32_bf16 v[48:51], v[88:91], v[68:71], v[48:51]
    v_mfma_f32_16x16x32_bf16 v[56:59], v[88:91], v[72:75], v[56:59]
    s_waitcnt lgkmcnt(0)
    v_mfma_f32_16x16x32_bf16 v[44:47], v[76:79], v[60:63], v[44:47]
    ds_read_b128 v[68:71], v31 offset:32768
    ds_read_b128 v[72:75], v31 offset:34816
    ds_read_b64_tr_b16 v[84:85], v39 offset:45056
    v_mfma_f32_16x16x32_bf16 v[52:55], v[76:79], v[64:67], v[52:55]
    ds_read_b64_tr_b16 v[86:87], v39 offset:45568
    ds_read_b64_tr_b16 v[88:89], v41 offset:45056
    ds_read_b64_tr_b16 v[90:91], v41 offset:45568
    v_mfma_f32_16x16x32_bf16 v[48:51], v[80:83], v[60:63], v[48:51]
    v_mfma_f32_16x16x32_bf16 v[56:59], v[80:83], v[64:67], v[56:59]
    s_waitcnt lgkmcnt(0)
    s_waitcnt vmcnt(18)
    s_waitcnt vmcnt(16)
    s_barrier
    v_mfma_f32_16x16x32_bf16 v[44:47], v[84:87], v[68:71], v[44:47]
    ds_read_b128 v[60:63], v30 offset:40960
    ds_read_b128 v[64:67], v30 offset:43008
    ds_read_b64_tr_b16 v[76:77], v39 offset:49152
    v_mfma_f32_16x16x32_bf16 v[52:55], v[84:87], v[72:75], v[52:55]
    ds_read_b64_tr_b16 v[78:79], v39 offset:49664
    ds_read_b64_tr_b16 v[80:81], v41 offset:49152
    ds_read_b64_tr_b16 v[82:83], v41 offset:49664
    v_mfma_f32_16x16x32_bf16 v[48:51], v[88:91], v[68:71], v[48:51]
    v_mfma_f32_16x16x32_bf16 v[56:59], v[88:91], v[72:75], v[56:59]
    s_waitcnt lgkmcnt(0)
    v_mfma_f32_16x16x32_bf16 v[44:47], v[76:79], v[60:63], v[44:47]
    ds_read_b128 v[68:71], v31 offset:40960
    ds_read_b128 v[72:75], v31 offset:43008
    ds_read_b64_tr_b16 v[84:85], v39 offset:53248
    v_mfma_f32_16x16x32_bf16 v[52:55], v[76:79], v[64:67], v[52:55]
    ds_read_b64_tr_b16 v[86:87], v39 offset:53760
    ds_read_b64_tr_b16 v[88:89], v41 offset:53248
    ds_read_b64_tr_b16 v[90:91], v41 offset:53760
    v_mfma_f32_16x16x32_bf16 v[48:51], v[80:83], v[60:63], v[48:51]
    v_mfma_f32_16x16x32_bf16 v[56:59], v[80:83], v[64:67], v[56:59]
    s_waitcnt lgkmcnt(0)
    s_waitcnt vmcnt(14)
    s_waitcnt vmcnt(12)
    s_barrier
    v_mfma_f32_16x16x32_bf16 v[44:47], v[84:87], v[68:71], v[44:47]
    ds_read_b128 v[60:63], v30 offset:49152
    ds_read_b128 v[64:67], v30 offset:51200
    ds_read_b64_tr_b16 v[76:77], v39 offset:57344
    v_mfma_f32_16x16x32_bf16 v[52:55], v[84:87], v[72:75], v[52:55]
    ds_read_b64_tr_b16 v[78:79], v39 offset:57856
    ds_read_b64_tr_b16 v[80:81], v41 offset:57344
    ds_read_b64_tr_b16 v[82:83], v41 offset:57856
    v_mfma_f32_16x16x32_bf16 v[48:51], v[88:91], v[68:71], v[48:51]
    v_mfma_f32_16x16x32_bf16 v[56:59], v[88:91], v[72:75], v[56:59]
    s_waitcnt lgkmcnt(0)
    v_mfma_f32_16x16x32_bf16 v[44:47], v[76:79], v[60:63], v[44:47]
    ds_read_b128 v[68:71], v31 offset:49152
    ds_read_b128 v[72:75], v31 offset:51200
    ds_read_b64_tr_b16 v[84:85], v39 offset:61440
    v_mfma_f32_16x16x32_bf16 v[52:55], v[76:79], v[64:67], v[52:55]
    ds_read_b64_tr_b16 v[86:87], v39 offset:61952
    ds_read_b64_tr_b16 v[88:89], v41 offset:61440
    ds_read_b64_tr_b16 v[90:91], v41 offset:61952
    v_mfma_f32_16x16x32_bf16 v[48:51], v[80:83], v[60:63], v[48:51]
    v_mfma_f32_16x16x32_bf16 v[56:59], v[80:83], v[64:67], v[56:59]
    s_waitcnt lgkmcnt(0)
    s_waitcnt vmcnt(10)
    s_waitcnt vmcnt(8)
    s_barrier
    v_mfma_f32_16x16x32_bf16 v[44:47], v[84:87], v[68:71], v[44:47]
    ds_read_b128 v[60:63], v30 offset:57344
    ds_read_b128 v[64:67], v30 offset:59392
    ds_read_b64_tr_b16 v[76:77], v40 offset:0
    v_mfma_f32_16x16x32_bf16 v[52:55], v[84:87], v[72:75], v[52:55]
    ds_read_b64_tr_b16 v[78:79], v40 offset:512
    ds_read_b64_tr_b16 v[80:81], v42 offset:0
    ds_read_b64_tr_b16 v[82:83], v42 offset:512
    v_mfma_f32_16x16x32_bf16 v[48:51], v[88:91], v[68:71], v[48:51]
    v_mfma_f32_16x16x32_bf16 v[56:59], v[88:91], v[72:75], v[56:59]
    s_waitcnt lgkmcnt(0)
    v_mfma_f32_16x16x32_bf16 v[44:47], v[76:79], v[60:63], v[44:47]
    ds_read_b128 v[68:71], v31 offset:57344
    ds_read_b128 v[72:75], v31 offset:59392
    ds_read_b64_tr_b16 v[84:85], v40 offset:4096
    v_mfma_f32_16x16x32_bf16 v[52:55], v[76:79], v[64:67], v[52:55]
    ds_read_b64_tr_b16 v[86:87], v40 offset:4608
    ds_read_b64_tr_b16 v[88:89], v42 offset:4096
    ds_read_b64_tr_b16 v[90:91], v42 offset:4608
    v_mfma_f32_16x16x32_bf16 v[48:51], v[80:83], v[60:63], v[48:51]
    v_mfma_f32_16x16x32_bf16 v[56:59], v[80:83], v[64:67], v[56:59]
    s_waitcnt lgkmcnt(0)
    s_waitcnt vmcnt(6)
    s_waitcnt vmcnt(4)
    s_barrier
    v_mfma_f32_16x16x32_bf16 v[44:47], v[84:87], v[68:71], v[44:47]
    ds_read_b128 v[60:63], v37 offset:0
    ds_read_b128 v[64:67], v37 offset:2048
    ds_read_b64_tr_b16 v[76:77], v40 offset:8192
    v_mfma_f32_16x16x32_bf16 v[52:55], v[84:87], v[72:75], v[52:55]
    ds_read_b64_tr_b16 v[78:79], v40 offset:8704
    ds_read_b64_tr_b16 v[80:81], v42 offset:8192
    ds_read_b64_tr_b16 v[82:83], v42 offset:8704
    v_mfma_f32_16x16x32_bf16 v[48:51], v[88:91], v[68:71], v[48:51]
    v_mfma_f32_16x16x32_bf16 v[56:59], v[88:91], v[72:75], v[56:59]
    s_waitcnt lgkmcnt(0)
    v_mfma_f32_16x16x32_bf16 v[44:47], v[76:79], v[60:63], v[44:47]
    ds_read_b128 v[68:71], v38 offset:0
    ds_read_b128 v[72:75], v38 offset:2048
    ds_read_b64_tr_b16 v[84:85], v40 offset:12288
    v_mfma_f32_16x16x32_bf16 v[52:55], v[76:79], v[64:67], v[52:55]
    ds_read_b64_tr_b16 v[86:87], v40 offset:12800
    ds_read_b64_tr_b16 v[88:89], v42 offset:12288
    ds_read_b64_tr_b16 v[90:91], v42 offset:12800
    v_mfma_f32_16x16x32_bf16 v[48:51], v[80:83], v[60:63], v[48:51]
    v_mfma_f32_16x16x32_bf16 v[56:59], v[80:83], v[64:67], v[56:59]
    s_waitcnt lgkmcnt(0)
    s_waitcnt vmcnt(2)
    s_waitcnt vmcnt(0)
    s_barrier
    v_mfma_f32_16x16x32_bf16 v[44:47], v[84:87], v[68:71], v[44:47]
    ds_read_b128 v[60:63], v30 offset:0
    ds_read_b128 v[64:67], v30 offset:2048
    ds_read_b64_tr_b16 v[76:77], v39 offset:8192
    v_mfma_f32_16x16x32_bf16 v[52:55], v[84:87], v[72:75], v[52:55]
    ds_read_b64_tr_b16 v[78:79], v39 offset:8704
    ds_read_b64_tr_b16 v[80:81], v41 offset:8192
    ds_read_b64_tr_b16 v[82:83], v41 offset:8704
    v_mfma_f32_16x16x32_bf16 v[48:51], v[88:91], v[68:71], v[48:51]
    v_mfma_f32_16x16x32_bf16 v[56:59], v[88:91], v[72:75], v[56:59]
    s_waitcnt lgkmcnt(0)
    v_mfma_f32_16x16x32_bf16 v[44:47], v[76:79], v[60:63], v[44:47]
    ds_read_b128 v[68:71], v31 offset:0
    ds_read_b128 v[72:75], v31 offset:2048
    ds_read_b64_tr_b16 v[84:85], v39 offset:12288
    v_mfma_f32_16x16x32_bf16 v[52:55], v[76:79], v[64:67], v[52:55]
    ds_read_b64_tr_b16 v[86:87], v39 offset:12800
    ds_read_b64_tr_b16 v[88:89], v41 offset:12288
    ds_read_b64_tr_b16 v[90:91], v41 offset:12800
    v_mfma_f32_16x16x32_bf16 v[48:51], v[80:83], v[60:63], v[48:51]
    v_mfma_f32_16x16x32_bf16 v[56:59], v[80:83], v[64:67], v[56:59]
    s_waitcnt lgkmcnt(0)
    v_mfma_f32_16x16x32_bf16 v[44:47], v[84:87], v[68:71], v[44:47]
    v_mfma_f32_16x16x32_bf16 v[52:55], v[84:87], v[72:75], v[52:55]
    v_mfma_f32_16x16x32_bf16 v[48:51], v[88:91], v[68:71], v[48:51]
    v_mfma_f32_16x16x32_bf16 v[56:59], v[88:91], v[72:75], v[56:59]
    s_nop 7
    s_nop 7
    s_mov_b32 s54, 1027024659
    s_mov_b32 s55, 3222493025
    s_mov_b32 s16, s80
    s_mov_b32 s17, s81
    s_mov_b32 s18, 1835008
    s_mov_b32 s19, 0x00020000
    s_lshl_b32 s37, s87, 6
    s_lshr_b32 s38, s86, 1
    s_mul_i32 s38, s38, 32
    s_add_u32 s37, s37, s38
    v_add_u32 v60, s37, v2
    s_mov_b32 s38, 896
    v_mul_lo_u32 v68, v60, s38
    v_and_b32 v60, 1, v3
    v_lshl_add_u32 v68, v60, 5, v68
    v_lshrrev_b32 v60, 1, v3
    v_lshl_add_u32 v68, v60, 4, v68
    v_lshlrev_b32 v60, 16, v22
    v_add_f32 v44, v44, v60
    v_lshlrev_b32 v60, 16, v14
    v_add_f32 v44, v44, v60
    v_and_b32 v60, 0xffff0000, v22
    v_add_f32 v45, v45, v60
    v_and_b32 v60, 0xffff0000, v14
    v_add_f32 v45, v45, v60
    v_lshlrev_b32 v60, 16, v23
    v_add_f32 v46, v46, v60
    v_lshlrev_b32 v60, 16, v15
    v_add_f32 v46, v46, v60
    v_and_b32 v60, 0xffff0000, v23
    v_add_f32 v47, v47, v60
    v_and_b32 v60, 0xffff0000, v15
    v_add_f32 v47, v47, v60
    v_lshlrev_b32 v60, 16, v24
    v_add_f32 v48, v48, v60
    v_lshlrev_b32 v60, 16, v16
    v_add_f32 v48, v48, v60
    v_and_b32 v60, 0xffff0000, v24
    v_add_f32 v49, v49, v60
    v_and_b32 v60, 0xffff0000, v16
    v_add_f32 v49, v49, v60
    v_lshlrev_b32 v60, 16, v25
    v_add_f32 v50, v50, v60
    v_lshlrev_b32 v60, 16, v17
    v_add_f32 v50, v50, v60
    v_and_b32 v60, 0xffff0000, v25
    v_add_f32 v51, v51, v60
    v_and_b32 v60, 0xffff0000, v17
    v_add_f32 v51, v51, v60
    v_cvt_pk_bf16_f32 v72, v44, v45
    v_cvt_pk_bf16_f32 v73, v46, v47
    v_cvt_pk_bf16_f32 v74, v48, v49
    v_cvt_pk_bf16_f32 v75, v50, v51
    s_nop 1
    v_permlane16_swap_b32 v72, v74
    v_permlane16_swap_b32 v73, v75
    s_and_b32 s37, s86, 1
    s_lshl_b32 s37, s37, 6
    s_mul_i32 s38, s88, 112
    s_add_u32 s37, s37, s38
    s_add_u32 s37, s37, 0
    s_and_b32 s38, s86, 1
    s_cmp_eq_u32 s38, 1
    s_cselect_b32 exec_hi, 0xffff, -1
    s_cmp_eq_u32 s91, 1
    s_cbranch_scc1 Ls69_p
    buffer_store_dwordx4 v[72:75], v68, s[16:19], s37 offen sc1
    s_branch Ls69_d
Ls69_p:
    buffer_store_dwordx4 v[72:75], v68, s[16:19], s37 offen
Ls69_d:
    s_mov_b64 exec, -1
    s_nop 1
    v_lshlrev_b32 v60, 16, v26
    v_add_f32 v52, v52, v60
    v_lshlrev_b32 v60, 16, v18
    v_add_f32 v52, v52, v60
    v_and_b32 v60, 0xffff0000, v26
    v_add_f32 v53, v53, v60
    v_and_b32 v60, 0xffff0000, v18
    v_add_f32 v53, v53, v60
    v_lshlrev_b32 v60, 16, v27
    v_add_f32 v54, v54, v60
    v_lshlrev_b32 v60, 16, v19
    v_add_f32 v54, v54, v60
    v_and_b32 v60, 0xffff0000, v27
    v_add_f32 v55, v55, v60
    v_and_b32 v60, 0xffff0000, v19
    v_add_f32 v55, v55, v60
    v_lshlrev_b32 v60, 16, v28
    v_add_f32 v56, v56, v60
    v_lshlrev_b32 v60, 16, v20
    v_add_f32 v56, v56, v60
    v_and_b32 v60, 0xffff0000, v28
    v_add_f32 v57, v57, v60
    v_and_b32 v60, 0xffff0000, v20
    v_add_f32 v57, v57, v60
    v_lshlrev_b32 v60, 16, v29
    v_add_f32 v58, v58, v60
    v_lshlrev_b32 v60, 16, v21
    v_add_f32 v58, v58, v60
    v_and_b32 v60, 0xffff0000, v29
    v_add_f32 v59, v59, v60
    v_and_b32 v60, 0xffff0000, v21
    v_add_f32 v59, v59, v60
    v_cvt_pk_bf16_f32 v72, v52, v53
    v_cvt_pk_bf16_f32 v73, v54, v55
    v_cvt_pk_bf16_f32 v74, v56, v57
    v_cvt_pk_bf16_f32 v75, v58, v59
    s_nop 1
    v_permlane16_swap_b32 v72, v74
    v_permlane16_swap_b32 v73, v75
    s_and_b32 s37, s86, 1
    s_lshl_b32 s37, s37, 6
    s_mul_i32 s38, s88, 112
    s_add_u32 s37, s37, s38
    s_add_u32 s37, s37, 14336
    s_and_b32 s38, s86, 1
    s_cmp_eq_u32 s38, 1
    s_cselect_b32 exec_hi, 0xffff, -1
    s_cmp_eq_u32 s91, 1
    s_cbranch_scc1 Ls70_p
    buffer_store_dwordx4 v[72:75], v68, s[16:19], s37 offen sc1
    s_branch Ls70_d
Ls70_p:
    buffer_store_dwordx4 v[72:75], v68, s[16:19], s37 offen
Ls70_d:
    s_mov_b64 exec, -1
    s_nop 1
    s_and_b32 s37, s86, 1
    s_cmp_eq_u32 s37, 1
    s_cselect_b32 s61, 0, -1
    s_mov_b32 s60, -1
    s_add_u32 s20, s84, 44826624
    s_addc_u32 s21, s85, 0
    s_mov_b32 s22, 262144
    s_mov_b32 s23, 0x00020000
    v_mov_b32 v72, 0
    s_lshl_b32 s37, s87, 6
    s_lshr_b32 s38, s86, 1
    s_mul_i32 s38, s38, 32
    s_add_u32 s37, s37, s38
    v_add_u32 v69, s37, v2
    v_lshlrev_b32 v69, 7, v69
    s_lshl_b32 s37, s88, 1
    s_and_b32 s38, s86, 1
    s_add_u32 s37, s37, s38
    s_lshl_b32 s37, s37, 3
    v_add_u32 v69, s37, v69
    v_mov_b32 v70, v44
    v_mul_f32 v71, v44, v44
    v_add_f32 v70, v70, v45
    v_fma_f32 v71, v45, v45, v71
    v_add_f32 v70, v70, v46
    v_fma_f32 v71, v46, v46, v71
    v_add_f32 v70, v70, v47
    v_fma_f32 v71, v47, v47, v71
    v_cndmask_b32 v60, v72, v48, s[60:61]
    v_add_f32 v70, v70, v60
    v_fma_f32 v71, v60, v60, v71
    v_cndmask_b32 v60, v72, v49, s[60:61]
    v_add_f32 v70, v70, v60
    v_fma_f32 v71, v60, v60, v71
    v_cndmask_b32 v60, v72, v50, s[60:61]
    v_add_f32 v70, v70, v60
    v_fma_f32 v71, v60, v60, v71
    v_cndmask_b32 v60, v72, v51, s[60:61]
    v_add_f32 v70, v70, v60
    v_fma_f32 v71, v60, v60, v71
    v_mov_b32 v60, v70
    s_nop 1
    v_permlane16_swap_b32 v70, v60
    v_add_f32 v70, v70, v60
    v_mov_b32 v60, v70
    s_nop 1
    v_permlane32_swap_b32 v70, v60
    v_add_f32 v70, v70, v60
    v_mov_b32 v60, v71
    s_nop 1
    v_permlane16_swap_b32 v71, v60
    v_add_f32 v71, v71, v60
    v_mov_b32 v60, v71
    s_nop 1
    v_permlane32_swap_b32 v71, v60
    v_add_f32 v71, v71, v60
    s_mov_b32 exec_lo, 0xffff
    s_mov_b32 exec_hi, 0
    s_cmp_eq_u32 s91, 1
    s_cbranch_scc1 Ls71_p
    buffer_store_dwordx2 v[70:71], v69, s[20:23], 0 offen offset:0 sc1
    s_branch Ls71_d
Ls71_p:
    buffer_store_dwordx2 v[70:71], v69, s[20:23], 0 offen offset:0
Ls71_d:
    s_mov_b64 exec, -1
    s_nop 1
    v_mov_b32 v70, v52
    v_mul_f32 v71, v52, v52
    v_add_f32 v70, v70, v53
    v_fma_f32 v71, v53, v53, v71
    v_add_f32 v70, v70, v54
    v_fma_f32 v71, v54, v54, v71
    v_add_f32 v70, v70, v55
    v_fma_f32 v71, v55, v55, v71
    v_cndmask_b32 v60, v72, v56, s[60:61]
    v_add_f32 v70, v70, v60
    v_fma_f32 v71, v60, v60, v71
    v_cndmask_b32 v60, v72, v57, s[60:61]
    v_add_f32 v70, v70, v60
    v_fma_f32 v71, v60, v60, v71
    v_cndmask_b32 v60, v72, v58, s[60:61]
    v_add_f32 v70, v70, v60
    v_fma_f32 v71, v60, v60, v71
    v_cndmask_b32 v60, v72, v59, s[60:61]
    v_add_f32 v70, v70, v60
    v_fma_f32 v71, v60, v60, v71
    v_mov_b32 v60, v70
    s_nop 1
    v_permlane16_swap_b32 v70, v60
    v_add_f32 v70, v70, v60
    v_mov_b32 v60, v70
    s_nop 1
    v_permlane32_swap_b32 v70, v60
    v_add_f32 v70, v70, v60
    v_mov_b32 v60, v71
    s_nop 1
    v_permlane16_swap_b32 v71, v60
    v_add_f32 v71, v71, v60
    v_mov_b32 v60, v71
    s_nop 1
    v_permlane32_swap_b32 v71, v60
    v_add_f32 v71, v71, v60
    s_mov_b32 exec_lo, 0xffff
    s_mov_b32 exec_hi, 0
    s_cmp_eq_u32 s91, 1
    s_cbranch_scc1 Ls72_p
    buffer_store_dwordx2 v[70:71], v69, s[20:23], 0 offen offset:2048 sc1
    s_branch Ls72_d
Ls72_p:
    buffer_store_dwordx2 v[70:71], v69, s[20:23], 0 offen offset:2048
Ls72_d:
    s_mov_b64 exec, -1
    s_nop 1
    s_waitcnt vmcnt(0)
    s_lshl_b32 s32, s89, 7
    s_lshl_b32 s33, s86, 2
    s_add_u32 s32, s32, s33
    v_mov_b32 v73, s32
    v_mov_b32 v74, 13
    s_mov_b64 exec, 1
    s_mov_b32 s57, s91
    s_cmp_eq_u32 s57, 1
    s_cbranch_scc1 Ls73_p
    buffer_store_dword v74, v73, s[24:27], 0 offen sc1
    s_branch Ls73_d
Ls73_p:
    buffer_store_dword v74, v73, s[24:27], 0 offen
Ls73_d:
    s_mov_b64 exec, -1
L_exit:
    s_endpgm
.section .rodata,"a"
.p2align 6
.amdhsa_kernel interleave_layers__sliding_local_dilated__mixer_s_mlp__prompt_kernel
  .amdhsa_next_free_vgpr 248
  .amdhsa_next_free_sgpr 100
  .amdhsa_accum_offset 248
  .amdhsa_group_segment_fixed_size 0
  .amdhsa_kernarg_size 88
  .amdhsa_user_sgpr_count 2
  .amdhsa_user_sgpr_kernarg_segment_ptr 1
  .amdhsa_system_sgpr_workgroup_id_x 1
.end_amdhsa_kernel
```
